```python
import torch

def _softmax(x, axis=-1):
    return torch.softmax(x, dim=axis)
def _gelu(x):
    return torch.nn.functional.gelu(x, approximate="tanh")
def _silu(x):
    return torch.nn.functional.silu(x)
def _sigmoid(x):
    return torch.sigmoid(x)
def _layernorm(x, axis=-1, eps=1e-5):
    m = x.mean(dim=axis, keepdim=True)
    v = x.var(dim=axis, keepdim=True, unbiased=False)
    return (x - m) / torch.sqrt(v + eps)
def _scatter_add(tgt, idx, src, axis=0):
    return tgt.clone().index_add_(axis, idx, src)
def _segment_sum(src, seg, n):
    out = torch.zeros((n,) + src.shape[1:], dtype=src.dtype)
    return out.index_add_(0, seg, src)
def _pad(x, pw):
    flat = tuple(v for pair in reversed(pw) for v in pair)
    return torch.nn.functional.pad(x, flat)

kernel_name = 'interleave_layers__ssm_conv_s4d__glu_gated_swiglu__prompt'

def setup_inputs():

    _w = (lambda a: (lambda t: t.to(torch.bfloat16) if t.is_floating_point() else t)(torch.as_tensor(a)))
    def _A_setup():
        Bsz, L, D, N = 1, 2048, 512, 128
        return {
            "u": _w((lambda *s: torch.randn(*s, dtype=torch.bfloat16) * 0.05)(Bsz, L, D)),
            "log_A_real": _w((lambda *s: torch.randn(*s, dtype=torch.bfloat16) * 3.2)(D, N) * 0.5),
            "A_imag": _w((lambda *s: torch.randn(*s, dtype=torch.bfloat16) * 0.05)(D, N) * 3.14),
            "C_real": _w((lambda *s: torch.randn(*s, dtype=torch.bfloat16) * 0.05)(D, N) / N ** 0.5),
            "C_imag": _w((lambda *s: torch.randn(*s, dtype=torch.bfloat16) * 0.05)(D, N) / N ** 0.5),
            "log_dt": _w((lambda *s: torch.randn(*s, dtype=torch.bfloat16) * 0.05)(D) * 0.5 - 4.0),
            "D_skip": _w((lambda *s: torch.randn(*s, dtype=torch.bfloat16) * 0.05)(D)),
        }
    _A_in = _A_setup()

    def _B_setup():
        B, S, D, F = 1, 2048, 512, 1376
        return {
            "x": _w((lambda *s: torch.randn(*s, dtype=torch.bfloat16) * 0.05)(B, S, D)),
            "w1": _w((lambda *s: torch.randn(*s, dtype=torch.bfloat16) * 0.4)(D, F) * (2.0 / D) ** 0.5),
            "w3": _w((lambda *s: torch.randn(*s, dtype=torch.bfloat16) * 0.4)(D, F) * (2.0 / D) ** 0.5),
            "w2": _w((lambda *s: torch.randn(*s, dtype=torch.bfloat16) * 0.4)(F, D) * (2.0 / F) ** 0.5),
        }
    _B_in = _B_setup()

    return {
        "A_u": _A_in["u"],
        "A_log_A_real": _A_in["log_A_real"],
        "A_A_imag": _A_in["A_imag"],
        "A_C_real": _A_in["C_real"],
        "A_C_imag": _A_in["C_imag"],
        "A_log_dt": _A_in["log_dt"],
        "A_D_skip": _A_in["D_skip"],
        "B_x": _B_in["x"],
        "B_w1": _B_in["w1"],
        "B_w3": _B_in["w3"],
        "B_w2": _B_in["w2"],
    }

def reference(A_u, A_log_A_real, A_A_imag, A_C_real, A_C_imag, A_log_dt, A_D_skip, B_x, B_w1, B_w3, B_w2):
    def _A_ref(u, log_A_real, A_imag, C_real, C_imag, log_dt, D_skip):
        L = u.shape[1]
        dt = torch.exp(log_dt)
        A = -torch.exp(log_A_real) + 1j * A_imag
        C = (C_real + 1j * C_imag) * dt[:, None]
        pos = (lambda x, dt: x.to(dt))(torch.arange(L), log_dt.dtype)
        P = torch.exp((A * dt[:, None])[:, :, None] * pos[None, None, :])
        K = 2.0 * torch.einsum("dn,dnl->dl", C, P).real
        L2 = 2 * L
        u_t = (lambda x, *d: x.permute(*d))(u, 0, 2, 1)
        Kf = (lambda x, *a, **k: torch.fft.rfft(x.float(), *a, **k))(K, L2)
        Uf = (lambda x, *a, **k: torch.fft.rfft(x.float(), *a, **k))(u_t, L2)
        y = (lambda x, *a, **k: torch.fft.irfft(x, *a, **k).to(torch.bfloat16))(Uf * Kf[None, :, :], L2)[:, :, :L]
        y = (lambda x, *d: x.permute(*d))(y, 0, 2, 1)
        return y + u * D_skip[None, None, :]

    def _B_ref(x, w1, w3, w2):
        gate = torch.einsum("bsd,df->bsf", x, w1)
        up = torch.einsum("bsd,df->bsf", x, w3)
        h = _silu(gate) * up
        out = torch.einsum("bsf,fd->bsd", h, w2)
        return out

    x = A_u
    x = x + _A_ref(_layernorm(x, axis=-1), A_log_A_real, A_A_imag, A_C_real, A_C_imag, A_log_dt, A_D_skip)
    x = x + _B_ref(_layernorm(x, axis=-1), B_w1, B_w3, B_w2)
    x = x + _A_ref(_layernorm(x, axis=-1), A_log_A_real, A_A_imag, A_C_real, A_C_imag, A_log_dt, A_D_skip)
    x = x + _B_ref(_layernorm(x, axis=-1), B_w1, B_w3, B_w2)
    return x
```

```asm
; @launch kernel=prep_kernel grid=(769,1,1) block=(256,1,1) lds=17408
; @launch kernel=conv1_kernel grid=(512,1,1) block=(256,1,1) lds=44544
; @launch kernel=t1_kernel grid=(256,1,1) block=(256,1,1) lds=9216
; @launch kernel=ffn1_kernel grid=(256,1,1) block=(256,1,1) lds=131072
; @launch kernel=conv2_kernel grid=(512,1,1) block=(256,1,1) lds=44544
; @launch kernel=t2_kernel grid=(256,1,1) block=(256,1,1) lds=9216
; @launch kernel=ffn2_kernel grid=(256,1,1) block=(256,1,1) lds=131072
.amdgcn_target "amdgcn-amd-amdhsa--gfx950"
.text
.globl prep_kernel
.p2align 8
.type prep_kernel,@function
prep_kernel:
    s_cmp_ge_u32 s2, 769
    s_cbranch_scc1 prep_done
    s_load_dwordx16 s[4:19], s[0:1], 0
    s_load_dwordx8 s[20:27], s[0:1], 64
    s_load_dwordx4 s[28:31], s[0:1], 96
    v_and_b32 v1, 63, v0
    s_cmp_ge_u32 s2, 726
    s_cbranch_scc1 prep_w2
    s_cmp_ge_u32 s2, 640
    s_cbranch_scc1 prep_w13
    s_cmp_ge_u32 s2, 512
    s_cbranch_scc1 prep_xt
    s_waitcnt lgkmcnt(0)
    s_mov_b32 s44, s6
    s_mov_b32 s45, s7
    s_mov_b32 s46, 0x20000
    s_mov_b32 s47, 0x20000
    s_mov_b32 s48, s8
    s_mov_b32 s49, s9
    s_mov_b32 s50, 0x20000
    s_mov_b32 s51, 0x20000
    s_mov_b32 s52, s10
    s_mov_b32 s53, s11
    s_mov_b32 s54, 0x20000
    s_mov_b32 s55, 0x20000
    s_mov_b32 s56, s12
    s_mov_b32 s57, s13
    s_mov_b32 s58, 0x20000
    s_mov_b32 s59, 0x20000
    v_and_b32 v2, 15, v0
    v_lshrrev_b32 v3, 4, v0
    v_lshlrev_b32 v3, 4, v3
    s_lshl_b32 s40, s2, 8
    buffer_load_dwordx4 v[8:11], v3, s[44:47], s40 offen
    buffer_load_dwordx4 v[12:15], v3, s[48:51], s40 offen
    buffer_load_dwordx4 v[16:19], v3, s[52:55], s40 offen
    buffer_load_dwordx4 v[20:23], v3, s[56:59], s40 offen
    s_lshr_b32 s42, s2, 1
    s_lshl_b32 s42, s42, 2
    s_load_dword s41, s[14:15], s42
    s_and_b32 s43, s2, 1
    s_lshl_b32 s43, s43, 4
    s_waitcnt lgkmcnt(0)
    s_lshr_b32 s41, s41, s43
    s_lshl_b32 s41, s41, 16
    v_mov_b32 v4, s41
    v_mul_f32 v4, 0x3fb8aa3b, v4
    v_exp_f32 v4, v4
    s_nop 0
    v_cvt_pk_bf16_f32 v4, v4, v4
    v_lshlrev_b32 v4, 16, v4
    v_and_b32 v24, 7, v2
    v_lshrrev_b32 v25, 3, v2
    v_lshl_add_u32 v26, v25, 7, v24
    v_cvt_f32_u32 v26, v26
    v_and_b32 v24, 3, v2
    v_lshlrev_b32 v24, 1, v24
    v_lshrrev_b32 v25, 2, v2
    v_lshl_add_u32 v24, v25, 7, v24
    v_add_u32 v24, 256, v24
    v_and_b32 v25, 1, v2
    v_lshlrev_b32 v25, 2, v25
    v_lshrrev_b32 v27, 1, v2
    v_lshl_add_u32 v25, v27, 7, v25
    v_cmp_gt_u32 vcc, 8, v2
    s_nop 1
    v_cndmask_b32 v27, v25, v24, vcc
    v_cvt_f32_u32 v27, v27
    v_lshlrev_b32 v24, 7, v2
    v_add_u32 v24, 1024, v24
    v_min_u32 v24, 2048, v24
    v_cvt_f32_u32 v28, v24
    v_lshlrev_b32 v24, 3, v2
    v_cvt_f32_u32 v29, v24
    v_mov_b32 v32, 0
    v_mov_b32 v33, 0
    v_mov_b32 v34, 0
    v_mov_b32 v35, 0
    v_mov_b32 v36, 0
    v_mov_b32 v37, 0
    v_mov_b32 v38, 0
    v_mov_b32 v39, 0
    v_mov_b32 v40, 0
    v_mov_b32 v41, 0
    v_mov_b32 v42, 0
    v_mov_b32 v43, 0
    s_waitcnt vmcnt(0)
    v_lshlrev_b32 v48, 16, v8
    v_lshlrev_b32 v49, 16, v12
    v_lshlrev_b32 v50, 16, v16
    v_lshlrev_b32 v51, 16, v20
    v_mul_f32 v48, 0x3fb8aa3b, v48
    v_exp_f32 v48, v48
    s_nop 0
    v_cvt_pk_bf16_f32 v48, v48, v48
    v_lshlrev_b32 v48, 16, v48
    v_mul_f32 v48, v48, v4
    v_mul_f32 v48, 0xbfb8aa3b, v48
    v_mul_f32 v49, v49, v4
    v_mul_f32 v49, 0x3e22f983, v49
    v_mul_f32 v50, v50, v4
    v_add_f32 v50, v50, v50
    v_mul_f32 v51, v51, v4
    v_add_f32 v51, v51, v51
    v_mul_f32 v52, v48, v29
    v_mul_f32 v53, v49, v29
    v_exp_f32 v52, v52
    v_fract_f32 v53, v53
    v_cos_f32 v54, v53
    v_sin_f32 v55, v53
    v_mul_f32 v56, v50, v54
    v_fma_f32 v56, -v51, v55, v56
    v_mul_f32 v57, v50, v55
    v_fma_f32 v57, v51, v54, v57
    v_mul_f32 v56, v52, v56
    v_mul_f32 v57, -v52, v57
    v_mul_f32 v60, v48, v26
    v_mul_f32 v61, v49, v26
    v_exp_f32 v60, v60
    v_fract_f32 v61, v61
    v_cos_f32 v62, v61
    v_sin_f32 v63, v61
    v_mul_f32 v62, v60, v62
    v_mul_f32 v63, v60, v63
    v_mul_f32 v64, v48, v27
    v_mul_f32 v65, v49, v27
    v_exp_f32 v64, v64
    v_fract_f32 v65, v65
    v_cos_f32 v66, v65
    v_sin_f32 v67, v65
    v_mul_f32 v66, v64, v66
    v_mul_f32 v67, v64, v67
    v_mul_f32 v68, v48, v28
    v_mul_f32 v69, v49, v28
    v_exp_f32 v68, v68
    v_fract_f32 v69, v69
    v_cos_f32 v70, v69
    v_sin_f32 v71, v69
    v_mul_f32 v70, v68, v70
    v_mul_f32 v71, v68, v71
    v_mfma_f32_16x16x4_f32 v[32:35], v62, v56, v[32:35]
    v_mfma_f32_16x16x4_f32 v[36:39], v66, v56, v[36:39]
    v_mfma_f32_16x16x4_f32 v[40:43], v70, v56, v[40:43]
    v_mfma_f32_16x16x4_f32 v[32:35], v63, v57, v[32:35]
    v_mfma_f32_16x16x4_f32 v[36:39], v67, v57, v[36:39]
    v_mfma_f32_16x16x4_f32 v[40:43], v71, v57, v[40:43]
    v_and_b32 v48, 0xffff0000, v8
    v_and_b32 v49, 0xffff0000, v12
    v_and_b32 v50, 0xffff0000, v16
    v_and_b32 v51, 0xffff0000, v20
    v_mul_f32 v48, 0x3fb8aa3b, v48
    v_exp_f32 v48, v48
    s_nop 0
    v_cvt_pk_bf16_f32 v48, v48, v48
    v_lshlrev_b32 v48, 16, v48
    v_mul_f32 v48, v48, v4
    v_mul_f32 v48, 0xbfb8aa3b, v48
    v_mul_f32 v49, v49, v4
    v_mul_f32 v49, 0x3e22f983, v49
    v_mul_f32 v50, v50, v4
    v_add_f32 v50, v50, v50
    v_mul_f32 v51, v51, v4
    v_add_f32 v51, v51, v51
    v_mul_f32 v52, v48, v29
    v_mul_f32 v53, v49, v29
    v_exp_f32 v52, v52
    v_fract_f32 v53, v53
    v_cos_f32 v54, v53
    v_sin_f32 v55, v53
    v_mul_f32 v56, v50, v54
    v_fma_f32 v56, -v51, v55, v56
    v_mul_f32 v57, v50, v55
    v_fma_f32 v57, v51, v54, v57
    v_mul_f32 v56, v52, v56
    v_mul_f32 v57, -v52, v57
    v_mul_f32 v60, v48, v26
    v_mul_f32 v61, v49, v26
    v_exp_f32 v60, v60
    v_fract_f32 v61, v61
    v_cos_f32 v62, v61
    v_sin_f32 v63, v61
    v_mul_f32 v62, v60, v62
    v_mul_f32 v63, v60, v63
    v_mul_f32 v64, v48, v27
    v_mul_f32 v65, v49, v27
    v_exp_f32 v64, v64
    v_fract_f32 v65, v65
    v_cos_f32 v66, v65
    v_sin_f32 v67, v65
    v_mul_f32 v66, v64, v66
    v_mul_f32 v67, v64, v67
    v_mul_f32 v68, v48, v28
    v_mul_f32 v69, v49, v28
    v_exp_f32 v68, v68
    v_fract_f32 v69, v69
    v_cos_f32 v70, v69
    v_sin_f32 v71, v69
    v_mul_f32 v70, v68, v70
    v_mul_f32 v71, v68, v71
    v_mfma_f32_16x16x4_f32 v[32:35], v62, v56, v[32:35]
    v_mfma_f32_16x16x4_f32 v[36:39], v66, v56, v[36:39]
    v_mfma_f32_16x16x4_f32 v[40:43], v70, v56, v[40:43]
    v_mfma_f32_16x16x4_f32 v[32:35], v63, v57, v[32:35]
    v_mfma_f32_16x16x4_f32 v[36:39], v67, v57, v[36:39]
    v_mfma_f32_16x16x4_f32 v[40:43], v71, v57, v[40:43]
    v_lshlrev_b32 v48, 16, v9
    v_lshlrev_b32 v49, 16, v13
    v_lshlrev_b32 v50, 16, v17
    v_lshlrev_b32 v51, 16, v21
    v_mul_f32 v48, 0x3fb8aa3b, v48
    v_exp_f32 v48, v48
    s_nop 0
    v_cvt_pk_bf16_f32 v48, v48, v48
    v_lshlrev_b32 v48, 16, v48
    v_mul_f32 v48, v48, v4
    v_mul_f32 v48, 0xbfb8aa3b, v48
    v_mul_f32 v49, v49, v4
    v_mul_f32 v49, 0x3e22f983, v49
    v_mul_f32 v50, v50, v4
    v_add_f32 v50, v50, v50
    v_mul_f32 v51, v51, v4
    v_add_f32 v51, v51, v51
    v_mul_f32 v52, v48, v29
    v_mul_f32 v53, v49, v29
    v_exp_f32 v52, v52
    v_fract_f32 v53, v53
    v_cos_f32 v54, v53
    v_sin_f32 v55, v53
    v_mul_f32 v56, v50, v54
    v_fma_f32 v56, -v51, v55, v56
    v_mul_f32 v57, v50, v55
    v_fma_f32 v57, v51, v54, v57
    v_mul_f32 v56, v52, v56
    v_mul_f32 v57, -v52, v57
    v_mul_f32 v60, v48, v26
    v_mul_f32 v61, v49, v26
    v_exp_f32 v60, v60
    v_fract_f32 v61, v61
    v_cos_f32 v62, v61
    v_sin_f32 v63, v61
    v_mul_f32 v62, v60, v62
    v_mul_f32 v63, v60, v63
    v_mul_f32 v64, v48, v27
    v_mul_f32 v65, v49, v27
    v_exp_f32 v64, v64
    v_fract_f32 v65, v65
    v_cos_f32 v66, v65
    v_sin_f32 v67, v65
    v_mul_f32 v66, v64, v66
    v_mul_f32 v67, v64, v67
    v_mul_f32 v68, v48, v28
    v_mul_f32 v69, v49, v28
    v_exp_f32 v68, v68
    v_fract_f32 v69, v69
    v_cos_f32 v70, v69
    v_sin_f32 v71, v69
    v_mul_f32 v70, v68, v70
    v_mul_f32 v71, v68, v71
    v_mfma_f32_16x16x4_f32 v[32:35], v62, v56, v[32:35]
    v_mfma_f32_16x16x4_f32 v[36:39], v66, v56, v[36:39]
    v_mfma_f32_16x16x4_f32 v[40:43], v70, v56, v[40:43]
    v_mfma_f32_16x16x4_f32 v[32:35], v63, v57, v[32:35]
    v_mfma_f32_16x16x4_f32 v[36:39], v67, v57, v[36:39]
    v_mfma_f32_16x16x4_f32 v[40:43], v71, v57, v[40:43]
    v_and_b32 v48, 0xffff0000, v9
    v_and_b32 v49, 0xffff0000, v13
    v_and_b32 v50, 0xffff0000, v17
    v_and_b32 v51, 0xffff0000, v21
    v_mul_f32 v48, 0x3fb8aa3b, v48
    v_exp_f32 v48, v48
    s_nop 0
    v_cvt_pk_bf16_f32 v48, v48, v48
    v_lshlrev_b32 v48, 16, v48
    v_mul_f32 v48, v48, v4
    v_mul_f32 v48, 0xbfb8aa3b, v48
    v_mul_f32 v49, v49, v4
    v_mul_f32 v49, 0x3e22f983, v49
    v_mul_f32 v50, v50, v4
    v_add_f32 v50, v50, v50
    v_mul_f32 v51, v51, v4
    v_add_f32 v51, v51, v51
    v_mul_f32 v52, v48, v29
    v_mul_f32 v53, v49, v29
    v_exp_f32 v52, v52
    v_fract_f32 v53, v53
    v_cos_f32 v54, v53
    v_sin_f32 v55, v53
    v_mul_f32 v56, v50, v54
    v_fma_f32 v56, -v51, v55, v56
    v_mul_f32 v57, v50, v55
    v_fma_f32 v57, v51, v54, v57
    v_mul_f32 v56, v52, v56
    v_mul_f32 v57, -v52, v57
    v_mul_f32 v60, v48, v26
    v_mul_f32 v61, v49, v26
    v_exp_f32 v60, v60
    v_fract_f32 v61, v61
    v_cos_f32 v62, v61
    v_sin_f32 v63, v61
    v_mul_f32 v62, v60, v62
    v_mul_f32 v63, v60, v63
    v_mul_f32 v64, v48, v27
    v_mul_f32 v65, v49, v27
    v_exp_f32 v64, v64
    v_fract_f32 v65, v65
    v_cos_f32 v66, v65
    v_sin_f32 v67, v65
    v_mul_f32 v66, v64, v66
    v_mul_f32 v67, v64, v67
    v_mul_f32 v68, v48, v28
    v_mul_f32 v69, v49, v28
    v_exp_f32 v68, v68
    v_fract_f32 v69, v69
    v_cos_f32 v70, v69
    v_sin_f32 v71, v69
    v_mul_f32 v70, v68, v70
    v_mul_f32 v71, v68, v71
    v_mfma_f32_16x16x4_f32 v[32:35], v62, v56, v[32:35]
    v_mfma_f32_16x16x4_f32 v[36:39], v66, v56, v[36:39]
    v_mfma_f32_16x16x4_f32 v[40:43], v70, v56, v[40:43]
    v_mfma_f32_16x16x4_f32 v[32:35], v63, v57, v[32:35]
    v_mfma_f32_16x16x4_f32 v[36:39], v67, v57, v[36:39]
    v_mfma_f32_16x16x4_f32 v[40:43], v71, v57, v[40:43]
    v_lshlrev_b32 v48, 16, v10
    v_lshlrev_b32 v49, 16, v14
    v_lshlrev_b32 v50, 16, v18
    v_lshlrev_b32 v51, 16, v22
    v_mul_f32 v48, 0x3fb8aa3b, v48
    v_exp_f32 v48, v48
    s_nop 0
    v_cvt_pk_bf16_f32 v48, v48, v48
    v_lshlrev_b32 v48, 16, v48
    v_mul_f32 v48, v48, v4
    v_mul_f32 v48, 0xbfb8aa3b, v48
    v_mul_f32 v49, v49, v4
    v_mul_f32 v49, 0x3e22f983, v49
    v_mul_f32 v50, v50, v4
    v_add_f32 v50, v50, v50
    v_mul_f32 v51, v51, v4
    v_add_f32 v51, v51, v51
    v_mul_f32 v52, v48, v29
    v_mul_f32 v53, v49, v29
    v_exp_f32 v52, v52
    v_fract_f32 v53, v53
    v_cos_f32 v54, v53
    v_sin_f32 v55, v53
    v_mul_f32 v56, v50, v54
    v_fma_f32 v56, -v51, v55, v56
    v_mul_f32 v57, v50, v55
    v_fma_f32 v57, v51, v54, v57
    v_mul_f32 v56, v52, v56
    v_mul_f32 v57, -v52, v57
    v_mul_f32 v60, v48, v26
    v_mul_f32 v61, v49, v26
    v_exp_f32 v60, v60
    v_fract_f32 v61, v61
    v_cos_f32 v62, v61
    v_sin_f32 v63, v61
    v_mul_f32 v62, v60, v62
    v_mul_f32 v63, v60, v63
    v_mul_f32 v64, v48, v27
    v_mul_f32 v65, v49, v27
    v_exp_f32 v64, v64
    v_fract_f32 v65, v65
    v_cos_f32 v66, v65
    v_sin_f32 v67, v65
    v_mul_f32 v66, v64, v66
    v_mul_f32 v67, v64, v67
    v_mul_f32 v68, v48, v28
    v_mul_f32 v69, v49, v28
    v_exp_f32 v68, v68
    v_fract_f32 v69, v69
    v_cos_f32 v70, v69
    v_sin_f32 v71, v69
    v_mul_f32 v70, v68, v70
    v_mul_f32 v71, v68, v71
    v_mfma_f32_16x16x4_f32 v[32:35], v62, v56, v[32:35]
    v_mfma_f32_16x16x4_f32 v[36:39], v66, v56, v[36:39]
    v_mfma_f32_16x16x4_f32 v[40:43], v70, v56, v[40:43]
    v_mfma_f32_16x16x4_f32 v[32:35], v63, v57, v[32:35]
    v_mfma_f32_16x16x4_f32 v[36:39], v67, v57, v[36:39]
    v_mfma_f32_16x16x4_f32 v[40:43], v71, v57, v[40:43]
    v_and_b32 v48, 0xffff0000, v10
    v_and_b32 v49, 0xffff0000, v14
    v_and_b32 v50, 0xffff0000, v18
    v_and_b32 v51, 0xffff0000, v22
    v_mul_f32 v48, 0x3fb8aa3b, v48
    v_exp_f32 v48, v48
    s_nop 0
    v_cvt_pk_bf16_f32 v48, v48, v48
    v_lshlrev_b32 v48, 16, v48
    v_mul_f32 v48, v48, v4
    v_mul_f32 v48, 0xbfb8aa3b, v48
    v_mul_f32 v49, v49, v4
    v_mul_f32 v49, 0x3e22f983, v49
    v_mul_f32 v50, v50, v4
    v_add_f32 v50, v50, v50
    v_mul_f32 v51, v51, v4
    v_add_f32 v51, v51, v51
    v_mul_f32 v52, v48, v29
    v_mul_f32 v53, v49, v29
    v_exp_f32 v52, v52
    v_fract_f32 v53, v53
    v_cos_f32 v54, v53
    v_sin_f32 v55, v53
    v_mul_f32 v56, v50, v54
    v_fma_f32 v56, -v51, v55, v56
    v_mul_f32 v57, v50, v55
    v_fma_f32 v57, v51, v54, v57
    v_mul_f32 v56, v52, v56
    v_mul_f32 v57, -v52, v57
    v_mul_f32 v60, v48, v26
    v_mul_f32 v61, v49, v26
    v_exp_f32 v60, v60
    v_fract_f32 v61, v61
    v_cos_f32 v62, v61
    v_sin_f32 v63, v61
    v_mul_f32 v62, v60, v62
    v_mul_f32 v63, v60, v63
    v_mul_f32 v64, v48, v27
    v_mul_f32 v65, v49, v27
    v_exp_f32 v64, v64
    v_fract_f32 v65, v65
    v_cos_f32 v66, v65
    v_sin_f32 v67, v65
    v_mul_f32 v66, v64, v66
    v_mul_f32 v67, v64, v67
    v_mul_f32 v68, v48, v28
    v_mul_f32 v69, v49, v28
    v_exp_f32 v68, v68
    v_fract_f32 v69, v69
    v_cos_f32 v70, v69
    v_sin_f32 v71, v69
    v_mul_f32 v70, v68, v70
    v_mul_f32 v71, v68, v71
    v_mfma_f32_16x16x4_f32 v[32:35], v62, v56, v[32:35]
    v_mfma_f32_16x16x4_f32 v[36:39], v66, v56, v[36:39]
    v_mfma_f32_16x16x4_f32 v[40:43], v70, v56, v[40:43]
    v_mfma_f32_16x16x4_f32 v[32:35], v63, v57, v[32:35]
    v_mfma_f32_16x16x4_f32 v[36:39], v67, v57, v[36:39]
    v_mfma_f32_16x16x4_f32 v[40:43], v71, v57, v[40:43]
    v_lshlrev_b32 v48, 16, v11
    v_lshlrev_b32 v49, 16, v15
    v_lshlrev_b32 v50, 16, v19
    v_lshlrev_b32 v51, 16, v23
    v_mul_f32 v48, 0x3fb8aa3b, v48
    v_exp_f32 v48, v48
    s_nop 0
    v_cvt_pk_bf16_f32 v48, v48, v48
    v_lshlrev_b32 v48, 16, v48
    v_mul_f32 v48, v48, v4
    v_mul_f32 v48, 0xbfb8aa3b, v48
    v_mul_f32 v49, v49, v4
    v_mul_f32 v49, 0x3e22f983, v49
    v_mul_f32 v50, v50, v4
    v_add_f32 v50, v50, v50
    v_mul_f32 v51, v51, v4
    v_add_f32 v51, v51, v51
    v_mul_f32 v52, v48, v29
    v_mul_f32 v53, v49, v29
    v_exp_f32 v52, v52
    v_fract_f32 v53, v53
    v_cos_f32 v54, v53
    v_sin_f32 v55, v53
    v_mul_f32 v56, v50, v54
    v_fma_f32 v56, -v51, v55, v56
    v_mul_f32 v57, v50, v55
    v_fma_f32 v57, v51, v54, v57
    v_mul_f32 v56, v52, v56
    v_mul_f32 v57, -v52, v57
    v_mul_f32 v60, v48, v26
    v_mul_f32 v61, v49, v26
    v_exp_f32 v60, v60
    v_fract_f32 v61, v61
    v_cos_f32 v62, v61
    v_sin_f32 v63, v61
    v_mul_f32 v62, v60, v62
    v_mul_f32 v63, v60, v63
    v_mul_f32 v64, v48, v27
    v_mul_f32 v65, v49, v27
    v_exp_f32 v64, v64
    v_fract_f32 v65, v65
    v_cos_f32 v66, v65
    v_sin_f32 v67, v65
    v_mul_f32 v66, v64, v66
    v_mul_f32 v67, v64, v67
    v_mul_f32 v68, v48, v28
    v_mul_f32 v69, v49, v28
    v_exp_f32 v68, v68
    v_fract_f32 v69, v69
    v_cos_f32 v70, v69
    v_sin_f32 v71, v69
    v_mul_f32 v70, v68, v70
    v_mul_f32 v71, v68, v71
    v_mfma_f32_16x16x4_f32 v[32:35], v62, v56, v[32:35]
    v_mfma_f32_16x16x4_f32 v[36:39], v66, v56, v[36:39]
    v_mfma_f32_16x16x4_f32 v[40:43], v70, v56, v[40:43]
    v_mfma_f32_16x16x4_f32 v[32:35], v63, v57, v[32:35]
    v_mfma_f32_16x16x4_f32 v[36:39], v67, v57, v[36:39]
    v_mfma_f32_16x16x4_f32 v[40:43], v71, v57, v[40:43]
    v_and_b32 v48, 0xffff0000, v11
    v_and_b32 v49, 0xffff0000, v15
    v_and_b32 v50, 0xffff0000, v19
    v_and_b32 v51, 0xffff0000, v23
    v_mul_f32 v48, 0x3fb8aa3b, v48
    v_exp_f32 v48, v48
    s_nop 0
    v_cvt_pk_bf16_f32 v48, v48, v48
    v_lshlrev_b32 v48, 16, v48
    v_mul_f32 v48, v48, v4
    v_mul_f32 v48, 0xbfb8aa3b, v48
    v_mul_f32 v49, v49, v4
    v_mul_f32 v49, 0x3e22f983, v49
    v_mul_f32 v50, v50, v4
    v_add_f32 v50, v50, v50
    v_mul_f32 v51, v51, v4
    v_add_f32 v51, v51, v51
    v_mul_f32 v52, v48, v29
    v_mul_f32 v53, v49, v29
    v_exp_f32 v52, v52
    v_fract_f32 v53, v53
    v_cos_f32 v54, v53
    v_sin_f32 v55, v53
    v_mul_f32 v56, v50, v54
    v_fma_f32 v56, -v51, v55, v56
    v_mul_f32 v57, v50, v55
    v_fma_f32 v57, v51, v54, v57
    v_mul_f32 v56, v52, v56
    v_mul_f32 v57, -v52, v57
    v_mul_f32 v60, v48, v26
    v_mul_f32 v61, v49, v26
    v_exp_f32 v60, v60
    v_fract_f32 v61, v61
    v_cos_f32 v62, v61
    v_sin_f32 v63, v61
    v_mul_f32 v62, v60, v62
    v_mul_f32 v63, v60, v63
    v_mul_f32 v64, v48, v27
    v_mul_f32 v65, v49, v27
    v_exp_f32 v64, v64
    v_fract_f32 v65, v65
    v_cos_f32 v66, v65
    v_sin_f32 v67, v65
    v_mul_f32 v66, v64, v66
    v_mul_f32 v67, v64, v67
    v_mul_f32 v68, v48, v28
    v_mul_f32 v69, v49, v28
    v_exp_f32 v68, v68
    v_fract_f32 v69, v69
    v_cos_f32 v70, v69
    v_sin_f32 v71, v69
    v_mul_f32 v70, v68, v70
    v_mul_f32 v71, v68, v71
    v_mfma_f32_16x16x4_f32 v[32:35], v62, v56, v[32:35]
    v_mfma_f32_16x16x4_f32 v[36:39], v66, v56, v[36:39]
    v_mfma_f32_16x16x4_f32 v[40:43], v70, v56, v[40:43]
    v_mfma_f32_16x16x4_f32 v[32:35], v63, v57, v[32:35]
    v_mfma_f32_16x16x4_f32 v[36:39], v67, v57, v[36:39]
    v_mfma_f32_16x16x4_f32 v[40:43], v71, v57, v[40:43]
    v_lshrrev_b32 v5, 6, v0
    v_mul_u32_u24 v6, 3072, v5
    v_lshl_add_u32 v6, v1, 4, v6
    s_nop 4
    ds_write_b128 v6, v[32:35] offset:0
    ds_write_b128 v6, v[36:39] offset:1024
    ds_write_b128 v6, v[40:43] offset:2048
    s_waitcnt lgkmcnt(0)
    s_barrier
    v_readfirstlane_b32 s40, v5
    s_nop 1
    s_cmp_eq_u32 s40, 3
    s_cbranch_scc1 kg_tab_done
    v_lshlrev_b32 v6, 4, v0
    ds_read_b128 v[32:35], v6
    ds_read_b128 v[36:39], v6 offset:3072
    ds_read_b128 v[40:43], v6 offset:6144
    ds_read_b128 v[44:47], v6 offset:9216
    v_lshrrev_b32 v7, 4, v1
    s_waitcnt lgkmcnt(0)
    v_add_f32 v32, v32, v36
    v_add_f32 v40, v40, v44
    v_add_f32 v32, v32, v40
    v_add_f32 v33, v33, v37
    v_add_f32 v41, v41, v45
    v_add_f32 v33, v33, v41
    v_add_f32 v34, v34, v38
    v_add_f32 v42, v42, v46
    v_add_f32 v34, v34, v42
    v_add_f32 v35, v35, v39
    v_add_f32 v43, v43, v47
    v_add_f32 v35, v35, v43
    s_cmp_eq_u32 s40, 1
    s_cbranch_scc1 kg_t1
    s_cmp_eq_u32 s40, 2
    s_cbranch_scc1 kg_t2
    v_and_b32 v24, 1, v7
    v_lshlrev_b32 v24, 2, v24
    v_lshrrev_b32 v25, 1, v7
    v_lshl_add_u32 v24, v25, 7, v24
    v_lshl_add_u32 v48, v2, 3, v24
    v_add_u32 v49, 1, v48
    v_add_u32 v50, 2, v48
    v_add_u32 v51, 3, v48
    s_branch kg_tw
kg_t1:
    v_lshlrev_b32 v24, 6, v7
    v_lshl_add_u32 v24, v2, 2, v24
    v_add_u32 v24, 256, v24
    v_lshlrev_b32 v25, 6, v7
    v_lshl_add_u32 v25, v2, 1, v25
    v_add_u32 v25, 256, v25
    v_cmp_gt_u32 vcc, 2, v7
    s_nop 1
    v_cndmask_b32 v48, v25, v24, vcc
    v_add_u32 v49, 1, v48
    v_add_u32 v24, 2, v24
    v_add_u32 v25, 32, v25
    v_cndmask_b32 v50, v25, v24, vcc
    v_add_u32 v51, 1, v50
    s_branch kg_tw
kg_t2:
    v_lshlrev_b32 v24, 6, v7
    v_add_u32 v24, v2, v24
    v_add_u32 v24, 512, v24
    v_mov_b32 v25, 700
    v_cmp_gt_u32 vcc, 2, v7
    s_nop 1
    v_cndmask_b32 v48, v25, v24, vcc
    v_add_u32 v49, 16, v24
    v_cndmask_b32 v49, v25, v49, vcc
    v_add_u32 v50, 32, v24
    v_cndmask_b32 v50, v25, v50, vcc
    v_add_u32 v51, 48, v24
    v_cndmask_b32 v51, v25, v51, vcc
    v_mov_b32 v24, 640
    v_cmp_eq_u32 vcc, 32, v1
    s_nop 1
    v_cndmask_b32 v48, v48, v24, vcc
kg_tw:
    v_lshlrev_b32 v48, 2, v48
    ds_write_b32 v48, v32 offset:12288
    v_lshlrev_b32 v49, 2, v49
    ds_write_b32 v49, v33 offset:12288
    v_lshlrev_b32 v50, 2, v50
    ds_write_b32 v50, v34 offset:12288
    v_lshlrev_b32 v51, 2, v51
    ds_write_b32 v51, v35 offset:12288
kg_tab_done:
    s_waitcnt lgkmcnt(0)
    s_barrier
    v_lshlrev_b32 v6, 2, v0
    ds_read_b32 v32, v6 offset:12288
    ds_read_b32 v33, v6 offset:13312
    v_min_u32 v7, 128, v0
    v_lshlrev_b32 v7, 2, v7
    ds_read_b32 v34, v7 offset:14336
    s_waitcnt lgkmcnt(0)
    v_max_f32 v32, |v32|, |v33|
    v_max_f32 v32, |v34|, v32
    s_nop 1
    v_max_f32_dpp v32, v32, v32 quad_perm:[1,0,3,2] row_mask:0xf bank_mask:0xf
    s_nop 1
    v_max_f32_dpp v32, v32, v32 quad_perm:[2,3,0,1] row_mask:0xf bank_mask:0xf
    s_nop 1
    v_max_f32_dpp v32, v32, v32 row_half_mirror row_mask:0xf bank_mask:0xf
    s_nop 1
    v_max_f32_dpp v32, v32, v32 row_mirror row_mask:0xf bank_mask:0xf
    s_nop 0
    v_readlane_b32 s60, v32, 0
    v_readlane_b32 s61, v32, 16
    v_readlane_b32 s62, v32, 32
    v_readlane_b32 s63, v32, 48
    v_mov_b32 v32, s60
    v_max_f32 v32, s61, v32
    v_max_f32 v32, s62, v32
    v_max_f32 v32, s63, v32
    v_lshlrev_b32 v6, 2, v5
    ds_write_b32 v6, v32 offset:16384
    s_waitcnt lgkmcnt(0)
    s_barrier
    v_mov_b32 v6, 0
    ds_read_b128 v[32:35], v6 offset:16384
    s_waitcnt lgkmcnt(0)
    v_max_f32 v32, v32, v33
    v_max_f32 v34, v34, v35
    v_max_f32 v32, v32, v34
    v_lshrrev_b32 v32, 23, v32
    v_max_u32 v32, 32, v32
    v_min_u32 v32, 254, v32
    v_sub_u32 v33, 268, v32
    v_lshlrev_b32 v33, 23, v33
    v_subrev_u32 v34, 14, v32
    v_lshlrev_b32 v34, 23, v34
    v_lshlrev_b32 v6, 3, v0
    v_or_b32 v7, 128, v6
    v_ffbh_u32 v7, v7
    v_sub_u32 v7, 24, v7
    v_lshlrev_b32 v8, 1, 1
    v_lshlrev_b32 v8, v7, 1
    v_lshrrev_b32 v8, 1, v8
    v_subrev_u32 v8, 1, v8
    v_lshlrev_b32 v9, 7, v7
    v_cmp_lt_u32 vcc, 0, v7
    v_add_u32 v10, 0, v6
    v_lshrrev_b32 v11, v7, v10
    v_and_b32 v11, 1, v11
    v_add_u32 v11, v8, v11
    v_cndmask_b32 v11, 0, v11, vcc
    v_add_u32 v10, v10, v11
    v_lshrrev_b32 v10, v7, v10
    v_add_u32 v10, v9, v10
    v_lshlrev_b32 v10, 2, v10
    ds_read_b32 v40, v10 offset:12288
    v_add_u32 v10, 1, v6
    v_lshrrev_b32 v11, v7, v10
    v_and_b32 v11, 1, v11
    v_add_u32 v11, v8, v11
    v_cndmask_b32 v11, 0, v11, vcc
    v_add_u32 v10, v10, v11
    v_lshrrev_b32 v10, v7, v10
    v_add_u32 v10, v9, v10
    v_lshlrev_b32 v10, 2, v10
    ds_read_b32 v41, v10 offset:12288
    v_add_u32 v10, 2, v6
    v_lshrrev_b32 v11, v7, v10
    v_and_b32 v11, 1, v11
    v_add_u32 v11, v8, v11
    v_cndmask_b32 v11, 0, v11, vcc
    v_add_u32 v10, v10, v11
    v_lshrrev_b32 v10, v7, v10
    v_add_u32 v10, v9, v10
    v_lshlrev_b32 v10, 2, v10
    ds_read_b32 v42, v10 offset:12288
    v_add_u32 v10, 3, v6
    v_lshrrev_b32 v11, v7, v10
    v_and_b32 v11, 1, v11
    v_add_u32 v11, v8, v11
    v_cndmask_b32 v11, 0, v11, vcc
    v_add_u32 v10, v10, v11
    v_lshrrev_b32 v10, v7, v10
    v_add_u32 v10, v9, v10
    v_lshlrev_b32 v10, 2, v10
    ds_read_b32 v43, v10 offset:12288
    v_add_u32 v10, 4, v6
    v_lshrrev_b32 v11, v7, v10
    v_and_b32 v11, 1, v11
    v_add_u32 v11, v8, v11
    v_cndmask_b32 v11, 0, v11, vcc
    v_add_u32 v10, v10, v11
    v_lshrrev_b32 v10, v7, v10
    v_add_u32 v10, v9, v10
    v_lshlrev_b32 v10, 2, v10
    ds_read_b32 v44, v10 offset:12288
    v_add_u32 v10, 5, v6
    v_lshrrev_b32 v11, v7, v10
    v_and_b32 v11, 1, v11
    v_add_u32 v11, v8, v11
    v_cndmask_b32 v11, 0, v11, vcc
    v_add_u32 v10, v10, v11
    v_lshrrev_b32 v10, v7, v10
    v_add_u32 v10, v9, v10
    v_lshlrev_b32 v10, 2, v10
    ds_read_b32 v45, v10 offset:12288
    v_add_u32 v10, 6, v6
    v_lshrrev_b32 v11, v7, v10
    v_and_b32 v11, 1, v11
    v_add_u32 v11, v8, v11
    v_cndmask_b32 v11, 0, v11, vcc
    v_add_u32 v10, v10, v11
    v_lshrrev_b32 v10, v7, v10
    v_add_u32 v10, v9, v10
    v_lshlrev_b32 v10, 2, v10
    ds_read_b32 v46, v10 offset:12288
    v_add_u32 v10, 7, v6
    v_lshrrev_b32 v11, v7, v10
    v_and_b32 v11, 1, v11
    v_add_u32 v11, v8, v11
    v_cndmask_b32 v11, 0, v11, vcc
    v_add_u32 v10, v10, v11
    v_lshrrev_b32 v10, v7, v10
    v_add_u32 v10, v9, v10
    v_lshlrev_b32 v10, 2, v10
    ds_read_b32 v47, v10 offset:12288
    s_waitcnt lgkmcnt(0)
    v_mul_f32 v40, v40, v33
    v_mul_f32 v41, v41, v33
    v_mul_f32 v42, v42, v33
    v_mul_f32 v43, v43, v33
    v_mul_f32 v44, v44, v33
    v_mul_f32 v45, v45, v33
    v_mul_f32 v46, v46, v33
    v_mul_f32 v47, v47, v33
    v_cvt_f16_f32 v40, v40
    v_cvt_f16_f32 v41, v41
    v_pack_b32_f16 v48, v40, v41
    v_cvt_f16_f32 v42, v42
    v_cvt_f16_f32 v43, v43
    v_pack_b32_f16 v49, v42, v43
    v_cvt_f16_f32 v44, v44
    v_cvt_f16_f32 v45, v45
    v_pack_b32_f16 v50, v44, v45
    v_cvt_f16_f32 v46, v46
    v_cvt_f16_f32 v47, v47
    v_pack_b32_f16 v51, v46, v47
    s_mov_b32 s44, s30
    s_mov_b32 s45, s31
    s_mov_b32 s46, 0x240000
    s_mov_b32 s47, 0x20000
    s_add_u32 s48, s30, 0x240000
    s_addc_u32 s49, s31, 0
    s_mov_b32 s50, 0x800
    s_mov_b32 s51, 0x20000
    s_mul_i32 s40, s2, 4608
    v_lshlrev_b32 v6, 4, v0
    buffer_store_dwordx4 v[48:51], v6, s[44:47], s40 offen offset:128
    v_mov_b32 v52, 0
    v_mov_b32 v53, 0
    v_mov_b32 v54, 0
    v_mov_b32 v55, 0
    v_add_u32 v7, 4096, v6
    v_cmp_gt_u32 vcc, 8, v0
    s_nop 1
    v_cndmask_b32 v7, v7, v6, vcc
    v_cmp_gt_u32 vcc, 32, v0
    s_nop 1
    s_and_saveexec_b64 s[60:61], vcc
    s_cbranch_execz kg_z
    buffer_store_dwordx4 v[52:55], v7, s[44:47], s40 offen
kg_z:
    s_mov_b64 exec, s[60:61]
    v_cmp_eq_u32 vcc, 0, v0
    s_nop 1
    s_and_saveexec_b64 s[60:61], vcc
    s_cbranch_execz kg_z2
    s_lshl_b32 s41, s2, 2
    v_mov_b32 v7, 0
    buffer_store_dword v34, v7, s[48:51], s41 offen
kg_z2:
    s_endpgm
prep_xt:
    s_waitcnt lgkmcnt(0)
    s_mov_b32 s44, s4
    s_mov_b32 s45, s5
    s_mov_b32 s46, 0x200000
    s_mov_b32 s47, 0x20000
    s_add_u32 s48, s30, 0x250000
    s_addc_u32 s49, s31, 0
    s_mov_b32 s50, 0x200000
    s_mov_b32 s51, 0x20000
    s_add_u32 s52, s30, 0x241000
    s_addc_u32 s53, s31, 0
    s_mov_b32 s54, 0x4000
    s_mov_b32 s55, 0x20000
    s_add_u32 s56, s30, 0x245000
    s_addc_u32 s57, s31, 0
    s_mov_b32 s58, 0x4000
    s_mov_b32 s59, 0x20000
    s_sub_u32 s40, s2, 512
    v_lshrrev_b32 v5, 6, v0
    s_lshl_b32 s41, s40, 14
    v_lshlrev_b32 v6, 12, v5
    v_lshl_add_u32 v6, v1, 4, v6
    buffer_load_dwordx4 v[8:11], v6, s[44:47], s41 offen
    buffer_load_dwordx4 v[12:15], v6, s[44:47], s41 offen offset:1024
    buffer_load_dwordx4 v[16:19], v6, s[44:47], s41 offen offset:2048
    buffer_load_dwordx4 v[20:23], v6, s[44:47], s41 offen offset:3072
    s_lshl_b32 s42, s40, 5
    v_lshlrev_b32 v7, 15, v1
    v_lshl_add_u32 v7, v5, 3, v7
    s_mov_b32 s43, 0x07060302
    s_mov_b32 s46, 0x05040100
    s_waitcnt vmcnt(0)
    v_perm_b32 v24, v12, v8, s46
    v_perm_b32 v25, v20, v16, s46
    v_perm_b32 v26, v12, v8, s43
    v_perm_b32 v27, v20, v16, s43
    v_perm_b32 v28, v13, v9, s46
    v_perm_b32 v29, v21, v17, s46
    v_perm_b32 v30, v13, v9, s43
    v_perm_b32 v31, v21, v17, s43
    v_perm_b32 v32, v14, v10, s46
    v_perm_b32 v33, v22, v18, s46
    v_perm_b32 v34, v14, v10, s43
    v_perm_b32 v35, v22, v18, s43
    v_perm_b32 v36, v15, v11, s46
    v_perm_b32 v37, v23, v19, s46
    v_perm_b32 v38, v15, v11, s43
    v_perm_b32 v39, v23, v19, s43
    buffer_store_dwordx2 v[24:25], v7, s[48:51], s42 offen
    v_add_u32 v7, 4096, v7
    buffer_store_dwordx2 v[26:27], v7, s[48:51], s42 offen
    v_add_u32 v7, 4096, v7
    buffer_store_dwordx2 v[28:29], v7, s[48:51], s42 offen
    v_add_u32 v7, 4096, v7
    buffer_store_dwordx2 v[30:31], v7, s[48:51], s42 offen
    v_add_u32 v7, 4096, v7
    buffer_store_dwordx2 v[32:33], v7, s[48:51], s42 offen
    v_add_u32 v7, 4096, v7
    buffer_store_dwordx2 v[34:35], v7, s[48:51], s42 offen
    v_add_u32 v7, 4096, v7
    buffer_store_dwordx2 v[36:37], v7, s[48:51], s42 offen
    v_add_u32 v7, 4096, v7
    buffer_store_dwordx2 v[38:39], v7, s[48:51], s42 offen
    v_lshlrev_b32 v44, 16, v8
    v_and_b32 v45, 0xffff0000, v8
    v_add_f32 v46, v44, v45
    v_mul_f32 v47, v44, v44
    v_fmac_f32 v47, v45, v45
    v_lshlrev_b32 v44, 16, v9
    v_and_b32 v45, 0xffff0000, v9
    v_add_f32 v46, v46, v44
    v_add_f32 v46, v46, v45
    v_fmac_f32 v47, v44, v44
    v_fmac_f32 v47, v45, v45
    v_lshlrev_b32 v44, 16, v10
    v_and_b32 v45, 0xffff0000, v10
    v_add_f32 v46, v46, v44
    v_add_f32 v46, v46, v45
    v_fmac_f32 v47, v44, v44
    v_fmac_f32 v47, v45, v45
    v_lshlrev_b32 v44, 16, v11
    v_and_b32 v45, 0xffff0000, v11
    v_add_f32 v46, v46, v44
    v_add_f32 v46, v46, v45
    v_fmac_f32 v47, v44, v44
    v_fmac_f32 v47, v45, v45
    v_add_f32_dpp v46, v46, v46 quad_perm:[1,0,3,2] row_mask:0xf bank_mask:0xf
    s_nop 1
    v_add_f32_dpp v46, v46, v46 quad_perm:[2,3,0,1] row_mask:0xf bank_mask:0xf
    s_nop 1
    v_add_f32_dpp v46, v46, v46 row_half_mirror row_mask:0xf bank_mask:0xf
    s_nop 1
    v_add_f32_dpp v46, v46, v46 row_mirror row_mask:0xf bank_mask:0xf
    s_nop 0
    v_readlane_b32 s60, v46, 0
    v_readlane_b32 s61, v46, 16
    v_readlane_b32 s62, v46, 32
    v_readlane_b32 s63, v46, 48
    v_mov_b32 v46, s60
    v_add_f32 v46, s61, v46
    v_add_f32 v46, s62, v46
    v_add_f32 v46, s63, v46
    v_add_f32_dpp v47, v47, v47 quad_perm:[1,0,3,2] row_mask:0xf bank_mask:0xf
    s_nop 1
    v_add_f32_dpp v47, v47, v47 quad_perm:[2,3,0,1] row_mask:0xf bank_mask:0xf
    s_nop 1
    v_add_f32_dpp v47, v47, v47 row_half_mirror row_mask:0xf bank_mask:0xf
    s_nop 1
    v_add_f32_dpp v47, v47, v47 row_mirror row_mask:0xf bank_mask:0xf
    s_nop 0
    v_readlane_b32 s64, v47, 0
    v_readlane_b32 s65, v47, 16
    v_readlane_b32 s66, v47, 32
    v_readlane_b32 s67, v47, 48
    v_mov_b32 v47, s64
    v_add_f32 v47, s65, v47
    v_add_f32 v47, s66, v47
    v_add_f32 v47, s67, v47
    v_mov_b32 v48, v46
    v_mov_b32 v49, v47
    v_lshlrev_b32 v44, 16, v12
    v_and_b32 v45, 0xffff0000, v12
    v_add_f32 v46, v44, v45
    v_mul_f32 v47, v44, v44
    v_fmac_f32 v47, v45, v45
    v_lshlrev_b32 v44, 16, v13
    v_and_b32 v45, 0xffff0000, v13
    v_add_f32 v46, v46, v44
    v_add_f32 v46, v46, v45
    v_fmac_f32 v47, v44, v44
    v_fmac_f32 v47, v45, v45
    v_lshlrev_b32 v44, 16, v14
    v_and_b32 v45, 0xffff0000, v14
    v_add_f32 v46, v46, v44
    v_add_f32 v46, v46, v45
    v_fmac_f32 v47, v44, v44
    v_fmac_f32 v47, v45, v45
    v_lshlrev_b32 v44, 16, v15
    v_and_b32 v45, 0xffff0000, v15
    v_add_f32 v46, v46, v44
    v_add_f32 v46, v46, v45
    v_fmac_f32 v47, v44, v44
    v_fmac_f32 v47, v45, v45
    v_add_f32_dpp v46, v46, v46 quad_perm:[1,0,3,2] row_mask:0xf bank_mask:0xf
    s_nop 1
    v_add_f32_dpp v46, v46, v46 quad_perm:[2,3,0,1] row_mask:0xf bank_mask:0xf
    s_nop 1
    v_add_f32_dpp v46, v46, v46 row_half_mirror row_mask:0xf bank_mask:0xf
    s_nop 1
    v_add_f32_dpp v46, v46, v46 row_mirror row_mask:0xf bank_mask:0xf
    s_nop 0
    v_readlane_b32 s60, v46, 0
    v_readlane_b32 s61, v46, 16
    v_readlane_b32 s62, v46, 32
    v_readlane_b32 s63, v46, 48
    v_mov_b32 v46, s60
    v_add_f32 v46, s61, v46
    v_add_f32 v46, s62, v46
    v_add_f32 v46, s63, v46
    v_add_f32_dpp v47, v47, v47 quad_perm:[1,0,3,2] row_mask:0xf bank_mask:0xf
    s_nop 1
    v_add_f32_dpp v47, v47, v47 quad_perm:[2,3,0,1] row_mask:0xf bank_mask:0xf
    s_nop 1
    v_add_f32_dpp v47, v47, v47 row_half_mirror row_mask:0xf bank_mask:0xf
    s_nop 1
    v_add_f32_dpp v47, v47, v47 row_mirror row_mask:0xf bank_mask:0xf
    s_nop 0
    v_readlane_b32 s64, v47, 0
    v_readlane_b32 s65, v47, 16
    v_readlane_b32 s66, v47, 32
    v_readlane_b32 s67, v47, 48
    v_mov_b32 v47, s64
    v_add_f32 v47, s65, v47
    v_add_f32 v47, s66, v47
    v_add_f32 v47, s67, v47
    v_mov_b32 v50, v46
    v_mov_b32 v51, v47
    v_lshlrev_b32 v44, 16, v16
    v_and_b32 v45, 0xffff0000, v16
    v_add_f32 v46, v44, v45
    v_mul_f32 v47, v44, v44
    v_fmac_f32 v47, v45, v45
    v_lshlrev_b32 v44, 16, v17
    v_and_b32 v45, 0xffff0000, v17
    v_add_f32 v46, v46, v44
    v_add_f32 v46, v46, v45
    v_fmac_f32 v47, v44, v44
    v_fmac_f32 v47, v45, v45
    v_lshlrev_b32 v44, 16, v18
    v_and_b32 v45, 0xffff0000, v18
    v_add_f32 v46, v46, v44
    v_add_f32 v46, v46, v45
    v_fmac_f32 v47, v44, v44
    v_fmac_f32 v47, v45, v45
    v_lshlrev_b32 v44, 16, v19
    v_and_b32 v45, 0xffff0000, v19
    v_add_f32 v46, v46, v44
    v_add_f32 v46, v46, v45
    v_fmac_f32 v47, v44, v44
    v_fmac_f32 v47, v45, v45
    v_add_f32_dpp v46, v46, v46 quad_perm:[1,0,3,2] row_mask:0xf bank_mask:0xf
    s_nop 1
    v_add_f32_dpp v46, v46, v46 quad_perm:[2,3,0,1] row_mask:0xf bank_mask:0xf
    s_nop 1
    v_add_f32_dpp v46, v46, v46 row_half_mirror row_mask:0xf bank_mask:0xf
    s_nop 1
    v_add_f32_dpp v46, v46, v46 row_mirror row_mask:0xf bank_mask:0xf
    s_nop 0
    v_readlane_b32 s60, v46, 0
    v_readlane_b32 s61, v46, 16
    v_readlane_b32 s62, v46, 32
    v_readlane_b32 s63, v46, 48
    v_mov_b32 v46, s60
    v_add_f32 v46, s61, v46
    v_add_f32 v46, s62, v46
    v_add_f32 v46, s63, v46
    v_add_f32_dpp v47, v47, v47 quad_perm:[1,0,3,2] row_mask:0xf bank_mask:0xf
    s_nop 1
    v_add_f32_dpp v47, v47, v47 quad_perm:[2,3,0,1] row_mask:0xf bank_mask:0xf
    s_nop 1
    v_add_f32_dpp v47, v47, v47 row_half_mirror row_mask:0xf bank_mask:0xf
    s_nop 1
    v_add_f32_dpp v47, v47, v47 row_mirror row_mask:0xf bank_mask:0xf
    s_nop 0
    v_readlane_b32 s64, v47, 0
    v_readlane_b32 s65, v47, 16
    v_readlane_b32 s66, v47, 32
    v_readlane_b32 s67, v47, 48
    v_mov_b32 v47, s64
    v_add_f32 v47, s65, v47
    v_add_f32 v47, s66, v47
    v_add_f32 v47, s67, v47
    v_mov_b32 v52, v46
    v_mov_b32 v53, v47
    v_lshlrev_b32 v44, 16, v20
    v_and_b32 v45, 0xffff0000, v20
    v_add_f32 v46, v44, v45
    v_mul_f32 v47, v44, v44
    v_fmac_f32 v47, v45, v45
    v_lshlrev_b32 v44, 16, v21
    v_and_b32 v45, 0xffff0000, v21
    v_add_f32 v46, v46, v44
    v_add_f32 v46, v46, v45
    v_fmac_f32 v47, v44, v44
    v_fmac_f32 v47, v45, v45
    v_lshlrev_b32 v44, 16, v22
    v_and_b32 v45, 0xffff0000, v22
    v_add_f32 v46, v46, v44
    v_add_f32 v46, v46, v45
    v_fmac_f32 v47, v44, v44
    v_fmac_f32 v47, v45, v45
    v_lshlrev_b32 v44, 16, v23
    v_and_b32 v45, 0xffff0000, v23
    v_add_f32 v46, v46, v44
    v_add_f32 v46, v46, v45
    v_fmac_f32 v47, v44, v44
    v_fmac_f32 v47, v45, v45
    v_add_f32_dpp v46, v46, v46 quad_perm:[1,0,3,2] row_mask:0xf bank_mask:0xf
    s_nop 1
    v_add_f32_dpp v46, v46, v46 quad_perm:[2,3,0,1] row_mask:0xf bank_mask:0xf
    s_nop 1
    v_add_f32_dpp v46, v46, v46 row_half_mirror row_mask:0xf bank_mask:0xf
    s_nop 1
    v_add_f32_dpp v46, v46, v46 row_mirror row_mask:0xf bank_mask:0xf
    s_nop 0
    v_readlane_b32 s60, v46, 0
    v_readlane_b32 s61, v46, 16
    v_readlane_b32 s62, v46, 32
    v_readlane_b32 s63, v46, 48
    v_mov_b32 v46, s60
    v_add_f32 v46, s61, v46
    v_add_f32 v46, s62, v46
    v_add_f32 v46, s63, v46
    v_add_f32_dpp v47, v47, v47 quad_perm:[1,0,3,2] row_mask:0xf bank_mask:0xf
    s_nop 1
    v_add_f32_dpp v47, v47, v47 quad_perm:[2,3,0,1] row_mask:0xf bank_mask:0xf
    s_nop 1
    v_add_f32_dpp v47, v47, v47 row_half_mirror row_mask:0xf bank_mask:0xf
    s_nop 1
    v_add_f32_dpp v47, v47, v47 row_mirror row_mask:0xf bank_mask:0xf
    s_nop 0
    v_readlane_b32 s64, v47, 0
    v_readlane_b32 s65, v47, 16
    v_readlane_b32 s66, v47, 32
    v_readlane_b32 s67, v47, 48
    v_mov_b32 v47, s64
    v_add_f32 v47, s65, v47
    v_add_f32 v47, s66, v47
    v_add_f32 v47, s67, v47
    v_mov_b32 v54, v46
    v_mov_b32 v55, v47
    v_mov_b32 v56, 0
    v_mov_b32 v57, 0
    v_mov_b32 v58, 0
    v_mov_b32 v59, 0
    s_add_u32 s68, s30, 24903680
    s_addc_u32 s69, s31, 0
    s_mov_b32 s70, 65536
    s_mov_b32 s71, 0x20000
    v_lshlrev_b32 v6, 1, v0
    s_lshl_b32 s42, s40, 9
    buffer_store_short v56, v6, s[68:71], s42 offen
    v_lshlrev_b32 v6, 5, v5
    s_lshl_b32 s42, s40, 7
    v_cmp_eq_u32 vcc, 0, v1
    s_nop 1
    s_and_saveexec_b64 s[60:61], vcc
    s_cbranch_execz xt_z
    buffer_store_dwordx4 v[48:51], v6, s[52:55], s42 offen
    buffer_store_dwordx4 v[52:55], v6, s[52:55], s42 offen offset:16
    buffer_store_dwordx4 v[56:59], v6, s[56:59], s42 offen
    buffer_store_dwordx4 v[56:59], v6, s[56:59], s42 offen offset:16
xt_z:
    s_endpgm
prep_w13:
    s_waitcnt lgkmcnt(0)
    s_sub_u32 s40, s2, 640
    s_lshr_b32 s41, s40, 1
    s_and_b32 s42, s40, 1
    s_cmp_eq_u32 s42, 0
    s_cselect_b32 s44, s20, s22
    s_cselect_b32 s45, s21, s23
    s_mov_b32 s46, 1409024
    s_mov_b32 s47, 0x20000
    s_add_u32 s48, s30, 0x13b0000
    s_addc_u32 s49, s31, 0
    s_mov_b32 s50, 0x2b0000
    s_mov_b32 s51, 0x20000
    v_and_b32 v2, 15, v0
    v_lshrrev_b32 v3, 4, v0
    s_movk_i32 s43, 22016
    v_mul_lo_u32 v4, v3, s43
    v_lshl_add_u32 v4, v2, 2, v4
    s_lshl_b32 s52, s41, 6
    s_mov_b32 s53, 0x07060302
    s_mov_b32 s54, 0x05040100
    v_lshrrev_b32 v5, 2, v3
    v_lshlrev_b32 v5, 12, v5
    v_lshrrev_b32 v6, 3, v2
    v_lshl_add_u32 v5, v6, 10, v5
    v_and_b32 v6, 3, v3
    v_lshl_add_u32 v5, v6, 8, v5
    v_and_b32 v6, 7, v2
    v_lshl_add_u32 v5, v6, 5, v5
    s_lshl_b32 s55, s41, 16
    s_lshl_b32 s56, s42, 11
    s_add_u32 s55, s55, s56
    s_add_u32 s57, s52, 0
    buffer_load_dword v8, v4, s[44:47], s57 offen
    s_add_u32 s57, s52, 2752
    buffer_load_dword v9, v4, s[44:47], s57 offen
    s_add_u32 s57, s52, 5504
    buffer_load_dword v10, v4, s[44:47], s57 offen
    s_add_u32 s57, s52, 8256
    buffer_load_dword v11, v4, s[44:47], s57 offen
    s_add_u32 s57, s52, 11008
    buffer_load_dword v12, v4, s[44:47], s57 offen
    s_add_u32 s57, s52, 13760
    buffer_load_dword v13, v4, s[44:47], s57 offen
    s_add_u32 s57, s52, 16512
    buffer_load_dword v14, v4, s[44:47], s57 offen
    s_add_u32 s57, s52, 19264
    buffer_load_dword v15, v4, s[44:47], s57 offen
    s_waitcnt vmcnt(0)
    v_perm_b32 v16, v9, v8, s54
    v_perm_b32 v20, v9, v8, s53
    v_perm_b32 v17, v11, v10, s54
    v_perm_b32 v21, v11, v10, s53
    v_perm_b32 v18, v13, v12, s54
    v_perm_b32 v22, v13, v12, s53
    v_perm_b32 v19, v15, v14, s54
    v_perm_b32 v23, v15, v14, s53
    s_add_u32 s57, s55, 0
    buffer_store_dwordx4 v[16:19], v5, s[48:51], s57 offen
    buffer_store_dwordx4 v[20:23], v5, s[48:51], s57 offen offset:16
    s_add_u32 s57, s52, 352256
    buffer_load_dword v8, v4, s[44:47], s57 offen
    s_add_u32 s57, s52, 355008
    buffer_load_dword v9, v4, s[44:47], s57 offen
    s_add_u32 s57, s52, 357760
    buffer_load_dword v10, v4, s[44:47], s57 offen
    s_add_u32 s57, s52, 360512
    buffer_load_dword v11, v4, s[44:47], s57 offen
    s_add_u32 s57, s52, 363264
    buffer_load_dword v12, v4, s[44:47], s57 offen
    s_add_u32 s57, s52, 366016
    buffer_load_dword v13, v4, s[44:47], s57 offen
    s_add_u32 s57, s52, 368768
    buffer_load_dword v14, v4, s[44:47], s57 offen
    s_add_u32 s57, s52, 371520
    buffer_load_dword v15, v4, s[44:47], s57 offen
    s_waitcnt vmcnt(0)
    v_perm_b32 v16, v9, v8, s54
    v_perm_b32 v20, v9, v8, s53
    v_perm_b32 v17, v11, v10, s54
    v_perm_b32 v21, v11, v10, s53
    v_perm_b32 v18, v13, v12, s54
    v_perm_b32 v22, v13, v12, s53
    v_perm_b32 v19, v15, v14, s54
    v_perm_b32 v23, v15, v14, s53
    s_add_u32 s57, s55, 16384
    buffer_store_dwordx4 v[16:19], v5, s[48:51], s57 offen
    buffer_store_dwordx4 v[20:23], v5, s[48:51], s57 offen offset:16
    s_add_u32 s57, s52, 704512
    buffer_load_dword v8, v4, s[44:47], s57 offen
    s_add_u32 s57, s52, 707264
    buffer_load_dword v9, v4, s[44:47], s57 offen
    s_add_u32 s57, s52, 710016
    buffer_load_dword v10, v4, s[44:47], s57 offen
    s_add_u32 s57, s52, 712768
    buffer_load_dword v11, v4, s[44:47], s57 offen
    s_add_u32 s57, s52, 715520
    buffer_load_dword v12, v4, s[44:47], s57 offen
    s_add_u32 s57, s52, 718272
    buffer_load_dword v13, v4, s[44:47], s57 offen
    s_add_u32 s57, s52, 721024
    buffer_load_dword v14, v4, s[44:47], s57 offen
    s_add_u32 s57, s52, 723776
    buffer_load_dword v15, v4, s[44:47], s57 offen
    s_waitcnt vmcnt(0)
    v_perm_b32 v16, v9, v8, s54
    v_perm_b32 v20, v9, v8, s53
    v_perm_b32 v17, v11, v10, s54
    v_perm_b32 v21, v11, v10, s53
    v_perm_b32 v18, v13, v12, s54
    v_perm_b32 v22, v13, v12, s53
    v_perm_b32 v19, v15, v14, s54
    v_perm_b32 v23, v15, v14, s53
    s_add_u32 s57, s55, 32768
    buffer_store_dwordx4 v[16:19], v5, s[48:51], s57 offen
    buffer_store_dwordx4 v[20:23], v5, s[48:51], s57 offen offset:16
    s_add_u32 s57, s52, 1056768
    buffer_load_dword v8, v4, s[44:47], s57 offen
    s_add_u32 s57, s52, 1059520
    buffer_load_dword v9, v4, s[44:47], s57 offen
    s_add_u32 s57, s52, 1062272
    buffer_load_dword v10, v4, s[44:47], s57 offen
    s_add_u32 s57, s52, 1065024
    buffer_load_dword v11, v4, s[44:47], s57 offen
    s_add_u32 s57, s52, 1067776
    buffer_load_dword v12, v4, s[44:47], s57 offen
    s_add_u32 s57, s52, 1070528
    buffer_load_dword v13, v4, s[44:47], s57 offen
    s_add_u32 s57, s52, 1073280
    buffer_load_dword v14, v4, s[44:47], s57 offen
    s_add_u32 s57, s52, 1076032
    buffer_load_dword v15, v4, s[44:47], s57 offen
    s_waitcnt vmcnt(0)
    v_perm_b32 v16, v9, v8, s54
    v_perm_b32 v20, v9, v8, s53
    v_perm_b32 v17, v11, v10, s54
    v_perm_b32 v21, v11, v10, s53
    v_perm_b32 v18, v13, v12, s54
    v_perm_b32 v22, v13, v12, s53
    v_perm_b32 v19, v15, v14, s54
    v_perm_b32 v23, v15, v14, s53
    s_add_u32 s57, s55, 49152
    buffer_store_dwordx4 v[16:19], v5, s[48:51], s57 offen
    buffer_store_dwordx4 v[20:23], v5, s[48:51], s57 offen offset:16
    s_endpgm
prep_w2:
    s_waitcnt lgkmcnt(0)
    s_mov_b32 s44, s24
    s_mov_b32 s45, s25
    s_mov_b32 s46, 0x158000
    s_mov_b32 s47, 0x20000
    s_add_u32 s48, s30, 0x1660000
    s_addc_u32 s49, s31, 0
    s_mov_b32 s50, 0x158000
    s_mov_b32 s51, 0x20000
    s_sub_u32 s40, s2, 726
    v_lshrrev_b32 v5, 6, v0
    v_lshlrev_b32 v4, 12, v5
    v_lshl_add_u32 v4, v1, 2, v4
    s_lshl_b32 s52, s40, 15
    s_mov_b32 s53, 0x07060302
    s_mov_b32 s54, 0x05040100
    v_lshrrev_b32 v6, 5, v1
    s_mov_b32 s55, 176128
    v_mul_lo_u32 v6, v6, s55
    v_and_b32 v7, 31, v1
    v_lshlrev_b32 v7, 1, v7
    v_lshrrev_b32 v8, 4, v7
    v_lshl_add_u32 v6, v8, 6, v6
    v_bfe_u32 v8, v7, 2, 2
    v_lshl_add_u32 v6, v8, 10, v6
    v_and_b32 v8, 3, v7
    v_lshl_add_u32 v6, v8, 4, v6
    v_lshl_add_u32 v6, v5, 8, v6
    s_lshl_b32 s56, s40, 12
    s_add_u32 s57, s52, 0
    buffer_load_dword v8, v4, s[44:47], s57 offen
    s_add_u32 s57, s52, 1024
    buffer_load_dword v9, v4, s[44:47], s57 offen
    s_add_u32 s57, s52, 2048
    buffer_load_dword v10, v4, s[44:47], s57 offen
    s_add_u32 s57, s52, 3072
    buffer_load_dword v11, v4, s[44:47], s57 offen
    s_add_u32 s57, s52, 16384
    buffer_load_dword v12, v4, s[44:47], s57 offen
    s_add_u32 s57, s52, 17408
    buffer_load_dword v13, v4, s[44:47], s57 offen
    s_add_u32 s57, s52, 18432
    buffer_load_dword v14, v4, s[44:47], s57 offen
    s_add_u32 s57, s52, 19456
    buffer_load_dword v15, v4, s[44:47], s57 offen
    s_waitcnt vmcnt(0)
    v_perm_b32 v16, v9, v8, s54
    v_perm_b32 v20, v9, v8, s53
    v_perm_b32 v17, v11, v10, s54
    v_perm_b32 v21, v11, v10, s53
    v_perm_b32 v18, v13, v12, s54
    v_perm_b32 v22, v13, v12, s53
    v_perm_b32 v19, v15, v14, s54
    v_perm_b32 v23, v15, v14, s53
    s_add_u32 s57, s56, 0
    buffer_store_dwordx4 v[16:19], v6, s[48:51], s57 offen
    buffer_store_dwordx4 v[20:23], v6, s[48:51], s57 offen offset:16
    s_add_u32 s57, s52, 256
    buffer_load_dword v8, v4, s[44:47], s57 offen
    s_add_u32 s57, s52, 1280
    buffer_load_dword v9, v4, s[44:47], s57 offen
    s_add_u32 s57, s52, 2304
    buffer_load_dword v10, v4, s[44:47], s57 offen
    s_add_u32 s57, s52, 3328
    buffer_load_dword v11, v4, s[44:47], s57 offen
    s_add_u32 s57, s52, 16640
    buffer_load_dword v12, v4, s[44:47], s57 offen
    s_add_u32 s57, s52, 17664
    buffer_load_dword v13, v4, s[44:47], s57 offen
    s_add_u32 s57, s52, 18688
    buffer_load_dword v14, v4, s[44:47], s57 offen
    s_add_u32 s57, s52, 19712
    buffer_load_dword v15, v4, s[44:47], s57 offen
    s_waitcnt vmcnt(0)
    v_perm_b32 v16, v9, v8, s54
    v_perm_b32 v20, v9, v8, s53
    v_perm_b32 v17, v11, v10, s54
    v_perm_b32 v21, v11, v10, s53
    v_perm_b32 v18, v13, v12, s54
    v_perm_b32 v22, v13, v12, s53
    v_perm_b32 v19, v15, v14, s54
    v_perm_b32 v23, v15, v14, s53
    s_add_u32 s57, s56, 352256
    buffer_store_dwordx4 v[16:19], v6, s[48:51], s57 offen
    buffer_store_dwordx4 v[20:23], v6, s[48:51], s57 offen offset:16
    s_add_u32 s57, s52, 512
    buffer_load_dword v8, v4, s[44:47], s57 offen
    s_add_u32 s57, s52, 1536
    buffer_load_dword v9, v4, s[44:47], s57 offen
    s_add_u32 s57, s52, 2560
    buffer_load_dword v10, v4, s[44:47], s57 offen
    s_add_u32 s57, s52, 3584
    buffer_load_dword v11, v4, s[44:47], s57 offen
    s_add_u32 s57, s52, 16896
    buffer_load_dword v12, v4, s[44:47], s57 offen
    s_add_u32 s57, s52, 17920
    buffer_load_dword v13, v4, s[44:47], s57 offen
    s_add_u32 s57, s52, 18944
    buffer_load_dword v14, v4, s[44:47], s57 offen
    s_add_u32 s57, s52, 19968
    buffer_load_dword v15, v4, s[44:47], s57 offen
    s_waitcnt vmcnt(0)
    v_perm_b32 v16, v9, v8, s54
    v_perm_b32 v20, v9, v8, s53
    v_perm_b32 v17, v11, v10, s54
    v_perm_b32 v21, v11, v10, s53
    v_perm_b32 v18, v13, v12, s54
    v_perm_b32 v22, v13, v12, s53
    v_perm_b32 v19, v15, v14, s54
    v_perm_b32 v23, v15, v14, s53
    s_add_u32 s57, s56, 704512
    buffer_store_dwordx4 v[16:19], v6, s[48:51], s57 offen
    buffer_store_dwordx4 v[20:23], v6, s[48:51], s57 offen offset:16
    s_add_u32 s57, s52, 768
    buffer_load_dword v8, v4, s[44:47], s57 offen
    s_add_u32 s57, s52, 1792
    buffer_load_dword v9, v4, s[44:47], s57 offen
    s_add_u32 s57, s52, 2816
    buffer_load_dword v10, v4, s[44:47], s57 offen
    s_add_u32 s57, s52, 3840
    buffer_load_dword v11, v4, s[44:47], s57 offen
    s_add_u32 s57, s52, 17152
    buffer_load_dword v12, v4, s[44:47], s57 offen
    s_add_u32 s57, s52, 18176
    buffer_load_dword v13, v4, s[44:47], s57 offen
    s_add_u32 s57, s52, 19200
    buffer_load_dword v14, v4, s[44:47], s57 offen
    s_add_u32 s57, s52, 20224
    buffer_load_dword v15, v4, s[44:47], s57 offen
    s_waitcnt vmcnt(0)
    v_perm_b32 v16, v9, v8, s54
    v_perm_b32 v20, v9, v8, s53
    v_perm_b32 v17, v11, v10, s54
    v_perm_b32 v21, v11, v10, s53
    v_perm_b32 v18, v13, v12, s54
    v_perm_b32 v22, v13, v12, s53
    v_perm_b32 v19, v15, v14, s54
    v_perm_b32 v23, v15, v14, s53
    s_add_u32 s57, s56, 1056768
    buffer_store_dwordx4 v[16:19], v6, s[48:51], s57 offen
    buffer_store_dwordx4 v[20:23], v6, s[48:51], s57 offen offset:16
prep_done:
    s_endpgm
.section .rodata,"a"
.p2align 6
.amdhsa_kernel prep_kernel
  .amdhsa_next_free_vgpr 80
  .amdhsa_next_free_sgpr 102
  .amdhsa_accum_offset 80
  .amdhsa_group_segment_fixed_size 0
  .amdhsa_kernarg_size 112
  .amdhsa_user_sgpr_count 2
  .amdhsa_user_sgpr_kernarg_segment_ptr 1
  .amdhsa_system_sgpr_workgroup_id_x 1
.end_amdhsa_kernel

.text
.globl conv1_kernel
.p2align 8
.type conv1_kernel,@function
conv1_kernel:
    s_cmp_ge_u32 s2, 512
    s_cbranch_scc1 conv1_kernel_done
    s_load_dwordx16 s[4:19], s[0:1], 0
    s_load_dwordx8 s[20:27], s[0:1], 64
    s_load_dwordx4 s[28:31], s[0:1], 96
    v_and_b32 v1, 63, v0
    v_lshrrev_b32 v5, 6, v0
    s_waitcnt lgkmcnt(0)
    s_mov_b32 s44, s30
    s_mov_b32 s45, s31
    s_mov_b32 s46, 0x240000
    s_mov_b32 s47, 0x20000
    s_add_u32 s48, s30, 0x250000
    s_addc_u32 s49, s31, 0
    s_mov_b32 s50, 0x200000
    s_mov_b32 s51, 0x20000
    s_add_u32 s52, s30, 0x241000
    s_addc_u32 s53, s31, 0
    s_mov_b32 s54, 0x4000
    s_mov_b32 s55, 0x20000
    s_add_u32 s56, s30, 0x450000
    s_addc_u32 s57, s31, 0
    s_mov_b32 s58, 0x200000
    s_mov_b32 s59, 0x20000
    s_mul_i32 s40, s2, 4608
    s_lshl_b32 s41, s2, 12
    v_lshlrev_b32 v6, 4, v0
    buffer_load_dwordx4 v[8:11], v6, s[44:47], s40 offen
    buffer_load_dwordx4 v[12:15], v6, s[44:47], s40 offen offset:16
    v_add_u32 v7, 16, v6
    buffer_load_dwordx4 v[16:19], v7, s[44:47], s40 offen offset:4080
    v_add_u32 v7, 32, v6
    buffer_load_dwordx4 v[20:23], v7, s[44:47], s40 offen offset:4080
    buffer_load_dwordx4 v[24:27], v6, s[48:51], s41 offen
    v_lshlrev_b32 v7, 6, v0
    buffer_load_dwordx4 v[28:31], v7, s[52:55], 0 offen
    buffer_load_dwordx4 v[32:35], v7, s[52:55], 0 offen offset:16
    buffer_load_dwordx4 v[36:39], v7, s[52:55], 0 offen offset:32
    buffer_load_dwordx4 v[40:43], v7, s[52:55], 0 offen offset:48
    s_add_u32 s60, s30, 2359296
    s_addc_u32 s61, s31, 0
    s_lshl_b32 s42, s2, 2
    s_load_dword s62, s[60:61], s42
    v_mov_b32 v44, 0
    v_mov_b32 v45, 0
    v_mov_b32 v46, 0
    v_mov_b32 v47, 0
    ds_write_b128 v6, v[44:47] offset:39936
    v_cmp_gt_u32 vcc, 32, v0
    s_nop 1
    s_and_saveexec_b64 s[64:65], vcc
    ds_write_b128 v6, v[44:47] offset:44032
    s_mov_b64 exec, s[64:65]
    s_waitcnt vmcnt(7)
    v_alignbit_b32 v48, v9, v8, 16
    v_alignbit_b32 v49, v10, v9, 16
    v_alignbit_b32 v50, v11, v10, 16
    v_alignbit_b32 v51, v12, v11, 16
    v_alignbit_b32 v52, v13, v12, 16
    v_alignbit_b32 v53, v14, v13, 16
    v_alignbit_b32 v54, v15, v14, 16
    ds_write_b128 v6, v[48:51] offset:0
    v_mov_b32 v56, v9
    v_mov_b32 v57, v10
    v_mov_b32 v58, v11
    v_mov_b32 v59, v12
    ds_write_b128 v6, v[56:59] offset:4416
    v_mov_b32 v60, v49
    v_mov_b32 v61, v50
    v_mov_b32 v62, v51
    v_mov_b32 v63, v52
    ds_write_b128 v6, v[60:63] offset:8832
    ds_write_b128 v6, v[10:13] offset:13248
    ds_write_b128 v6, v[50:53] offset:17664
    v_mov_b32 v56, v11
    v_mov_b32 v57, v12
    v_mov_b32 v58, v13
    v_mov_b32 v59, v14
    ds_write_b128 v6, v[56:59] offset:22080
    v_mov_b32 v60, v51
    v_mov_b32 v61, v52
    v_mov_b32 v62, v53
    v_mov_b32 v63, v54
    ds_write_b128 v6, v[60:63] offset:26496
    ds_write_b128 v6, v[12:15] offset:30912
    s_waitcnt vmcnt(5)
    v_cmp_gt_u32 vcc, 8, v0
    s_nop 1
    s_and_saveexec_b64 s[64:65], vcc
    s_cbranch_execz conv1_kernel_c2
    v_alignbit_b32 v48, v17, v16, 16
    v_alignbit_b32 v49, v18, v17, 16
    v_alignbit_b32 v50, v19, v18, 16
    v_alignbit_b32 v51, v20, v19, 16
    v_alignbit_b32 v52, v21, v20, 16
    v_alignbit_b32 v53, v22, v21, 16
    v_alignbit_b32 v54, v23, v22, 16
    ds_write_b128 v6, v[48:51] offset:4096
    v_mov_b32 v56, v17
    v_mov_b32 v57, v18
    v_mov_b32 v58, v19
    v_mov_b32 v59, v20
    ds_write_b128 v6, v[56:59] offset:8512
    v_mov_b32 v60, v49
    v_mov_b32 v61, v50
    v_mov_b32 v62, v51
    v_mov_b32 v63, v52
    ds_write_b128 v6, v[60:63] offset:12928
    ds_write_b128 v6, v[18:21] offset:17344
    ds_write_b128 v6, v[50:53] offset:21760
    v_mov_b32 v56, v19
    v_mov_b32 v57, v20
    v_mov_b32 v58, v21
    v_mov_b32 v59, v22
    ds_write_b128 v6, v[56:59] offset:26176
    v_mov_b32 v60, v51
    v_mov_b32 v61, v52
    v_mov_b32 v62, v53
    v_mov_b32 v63, v54
    ds_write_b128 v6, v[60:63] offset:30592
    ds_write_b128 v6, v[20:23] offset:35008
conv1_kernel_c2:
    s_mov_b64 exec, s[64:65]
    s_waitcnt vmcnt(0)
    v_lshlrev_b32 v64, 16, v24
    v_mul_f32 v75, 0x3b000000, v28
    v_mul_f32 v29, 0x3b000000, v29
    v_fma_f32 v29, -v75, v75, v29
    v_max_f32 v29, 0, v29
    v_cvt_pk_bf16_f32 v72, v75, v75
    v_lshlrev_b32 v72, 16, v72
    v_cvt_pk_bf16_f32 v29, v29, v29
    v_lshlrev_b32 v29, 16, v29
    v_add_f32 v29, 0x3727c5ac, v29
    v_cvt_pk_bf16_f32 v29, v29, v29
    v_lshlrev_b32 v29, 16, v29
    v_sqrt_f32 v29, v29
    s_nop 0
    v_cvt_pk_bf16_f32 v73, v29, v29
    v_lshlrev_b32 v73, 16, v73
    v_rcp_f32 v74, v73
    v_sub_f32 v64, v64, v72
    v_cvt_pk_bf16_f32 v64, v64, v64
    v_lshlrev_b32 v64, 16, v64
    v_mul_f32 v75, v64, v74
    v_fma_f32 v76, -v75, v73, v64
    v_fma_f32 v64, v76, v74, v75
    v_cvt_pk_bf16_f32 v64, v64, v64
    v_lshlrev_b32 v64, 16, v64
    v_cvt_f16_f32 v64, v64
    v_and_b32 v65, 0xffff0000, v24
    v_mul_f32 v75, 0x3b000000, v30
    v_mul_f32 v31, 0x3b000000, v31
    v_fma_f32 v31, -v75, v75, v31
    v_max_f32 v31, 0, v31
    v_cvt_pk_bf16_f32 v72, v75, v75
    v_lshlrev_b32 v72, 16, v72
    v_cvt_pk_bf16_f32 v31, v31, v31
    v_lshlrev_b32 v31, 16, v31
    v_add_f32 v31, 0x3727c5ac, v31
    v_cvt_pk_bf16_f32 v31, v31, v31
    v_lshlrev_b32 v31, 16, v31
    v_sqrt_f32 v31, v31
    s_nop 0
    v_cvt_pk_bf16_f32 v73, v31, v31
    v_lshlrev_b32 v73, 16, v73
    v_rcp_f32 v74, v73
    v_sub_f32 v65, v65, v72
    v_cvt_pk_bf16_f32 v65, v65, v65
    v_lshlrev_b32 v65, 16, v65
    v_mul_f32 v75, v65, v74
    v_fma_f32 v76, -v75, v73, v65
    v_fma_f32 v65, v76, v74, v75
    v_cvt_pk_bf16_f32 v65, v65, v65
    v_lshlrev_b32 v65, 16, v65
    v_cvt_f16_f32 v65, v65
    v_lshlrev_b32 v66, 16, v25
    v_mul_f32 v75, 0x3b000000, v32
    v_mul_f32 v33, 0x3b000000, v33
    v_fma_f32 v33, -v75, v75, v33
    v_max_f32 v33, 0, v33
    v_cvt_pk_bf16_f32 v72, v75, v75
    v_lshlrev_b32 v72, 16, v72
    v_cvt_pk_bf16_f32 v33, v33, v33
    v_lshlrev_b32 v33, 16, v33
    v_add_f32 v33, 0x3727c5ac, v33
    v_cvt_pk_bf16_f32 v33, v33, v33
    v_lshlrev_b32 v33, 16, v33
    v_sqrt_f32 v33, v33
    s_nop 0
    v_cvt_pk_bf16_f32 v73, v33, v33
    v_lshlrev_b32 v73, 16, v73
    v_rcp_f32 v74, v73
    v_sub_f32 v66, v66, v72
    v_cvt_pk_bf16_f32 v66, v66, v66
    v_lshlrev_b32 v66, 16, v66
    v_mul_f32 v75, v66, v74
    v_fma_f32 v76, -v75, v73, v66
    v_fma_f32 v66, v76, v74, v75
    v_cvt_pk_bf16_f32 v66, v66, v66
    v_lshlrev_b32 v66, 16, v66
    v_cvt_f16_f32 v66, v66
    v_and_b32 v67, 0xffff0000, v25
    v_mul_f32 v75, 0x3b000000, v34
    v_mul_f32 v35, 0x3b000000, v35
    v_fma_f32 v35, -v75, v75, v35
    v_max_f32 v35, 0, v35
    v_cvt_pk_bf16_f32 v72, v75, v75
    v_lshlrev_b32 v72, 16, v72
    v_cvt_pk_bf16_f32 v35, v35, v35
    v_lshlrev_b32 v35, 16, v35
    v_add_f32 v35, 0x3727c5ac, v35
    v_cvt_pk_bf16_f32 v35, v35, v35
    v_lshlrev_b32 v35, 16, v35
    v_sqrt_f32 v35, v35
    s_nop 0
    v_cvt_pk_bf16_f32 v73, v35, v35
    v_lshlrev_b32 v73, 16, v73
    v_rcp_f32 v74, v73
    v_sub_f32 v67, v67, v72
    v_cvt_pk_bf16_f32 v67, v67, v67
    v_lshlrev_b32 v67, 16, v67
    v_mul_f32 v75, v67, v74
    v_fma_f32 v76, -v75, v73, v67
    v_fma_f32 v67, v76, v74, v75
    v_cvt_pk_bf16_f32 v67, v67, v67
    v_lshlrev_b32 v67, 16, v67
    v_cvt_f16_f32 v67, v67
    v_lshlrev_b32 v68, 16, v26
    v_mul_f32 v75, 0x3b000000, v36
    v_mul_f32 v37, 0x3b000000, v37
    v_fma_f32 v37, -v75, v75, v37
    v_max_f32 v37, 0, v37
    v_cvt_pk_bf16_f32 v72, v75, v75
    v_lshlrev_b32 v72, 16, v72
    v_cvt_pk_bf16_f32 v37, v37, v37
    v_lshlrev_b32 v37, 16, v37
    v_add_f32 v37, 0x3727c5ac, v37
    v_cvt_pk_bf16_f32 v37, v37, v37
    v_lshlrev_b32 v37, 16, v37
    v_sqrt_f32 v37, v37
    s_nop 0
    v_cvt_pk_bf16_f32 v73, v37, v37
    v_lshlrev_b32 v73, 16, v73
    v_rcp_f32 v74, v73
    v_sub_f32 v68, v68, v72
    v_cvt_pk_bf16_f32 v68, v68, v68
    v_lshlrev_b32 v68, 16, v68
    v_mul_f32 v75, v68, v74
    v_fma_f32 v76, -v75, v73, v68
    v_fma_f32 v68, v76, v74, v75
    v_cvt_pk_bf16_f32 v68, v68, v68
    v_lshlrev_b32 v68, 16, v68
    v_cvt_f16_f32 v68, v68
    v_and_b32 v69, 0xffff0000, v26
    v_mul_f32 v75, 0x3b000000, v38
    v_mul_f32 v39, 0x3b000000, v39
    v_fma_f32 v39, -v75, v75, v39
    v_max_f32 v39, 0, v39
    v_cvt_pk_bf16_f32 v72, v75, v75
    v_lshlrev_b32 v72, 16, v72
    v_cvt_pk_bf16_f32 v39, v39, v39
    v_lshlrev_b32 v39, 16, v39
    v_add_f32 v39, 0x3727c5ac, v39
    v_cvt_pk_bf16_f32 v39, v39, v39
    v_lshlrev_b32 v39, 16, v39
    v_sqrt_f32 v39, v39
    s_nop 0
    v_cvt_pk_bf16_f32 v73, v39, v39
    v_lshlrev_b32 v73, 16, v73
    v_rcp_f32 v74, v73
    v_sub_f32 v69, v69, v72
    v_cvt_pk_bf16_f32 v69, v69, v69
    v_lshlrev_b32 v69, 16, v69
    v_mul_f32 v75, v69, v74
    v_fma_f32 v76, -v75, v73, v69
    v_fma_f32 v69, v76, v74, v75
    v_cvt_pk_bf16_f32 v69, v69, v69
    v_lshlrev_b32 v69, 16, v69
    v_cvt_f16_f32 v69, v69
    v_lshlrev_b32 v70, 16, v27
    v_mul_f32 v75, 0x3b000000, v40
    v_mul_f32 v41, 0x3b000000, v41
    v_fma_f32 v41, -v75, v75, v41
    v_max_f32 v41, 0, v41
    v_cvt_pk_bf16_f32 v72, v75, v75
    v_lshlrev_b32 v72, 16, v72
    v_cvt_pk_bf16_f32 v41, v41, v41
    v_lshlrev_b32 v41, 16, v41
    v_add_f32 v41, 0x3727c5ac, v41
    v_cvt_pk_bf16_f32 v41, v41, v41
    v_lshlrev_b32 v41, 16, v41
    v_sqrt_f32 v41, v41
    s_nop 0
    v_cvt_pk_bf16_f32 v73, v41, v41
    v_lshlrev_b32 v73, 16, v73
    v_rcp_f32 v74, v73
    v_sub_f32 v70, v70, v72
    v_cvt_pk_bf16_f32 v70, v70, v70
    v_lshlrev_b32 v70, 16, v70
    v_mul_f32 v75, v70, v74
    v_fma_f32 v76, -v75, v73, v70
    v_fma_f32 v70, v76, v74, v75
    v_cvt_pk_bf16_f32 v70, v70, v70
    v_lshlrev_b32 v70, 16, v70
    v_cvt_f16_f32 v70, v70
    v_and_b32 v71, 0xffff0000, v27
    v_mul_f32 v75, 0x3b000000, v42
    v_mul_f32 v43, 0x3b000000, v43
    v_fma_f32 v43, -v75, v75, v43
    v_max_f32 v43, 0, v43
    v_cvt_pk_bf16_f32 v72, v75, v75
    v_lshlrev_b32 v72, 16, v72
    v_cvt_pk_bf16_f32 v43, v43, v43
    v_lshlrev_b32 v43, 16, v43
    v_add_f32 v43, 0x3727c5ac, v43
    v_cvt_pk_bf16_f32 v43, v43, v43
    v_lshlrev_b32 v43, 16, v43
    v_sqrt_f32 v43, v43
    s_nop 0
    v_cvt_pk_bf16_f32 v73, v43, v43
    v_lshlrev_b32 v73, 16, v73
    v_rcp_f32 v74, v73
    v_sub_f32 v71, v71, v72
    v_cvt_pk_bf16_f32 v71, v71, v71
    v_lshlrev_b32 v71, 16, v71
    v_mul_f32 v75, v71, v74
    v_fma_f32 v76, -v75, v73, v71
    v_fma_f32 v71, v76, v74, v75
    v_cvt_pk_bf16_f32 v71, v71, v71
    v_lshlrev_b32 v71, 16, v71
    v_cvt_f16_f32 v71, v71
    v_pack_b32_f16 v80, v71, v70
    v_pack_b32_f16 v81, v69, v68
    v_pack_b32_f16 v82, v67, v66
    v_pack_b32_f16 v83, v65, v64
    v_lshlrev_b32 v7, 3, v0
    v_sub_u32 v7, 2040, v7
    v_lshrrev_b32 v84, 6, v7
    v_mul_u32_u24 v84, 144, v84
    v_and_b32 v7, 63, v7
    v_lshl_add_u32 v7, v7, 1, v84
    ds_write_b128 v7, v[80:83] offset:35328
    v_and_b32 v2, 31, v1
    v_lshrrev_b32 v3, 5, v1
    v_and_b32 v7, 7, v2
    v_mul_u32_u24 v90, 4416, v7
    v_lshrrev_b32 v7, 3, v2
    v_add_u32 v7, v7, v3
    v_lshl_add_u32 v90, v7, 4, v90
    v_lshl_add_u32 v90, v5, 10, v90
    v_sub_u32 v7, 31, v2
    v_lshl_add_u32 v7, v5, 3, v7
    v_mul_u32_u24 v91, 144, v7
    v_lshl_add_u32 v91, v3, 4, v91
    v_add_u32 v91, 35328, v91
    v_mov_b32 v128, 0
    v_mov_b32 v129, 0
    v_mov_b32 v130, 0
    v_mov_b32 v131, 0
    v_mov_b32 v132, 0
    v_mov_b32 v133, 0
    v_mov_b32 v134, 0
    v_mov_b32 v135, 0
    v_mov_b32 v136, 0
    v_mov_b32 v137, 0
    v_mov_b32 v138, 0
    v_mov_b32 v139, 0
    v_mov_b32 v140, 0
    v_mov_b32 v141, 0
    v_mov_b32 v142, 0
    v_mov_b32 v143, 0
    v_mov_b32 v144, 0
    v_mov_b32 v145, 0
    v_mov_b32 v146, 0
    v_mov_b32 v147, 0
    v_mov_b32 v148, 0
    v_mov_b32 v149, 0
    v_mov_b32 v150, 0
    v_mov_b32 v151, 0
    v_mov_b32 v152, 0
    v_mov_b32 v153, 0
    v_mov_b32 v154, 0
    v_mov_b32 v155, 0
    v_mov_b32 v156, 0
    v_mov_b32 v157, 0
    v_mov_b32 v158, 0
    v_mov_b32 v159, 0
    s_waitcnt lgkmcnt(0)
    s_barrier
    ds_read_b128 v[96:99], v90 offset:0
    ds_read_b128 v[100:103], v90 offset:32
    ds_read_b128 v[104:107], v90 offset:64
    ds_read_b128 v[112:115], v91 offset:0
    ds_read_b128 v[108:111], v90 offset:96
    ds_read_b128 v[116:119], v91 offset:32
    s_waitcnt lgkmcnt(2)
    v_mfma_f32_32x32x16_f16 v[128:143], v[96:99], v[112:115], v[128:143]
    v_mfma_f32_32x32x16_f16 v[144:159], v[104:107], v[112:115], v[144:159]
    ds_read_b128 v[96:99], v90 offset:128
    ds_read_b128 v[120:123], v91 offset:64
    s_waitcnt lgkmcnt(2)
    v_mfma_f32_32x32x16_f16 v[128:143], v[100:103], v[116:119], v[128:143]
    v_mfma_f32_32x32x16_f16 v[144:159], v[108:111], v[116:119], v[144:159]
    ds_read_b128 v[100:103], v90 offset:160
    ds_read_b128 v[112:115], v91 offset:96
    s_waitcnt lgkmcnt(2)
    v_mfma_f32_32x32x16_f16 v[128:143], v[104:107], v[120:123], v[128:143]
    v_mfma_f32_32x32x16_f16 v[144:159], v[96:99], v[120:123], v[144:159]
    ds_read_b128 v[104:107], v90 offset:192
    ds_read_b128 v[116:119], v91 offset:144
    s_waitcnt lgkmcnt(2)
    v_mfma_f32_32x32x16_f16 v[128:143], v[108:111], v[112:115], v[128:143]
    v_mfma_f32_32x32x16_f16 v[144:159], v[100:103], v[112:115], v[144:159]
    ds_read_b128 v[108:111], v90 offset:224
    ds_read_b128 v[120:123], v91 offset:176
    s_waitcnt lgkmcnt(2)
    v_mfma_f32_32x32x16_f16 v[128:143], v[96:99], v[116:119], v[128:143]
    v_mfma_f32_32x32x16_f16 v[144:159], v[104:107], v[116:119], v[144:159]
    ds_read_b128 v[96:99], v90 offset:256
    ds_read_b128 v[112:115], v91 offset:208
    s_waitcnt lgkmcnt(2)
    v_mfma_f32_32x32x16_f16 v[128:143], v[100:103], v[120:123], v[128:143]
    v_mfma_f32_32x32x16_f16 v[144:159], v[108:111], v[120:123], v[144:159]
    ds_read_b128 v[100:103], v90 offset:288
    ds_read_b128 v[116:119], v91 offset:240
    s_waitcnt lgkmcnt(2)
    v_mfma_f32_32x32x16_f16 v[128:143], v[104:107], v[112:115], v[128:143]
    v_mfma_f32_32x32x16_f16 v[144:159], v[96:99], v[112:115], v[144:159]
    ds_read_b128 v[104:107], v90 offset:320
    ds_read_b128 v[120:123], v91 offset:288
    s_waitcnt lgkmcnt(2)
    v_mfma_f32_32x32x16_f16 v[128:143], v[108:111], v[116:119], v[128:143]
    v_mfma_f32_32x32x16_f16 v[144:159], v[100:103], v[116:119], v[144:159]
    ds_read_b128 v[108:111], v90 offset:352
    ds_read_b128 v[112:115], v91 offset:320
    s_waitcnt lgkmcnt(2)
    v_mfma_f32_32x32x16_f16 v[128:143], v[96:99], v[120:123], v[128:143]
    v_mfma_f32_32x32x16_f16 v[144:159], v[104:107], v[120:123], v[144:159]
    ds_read_b128 v[96:99], v90 offset:384
    ds_read_b128 v[116:119], v91 offset:352
    s_waitcnt lgkmcnt(2)
    v_mfma_f32_32x32x16_f16 v[128:143], v[100:103], v[112:115], v[128:143]
    v_mfma_f32_32x32x16_f16 v[144:159], v[108:111], v[112:115], v[144:159]
    ds_read_b128 v[100:103], v90 offset:416
    ds_read_b128 v[120:123], v91 offset:384
    s_waitcnt lgkmcnt(2)
    v_mfma_f32_32x32x16_f16 v[128:143], v[104:107], v[116:119], v[128:143]
    v_mfma_f32_32x32x16_f16 v[144:159], v[96:99], v[116:119], v[144:159]
    ds_read_b128 v[104:107], v90 offset:448
    ds_read_b128 v[112:115], v91 offset:432
    s_waitcnt lgkmcnt(2)
    v_mfma_f32_32x32x16_f16 v[128:143], v[108:111], v[120:123], v[128:143]
    v_mfma_f32_32x32x16_f16 v[144:159], v[100:103], v[120:123], v[144:159]
    ds_read_b128 v[108:111], v90 offset:480
    ds_read_b128 v[116:119], v91 offset:464
    s_waitcnt lgkmcnt(2)
    v_mfma_f32_32x32x16_f16 v[128:143], v[96:99], v[112:115], v[128:143]
    v_mfma_f32_32x32x16_f16 v[144:159], v[104:107], v[112:115], v[144:159]
    ds_read_b128 v[96:99], v90 offset:512
    ds_read_b128 v[120:123], v91 offset:496
    s_waitcnt lgkmcnt(2)
    v_mfma_f32_32x32x16_f16 v[128:143], v[100:103], v[116:119], v[128:143]
    v_mfma_f32_32x32x16_f16 v[144:159], v[108:111], v[116:119], v[144:159]
    ds_read_b128 v[100:103], v90 offset:544
    ds_read_b128 v[112:115], v91 offset:528
    s_waitcnt lgkmcnt(2)
    v_mfma_f32_32x32x16_f16 v[128:143], v[104:107], v[120:123], v[128:143]
    v_mfma_f32_32x32x16_f16 v[144:159], v[96:99], v[120:123], v[144:159]
    ds_read_b128 v[104:107], v90 offset:576
    ds_read_b128 v[116:119], v91 offset:576
    s_waitcnt lgkmcnt(2)
    v_mfma_f32_32x32x16_f16 v[128:143], v[108:111], v[112:115], v[128:143]
    v_mfma_f32_32x32x16_f16 v[144:159], v[100:103], v[112:115], v[144:159]
    ds_read_b128 v[108:111], v90 offset:608
    ds_read_b128 v[120:123], v91 offset:608
    s_waitcnt lgkmcnt(2)
    v_mfma_f32_32x32x16_f16 v[128:143], v[96:99], v[116:119], v[128:143]
    v_mfma_f32_32x32x16_f16 v[144:159], v[104:107], v[116:119], v[144:159]
    ds_read_b128 v[96:99], v90 offset:640
    ds_read_b128 v[112:115], v91 offset:640
    s_waitcnt lgkmcnt(2)
    v_mfma_f32_32x32x16_f16 v[128:143], v[100:103], v[120:123], v[128:143]
    v_mfma_f32_32x32x16_f16 v[144:159], v[108:111], v[120:123], v[144:159]
    ds_read_b128 v[100:103], v90 offset:672
    ds_read_b128 v[116:119], v91 offset:672
    s_waitcnt lgkmcnt(2)
    v_mfma_f32_32x32x16_f16 v[128:143], v[104:107], v[112:115], v[128:143]
    v_mfma_f32_32x32x16_f16 v[144:159], v[96:99], v[112:115], v[144:159]
    ds_read_b128 v[104:107], v90 offset:704
    ds_read_b128 v[120:123], v91 offset:720
    s_waitcnt lgkmcnt(2)
    v_mfma_f32_32x32x16_f16 v[128:143], v[108:111], v[116:119], v[128:143]
    v_mfma_f32_32x32x16_f16 v[144:159], v[100:103], v[116:119], v[144:159]
    ds_read_b128 v[108:111], v90 offset:736
    ds_read_b128 v[112:115], v91 offset:752
    s_waitcnt lgkmcnt(2)
    v_mfma_f32_32x32x16_f16 v[128:143], v[96:99], v[120:123], v[128:143]
    v_mfma_f32_32x32x16_f16 v[144:159], v[104:107], v[120:123], v[144:159]
    ds_read_b128 v[96:99], v90 offset:768
    ds_read_b128 v[116:119], v91 offset:784
    s_waitcnt lgkmcnt(2)
    v_mfma_f32_32x32x16_f16 v[128:143], v[100:103], v[112:115], v[128:143]
    v_mfma_f32_32x32x16_f16 v[144:159], v[108:111], v[112:115], v[144:159]
    ds_read_b128 v[100:103], v90 offset:800
    ds_read_b128 v[120:123], v91 offset:816
    s_waitcnt lgkmcnt(2)
    v_mfma_f32_32x32x16_f16 v[128:143], v[104:107], v[116:119], v[128:143]
    v_mfma_f32_32x32x16_f16 v[144:159], v[96:99], v[116:119], v[144:159]
    ds_read_b128 v[104:107], v90 offset:832
    ds_read_b128 v[112:115], v91 offset:864
    s_waitcnt lgkmcnt(2)
    v_mfma_f32_32x32x16_f16 v[128:143], v[108:111], v[120:123], v[128:143]
    v_mfma_f32_32x32x16_f16 v[144:159], v[100:103], v[120:123], v[144:159]
    ds_read_b128 v[108:111], v90 offset:864
    ds_read_b128 v[116:119], v91 offset:896
    s_waitcnt lgkmcnt(2)
    v_mfma_f32_32x32x16_f16 v[128:143], v[96:99], v[112:115], v[128:143]
    v_mfma_f32_32x32x16_f16 v[144:159], v[104:107], v[112:115], v[144:159]
    ds_read_b128 v[96:99], v90 offset:896
    ds_read_b128 v[120:123], v91 offset:928
    s_waitcnt lgkmcnt(2)
    v_mfma_f32_32x32x16_f16 v[128:143], v[100:103], v[116:119], v[128:143]
    v_mfma_f32_32x32x16_f16 v[144:159], v[108:111], v[116:119], v[144:159]
    ds_read_b128 v[100:103], v90 offset:928
    ds_read_b128 v[112:115], v91 offset:960
    s_waitcnt lgkmcnt(2)
    v_mfma_f32_32x32x16_f16 v[128:143], v[104:107], v[120:123], v[128:143]
    v_mfma_f32_32x32x16_f16 v[144:159], v[96:99], v[120:123], v[144:159]
    ds_read_b128 v[104:107], v90 offset:960
    ds_read_b128 v[116:119], v91 offset:1008
    s_waitcnt lgkmcnt(2)
    v_mfma_f32_32x32x16_f16 v[128:143], v[108:111], v[112:115], v[128:143]
    v_mfma_f32_32x32x16_f16 v[144:159], v[100:103], v[112:115], v[144:159]
    ds_read_b128 v[108:111], v90 offset:992
    ds_read_b128 v[120:123], v91 offset:1040
    s_waitcnt lgkmcnt(2)
    v_mfma_f32_32x32x16_f16 v[128:143], v[96:99], v[116:119], v[128:143]
    v_mfma_f32_32x32x16_f16 v[144:159], v[104:107], v[116:119], v[144:159]
    ds_read_b128 v[96:99], v90 offset:1024
    ds_read_b128 v[112:115], v91 offset:1072
    s_waitcnt lgkmcnt(2)
    v_mfma_f32_32x32x16_f16 v[128:143], v[100:103], v[120:123], v[128:143]
    v_mfma_f32_32x32x16_f16 v[144:159], v[108:111], v[120:123], v[144:159]
    ds_read_b128 v[100:103], v90 offset:1056
    ds_read_b128 v[116:119], v91 offset:1104
    s_waitcnt lgkmcnt(2)
    v_mfma_f32_32x32x16_f16 v[128:143], v[104:107], v[112:115], v[128:143]
    v_mfma_f32_32x32x16_f16 v[144:159], v[96:99], v[112:115], v[144:159]
    s_waitcnt lgkmcnt(0)
    v_mfma_f32_32x32x16_f16 v[128:143], v[108:111], v[116:119], v[128:143]
    v_mfma_f32_32x32x16_f16 v[144:159], v[100:103], v[116:119], v[144:159]
    s_barrier
    v_lshlrev_b32 v7, 13, v5
    v_lshl_add_u32 v7, v1, 4, v7
    s_nop 7
    ds_write_b128 v7, v[128:131] offset:0
    ds_write_b128 v7, v[132:135] offset:1024
    ds_write_b128 v7, v[136:139] offset:2048
    ds_write_b128 v7, v[140:143] offset:3072
    ds_write_b128 v7, v[144:147] offset:4096
    ds_write_b128 v7, v[148:151] offset:5120
    ds_write_b128 v7, v[152:155] offset:6144
    ds_write_b128 v7, v[156:159] offset:7168
    s_waitcnt lgkmcnt(0)
    s_barrier
    v_lshlrev_b32 v7, 11, v5
    v_lshl_add_u32 v7, v1, 4, v7
    ds_read_b128 v[8:11], v7 offset:0
    ds_read_b128 v[12:15], v7 offset:8192
    ds_read_b128 v[16:19], v7 offset:16384
    ds_read_b128 v[20:23], v7 offset:24576
    ds_read_b128 v[24:27], v7 offset:1024
    ds_read_b128 v[28:31], v7 offset:9216
    ds_read_b128 v[32:35], v7 offset:17408
    ds_read_b128 v[36:39], v7 offset:25600
    s_waitcnt lgkmcnt(0)
    v_add_f32 v8, v8, v12
    v_add_f32 v16, v16, v20
    v_add_f32 v8, v8, v16
    v_mul_f32 v8, s62, v8
    v_add_f32 v9, v9, v13
    v_add_f32 v17, v17, v21
    v_add_f32 v9, v9, v17
    v_mul_f32 v9, s62, v9
    v_add_f32 v10, v10, v14
    v_add_f32 v18, v18, v22
    v_add_f32 v10, v10, v18
    v_mul_f32 v10, s62, v10
    v_add_f32 v11, v11, v15
    v_add_f32 v19, v19, v23
    v_add_f32 v11, v11, v19
    v_mul_f32 v11, s62, v11
    v_cvt_pk_bf16_f32 v44, v8, v9
    v_cvt_pk_bf16_f32 v45, v10, v11
    v_add_f32 v24, v24, v28
    v_add_f32 v32, v32, v36
    v_add_f32 v24, v24, v32
    v_mul_f32 v24, s62, v24
    v_add_f32 v25, v25, v29
    v_add_f32 v33, v33, v37
    v_add_f32 v25, v25, v33
    v_mul_f32 v25, s62, v25
    v_add_f32 v26, v26, v30
    v_add_f32 v34, v34, v38
    v_add_f32 v26, v26, v34
    v_mul_f32 v26, s62, v26
    v_add_f32 v27, v27, v31
    v_add_f32 v35, v35, v39
    v_add_f32 v27, v27, v35
    v_mul_f32 v27, s62, v27
    v_cvt_pk_bf16_f32 v46, v24, v25
    v_cvt_pk_bf16_f32 v47, v26, v27
    v_lshlrev_b32 v7, 3, v2
    v_lshl_add_u32 v7, v5, 1, v7
    v_lshlrev_b32 v7, 13, v7
    v_lshl_add_u32 v7, v3, 3, v7
    s_lshl_b32 s42, s2, 4
    buffer_store_dwordx2 v[44:45], v7, s[56:59], s42 offen
    v_add_u32 v7, 8192, v7
    buffer_store_dwordx2 v[46:47], v7, s[56:59], s42 offen
conv1_kernel_done:
    s_endpgm
.section .rodata,"a"
.p2align 6
.amdhsa_kernel conv1_kernel
  .amdhsa_next_free_vgpr 160
  .amdhsa_next_free_sgpr 102
  .amdhsa_accum_offset 160
  .amdhsa_group_segment_fixed_size 0
  .amdhsa_kernarg_size 112
  .amdhsa_user_sgpr_count 2
  .amdhsa_user_sgpr_kernarg_segment_ptr 1
  .amdhsa_system_sgpr_workgroup_id_x 1
.end_amdhsa_kernel

.text
.globl conv2_kernel
.p2align 8
.type conv2_kernel,@function
conv2_kernel:
    s_cmp_ge_u32 s2, 512
    s_cbranch_scc1 conv2_kernel_done
    s_load_dwordx16 s[4:19], s[0:1], 0
    s_load_dwordx8 s[20:27], s[0:1], 64
    s_load_dwordx4 s[28:31], s[0:1], 96
    v_and_b32 v1, 63, v0
    v_lshrrev_b32 v5, 6, v0
    s_waitcnt lgkmcnt(0)
    s_mov_b32 s44, s30
    s_mov_b32 s45, s31
    s_mov_b32 s46, 0x240000
    s_mov_b32 s47, 0x20000
    s_add_u32 s48, s30, 0x250000
    s_addc_u32 s49, s31, 0
    s_mov_b32 s50, 0x200000
    s_mov_b32 s51, 0x20000
    s_add_u32 s52, s30, 0x245000
    s_addc_u32 s53, s31, 0
    s_mov_b32 s54, 0x4000
    s_mov_b32 s55, 0x20000
    s_add_u32 s56, s30, 0x450000
    s_addc_u32 s57, s31, 0
    s_mov_b32 s58, 0x200000
    s_mov_b32 s59, 0x20000
    s_mul_i32 s40, s2, 4608
    s_lshl_b32 s41, s2, 12
    v_lshlrev_b32 v6, 4, v0
    buffer_load_dwordx4 v[8:11], v6, s[44:47], s40 offen
    buffer_load_dwordx4 v[12:15], v6, s[44:47], s40 offen offset:16
    v_add_u32 v7, 16, v6
    buffer_load_dwordx4 v[16:19], v7, s[44:47], s40 offen offset:4080
    v_add_u32 v7, 32, v6
    buffer_load_dwordx4 v[20:23], v7, s[44:47], s40 offen offset:4080
    buffer_load_dwordx4 v[24:27], v6, s[48:51], s41 offen
    v_lshlrev_b32 v7, 6, v0
    buffer_load_dwordx4 v[28:31], v7, s[52:55], 0 offen
    buffer_load_dwordx4 v[32:35], v7, s[52:55], 0 offen offset:16
    buffer_load_dwordx4 v[36:39], v7, s[52:55], 0 offen offset:32
    buffer_load_dwordx4 v[40:43], v7, s[52:55], 0 offen offset:48
    s_add_u32 s60, s30, 2359296
    s_addc_u32 s61, s31, 0
    s_lshl_b32 s42, s2, 2
    s_load_dword s62, s[60:61], s42
    v_mov_b32 v44, 0
    v_mov_b32 v45, 0
    v_mov_b32 v46, 0
    v_mov_b32 v47, 0
    ds_write_b128 v6, v[44:47] offset:39936
    v_cmp_gt_u32 vcc, 32, v0
    s_nop 1
    s_and_saveexec_b64 s[64:65], vcc
    ds_write_b128 v6, v[44:47] offset:44032
    s_mov_b64 exec, s[64:65]
    s_waitcnt vmcnt(7)
    v_alignbit_b32 v48, v9, v8, 16
    v_alignbit_b32 v49, v10, v9, 16
    v_alignbit_b32 v50, v11, v10, 16
    v_alignbit_b32 v51, v12, v11, 16
    v_alignbit_b32 v52, v13, v12, 16
    v_alignbit_b32 v53, v14, v13, 16
    v_alignbit_b32 v54, v15, v14, 16
    ds_write_b128 v6, v[48:51] offset:0
    v_mov_b32 v56, v9
    v_mov_b32 v57, v10
    v_mov_b32 v58, v11
    v_mov_b32 v59, v12
    ds_write_b128 v6, v[56:59] offset:4416
    v_mov_b32 v60, v49
    v_mov_b32 v61, v50
    v_mov_b32 v62, v51
    v_mov_b32 v63, v52
    ds_write_b128 v6, v[60:63] offset:8832
    ds_write_b128 v6, v[10:13] offset:13248
    ds_write_b128 v6, v[50:53] offset:17664
    v_mov_b32 v56, v11
    v_mov_b32 v57, v12
    v_mov_b32 v58, v13
    v_mov_b32 v59, v14
    ds_write_b128 v6, v[56:59] offset:22080
    v_mov_b32 v60, v51
    v_mov_b32 v61, v52
    v_mov_b32 v62, v53
    v_mov_b32 v63, v54
    ds_write_b128 v6, v[60:63] offset:26496
    ds_write_b128 v6, v[12:15] offset:30912
    s_waitcnt vmcnt(5)
    v_cmp_gt_u32 vcc, 8, v0
    s_nop 1
    s_and_saveexec_b64 s[64:65], vcc
    s_cbranch_execz conv2_kernel_c2
    v_alignbit_b32 v48, v17, v16, 16
    v_alignbit_b32 v49, v18, v17, 16
    v_alignbit_b32 v50, v19, v18, 16
    v_alignbit_b32 v51, v20, v19, 16
    v_alignbit_b32 v52, v21, v20, 16
    v_alignbit_b32 v53, v22, v21, 16
    v_alignbit_b32 v54, v23, v22, 16
    ds_write_b128 v6, v[48:51] offset:4096
    v_mov_b32 v56, v17
    v_mov_b32 v57, v18
    v_mov_b32 v58, v19
    v_mov_b32 v59, v20
    ds_write_b128 v6, v[56:59] offset:8512
    v_mov_b32 v60, v49
    v_mov_b32 v61, v50
    v_mov_b32 v62, v51
    v_mov_b32 v63, v52
    ds_write_b128 v6, v[60:63] offset:12928
    ds_write_b128 v6, v[18:21] offset:17344
    ds_write_b128 v6, v[50:53] offset:21760
    v_mov_b32 v56, v19
    v_mov_b32 v57, v20
    v_mov_b32 v58, v21
    v_mov_b32 v59, v22
    ds_write_b128 v6, v[56:59] offset:26176
    v_mov_b32 v60, v51
    v_mov_b32 v61, v52
    v_mov_b32 v62, v53
    v_mov_b32 v63, v54
    ds_write_b128 v6, v[60:63] offset:30592
    ds_write_b128 v6, v[20:23] offset:35008
conv2_kernel_c2:
    s_mov_b64 exec, s[64:65]
    s_waitcnt vmcnt(0)
    v_lshlrev_b32 v64, 16, v24
    v_mul_f32 v75, 0x3b000000, v28
    v_mul_f32 v29, 0x3b000000, v29
    v_fma_f32 v29, -v75, v75, v29
    v_max_f32 v29, 0, v29
    v_cvt_pk_bf16_f32 v72, v75, v75
    v_lshlrev_b32 v72, 16, v72
    v_cvt_pk_bf16_f32 v29, v29, v29
    v_lshlrev_b32 v29, 16, v29
    v_add_f32 v29, 0x3727c5ac, v29
    v_cvt_pk_bf16_f32 v29, v29, v29
    v_lshlrev_b32 v29, 16, v29
    v_sqrt_f32 v29, v29
    s_nop 0
    v_cvt_pk_bf16_f32 v73, v29, v29
    v_lshlrev_b32 v73, 16, v73
    v_rcp_f32 v74, v73
    v_sub_f32 v64, v64, v72
    v_cvt_pk_bf16_f32 v64, v64, v64
    v_lshlrev_b32 v64, 16, v64
    v_mul_f32 v75, v64, v74
    v_fma_f32 v76, -v75, v73, v64
    v_fma_f32 v64, v76, v74, v75
    v_cvt_pk_bf16_f32 v64, v64, v64
    v_lshlrev_b32 v64, 16, v64
    v_cvt_f16_f32 v64, v64
    v_and_b32 v65, 0xffff0000, v24
    v_mul_f32 v75, 0x3b000000, v30
    v_mul_f32 v31, 0x3b000000, v31
    v_fma_f32 v31, -v75, v75, v31
    v_max_f32 v31, 0, v31
    v_cvt_pk_bf16_f32 v72, v75, v75
    v_lshlrev_b32 v72, 16, v72
    v_cvt_pk_bf16_f32 v31, v31, v31
    v_lshlrev_b32 v31, 16, v31
    v_add_f32 v31, 0x3727c5ac, v31
    v_cvt_pk_bf16_f32 v31, v31, v31
    v_lshlrev_b32 v31, 16, v31
    v_sqrt_f32 v31, v31
    s_nop 0
    v_cvt_pk_bf16_f32 v73, v31, v31
    v_lshlrev_b32 v73, 16, v73
    v_rcp_f32 v74, v73
    v_sub_f32 v65, v65, v72
    v_cvt_pk_bf16_f32 v65, v65, v65
    v_lshlrev_b32 v65, 16, v65
    v_mul_f32 v75, v65, v74
    v_fma_f32 v76, -v75, v73, v65
    v_fma_f32 v65, v76, v74, v75
    v_cvt_pk_bf16_f32 v65, v65, v65
    v_lshlrev_b32 v65, 16, v65
    v_cvt_f16_f32 v65, v65
    v_lshlrev_b32 v66, 16, v25
    v_mul_f32 v75, 0x3b000000, v32
    v_mul_f32 v33, 0x3b000000, v33
    v_fma_f32 v33, -v75, v75, v33
    v_max_f32 v33, 0, v33
    v_cvt_pk_bf16_f32 v72, v75, v75
    v_lshlrev_b32 v72, 16, v72
    v_cvt_pk_bf16_f32 v33, v33, v33
    v_lshlrev_b32 v33, 16, v33
    v_add_f32 v33, 0x3727c5ac, v33
    v_cvt_pk_bf16_f32 v33, v33, v33
    v_lshlrev_b32 v33, 16, v33
    v_sqrt_f32 v33, v33
    s_nop 0
    v_cvt_pk_bf16_f32 v73, v33, v33
    v_lshlrev_b32 v73, 16, v73
    v_rcp_f32 v74, v73
    v_sub_f32 v66, v66, v72
    v_cvt_pk_bf16_f32 v66, v66, v66
    v_lshlrev_b32 v66, 16, v66
    v_mul_f32 v75, v66, v74
    v_fma_f32 v76, -v75, v73, v66
    v_fma_f32 v66, v76, v74, v75
    v_cvt_pk_bf16_f32 v66, v66, v66
    v_lshlrev_b32 v66, 16, v66
    v_cvt_f16_f32 v66, v66
    v_and_b32 v67, 0xffff0000, v25
    v_mul_f32 v75, 0x3b000000, v34
    v_mul_f32 v35, 0x3b000000, v35
    v_fma_f32 v35, -v75, v75, v35
    v_max_f32 v35, 0, v35
    v_cvt_pk_bf16_f32 v72, v75, v75
    v_lshlrev_b32 v72, 16, v72
    v_cvt_pk_bf16_f32 v35, v35, v35
    v_lshlrev_b32 v35, 16, v35
    v_add_f32 v35, 0x3727c5ac, v35
    v_cvt_pk_bf16_f32 v35, v35, v35
    v_lshlrev_b32 v35, 16, v35
    v_sqrt_f32 v35, v35
    s_nop 0
    v_cvt_pk_bf16_f32 v73, v35, v35
    v_lshlrev_b32 v73, 16, v73
    v_rcp_f32 v74, v73
    v_sub_f32 v67, v67, v72
    v_cvt_pk_bf16_f32 v67, v67, v67
    v_lshlrev_b32 v67, 16, v67
    v_mul_f32 v75, v67, v74
    v_fma_f32 v76, -v75, v73, v67
    v_fma_f32 v67, v76, v74, v75
    v_cvt_pk_bf16_f32 v67, v67, v67
    v_lshlrev_b32 v67, 16, v67
    v_cvt_f16_f32 v67, v67
    v_lshlrev_b32 v68, 16, v26
    v_mul_f32 v75, 0x3b000000, v36
    v_mul_f32 v37, 0x3b000000, v37
    v_fma_f32 v37, -v75, v75, v37
    v_max_f32 v37, 0, v37
    v_cvt_pk_bf16_f32 v72, v75, v75
    v_lshlrev_b32 v72, 16, v72
    v_cvt_pk_bf16_f32 v37, v37, v37
    v_lshlrev_b32 v37, 16, v37
    v_add_f32 v37, 0x3727c5ac, v37
    v_cvt_pk_bf16_f32 v37, v37, v37
    v_lshlrev_b32 v37, 16, v37
    v_sqrt_f32 v37, v37
    s_nop 0
    v_cvt_pk_bf16_f32 v73, v37, v37
    v_lshlrev_b32 v73, 16, v73
    v_rcp_f32 v74, v73
    v_sub_f32 v68, v68, v72
    v_cvt_pk_bf16_f32 v68, v68, v68
    v_lshlrev_b32 v68, 16, v68
    v_mul_f32 v75, v68, v74
    v_fma_f32 v76, -v75, v73, v68
    v_fma_f32 v68, v76, v74, v75
    v_cvt_pk_bf16_f32 v68, v68, v68
    v_lshlrev_b32 v68, 16, v68
    v_cvt_f16_f32 v68, v68
    v_and_b32 v69, 0xffff0000, v26
    v_mul_f32 v75, 0x3b000000, v38
    v_mul_f32 v39, 0x3b000000, v39
    v_fma_f32 v39, -v75, v75, v39
    v_max_f32 v39, 0, v39
    v_cvt_pk_bf16_f32 v72, v75, v75
    v_lshlrev_b32 v72, 16, v72
    v_cvt_pk_bf16_f32 v39, v39, v39
    v_lshlrev_b32 v39, 16, v39
    v_add_f32 v39, 0x3727c5ac, v39
    v_cvt_pk_bf16_f32 v39, v39, v39
    v_lshlrev_b32 v39, 16, v39
    v_sqrt_f32 v39, v39
    s_nop 0
    v_cvt_pk_bf16_f32 v73, v39, v39
    v_lshlrev_b32 v73, 16, v73
    v_rcp_f32 v74, v73
    v_sub_f32 v69, v69, v72
    v_cvt_pk_bf16_f32 v69, v69, v69
    v_lshlrev_b32 v69, 16, v69
    v_mul_f32 v75, v69, v74
    v_fma_f32 v76, -v75, v73, v69
    v_fma_f32 v69, v76, v74, v75
    v_cvt_pk_bf16_f32 v69, v69, v69
    v_lshlrev_b32 v69, 16, v69
    v_cvt_f16_f32 v69, v69
    v_lshlrev_b32 v70, 16, v27
    v_mul_f32 v75, 0x3b000000, v40
    v_mul_f32 v41, 0x3b000000, v41
    v_fma_f32 v41, -v75, v75, v41
    v_max_f32 v41, 0, v41
    v_cvt_pk_bf16_f32 v72, v75, v75
    v_lshlrev_b32 v72, 16, v72
    v_cvt_pk_bf16_f32 v41, v41, v41
    v_lshlrev_b32 v41, 16, v41
    v_add_f32 v41, 0x3727c5ac, v41
    v_cvt_pk_bf16_f32 v41, v41, v41
    v_lshlrev_b32 v41, 16, v41
    v_sqrt_f32 v41, v41
    s_nop 0
    v_cvt_pk_bf16_f32 v73, v41, v41
    v_lshlrev_b32 v73, 16, v73
    v_rcp_f32 v74, v73
    v_sub_f32 v70, v70, v72
    v_cvt_pk_bf16_f32 v70, v70, v70
    v_lshlrev_b32 v70, 16, v70
    v_mul_f32 v75, v70, v74
    v_fma_f32 v76, -v75, v73, v70
    v_fma_f32 v70, v76, v74, v75
    v_cvt_pk_bf16_f32 v70, v70, v70
    v_lshlrev_b32 v70, 16, v70
    v_cvt_f16_f32 v70, v70
    v_and_b32 v71, 0xffff0000, v27
    v_mul_f32 v75, 0x3b000000, v42
    v_mul_f32 v43, 0x3b000000, v43
    v_fma_f32 v43, -v75, v75, v43
    v_max_f32 v43, 0, v43
    v_cvt_pk_bf16_f32 v72, v75, v75
    v_lshlrev_b32 v72, 16, v72
    v_cvt_pk_bf16_f32 v43, v43, v43
    v_lshlrev_b32 v43, 16, v43
    v_add_f32 v43, 0x3727c5ac, v43
    v_cvt_pk_bf16_f32 v43, v43, v43
    v_lshlrev_b32 v43, 16, v43
    v_sqrt_f32 v43, v43
    s_nop 0
    v_cvt_pk_bf16_f32 v73, v43, v43
    v_lshlrev_b32 v73, 16, v73
    v_rcp_f32 v74, v73
    v_sub_f32 v71, v71, v72
    v_cvt_pk_bf16_f32 v71, v71, v71
    v_lshlrev_b32 v71, 16, v71
    v_mul_f32 v75, v71, v74
    v_fma_f32 v76, -v75, v73, v71
    v_fma_f32 v71, v76, v74, v75
    v_cvt_pk_bf16_f32 v71, v71, v71
    v_lshlrev_b32 v71, 16, v71
    v_cvt_f16_f32 v71, v71
    v_pack_b32_f16 v80, v71, v70
    v_pack_b32_f16 v81, v69, v68
    v_pack_b32_f16 v82, v67, v66
    v_pack_b32_f16 v83, v65, v64
    v_lshlrev_b32 v7, 3, v0
    v_sub_u32 v7, 2040, v7
    v_lshrrev_b32 v84, 6, v7
    v_mul_u32_u24 v84, 144, v84
    v_and_b32 v7, 63, v7
    v_lshl_add_u32 v7, v7, 1, v84
    ds_write_b128 v7, v[80:83] offset:35328
    v_and_b32 v2, 31, v1
    v_lshrrev_b32 v3, 5, v1
    v_and_b32 v7, 7, v2
    v_mul_u32_u24 v90, 4416, v7
    v_lshrrev_b32 v7, 3, v2
    v_add_u32 v7, v7, v3
    v_lshl_add_u32 v90, v7, 4, v90
    v_lshl_add_u32 v90, v5, 10, v90
    v_sub_u32 v7, 31, v2
    v_lshl_add_u32 v7, v5, 3, v7
    v_mul_u32_u24 v91, 144, v7
    v_lshl_add_u32 v91, v3, 4, v91
    v_add_u32 v91, 35328, v91
    v_mov_b32 v128, 0
    v_mov_b32 v129, 0
    v_mov_b32 v130, 0
    v_mov_b32 v131, 0
    v_mov_b32 v132, 0
    v_mov_b32 v133, 0
    v_mov_b32 v134, 0
    v_mov_b32 v135, 0
    v_mov_b32 v136, 0
    v_mov_b32 v137, 0
    v_mov_b32 v138, 0
    v_mov_b32 v139, 0
    v_mov_b32 v140, 0
    v_mov_b32 v141, 0
    v_mov_b32 v142, 0
    v_mov_b32 v143, 0
    v_mov_b32 v144, 0
    v_mov_b32 v145, 0
    v_mov_b32 v146, 0
    v_mov_b32 v147, 0
    v_mov_b32 v148, 0
    v_mov_b32 v149, 0
    v_mov_b32 v150, 0
    v_mov_b32 v151, 0
    v_mov_b32 v152, 0
    v_mov_b32 v153, 0
    v_mov_b32 v154, 0
    v_mov_b32 v155, 0
    v_mov_b32 v156, 0
    v_mov_b32 v157, 0
    v_mov_b32 v158, 0
    v_mov_b32 v159, 0
    s_waitcnt lgkmcnt(0)
    s_barrier
    ds_read_b128 v[96:99], v90 offset:0
    ds_read_b128 v[100:103], v90 offset:32
    ds_read_b128 v[104:107], v90 offset:64
    ds_read_b128 v[112:115], v91 offset:0
    ds_read_b128 v[108:111], v90 offset:96
    ds_read_b128 v[116:119], v91 offset:32
    s_waitcnt lgkmcnt(2)
    v_mfma_f32_32x32x16_f16 v[128:143], v[96:99], v[112:115], v[128:143]
    v_mfma_f32_32x32x16_f16 v[144:159], v[104:107], v[112:115], v[144:159]
    ds_read_b128 v[96:99], v90 offset:128
    ds_read_b128 v[120:123], v91 offset:64
    s_waitcnt lgkmcnt(2)
    v_mfma_f32_32x32x16_f16 v[128:143], v[100:103], v[116:119], v[128:143]
    v_mfma_f32_32x32x16_f16 v[144:159], v[108:111], v[116:119], v[144:159]
    ds_read_b128 v[100:103], v90 offset:160
    ds_read_b128 v[112:115], v91 offset:96
    s_waitcnt lgkmcnt(2)
    v_mfma_f32_32x32x16_f16 v[128:143], v[104:107], v[120:123], v[128:143]
    v_mfma_f32_32x32x16_f16 v[144:159], v[96:99], v[120:123], v[144:159]
    ds_read_b128 v[104:107], v90 offset:192
    ds_read_b128 v[116:119], v91 offset:144
    s_waitcnt lgkmcnt(2)
    v_mfma_f32_32x32x16_f16 v[128:143], v[108:111], v[112:115], v[128:143]
    v_mfma_f32_32x32x16_f16 v[144:159], v[100:103], v[112:115], v[144:159]
    ds_read_b128 v[108:111], v90 offset:224
    ds_read_b128 v[120:123], v91 offset:176
    s_waitcnt lgkmcnt(2)
    v_mfma_f32_32x32x16_f16 v[128:143], v[96:99], v[116:119], v[128:143]
    v_mfma_f32_32x32x16_f16 v[144:159], v[104:107], v[116:119], v[144:159]
    ds_read_b128 v[96:99], v90 offset:256
    ds_read_b128 v[112:115], v91 offset:208
    s_waitcnt lgkmcnt(2)
    v_mfma_f32_32x32x16_f16 v[128:143], v[100:103], v[120:123], v[128:143]
    v_mfma_f32_32x32x16_f16 v[144:159], v[108:111], v[120:123], v[144:159]
    ds_read_b128 v[100:103], v90 offset:288
    ds_read_b128 v[116:119], v91 offset:240
    s_waitcnt lgkmcnt(2)
    v_mfma_f32_32x32x16_f16 v[128:143], v[104:107], v[112:115], v[128:143]
    v_mfma_f32_32x32x16_f16 v[144:159], v[96:99], v[112:115], v[144:159]
    ds_read_b128 v[104:107], v90 offset:320
    ds_read_b128 v[120:123], v91 offset:288
    s_waitcnt lgkmcnt(2)
    v_mfma_f32_32x32x16_f16 v[128:143], v[108:111], v[116:119], v[128:143]
    v_mfma_f32_32x32x16_f16 v[144:159], v[100:103], v[116:119], v[144:159]
    ds_read_b128 v[108:111], v90 offset:352
    ds_read_b128 v[112:115], v91 offset:320
    s_waitcnt lgkmcnt(2)
    v_mfma_f32_32x32x16_f16 v[128:143], v[96:99], v[120:123], v[128:143]
    v_mfma_f32_32x32x16_f16 v[144:159], v[104:107], v[120:123], v[144:159]
    ds_read_b128 v[96:99], v90 offset:384
    ds_read_b128 v[116:119], v91 offset:352
    s_waitcnt lgkmcnt(2)
    v_mfma_f32_32x32x16_f16 v[128:143], v[100:103], v[112:115], v[128:143]
    v_mfma_f32_32x32x16_f16 v[144:159], v[108:111], v[112:115], v[144:159]
    ds_read_b128 v[100:103], v90 offset:416
    ds_read_b128 v[120:123], v91 offset:384
    s_waitcnt lgkmcnt(2)
    v_mfma_f32_32x32x16_f16 v[128:143], v[104:107], v[116:119], v[128:143]
    v_mfma_f32_32x32x16_f16 v[144:159], v[96:99], v[116:119], v[144:159]
    ds_read_b128 v[104:107], v90 offset:448
    ds_read_b128 v[112:115], v91 offset:432
    s_waitcnt lgkmcnt(2)
    v_mfma_f32_32x32x16_f16 v[128:143], v[108:111], v[120:123], v[128:143]
    v_mfma_f32_32x32x16_f16 v[144:159], v[100:103], v[120:123], v[144:159]
    ds_read_b128 v[108:111], v90 offset:480
    ds_read_b128 v[116:119], v91 offset:464
    s_waitcnt lgkmcnt(2)
    v_mfma_f32_32x32x16_f16 v[128:143], v[96:99], v[112:115], v[128:143]
    v_mfma_f32_32x32x16_f16 v[144:159], v[104:107], v[112:115], v[144:159]
    ds_read_b128 v[96:99], v90 offset:512
    ds_read_b128 v[120:123], v91 offset:496
    s_waitcnt lgkmcnt(2)
    v_mfma_f32_32x32x16_f16 v[128:143], v[100:103], v[116:119], v[128:143]
    v_mfma_f32_32x32x16_f16 v[144:159], v[108:111], v[116:119], v[144:159]
    ds_read_b128 v[100:103], v90 offset:544
    ds_read_b128 v[112:115], v91 offset:528
    s_waitcnt lgkmcnt(2)
    v_mfma_f32_32x32x16_f16 v[128:143], v[104:107], v[120:123], v[128:143]
    v_mfma_f32_32x32x16_f16 v[144:159], v[96:99], v[120:123], v[144:159]
    ds_read_b128 v[104:107], v90 offset:576
    ds_read_b128 v[116:119], v91 offset:576
    s_waitcnt lgkmcnt(2)
    v_mfma_f32_32x32x16_f16 v[128:143], v[108:111], v[112:115], v[128:143]
    v_mfma_f32_32x32x16_f16 v[144:159], v[100:103], v[112:115], v[144:159]
    ds_read_b128 v[108:111], v90 offset:608
    ds_read_b128 v[120:123], v91 offset:608
    s_waitcnt lgkmcnt(2)
    v_mfma_f32_32x32x16_f16 v[128:143], v[96:99], v[116:119], v[128:143]
    v_mfma_f32_32x32x16_f16 v[144:159], v[104:107], v[116:119], v[144:159]
    ds_read_b128 v[96:99], v90 offset:640
    ds_read_b128 v[112:115], v91 offset:640
    s_waitcnt lgkmcnt(2)
    v_mfma_f32_32x32x16_f16 v[128:143], v[100:103], v[120:123], v[128:143]
    v_mfma_f32_32x32x16_f16 v[144:159], v[108:111], v[120:123], v[144:159]
    ds_read_b128 v[100:103], v90 offset:672
    ds_read_b128 v[116:119], v91 offset:672
    s_waitcnt lgkmcnt(2)
    v_mfma_f32_32x32x16_f16 v[128:143], v[104:107], v[112:115], v[128:143]
    v_mfma_f32_32x32x16_f16 v[144:159], v[96:99], v[112:115], v[144:159]
    ds_read_b128 v[104:107], v90 offset:704
    ds_read_b128 v[120:123], v91 offset:720
    s_waitcnt lgkmcnt(2)
    v_mfma_f32_32x32x16_f16 v[128:143], v[108:111], v[116:119], v[128:143]
    v_mfma_f32_32x32x16_f16 v[144:159], v[100:103], v[116:119], v[144:159]
    ds_read_b128 v[108:111], v90 offset:736
    ds_read_b128 v[112:115], v91 offset:752
    s_waitcnt lgkmcnt(2)
    v_mfma_f32_32x32x16_f16 v[128:143], v[96:99], v[120:123], v[128:143]
    v_mfma_f32_32x32x16_f16 v[144:159], v[104:107], v[120:123], v[144:159]
    ds_read_b128 v[96:99], v90 offset:768
    ds_read_b128 v[116:119], v91 offset:784
    s_waitcnt lgkmcnt(2)
    v_mfma_f32_32x32x16_f16 v[128:143], v[100:103], v[112:115], v[128:143]
    v_mfma_f32_32x32x16_f16 v[144:159], v[108:111], v[112:115], v[144:159]
    ds_read_b128 v[100:103], v90 offset:800
    ds_read_b128 v[120:123], v91 offset:816
    s_waitcnt lgkmcnt(2)
    v_mfma_f32_32x32x16_f16 v[128:143], v[104:107], v[116:119], v[128:143]
    v_mfma_f32_32x32x16_f16 v[144:159], v[96:99], v[116:119], v[144:159]
    ds_read_b128 v[104:107], v90 offset:832
    ds_read_b128 v[112:115], v91 offset:864
    s_waitcnt lgkmcnt(2)
    v_mfma_f32_32x32x16_f16 v[128:143], v[108:111], v[120:123], v[128:143]
    v_mfma_f32_32x32x16_f16 v[144:159], v[100:103], v[120:123], v[144:159]
    ds_read_b128 v[108:111], v90 offset:864
    ds_read_b128 v[116:119], v91 offset:896
    s_waitcnt lgkmcnt(2)
    v_mfma_f32_32x32x16_f16 v[128:143], v[96:99], v[112:115], v[128:143]
    v_mfma_f32_32x32x16_f16 v[144:159], v[104:107], v[112:115], v[144:159]
    ds_read_b128 v[96:99], v90 offset:896
    ds_read_b128 v[120:123], v91 offset:928
    s_waitcnt lgkmcnt(2)
    v_mfma_f32_32x32x16_f16 v[128:143], v[100:103], v[116:119], v[128:143]
    v_mfma_f32_32x32x16_f16 v[144:159], v[108:111], v[116:119], v[144:159]
    ds_read_b128 v[100:103], v90 offset:928
    ds_read_b128 v[112:115], v91 offset:960
    s_waitcnt lgkmcnt(2)
    v_mfma_f32_32x32x16_f16 v[128:143], v[104:107], v[120:123], v[128:143]
    v_mfma_f32_32x32x16_f16 v[144:159], v[96:99], v[120:123], v[144:159]
    ds_read_b128 v[104:107], v90 offset:960
    ds_read_b128 v[116:119], v91 offset:1008
    s_waitcnt lgkmcnt(2)
    v_mfma_f32_32x32x16_f16 v[128:143], v[108:111], v[112:115], v[128:143]
    v_mfma_f32_32x32x16_f16 v[144:159], v[100:103], v[112:115], v[144:159]
    ds_read_b128 v[108:111], v90 offset:992
    ds_read_b128 v[120:123], v91 offset:1040
    s_waitcnt lgkmcnt(2)
    v_mfma_f32_32x32x16_f16 v[128:143], v[96:99], v[116:119], v[128:143]
    v_mfma_f32_32x32x16_f16 v[144:159], v[104:107], v[116:119], v[144:159]
    ds_read_b128 v[96:99], v90 offset:1024
    ds_read_b128 v[112:115], v91 offset:1072
    s_waitcnt lgkmcnt(2)
    v_mfma_f32_32x32x16_f16 v[128:143], v[100:103], v[120:123], v[128:143]
    v_mfma_f32_32x32x16_f16 v[144:159], v[108:111], v[120:123], v[144:159]
    ds_read_b128 v[100:103], v90 offset:1056
    ds_read_b128 v[116:119], v91 offset:1104
    s_waitcnt lgkmcnt(2)
    v_mfma_f32_32x32x16_f16 v[128:143], v[104:107], v[112:115], v[128:143]
    v_mfma_f32_32x32x16_f16 v[144:159], v[96:99], v[112:115], v[144:159]
    s_waitcnt lgkmcnt(0)
    v_mfma_f32_32x32x16_f16 v[128:143], v[108:111], v[116:119], v[128:143]
    v_mfma_f32_32x32x16_f16 v[144:159], v[100:103], v[116:119], v[144:159]
    s_barrier
    v_lshlrev_b32 v7, 13, v5
    v_lshl_add_u32 v7, v1, 4, v7
    s_nop 7
    ds_write_b128 v7, v[128:131] offset:0
    ds_write_b128 v7, v[132:135] offset:1024
    ds_write_b128 v7, v[136:139] offset:2048
    ds_write_b128 v7, v[140:143] offset:3072
    ds_write_b128 v7, v[144:147] offset:4096
    ds_write_b128 v7, v[148:151] offset:5120
    ds_write_b128 v7, v[152:155] offset:6144
    ds_write_b128 v7, v[156:159] offset:7168
    s_waitcnt lgkmcnt(0)
    s_barrier
    v_lshlrev_b32 v7, 11, v5
    v_lshl_add_u32 v7, v1, 4, v7
    ds_read_b128 v[8:11], v7 offset:0
    ds_read_b128 v[12:15], v7 offset:8192
    ds_read_b128 v[16:19], v7 offset:16384
    ds_read_b128 v[20:23], v7 offset:24576
    ds_read_b128 v[24:27], v7 offset:1024
    ds_read_b128 v[28:31], v7 offset:9216
    ds_read_b128 v[32:35], v7 offset:17408
    ds_read_b128 v[36:39], v7 offset:25600
    s_waitcnt lgkmcnt(0)
    v_add_f32 v8, v8, v12
    v_add_f32 v16, v16, v20
    v_add_f32 v8, v8, v16
    v_mul_f32 v8, s62, v8
    v_add_f32 v9, v9, v13
    v_add_f32 v17, v17, v21
    v_add_f32 v9, v9, v17
    v_mul_f32 v9, s62, v9
    v_add_f32 v10, v10, v14
    v_add_f32 v18, v18, v22
    v_add_f32 v10, v10, v18
    v_mul_f32 v10, s62, v10
    v_add_f32 v11, v11, v15
    v_add_f32 v19, v19, v23
    v_add_f32 v11, v11, v19
    v_mul_f32 v11, s62, v11
    v_cvt_pk_bf16_f32 v44, v8, v9
    v_cvt_pk_bf16_f32 v45, v10, v11
    v_add_f32 v24, v24, v28
    v_add_f32 v32, v32, v36
    v_add_f32 v24, v24, v32
    v_mul_f32 v24, s62, v24
    v_add_f32 v25, v25, v29
    v_add_f32 v33, v33, v37
    v_add_f32 v25, v25, v33
    v_mul_f32 v25, s62, v25
    v_add_f32 v26, v26, v30
    v_add_f32 v34, v34, v38
    v_add_f32 v26, v26, v34
    v_mul_f32 v26, s62, v26
    v_add_f32 v27, v27, v31
    v_add_f32 v35, v35, v39
    v_add_f32 v27, v27, v35
    v_mul_f32 v27, s62, v27
    v_cvt_pk_bf16_f32 v46, v24, v25
    v_cvt_pk_bf16_f32 v47, v26, v27
    v_lshlrev_b32 v7, 3, v2
    v_lshl_add_u32 v7, v5, 1, v7
    v_lshlrev_b32 v7, 13, v7
    v_lshl_add_u32 v7, v3, 3, v7
    s_lshl_b32 s42, s2, 4
    buffer_store_dwordx2 v[44:45], v7, s[56:59], s42 offen
    v_add_u32 v7, 8192, v7
    buffer_store_dwordx2 v[46:47], v7, s[56:59], s42 offen
conv2_kernel_done:
    s_endpgm
.section .rodata,"a"
.p2align 6
.amdhsa_kernel conv2_kernel
  .amdhsa_next_free_vgpr 160
  .amdhsa_next_free_sgpr 102
  .amdhsa_accum_offset 160
  .amdhsa_group_segment_fixed_size 0
  .amdhsa_kernarg_size 112
  .amdhsa_user_sgpr_count 2
  .amdhsa_user_sgpr_kernarg_segment_ptr 1
  .amdhsa_system_sgpr_workgroup_id_x 1
.end_amdhsa_kernel

.text
.globl t1_kernel
.p2align 8
.type t1_kernel,@function
t1_kernel:
    s_cmp_ge_u32 s2, 256
    s_cbranch_scc1 t1_kernel_done
    s_load_dwordx16 s[4:19], s[0:1], 0
    s_load_dwordx8 s[20:27], s[0:1], 64
    s_load_dwordx4 s[28:31], s[0:1], 96
    v_and_b32 v1, 63, v0
    v_lshrrev_b32 v5, 6, v0
    s_waitcnt lgkmcnt(0)
    s_mov_b32 s44, s4
    s_mov_b32 s45, s5
    s_mov_b32 s46, 0x200000
    s_mov_b32 s47, 0x20000
    s_add_u32 s48, s30, 0x450000
    s_addc_u32 s49, s31, 0
    s_mov_b32 s50, 0x200000
    s_mov_b32 s51, 0x20000
    s_add_u32 s52, s30, 0x241000
    s_addc_u32 s53, s31, 0
    s_mov_b32 s54, 0x4000
    s_mov_b32 s55, 0x20000
    s_mov_b32 s56, s16
    s_mov_b32 s57, s17
    s_mov_b32 s58, 0x400
    s_mov_b32 s59, 0x20000
    s_add_u32 s60, s30, 0x650000
    s_addc_u32 s61, s31, 0
    s_mov_b32 s62, 0x200000
    s_mov_b32 s63, 0x20000
    s_add_u32 s64, s30, 0xc50000
    s_addc_u32 s65, s31, 0
    s_mov_b32 s66, 0x200000
    s_mov_b32 s67, 0x20000
    s_lshl_b32 s40, s2, 13
    v_lshlrev_b32 v6, 5, v0
    buffer_load_dwordx4 v[8:11], v6, s[48:51], s40 offen
    buffer_load_dwordx4 v[12:15], v6, s[48:51], s40 offen offset:16
    v_lshlrev_b32 v7, 11, v5
    v_lshl_add_u32 v7, v1, 4, v7
    buffer_load_dwordx4 v[16:19], v7, s[44:47], s40 offen
    buffer_load_dwordx4 v[20:23], v7, s[44:47], s40 offen offset:1024
    v_lshlrev_b32 v2, 4, v5
    s_lshl_b32 s41, s2, 6
    buffer_load_dwordx4 v[24:27], v2, s[52:55], s41 offen
    v_lshlrev_b32 v3, 4, v1
    buffer_load_dwordx4 v[28:31], v3, s[56:59], 0 offen
    v_lshrrev_b32 v2, 2, v0
    v_lshl_add_u32 v2, v2, 4, v6
    s_waitcnt vmcnt(4)
    ds_write_b128 v2, v[8:11]
    ds_write_b128 v2, v[12:15] offset:16
    v_mul_u32_u24 v2, 144, v1
    v_lshl_add_u32 v2, v5, 2, v2
    s_waitcnt lgkmcnt(0)
    s_barrier
    ds_read_b32 v32, v2 offset:0
    ds_read_b32 v33, v2 offset:16
    ds_read_b32 v34, v2 offset:32
    ds_read_b32 v35, v2 offset:48
    ds_read_b32 v36, v2 offset:64
    ds_read_b32 v37, v2 offset:80
    ds_read_b32 v38, v2 offset:96
    ds_read_b32 v39, v2 offset:112
    s_waitcnt vmcnt(0) lgkmcnt(0)
    v_mul_f32 v43, 0x3b000000, v24
    v_mul_f32 v25, 0x3b000000, v25
    v_fma_f32 v25, -v43, v43, v25
    v_max_f32 v25, 0, v25
    v_cvt_pk_bf16_f32 v40, v43, v43
    v_lshlrev_b32 v40, 16, v40
    v_cvt_pk_bf16_f32 v25, v25, v25
    v_lshlrev_b32 v25, 16, v25
    v_add_f32 v25, 0x3727c5ac, v25
    v_cvt_pk_bf16_f32 v25, v25, v25
    v_lshlrev_b32 v25, 16, v25
    v_sqrt_f32 v25, v25
    s_nop 0
    v_cvt_pk_bf16_f32 v41, v25, v25
    v_lshlrev_b32 v41, 16, v41
    v_rcp_f32 v42, v41
    v_lshlrev_b32 v48, 16, v16
    v_mov_b32 v56, v48
    v_sub_f32 v56, v56, v40
    v_cvt_pk_bf16_f32 v56, v56, v56
    v_lshlrev_b32 v56, 16, v56
    v_mul_f32 v43, v56, v42
    v_fma_f32 v44, -v43, v41, v56
    v_fma_f32 v56, v44, v42, v43
    v_cvt_pk_bf16_f32 v56, v56, v56
    v_lshlrev_b32 v56, 16, v56
    v_lshlrev_b32 v43, 16, v28
    v_mul_f32 v56, v56, v43
    v_cvt_pk_bf16_f32 v56, v56, v56
    v_lshlrev_b32 v56, 16, v56
    v_lshlrev_b32 v43, 16, v32
    v_add_f32 v56, v43, v56
    v_cvt_pk_bf16_f32 v56, v56, v56
    v_lshlrev_b32 v56, 16, v56
    v_add_f32 v48, v48, v56
    v_cvt_pk_bf16_f32 v48, v48, v48
    v_lshlrev_b32 v48, 16, v48
    v_and_b32 v49, 0xffff0000, v16
    v_mov_b32 v57, v49
    v_sub_f32 v57, v57, v40
    v_cvt_pk_bf16_f32 v57, v57, v57
    v_lshlrev_b32 v57, 16, v57
    v_mul_f32 v43, v57, v42
    v_fma_f32 v44, -v43, v41, v57
    v_fma_f32 v57, v44, v42, v43
    v_cvt_pk_bf16_f32 v57, v57, v57
    v_lshlrev_b32 v57, 16, v57
    v_and_b32 v43, 0xffff0000, v28
    v_mul_f32 v57, v57, v43
    v_cvt_pk_bf16_f32 v57, v57, v57
    v_lshlrev_b32 v57, 16, v57
    v_lshlrev_b32 v43, 16, v33
    v_add_f32 v57, v43, v57
    v_cvt_pk_bf16_f32 v57, v57, v57
    v_lshlrev_b32 v57, 16, v57
    v_add_f32 v49, v49, v57
    v_cvt_pk_bf16_f32 v49, v49, v49
    v_lshlrev_b32 v49, 16, v49
    v_lshlrev_b32 v50, 16, v17
    v_mov_b32 v58, v50
    v_sub_f32 v58, v58, v40
    v_cvt_pk_bf16_f32 v58, v58, v58
    v_lshlrev_b32 v58, 16, v58
    v_mul_f32 v43, v58, v42
    v_fma_f32 v44, -v43, v41, v58
    v_fma_f32 v58, v44, v42, v43
    v_cvt_pk_bf16_f32 v58, v58, v58
    v_lshlrev_b32 v58, 16, v58
    v_lshlrev_b32 v43, 16, v29
    v_mul_f32 v58, v58, v43
    v_cvt_pk_bf16_f32 v58, v58, v58
    v_lshlrev_b32 v58, 16, v58
    v_lshlrev_b32 v43, 16, v34
    v_add_f32 v58, v43, v58
    v_cvt_pk_bf16_f32 v58, v58, v58
    v_lshlrev_b32 v58, 16, v58
    v_add_f32 v50, v50, v58
    v_cvt_pk_bf16_f32 v50, v50, v50
    v_lshlrev_b32 v50, 16, v50
    v_and_b32 v51, 0xffff0000, v17
    v_mov_b32 v59, v51
    v_sub_f32 v59, v59, v40
    v_cvt_pk_bf16_f32 v59, v59, v59
    v_lshlrev_b32 v59, 16, v59
    v_mul_f32 v43, v59, v42
    v_fma_f32 v44, -v43, v41, v59
    v_fma_f32 v59, v44, v42, v43
    v_cvt_pk_bf16_f32 v59, v59, v59
    v_lshlrev_b32 v59, 16, v59
    v_and_b32 v43, 0xffff0000, v29
    v_mul_f32 v59, v59, v43
    v_cvt_pk_bf16_f32 v59, v59, v59
    v_lshlrev_b32 v59, 16, v59
    v_lshlrev_b32 v43, 16, v35
    v_add_f32 v59, v43, v59
    v_cvt_pk_bf16_f32 v59, v59, v59
    v_lshlrev_b32 v59, 16, v59
    v_add_f32 v51, v51, v59
    v_cvt_pk_bf16_f32 v51, v51, v51
    v_lshlrev_b32 v51, 16, v51
    v_lshlrev_b32 v52, 16, v18
    v_mov_b32 v60, v52
    v_sub_f32 v60, v60, v40
    v_cvt_pk_bf16_f32 v60, v60, v60
    v_lshlrev_b32 v60, 16, v60
    v_mul_f32 v43, v60, v42
    v_fma_f32 v44, -v43, v41, v60
    v_fma_f32 v60, v44, v42, v43
    v_cvt_pk_bf16_f32 v60, v60, v60
    v_lshlrev_b32 v60, 16, v60
    v_lshlrev_b32 v43, 16, v30
    v_mul_f32 v60, v60, v43
    v_cvt_pk_bf16_f32 v60, v60, v60
    v_lshlrev_b32 v60, 16, v60
    v_lshlrev_b32 v43, 16, v36
    v_add_f32 v60, v43, v60
    v_cvt_pk_bf16_f32 v60, v60, v60
    v_lshlrev_b32 v60, 16, v60
    v_add_f32 v52, v52, v60
    v_cvt_pk_bf16_f32 v52, v52, v52
    v_lshlrev_b32 v52, 16, v52
    v_and_b32 v53, 0xffff0000, v18
    v_mov_b32 v61, v53
    v_sub_f32 v61, v61, v40
    v_cvt_pk_bf16_f32 v61, v61, v61
    v_lshlrev_b32 v61, 16, v61
    v_mul_f32 v43, v61, v42
    v_fma_f32 v44, -v43, v41, v61
    v_fma_f32 v61, v44, v42, v43
    v_cvt_pk_bf16_f32 v61, v61, v61
    v_lshlrev_b32 v61, 16, v61
    v_and_b32 v43, 0xffff0000, v30
    v_mul_f32 v61, v61, v43
    v_cvt_pk_bf16_f32 v61, v61, v61
    v_lshlrev_b32 v61, 16, v61
    v_lshlrev_b32 v43, 16, v37
    v_add_f32 v61, v43, v61
    v_cvt_pk_bf16_f32 v61, v61, v61
    v_lshlrev_b32 v61, 16, v61
    v_add_f32 v53, v53, v61
    v_cvt_pk_bf16_f32 v53, v53, v53
    v_lshlrev_b32 v53, 16, v53
    v_lshlrev_b32 v54, 16, v19
    v_mov_b32 v62, v54
    v_sub_f32 v62, v62, v40
    v_cvt_pk_bf16_f32 v62, v62, v62
    v_lshlrev_b32 v62, 16, v62
    v_mul_f32 v43, v62, v42
    v_fma_f32 v44, -v43, v41, v62
    v_fma_f32 v62, v44, v42, v43
    v_cvt_pk_bf16_f32 v62, v62, v62
    v_lshlrev_b32 v62, 16, v62
    v_lshlrev_b32 v43, 16, v31
    v_mul_f32 v62, v62, v43
    v_cvt_pk_bf16_f32 v62, v62, v62
    v_lshlrev_b32 v62, 16, v62
    v_lshlrev_b32 v43, 16, v38
    v_add_f32 v62, v43, v62
    v_cvt_pk_bf16_f32 v62, v62, v62
    v_lshlrev_b32 v62, 16, v62
    v_add_f32 v54, v54, v62
    v_cvt_pk_bf16_f32 v54, v54, v54
    v_lshlrev_b32 v54, 16, v54
    v_and_b32 v55, 0xffff0000, v19
    v_mov_b32 v63, v55
    v_sub_f32 v63, v63, v40
    v_cvt_pk_bf16_f32 v63, v63, v63
    v_lshlrev_b32 v63, 16, v63
    v_mul_f32 v43, v63, v42
    v_fma_f32 v44, -v43, v41, v63
    v_fma_f32 v63, v44, v42, v43
    v_cvt_pk_bf16_f32 v63, v63, v63
    v_lshlrev_b32 v63, 16, v63
    v_and_b32 v43, 0xffff0000, v31
    v_mul_f32 v63, v63, v43
    v_cvt_pk_bf16_f32 v63, v63, v63
    v_lshlrev_b32 v63, 16, v63
    v_lshlrev_b32 v43, 16, v39
    v_add_f32 v63, v43, v63
    v_cvt_pk_bf16_f32 v63, v63, v63
    v_lshlrev_b32 v63, 16, v63
    v_add_f32 v55, v55, v63
    v_cvt_pk_bf16_f32 v55, v55, v55
    v_lshlrev_b32 v55, 16, v55
    v_add_f32 v44, v48, v49
    v_add_f32 v44, v44, v50
    v_add_f32 v44, v44, v51
    v_add_f32 v44, v44, v52
    v_add_f32 v44, v44, v53
    v_add_f32 v44, v44, v54
    v_add_f32 v44, v44, v55
    s_nop 1
    v_add_f32_dpp v44, v44, v44 quad_perm:[1,0,3,2] row_mask:0xf bank_mask:0xf
    s_nop 1
    v_add_f32_dpp v44, v44, v44 quad_perm:[2,3,0,1] row_mask:0xf bank_mask:0xf
    s_nop 1
    v_add_f32_dpp v44, v44, v44 row_half_mirror row_mask:0xf bank_mask:0xf
    s_nop 1
    v_add_f32_dpp v44, v44, v44 row_mirror row_mask:0xf bank_mask:0xf
    s_nop 0
    v_readlane_b32 s70, v44, 0
    v_readlane_b32 s71, v44, 16
    v_readlane_b32 s72, v44, 32
    v_readlane_b32 s73, v44, 48
    v_mov_b32 v44, s70
    v_add_f32 v44, s71, v44
    v_add_f32 v44, s72, v44
    v_add_f32 v44, s73, v44
    v_mul_f32 v44, 0x3b000000, v44
    v_sub_f32 v56, v48, v44
    v_sub_f32 v57, v49, v44
    v_sub_f32 v58, v50, v44
    v_sub_f32 v59, v51, v44
    v_sub_f32 v60, v52, v44
    v_sub_f32 v61, v53, v44
    v_sub_f32 v62, v54, v44
    v_sub_f32 v63, v55, v44
    v_mul_f32 v45, v56, v56
    v_fmac_f32 v45, v57, v57
    v_fmac_f32 v45, v58, v58
    v_fmac_f32 v45, v59, v59
    v_fmac_f32 v45, v60, v60
    v_fmac_f32 v45, v61, v61
    v_fmac_f32 v45, v62, v62
    v_fmac_f32 v45, v63, v63
    s_nop 1
    v_add_f32_dpp v45, v45, v45 quad_perm:[1,0,3,2] row_mask:0xf bank_mask:0xf
    s_nop 1
    v_add_f32_dpp v45, v45, v45 quad_perm:[2,3,0,1] row_mask:0xf bank_mask:0xf
    s_nop 1
    v_add_f32_dpp v45, v45, v45 row_half_mirror row_mask:0xf bank_mask:0xf
    s_nop 1
    v_add_f32_dpp v45, v45, v45 row_mirror row_mask:0xf bank_mask:0xf
    s_nop 0
    v_readlane_b32 s74, v45, 0
    v_readlane_b32 s75, v45, 16
    v_readlane_b32 s76, v45, 32
    v_readlane_b32 s77, v45, 48
    v_mov_b32 v45, s74
    v_add_f32 v45, s75, v45
    v_add_f32 v45, s76, v45
    v_add_f32 v45, s77, v45
    v_mul_f32 v45, 0x3b000000, v45
    v_cvt_pk_bf16_f32 v40, v44, v44
    v_lshlrev_b32 v40, 16, v40
    v_cvt_pk_bf16_f32 v45, v45, v45
    v_lshlrev_b32 v45, 16, v45
    v_add_f32 v45, 0x3727c5ac, v45
    v_cvt_pk_bf16_f32 v45, v45, v45
    v_lshlrev_b32 v45, 16, v45
    v_sqrt_f32 v45, v45
    s_nop 0
    v_cvt_pk_bf16_f32 v41, v45, v45
    v_lshlrev_b32 v41, 16, v41
    v_rcp_f32 v42, v41
    s_mov_b32 s43, 0x07060302
    v_perm_b32 v64, v49, v48, s43
    v_perm_b32 v65, v51, v50, s43
    v_perm_b32 v66, v53, v52, s43
    v_perm_b32 v67, v55, v54, s43
    v_sub_f32 v48, v48, v40
    v_cvt_pk_bf16_f32 v48, v48, v48
    v_lshlrev_b32 v48, 16, v48
    v_mul_f32 v43, v48, v42
    v_fma_f32 v44, -v43, v41, v48
    v_fma_f32 v48, v44, v42, v43
    v_cvt_pk_bf16_f32 v48, v48, v48
    v_lshlrev_b32 v48, 16, v48
    v_sub_f32 v49, v49, v40
    v_cvt_pk_bf16_f32 v49, v49, v49
    v_lshlrev_b32 v49, 16, v49
    v_mul_f32 v43, v49, v42
    v_fma_f32 v44, -v43, v41, v49
    v_fma_f32 v49, v44, v42, v43
    v_cvt_pk_bf16_f32 v49, v49, v49
    v_lshlrev_b32 v49, 16, v49
    v_sub_f32 v50, v50, v40
    v_cvt_pk_bf16_f32 v50, v50, v50
    v_lshlrev_b32 v50, 16, v50
    v_mul_f32 v43, v50, v42
    v_fma_f32 v44, -v43, v41, v50
    v_fma_f32 v50, v44, v42, v43
    v_cvt_pk_bf16_f32 v50, v50, v50
    v_lshlrev_b32 v50, 16, v50
    v_sub_f32 v51, v51, v40
    v_cvt_pk_bf16_f32 v51, v51, v51
    v_lshlrev_b32 v51, 16, v51
    v_mul_f32 v43, v51, v42
    v_fma_f32 v44, -v43, v41, v51
    v_fma_f32 v51, v44, v42, v43
    v_cvt_pk_bf16_f32 v51, v51, v51
    v_lshlrev_b32 v51, 16, v51
    v_sub_f32 v52, v52, v40
    v_cvt_pk_bf16_f32 v52, v52, v52
    v_lshlrev_b32 v52, 16, v52
    v_mul_f32 v43, v52, v42
    v_fma_f32 v44, -v43, v41, v52
    v_fma_f32 v52, v44, v42, v43
    v_cvt_pk_bf16_f32 v52, v52, v52
    v_lshlrev_b32 v52, 16, v52
    v_sub_f32 v53, v53, v40
    v_cvt_pk_bf16_f32 v53, v53, v53
    v_lshlrev_b32 v53, 16, v53
    v_mul_f32 v43, v53, v42
    v_fma_f32 v44, -v43, v41, v53
    v_fma_f32 v53, v44, v42, v43
    v_cvt_pk_bf16_f32 v53, v53, v53
    v_lshlrev_b32 v53, 16, v53
    v_sub_f32 v54, v54, v40
    v_cvt_pk_bf16_f32 v54, v54, v54
    v_lshlrev_b32 v54, 16, v54
    v_mul_f32 v43, v54, v42
    v_fma_f32 v44, -v43, v41, v54
    v_fma_f32 v54, v44, v42, v43
    v_cvt_pk_bf16_f32 v54, v54, v54
    v_lshlrev_b32 v54, 16, v54
    v_sub_f32 v55, v55, v40
    v_cvt_pk_bf16_f32 v55, v55, v55
    v_lshlrev_b32 v55, 16, v55
    v_mul_f32 v43, v55, v42
    v_fma_f32 v44, -v43, v41, v55
    v_fma_f32 v55, v44, v42, v43
    v_cvt_pk_bf16_f32 v55, v55, v55
    v_lshlrev_b32 v55, 16, v55
    v_perm_b32 v68, v49, v48, s43
    v_perm_b32 v69, v51, v50, s43
    v_perm_b32 v70, v53, v52, s43
    v_perm_b32 v71, v55, v54, s43
    buffer_store_dwordx4 v[64:67], v7, s[60:63], s40 offen offset:0
    s_lshr_b32 s42, s2, 1
    s_lshl_b32 s42, s42, 14
    s_and_b32 s80, s2, 1
    s_lshl_b32 s80, s80, 7
    s_add_u32 s42, s42, s80
    s_add_u32 s42, s42, 0
    v_lshrrev_b32 v72, 2, v1
    v_lshlrev_b32 v72, 10, v72
    v_and_b32 v73, 3, v1
    v_lshl_add_u32 v72, v73, 8, v72
    v_lshl_add_u32 v72, v5, 5, v72
    buffer_store_dwordx4 v[68:71], v72, s[64:67], s42 offen
    v_mul_f32 v43, 0x3b000000, v26
    v_mul_f32 v27, 0x3b000000, v27
    v_fma_f32 v27, -v43, v43, v27
    v_max_f32 v27, 0, v27
    v_cvt_pk_bf16_f32 v40, v43, v43
    v_lshlrev_b32 v40, 16, v40
    v_cvt_pk_bf16_f32 v27, v27, v27
    v_lshlrev_b32 v27, 16, v27
    v_add_f32 v27, 0x3727c5ac, v27
    v_cvt_pk_bf16_f32 v27, v27, v27
    v_lshlrev_b32 v27, 16, v27
    v_sqrt_f32 v27, v27
    s_nop 0
    v_cvt_pk_bf16_f32 v41, v27, v27
    v_lshlrev_b32 v41, 16, v41
    v_rcp_f32 v42, v41
    v_lshlrev_b32 v48, 16, v20
    v_mov_b32 v56, v48
    v_sub_f32 v56, v56, v40
    v_cvt_pk_bf16_f32 v56, v56, v56
    v_lshlrev_b32 v56, 16, v56
    v_mul_f32 v43, v56, v42
    v_fma_f32 v44, -v43, v41, v56
    v_fma_f32 v56, v44, v42, v43
    v_cvt_pk_bf16_f32 v56, v56, v56
    v_lshlrev_b32 v56, 16, v56
    v_lshlrev_b32 v43, 16, v28
    v_mul_f32 v56, v56, v43
    v_cvt_pk_bf16_f32 v56, v56, v56
    v_lshlrev_b32 v56, 16, v56
    v_and_b32 v43, 0xffff0000, v32
    v_add_f32 v56, v43, v56
    v_cvt_pk_bf16_f32 v56, v56, v56
    v_lshlrev_b32 v56, 16, v56
    v_add_f32 v48, v48, v56
    v_cvt_pk_bf16_f32 v48, v48, v48
    v_lshlrev_b32 v48, 16, v48
    v_and_b32 v49, 0xffff0000, v20
    v_mov_b32 v57, v49
    v_sub_f32 v57, v57, v40
    v_cvt_pk_bf16_f32 v57, v57, v57
    v_lshlrev_b32 v57, 16, v57
    v_mul_f32 v43, v57, v42
    v_fma_f32 v44, -v43, v41, v57
    v_fma_f32 v57, v44, v42, v43
    v_cvt_pk_bf16_f32 v57, v57, v57
    v_lshlrev_b32 v57, 16, v57
    v_and_b32 v43, 0xffff0000, v28
    v_mul_f32 v57, v57, v43
    v_cvt_pk_bf16_f32 v57, v57, v57
    v_lshlrev_b32 v57, 16, v57
    v_and_b32 v43, 0xffff0000, v33
    v_add_f32 v57, v43, v57
    v_cvt_pk_bf16_f32 v57, v57, v57
    v_lshlrev_b32 v57, 16, v57
    v_add_f32 v49, v49, v57
    v_cvt_pk_bf16_f32 v49, v49, v49
    v_lshlrev_b32 v49, 16, v49
    v_lshlrev_b32 v50, 16, v21
    v_mov_b32 v58, v50
    v_sub_f32 v58, v58, v40
    v_cvt_pk_bf16_f32 v58, v58, v58
    v_lshlrev_b32 v58, 16, v58
    v_mul_f32 v43, v58, v42
    v_fma_f32 v44, -v43, v41, v58
    v_fma_f32 v58, v44, v42, v43
    v_cvt_pk_bf16_f32 v58, v58, v58
    v_lshlrev_b32 v58, 16, v58
    v_lshlrev_b32 v43, 16, v29
    v_mul_f32 v58, v58, v43
    v_cvt_pk_bf16_f32 v58, v58, v58
    v_lshlrev_b32 v58, 16, v58
    v_and_b32 v43, 0xffff0000, v34
    v_add_f32 v58, v43, v58
    v_cvt_pk_bf16_f32 v58, v58, v58
    v_lshlrev_b32 v58, 16, v58
    v_add_f32 v50, v50, v58
    v_cvt_pk_bf16_f32 v50, v50, v50
    v_lshlrev_b32 v50, 16, v50
    v_and_b32 v51, 0xffff0000, v21
    v_mov_b32 v59, v51
    v_sub_f32 v59, v59, v40
    v_cvt_pk_bf16_f32 v59, v59, v59
    v_lshlrev_b32 v59, 16, v59
    v_mul_f32 v43, v59, v42
    v_fma_f32 v44, -v43, v41, v59
    v_fma_f32 v59, v44, v42, v43
    v_cvt_pk_bf16_f32 v59, v59, v59
    v_lshlrev_b32 v59, 16, v59
    v_and_b32 v43, 0xffff0000, v29
    v_mul_f32 v59, v59, v43
    v_cvt_pk_bf16_f32 v59, v59, v59
    v_lshlrev_b32 v59, 16, v59
    v_and_b32 v43, 0xffff0000, v35
    v_add_f32 v59, v43, v59
    v_cvt_pk_bf16_f32 v59, v59, v59
    v_lshlrev_b32 v59, 16, v59
    v_add_f32 v51, v51, v59
    v_cvt_pk_bf16_f32 v51, v51, v51
    v_lshlrev_b32 v51, 16, v51
    v_lshlrev_b32 v52, 16, v22
    v_mov_b32 v60, v52
    v_sub_f32 v60, v60, v40
    v_cvt_pk_bf16_f32 v60, v60, v60
    v_lshlrev_b32 v60, 16, v60
    v_mul_f32 v43, v60, v42
    v_fma_f32 v44, -v43, v41, v60
    v_fma_f32 v60, v44, v42, v43
    v_cvt_pk_bf16_f32 v60, v60, v60
    v_lshlrev_b32 v60, 16, v60
    v_lshlrev_b32 v43, 16, v30
    v_mul_f32 v60, v60, v43
    v_cvt_pk_bf16_f32 v60, v60, v60
    v_lshlrev_b32 v60, 16, v60
    v_and_b32 v43, 0xffff0000, v36
    v_add_f32 v60, v43, v60
    v_cvt_pk_bf16_f32 v60, v60, v60
    v_lshlrev_b32 v60, 16, v60
    v_add_f32 v52, v52, v60
    v_cvt_pk_bf16_f32 v52, v52, v52
    v_lshlrev_b32 v52, 16, v52
    v_and_b32 v53, 0xffff0000, v22
    v_mov_b32 v61, v53
    v_sub_f32 v61, v61, v40
    v_cvt_pk_bf16_f32 v61, v61, v61
    v_lshlrev_b32 v61, 16, v61
    v_mul_f32 v43, v61, v42
    v_fma_f32 v44, -v43, v41, v61
    v_fma_f32 v61, v44, v42, v43
    v_cvt_pk_bf16_f32 v61, v61, v61
    v_lshlrev_b32 v61, 16, v61
    v_and_b32 v43, 0xffff0000, v30
    v_mul_f32 v61, v61, v43
    v_cvt_pk_bf16_f32 v61, v61, v61
    v_lshlrev_b32 v61, 16, v61
    v_and_b32 v43, 0xffff0000, v37
    v_add_f32 v61, v43, v61
    v_cvt_pk_bf16_f32 v61, v61, v61
    v_lshlrev_b32 v61, 16, v61
    v_add_f32 v53, v53, v61
    v_cvt_pk_bf16_f32 v53, v53, v53
    v_lshlrev_b32 v53, 16, v53
    v_lshlrev_b32 v54, 16, v23
    v_mov_b32 v62, v54
    v_sub_f32 v62, v62, v40
    v_cvt_pk_bf16_f32 v62, v62, v62
    v_lshlrev_b32 v62, 16, v62
    v_mul_f32 v43, v62, v42
    v_fma_f32 v44, -v43, v41, v62
    v_fma_f32 v62, v44, v42, v43
    v_cvt_pk_bf16_f32 v62, v62, v62
    v_lshlrev_b32 v62, 16, v62
    v_lshlrev_b32 v43, 16, v31
    v_mul_f32 v62, v62, v43
    v_cvt_pk_bf16_f32 v62, v62, v62
    v_lshlrev_b32 v62, 16, v62
    v_and_b32 v43, 0xffff0000, v38
    v_add_f32 v62, v43, v62
    v_cvt_pk_bf16_f32 v62, v62, v62
    v_lshlrev_b32 v62, 16, v62
    v_add_f32 v54, v54, v62
    v_cvt_pk_bf16_f32 v54, v54, v54
    v_lshlrev_b32 v54, 16, v54
    v_and_b32 v55, 0xffff0000, v23
    v_mov_b32 v63, v55
    v_sub_f32 v63, v63, v40
    v_cvt_pk_bf16_f32 v63, v63, v63
    v_lshlrev_b32 v63, 16, v63
    v_mul_f32 v43, v63, v42
    v_fma_f32 v44, -v43, v41, v63
    v_fma_f32 v63, v44, v42, v43
    v_cvt_pk_bf16_f32 v63, v63, v63
    v_lshlrev_b32 v63, 16, v63
    v_and_b32 v43, 0xffff0000, v31
    v_mul_f32 v63, v63, v43
    v_cvt_pk_bf16_f32 v63, v63, v63
    v_lshlrev_b32 v63, 16, v63
    v_and_b32 v43, 0xffff0000, v39
    v_add_f32 v63, v43, v63
    v_cvt_pk_bf16_f32 v63, v63, v63
    v_lshlrev_b32 v63, 16, v63
    v_add_f32 v55, v55, v63
    v_cvt_pk_bf16_f32 v55, v55, v55
    v_lshlrev_b32 v55, 16, v55
    v_add_f32 v44, v48, v49
    v_add_f32 v44, v44, v50
    v_add_f32 v44, v44, v51
    v_add_f32 v44, v44, v52
    v_add_f32 v44, v44, v53
    v_add_f32 v44, v44, v54
    v_add_f32 v44, v44, v55
    s_nop 1
    v_add_f32_dpp v44, v44, v44 quad_perm:[1,0,3,2] row_mask:0xf bank_mask:0xf
    s_nop 1
    v_add_f32_dpp v44, v44, v44 quad_perm:[2,3,0,1] row_mask:0xf bank_mask:0xf
    s_nop 1
    v_add_f32_dpp v44, v44, v44 row_half_mirror row_mask:0xf bank_mask:0xf
    s_nop 1
    v_add_f32_dpp v44, v44, v44 row_mirror row_mask:0xf bank_mask:0xf
    s_nop 0
    v_readlane_b32 s70, v44, 0
    v_readlane_b32 s71, v44, 16
    v_readlane_b32 s72, v44, 32
    v_readlane_b32 s73, v44, 48
    v_mov_b32 v44, s70
    v_add_f32 v44, s71, v44
    v_add_f32 v44, s72, v44
    v_add_f32 v44, s73, v44
    v_mul_f32 v44, 0x3b000000, v44
    v_sub_f32 v56, v48, v44
    v_sub_f32 v57, v49, v44
    v_sub_f32 v58, v50, v44
    v_sub_f32 v59, v51, v44
    v_sub_f32 v60, v52, v44
    v_sub_f32 v61, v53, v44
    v_sub_f32 v62, v54, v44
    v_sub_f32 v63, v55, v44
    v_mul_f32 v45, v56, v56
    v_fmac_f32 v45, v57, v57
    v_fmac_f32 v45, v58, v58
    v_fmac_f32 v45, v59, v59
    v_fmac_f32 v45, v60, v60
    v_fmac_f32 v45, v61, v61
    v_fmac_f32 v45, v62, v62
    v_fmac_f32 v45, v63, v63
    s_nop 1
    v_add_f32_dpp v45, v45, v45 quad_perm:[1,0,3,2] row_mask:0xf bank_mask:0xf
    s_nop 1
    v_add_f32_dpp v45, v45, v45 quad_perm:[2,3,0,1] row_mask:0xf bank_mask:0xf
    s_nop 1
    v_add_f32_dpp v45, v45, v45 row_half_mirror row_mask:0xf bank_mask:0xf
    s_nop 1
    v_add_f32_dpp v45, v45, v45 row_mirror row_mask:0xf bank_mask:0xf
    s_nop 0
    v_readlane_b32 s74, v45, 0
    v_readlane_b32 s75, v45, 16
    v_readlane_b32 s76, v45, 32
    v_readlane_b32 s77, v45, 48
    v_mov_b32 v45, s74
    v_add_f32 v45, s75, v45
    v_add_f32 v45, s76, v45
    v_add_f32 v45, s77, v45
    v_mul_f32 v45, 0x3b000000, v45
    v_cvt_pk_bf16_f32 v40, v44, v44
    v_lshlrev_b32 v40, 16, v40
    v_cvt_pk_bf16_f32 v45, v45, v45
    v_lshlrev_b32 v45, 16, v45
    v_add_f32 v45, 0x3727c5ac, v45
    v_cvt_pk_bf16_f32 v45, v45, v45
    v_lshlrev_b32 v45, 16, v45
    v_sqrt_f32 v45, v45
    s_nop 0
    v_cvt_pk_bf16_f32 v41, v45, v45
    v_lshlrev_b32 v41, 16, v41
    v_rcp_f32 v42, v41
    s_mov_b32 s43, 0x07060302
    v_perm_b32 v64, v49, v48, s43
    v_perm_b32 v65, v51, v50, s43
    v_perm_b32 v66, v53, v52, s43
    v_perm_b32 v67, v55, v54, s43
    v_sub_f32 v48, v48, v40
    v_cvt_pk_bf16_f32 v48, v48, v48
    v_lshlrev_b32 v48, 16, v48
    v_mul_f32 v43, v48, v42
    v_fma_f32 v44, -v43, v41, v48
    v_fma_f32 v48, v44, v42, v43
    v_cvt_pk_bf16_f32 v48, v48, v48
    v_lshlrev_b32 v48, 16, v48
    v_sub_f32 v49, v49, v40
    v_cvt_pk_bf16_f32 v49, v49, v49
    v_lshlrev_b32 v49, 16, v49
    v_mul_f32 v43, v49, v42
    v_fma_f32 v44, -v43, v41, v49
    v_fma_f32 v49, v44, v42, v43
    v_cvt_pk_bf16_f32 v49, v49, v49
    v_lshlrev_b32 v49, 16, v49
    v_sub_f32 v50, v50, v40
    v_cvt_pk_bf16_f32 v50, v50, v50
    v_lshlrev_b32 v50, 16, v50
    v_mul_f32 v43, v50, v42
    v_fma_f32 v44, -v43, v41, v50
    v_fma_f32 v50, v44, v42, v43
    v_cvt_pk_bf16_f32 v50, v50, v50
    v_lshlrev_b32 v50, 16, v50
    v_sub_f32 v51, v51, v40
    v_cvt_pk_bf16_f32 v51, v51, v51
    v_lshlrev_b32 v51, 16, v51
    v_mul_f32 v43, v51, v42
    v_fma_f32 v44, -v43, v41, v51
    v_fma_f32 v51, v44, v42, v43
    v_cvt_pk_bf16_f32 v51, v51, v51
    v_lshlrev_b32 v51, 16, v51
    v_sub_f32 v52, v52, v40
    v_cvt_pk_bf16_f32 v52, v52, v52
    v_lshlrev_b32 v52, 16, v52
    v_mul_f32 v43, v52, v42
    v_fma_f32 v44, -v43, v41, v52
    v_fma_f32 v52, v44, v42, v43
    v_cvt_pk_bf16_f32 v52, v52, v52
    v_lshlrev_b32 v52, 16, v52
    v_sub_f32 v53, v53, v40
    v_cvt_pk_bf16_f32 v53, v53, v53
    v_lshlrev_b32 v53, 16, v53
    v_mul_f32 v43, v53, v42
    v_fma_f32 v44, -v43, v41, v53
    v_fma_f32 v53, v44, v42, v43
    v_cvt_pk_bf16_f32 v53, v53, v53
    v_lshlrev_b32 v53, 16, v53
    v_sub_f32 v54, v54, v40
    v_cvt_pk_bf16_f32 v54, v54, v54
    v_lshlrev_b32 v54, 16, v54
    v_mul_f32 v43, v54, v42
    v_fma_f32 v44, -v43, v41, v54
    v_fma_f32 v54, v44, v42, v43
    v_cvt_pk_bf16_f32 v54, v54, v54
    v_lshlrev_b32 v54, 16, v54
    v_sub_f32 v55, v55, v40
    v_cvt_pk_bf16_f32 v55, v55, v55
    v_lshlrev_b32 v55, 16, v55
    v_mul_f32 v43, v55, v42
    v_fma_f32 v44, -v43, v41, v55
    v_fma_f32 v55, v44, v42, v43
    v_cvt_pk_bf16_f32 v55, v55, v55
    v_lshlrev_b32 v55, 16, v55
    v_perm_b32 v68, v49, v48, s43
    v_perm_b32 v69, v51, v50, s43
    v_perm_b32 v70, v53, v52, s43
    v_perm_b32 v71, v55, v54, s43
    buffer_store_dwordx4 v[64:67], v7, s[60:63], s40 offen offset:1024
    s_lshr_b32 s42, s2, 1
    s_lshl_b32 s42, s42, 14
    s_and_b32 s80, s2, 1
    s_lshl_b32 s80, s80, 7
    s_add_u32 s42, s42, s80
    s_add_u32 s42, s42, 16
    v_lshrrev_b32 v72, 2, v1
    v_lshlrev_b32 v72, 10, v72
    v_and_b32 v73, 3, v1
    v_lshl_add_u32 v72, v73, 8, v72
    v_lshl_add_u32 v72, v5, 5, v72
    buffer_store_dwordx4 v[68:71], v72, s[64:67], s42 offen
t1_kernel_done:
    s_endpgm
.section .rodata,"a"
.p2align 6
.amdhsa_kernel t1_kernel
  .amdhsa_next_free_vgpr 80
  .amdhsa_next_free_sgpr 102
  .amdhsa_accum_offset 80
  .amdhsa_group_segment_fixed_size 0
  .amdhsa_kernarg_size 112
  .amdhsa_user_sgpr_count 2
  .amdhsa_user_sgpr_kernarg_segment_ptr 1
  .amdhsa_system_sgpr_workgroup_id_x 1
.end_amdhsa_kernel

.text
.globl t2_kernel
.p2align 8
.type t2_kernel,@function
t2_kernel:
    s_cmp_ge_u32 s2, 256
    s_cbranch_scc1 t2_kernel_done
    s_load_dwordx16 s[4:19], s[0:1], 0
    s_load_dwordx8 s[20:27], s[0:1], 64
    s_load_dwordx4 s[28:31], s[0:1], 96
    v_and_b32 v1, 63, v0
    v_lshrrev_b32 v5, 6, v0
    s_waitcnt lgkmcnt(0)
    s_add_u32 s44, s30, 0x850000
    s_addc_u32 s45, s31, 0
    s_mov_b32 s46, 0x200000
    s_mov_b32 s47, 0x20000
    s_add_u32 s48, s30, 0x450000
    s_addc_u32 s49, s31, 0
    s_mov_b32 s50, 0x200000
    s_mov_b32 s51, 0x20000
    s_add_u32 s52, s30, 0x245000
    s_addc_u32 s53, s31, 0
    s_mov_b32 s54, 0x4000
    s_mov_b32 s55, 0x20000
    s_mov_b32 s56, s16
    s_mov_b32 s57, s17
    s_mov_b32 s58, 0x400
    s_mov_b32 s59, 0x20000
    s_add_u32 s60, s30, 0xa50000
    s_addc_u32 s61, s31, 0
    s_mov_b32 s62, 0x200000
    s_mov_b32 s63, 0x20000
    s_add_u32 s64, s30, 0xc50000
    s_addc_u32 s65, s31, 0
    s_mov_b32 s66, 0x200000
    s_mov_b32 s67, 0x20000
    s_lshl_b32 s40, s2, 13
    v_lshlrev_b32 v6, 5, v0
    buffer_load_dwordx4 v[8:11], v6, s[48:51], s40 offen
    buffer_load_dwordx4 v[12:15], v6, s[48:51], s40 offen offset:16
    v_lshlrev_b32 v7, 11, v5
    v_lshl_add_u32 v7, v1, 4, v7
    buffer_load_dwordx4 v[16:19], v7, s[44:47], s40 offen
    buffer_load_dwordx4 v[20:23], v7, s[44:47], s40 offen offset:1024
    v_lshlrev_b32 v2, 4, v5
    s_lshl_b32 s41, s2, 6
    buffer_load_dwordx4 v[24:27], v2, s[52:55], s41 offen
    v_lshlrev_b32 v3, 4, v1
    buffer_load_dwordx4 v[28:31], v3, s[56:59], 0 offen
    v_lshrrev_b32 v2, 2, v0
    v_lshl_add_u32 v2, v2, 4, v6
    s_waitcnt vmcnt(4)
    ds_write_b128 v2, v[8:11]
    ds_write_b128 v2, v[12:15] offset:16
    v_mul_u32_u24 v2, 144, v1
    v_lshl_add_u32 v2, v5, 2, v2
    s_waitcnt lgkmcnt(0)
    s_barrier
    ds_read_b32 v32, v2 offset:0
    ds_read_b32 v33, v2 offset:16
    ds_read_b32 v34, v2 offset:32
    ds_read_b32 v35, v2 offset:48
    ds_read_b32 v36, v2 offset:64
    ds_read_b32 v37, v2 offset:80
    ds_read_b32 v38, v2 offset:96
    ds_read_b32 v39, v2 offset:112
    s_waitcnt vmcnt(0) lgkmcnt(0)
    v_mul_f32 v43, 0x3b000000, v24
    v_mul_f32 v25, 0x3b000000, v25
    v_fma_f32 v25, -v43, v43, v25
    v_max_f32 v25, 0, v25
    v_cvt_pk_bf16_f32 v40, v43, v43
    v_lshlrev_b32 v40, 16, v40
    v_cvt_pk_bf16_f32 v25, v25, v25
    v_lshlrev_b32 v25, 16, v25
    v_add_f32 v25, 0x3727c5ac, v25
    v_cvt_pk_bf16_f32 v25, v25, v25
    v_lshlrev_b32 v25, 16, v25
    v_sqrt_f32 v25, v25
    s_nop 0
    v_cvt_pk_bf16_f32 v41, v25, v25
    v_lshlrev_b32 v41, 16, v41
    v_rcp_f32 v42, v41
    v_lshlrev_b32 v48, 16, v16
    v_mov_b32 v56, v48
    v_sub_f32 v56, v56, v40
    v_cvt_pk_bf16_f32 v56, v56, v56
    v_lshlrev_b32 v56, 16, v56
    v_mul_f32 v43, v56, v42
    v_fma_f32 v44, -v43, v41, v56
    v_fma_f32 v56, v44, v42, v43
    v_cvt_pk_bf16_f32 v56, v56, v56
    v_lshlrev_b32 v56, 16, v56
    v_lshlrev_b32 v43, 16, v28
    v_mul_f32 v56, v56, v43
    v_cvt_pk_bf16_f32 v56, v56, v56
    v_lshlrev_b32 v56, 16, v56
    v_lshlrev_b32 v43, 16, v32
    v_add_f32 v56, v43, v56
    v_cvt_pk_bf16_f32 v56, v56, v56
    v_lshlrev_b32 v56, 16, v56
    v_add_f32 v48, v48, v56
    v_cvt_pk_bf16_f32 v48, v48, v48
    v_lshlrev_b32 v48, 16, v48
    v_and_b32 v49, 0xffff0000, v16
    v_mov_b32 v57, v49
    v_sub_f32 v57, v57, v40
    v_cvt_pk_bf16_f32 v57, v57, v57
    v_lshlrev_b32 v57, 16, v57
    v_mul_f32 v43, v57, v42
    v_fma_f32 v44, -v43, v41, v57
    v_fma_f32 v57, v44, v42, v43
    v_cvt_pk_bf16_f32 v57, v57, v57
    v_lshlrev_b32 v57, 16, v57
    v_and_b32 v43, 0xffff0000, v28
    v_mul_f32 v57, v57, v43
    v_cvt_pk_bf16_f32 v57, v57, v57
    v_lshlrev_b32 v57, 16, v57
    v_lshlrev_b32 v43, 16, v33
    v_add_f32 v57, v43, v57
    v_cvt_pk_bf16_f32 v57, v57, v57
    v_lshlrev_b32 v57, 16, v57
    v_add_f32 v49, v49, v57
    v_cvt_pk_bf16_f32 v49, v49, v49
    v_lshlrev_b32 v49, 16, v49
    v_lshlrev_b32 v50, 16, v17
    v_mov_b32 v58, v50
    v_sub_f32 v58, v58, v40
    v_cvt_pk_bf16_f32 v58, v58, v58
    v_lshlrev_b32 v58, 16, v58
    v_mul_f32 v43, v58, v42
    v_fma_f32 v44, -v43, v41, v58
    v_fma_f32 v58, v44, v42, v43
    v_cvt_pk_bf16_f32 v58, v58, v58
    v_lshlrev_b32 v58, 16, v58
    v_lshlrev_b32 v43, 16, v29
    v_mul_f32 v58, v58, v43
    v_cvt_pk_bf16_f32 v58, v58, v58
    v_lshlrev_b32 v58, 16, v58
    v_lshlrev_b32 v43, 16, v34
    v_add_f32 v58, v43, v58
    v_cvt_pk_bf16_f32 v58, v58, v58
    v_lshlrev_b32 v58, 16, v58
    v_add_f32 v50, v50, v58
    v_cvt_pk_bf16_f32 v50, v50, v50
    v_lshlrev_b32 v50, 16, v50
    v_and_b32 v51, 0xffff0000, v17
    v_mov_b32 v59, v51
    v_sub_f32 v59, v59, v40
    v_cvt_pk_bf16_f32 v59, v59, v59
    v_lshlrev_b32 v59, 16, v59
    v_mul_f32 v43, v59, v42
    v_fma_f32 v44, -v43, v41, v59
    v_fma_f32 v59, v44, v42, v43
    v_cvt_pk_bf16_f32 v59, v59, v59
    v_lshlrev_b32 v59, 16, v59
    v_and_b32 v43, 0xffff0000, v29
    v_mul_f32 v59, v59, v43
    v_cvt_pk_bf16_f32 v59, v59, v59
    v_lshlrev_b32 v59, 16, v59
    v_lshlrev_b32 v43, 16, v35
    v_add_f32 v59, v43, v59
    v_cvt_pk_bf16_f32 v59, v59, v59
    v_lshlrev_b32 v59, 16, v59
    v_add_f32 v51, v51, v59
    v_cvt_pk_bf16_f32 v51, v51, v51
    v_lshlrev_b32 v51, 16, v51
    v_lshlrev_b32 v52, 16, v18
    v_mov_b32 v60, v52
    v_sub_f32 v60, v60, v40
    v_cvt_pk_bf16_f32 v60, v60, v60
    v_lshlrev_b32 v60, 16, v60
    v_mul_f32 v43, v60, v42
    v_fma_f32 v44, -v43, v41, v60
    v_fma_f32 v60, v44, v42, v43
    v_cvt_pk_bf16_f32 v60, v60, v60
    v_lshlrev_b32 v60, 16, v60
    v_lshlrev_b32 v43, 16, v30
    v_mul_f32 v60, v60, v43
    v_cvt_pk_bf16_f32 v60, v60, v60
    v_lshlrev_b32 v60, 16, v60
    v_lshlrev_b32 v43, 16, v36
    v_add_f32 v60, v43, v60
    v_cvt_pk_bf16_f32 v60, v60, v60
    v_lshlrev_b32 v60, 16, v60
    v_add_f32 v52, v52, v60
    v_cvt_pk_bf16_f32 v52, v52, v52
    v_lshlrev_b32 v52, 16, v52
    v_and_b32 v53, 0xffff0000, v18
    v_mov_b32 v61, v53
    v_sub_f32 v61, v61, v40
    v_cvt_pk_bf16_f32 v61, v61, v61
    v_lshlrev_b32 v61, 16, v61
    v_mul_f32 v43, v61, v42
    v_fma_f32 v44, -v43, v41, v61
    v_fma_f32 v61, v44, v42, v43
    v_cvt_pk_bf16_f32 v61, v61, v61
    v_lshlrev_b32 v61, 16, v61
    v_and_b32 v43, 0xffff0000, v30
    v_mul_f32 v61, v61, v43
    v_cvt_pk_bf16_f32 v61, v61, v61
    v_lshlrev_b32 v61, 16, v61
    v_lshlrev_b32 v43, 16, v37
    v_add_f32 v61, v43, v61
    v_cvt_pk_bf16_f32 v61, v61, v61
    v_lshlrev_b32 v61, 16, v61
    v_add_f32 v53, v53, v61
    v_cvt_pk_bf16_f32 v53, v53, v53
    v_lshlrev_b32 v53, 16, v53
    v_lshlrev_b32 v54, 16, v19
    v_mov_b32 v62, v54
    v_sub_f32 v62, v62, v40
    v_cvt_pk_bf16_f32 v62, v62, v62
    v_lshlrev_b32 v62, 16, v62
    v_mul_f32 v43, v62, v42
    v_fma_f32 v44, -v43, v41, v62
    v_fma_f32 v62, v44, v42, v43
    v_cvt_pk_bf16_f32 v62, v62, v62
    v_lshlrev_b32 v62, 16, v62
    v_lshlrev_b32 v43, 16, v31
    v_mul_f32 v62, v62, v43
    v_cvt_pk_bf16_f32 v62, v62, v62
    v_lshlrev_b32 v62, 16, v62
    v_lshlrev_b32 v43, 16, v38
    v_add_f32 v62, v43, v62
    v_cvt_pk_bf16_f32 v62, v62, v62
    v_lshlrev_b32 v62, 16, v62
    v_add_f32 v54, v54, v62
    v_cvt_pk_bf16_f32 v54, v54, v54
    v_lshlrev_b32 v54, 16, v54
    v_and_b32 v55, 0xffff0000, v19
    v_mov_b32 v63, v55
    v_sub_f32 v63, v63, v40
    v_cvt_pk_bf16_f32 v63, v63, v63
    v_lshlrev_b32 v63, 16, v63
    v_mul_f32 v43, v63, v42
    v_fma_f32 v44, -v43, v41, v63
    v_fma_f32 v63, v44, v42, v43
    v_cvt_pk_bf16_f32 v63, v63, v63
    v_lshlrev_b32 v63, 16, v63
    v_and_b32 v43, 0xffff0000, v31
    v_mul_f32 v63, v63, v43
    v_cvt_pk_bf16_f32 v63, v63, v63
    v_lshlrev_b32 v63, 16, v63
    v_lshlrev_b32 v43, 16, v39
    v_add_f32 v63, v43, v63
    v_cvt_pk_bf16_f32 v63, v63, v63
    v_lshlrev_b32 v63, 16, v63
    v_add_f32 v55, v55, v63
    v_cvt_pk_bf16_f32 v55, v55, v55
    v_lshlrev_b32 v55, 16, v55
    v_add_f32 v44, v48, v49
    v_add_f32 v44, v44, v50
    v_add_f32 v44, v44, v51
    v_add_f32 v44, v44, v52
    v_add_f32 v44, v44, v53
    v_add_f32 v44, v44, v54
    v_add_f32 v44, v44, v55
    s_nop 1
    v_add_f32_dpp v44, v44, v44 quad_perm:[1,0,3,2] row_mask:0xf bank_mask:0xf
    s_nop 1
    v_add_f32_dpp v44, v44, v44 quad_perm:[2,3,0,1] row_mask:0xf bank_mask:0xf
    s_nop 1
    v_add_f32_dpp v44, v44, v44 row_half_mirror row_mask:0xf bank_mask:0xf
    s_nop 1
    v_add_f32_dpp v44, v44, v44 row_mirror row_mask:0xf bank_mask:0xf
    s_nop 0
    v_readlane_b32 s70, v44, 0
    v_readlane_b32 s71, v44, 16
    v_readlane_b32 s72, v44, 32
    v_readlane_b32 s73, v44, 48
    v_mov_b32 v44, s70
    v_add_f32 v44, s71, v44
    v_add_f32 v44, s72, v44
    v_add_f32 v44, s73, v44
    v_mul_f32 v44, 0x3b000000, v44
    v_sub_f32 v56, v48, v44
    v_sub_f32 v57, v49, v44
    v_sub_f32 v58, v50, v44
    v_sub_f32 v59, v51, v44
    v_sub_f32 v60, v52, v44
    v_sub_f32 v61, v53, v44
    v_sub_f32 v62, v54, v44
    v_sub_f32 v63, v55, v44
    v_mul_f32 v45, v56, v56
    v_fmac_f32 v45, v57, v57
    v_fmac_f32 v45, v58, v58
    v_fmac_f32 v45, v59, v59
    v_fmac_f32 v45, v60, v60
    v_fmac_f32 v45, v61, v61
    v_fmac_f32 v45, v62, v62
    v_fmac_f32 v45, v63, v63
    s_nop 1
    v_add_f32_dpp v45, v45, v45 quad_perm:[1,0,3,2] row_mask:0xf bank_mask:0xf
    s_nop 1
    v_add_f32_dpp v45, v45, v45 quad_perm:[2,3,0,1] row_mask:0xf bank_mask:0xf
    s_nop 1
    v_add_f32_dpp v45, v45, v45 row_half_mirror row_mask:0xf bank_mask:0xf
    s_nop 1
    v_add_f32_dpp v45, v45, v45 row_mirror row_mask:0xf bank_mask:0xf
    s_nop 0
    v_readlane_b32 s74, v45, 0
    v_readlane_b32 s75, v45, 16
    v_readlane_b32 s76, v45, 32
    v_readlane_b32 s77, v45, 48
    v_mov_b32 v45, s74
    v_add_f32 v45, s75, v45
    v_add_f32 v45, s76, v45
    v_add_f32 v45, s77, v45
    v_mul_f32 v45, 0x3b000000, v45
    v_cvt_pk_bf16_f32 v40, v44, v44
    v_lshlrev_b32 v40, 16, v40
    v_cvt_pk_bf16_f32 v45, v45, v45
    v_lshlrev_b32 v45, 16, v45
    v_add_f32 v45, 0x3727c5ac, v45
    v_cvt_pk_bf16_f32 v45, v45, v45
    v_lshlrev_b32 v45, 16, v45
    v_sqrt_f32 v45, v45
    s_nop 0
    v_cvt_pk_bf16_f32 v41, v45, v45
    v_lshlrev_b32 v41, 16, v41
    v_rcp_f32 v42, v41
    s_mov_b32 s43, 0x07060302
    v_perm_b32 v64, v49, v48, s43
    v_perm_b32 v65, v51, v50, s43
    v_perm_b32 v66, v53, v52, s43
    v_perm_b32 v67, v55, v54, s43
    v_sub_f32 v48, v48, v40
    v_cvt_pk_bf16_f32 v48, v48, v48
    v_lshlrev_b32 v48, 16, v48
    v_mul_f32 v43, v48, v42
    v_fma_f32 v44, -v43, v41, v48
    v_fma_f32 v48, v44, v42, v43
    v_cvt_pk_bf16_f32 v48, v48, v48
    v_lshlrev_b32 v48, 16, v48
    v_sub_f32 v49, v49, v40
    v_cvt_pk_bf16_f32 v49, v49, v49
    v_lshlrev_b32 v49, 16, v49
    v_mul_f32 v43, v49, v42
    v_fma_f32 v44, -v43, v41, v49
    v_fma_f32 v49, v44, v42, v43
    v_cvt_pk_bf16_f32 v49, v49, v49
    v_lshlrev_b32 v49, 16, v49
    v_sub_f32 v50, v50, v40
    v_cvt_pk_bf16_f32 v50, v50, v50
    v_lshlrev_b32 v50, 16, v50
    v_mul_f32 v43, v50, v42
    v_fma_f32 v44, -v43, v41, v50
    v_fma_f32 v50, v44, v42, v43
    v_cvt_pk_bf16_f32 v50, v50, v50
    v_lshlrev_b32 v50, 16, v50
    v_sub_f32 v51, v51, v40
    v_cvt_pk_bf16_f32 v51, v51, v51
    v_lshlrev_b32 v51, 16, v51
    v_mul_f32 v43, v51, v42
    v_fma_f32 v44, -v43, v41, v51
    v_fma_f32 v51, v44, v42, v43
    v_cvt_pk_bf16_f32 v51, v51, v51
    v_lshlrev_b32 v51, 16, v51
    v_sub_f32 v52, v52, v40
    v_cvt_pk_bf16_f32 v52, v52, v52
    v_lshlrev_b32 v52, 16, v52
    v_mul_f32 v43, v52, v42
    v_fma_f32 v44, -v43, v41, v52
    v_fma_f32 v52, v44, v42, v43
    v_cvt_pk_bf16_f32 v52, v52, v52
    v_lshlrev_b32 v52, 16, v52
    v_sub_f32 v53, v53, v40
    v_cvt_pk_bf16_f32 v53, v53, v53
    v_lshlrev_b32 v53, 16, v53
    v_mul_f32 v43, v53, v42
    v_fma_f32 v44, -v43, v41, v53
    v_fma_f32 v53, v44, v42, v43
    v_cvt_pk_bf16_f32 v53, v53, v53
    v_lshlrev_b32 v53, 16, v53
    v_sub_f32 v54, v54, v40
    v_cvt_pk_bf16_f32 v54, v54, v54
    v_lshlrev_b32 v54, 16, v54
    v_mul_f32 v43, v54, v42
    v_fma_f32 v44, -v43, v41, v54
    v_fma_f32 v54, v44, v42, v43
    v_cvt_pk_bf16_f32 v54, v54, v54
    v_lshlrev_b32 v54, 16, v54
    v_sub_f32 v55, v55, v40
    v_cvt_pk_bf16_f32 v55, v55, v55
    v_lshlrev_b32 v55, 16, v55
    v_mul_f32 v43, v55, v42
    v_fma_f32 v44, -v43, v41, v55
    v_fma_f32 v55, v44, v42, v43
    v_cvt_pk_bf16_f32 v55, v55, v55
    v_lshlrev_b32 v55, 16, v55
    v_perm_b32 v68, v49, v48, s43
    v_perm_b32 v69, v51, v50, s43
    v_perm_b32 v70, v53, v52, s43
    v_perm_b32 v71, v55, v54, s43
    buffer_store_dwordx4 v[64:67], v7, s[60:63], s40 offen offset:0
    s_lshr_b32 s42, s2, 1
    s_lshl_b32 s42, s42, 14
    s_and_b32 s80, s2, 1
    s_lshl_b32 s80, s80, 7
    s_add_u32 s42, s42, s80
    s_add_u32 s42, s42, 0
    v_lshrrev_b32 v72, 2, v1
    v_lshlrev_b32 v72, 10, v72
    v_and_b32 v73, 3, v1
    v_lshl_add_u32 v72, v73, 8, v72
    v_lshl_add_u32 v72, v5, 5, v72
    buffer_store_dwordx4 v[68:71], v72, s[64:67], s42 offen
    v_mul_f32 v43, 0x3b000000, v26
    v_mul_f32 v27, 0x3b000000, v27
    v_fma_f32 v27, -v43, v43, v27
    v_max_f32 v27, 0, v27
    v_cvt_pk_bf16_f32 v40, v43, v43
    v_lshlrev_b32 v40, 16, v40
    v_cvt_pk_bf16_f32 v27, v27, v27
    v_lshlrev_b32 v27, 16, v27
    v_add_f32 v27, 0x3727c5ac, v27
    v_cvt_pk_bf16_f32 v27, v27, v27
    v_lshlrev_b32 v27, 16, v27
    v_sqrt_f32 v27, v27
    s_nop 0
    v_cvt_pk_bf16_f32 v41, v27, v27
    v_lshlrev_b32 v41, 16, v41
    v_rcp_f32 v42, v41
    v_lshlrev_b32 v48, 16, v20
    v_mov_b32 v56, v48
    v_sub_f32 v56, v56, v40
    v_cvt_pk_bf16_f32 v56, v56, v56
    v_lshlrev_b32 v56, 16, v56
    v_mul_f32 v43, v56, v42
    v_fma_f32 v44, -v43, v41, v56
    v_fma_f32 v56, v44, v42, v43
    v_cvt_pk_bf16_f32 v56, v56, v56
    v_lshlrev_b32 v56, 16, v56
    v_lshlrev_b32 v43, 16, v28
    v_mul_f32 v56, v56, v43
    v_cvt_pk_bf16_f32 v56, v56, v56
    v_lshlrev_b32 v56, 16, v56
    v_and_b32 v43, 0xffff0000, v32
    v_add_f32 v56, v43, v56
    v_cvt_pk_bf16_f32 v56, v56, v56
    v_lshlrev_b32 v56, 16, v56
    v_add_f32 v48, v48, v56
    v_cvt_pk_bf16_f32 v48, v48, v48
    v_lshlrev_b32 v48, 16, v48
    v_and_b32 v49, 0xffff0000, v20
    v_mov_b32 v57, v49
    v_sub_f32 v57, v57, v40
    v_cvt_pk_bf16_f32 v57, v57, v57
    v_lshlrev_b32 v57, 16, v57
    v_mul_f32 v43, v57, v42
    v_fma_f32 v44, -v43, v41, v57
    v_fma_f32 v57, v44, v42, v43
    v_cvt_pk_bf16_f32 v57, v57, v57
    v_lshlrev_b32 v57, 16, v57
    v_and_b32 v43, 0xffff0000, v28
    v_mul_f32 v57, v57, v43
    v_cvt_pk_bf16_f32 v57, v57, v57
    v_lshlrev_b32 v57, 16, v57
    v_and_b32 v43, 0xffff0000, v33
    v_add_f32 v57, v43, v57
    v_cvt_pk_bf16_f32 v57, v57, v57
    v_lshlrev_b32 v57, 16, v57
    v_add_f32 v49, v49, v57
    v_cvt_pk_bf16_f32 v49, v49, v49
    v_lshlrev_b32 v49, 16, v49
    v_lshlrev_b32 v50, 16, v21
    v_mov_b32 v58, v50
    v_sub_f32 v58, v58, v40
    v_cvt_pk_bf16_f32 v58, v58, v58
    v_lshlrev_b32 v58, 16, v58
    v_mul_f32 v43, v58, v42
    v_fma_f32 v44, -v43, v41, v58
    v_fma_f32 v58, v44, v42, v43
    v_cvt_pk_bf16_f32 v58, v58, v58
    v_lshlrev_b32 v58, 16, v58
    v_lshlrev_b32 v43, 16, v29
    v_mul_f32 v58, v58, v43
    v_cvt_pk_bf16_f32 v58, v58, v58
    v_lshlrev_b32 v58, 16, v58
    v_and_b32 v43, 0xffff0000, v34
    v_add_f32 v58, v43, v58
    v_cvt_pk_bf16_f32 v58, v58, v58
    v_lshlrev_b32 v58, 16, v58
    v_add_f32 v50, v50, v58
    v_cvt_pk_bf16_f32 v50, v50, v50
    v_lshlrev_b32 v50, 16, v50
    v_and_b32 v51, 0xffff0000, v21
    v_mov_b32 v59, v51
    v_sub_f32 v59, v59, v40
    v_cvt_pk_bf16_f32 v59, v59, v59
    v_lshlrev_b32 v59, 16, v59
    v_mul_f32 v43, v59, v42
    v_fma_f32 v44, -v43, v41, v59
    v_fma_f32 v59, v44, v42, v43
    v_cvt_pk_bf16_f32 v59, v59, v59
    v_lshlrev_b32 v59, 16, v59
    v_and_b32 v43, 0xffff0000, v29
    v_mul_f32 v59, v59, v43
    v_cvt_pk_bf16_f32 v59, v59, v59
    v_lshlrev_b32 v59, 16, v59
    v_and_b32 v43, 0xffff0000, v35
    v_add_f32 v59, v43, v59
    v_cvt_pk_bf16_f32 v59, v59, v59
    v_lshlrev_b32 v59, 16, v59
    v_add_f32 v51, v51, v59
    v_cvt_pk_bf16_f32 v51, v51, v51
    v_lshlrev_b32 v51, 16, v51
    v_lshlrev_b32 v52, 16, v22
    v_mov_b32 v60, v52
    v_sub_f32 v60, v60, v40
    v_cvt_pk_bf16_f32 v60, v60, v60
    v_lshlrev_b32 v60, 16, v60
    v_mul_f32 v43, v60, v42
    v_fma_f32 v44, -v43, v41, v60
    v_fma_f32 v60, v44, v42, v43
    v_cvt_pk_bf16_f32 v60, v60, v60
    v_lshlrev_b32 v60, 16, v60
    v_lshlrev_b32 v43, 16, v30
    v_mul_f32 v60, v60, v43
    v_cvt_pk_bf16_f32 v60, v60, v60
    v_lshlrev_b32 v60, 16, v60
    v_and_b32 v43, 0xffff0000, v36
    v_add_f32 v60, v43, v60
    v_cvt_pk_bf16_f32 v60, v60, v60
    v_lshlrev_b32 v60, 16, v60
    v_add_f32 v52, v52, v60
    v_cvt_pk_bf16_f32 v52, v52, v52
    v_lshlrev_b32 v52, 16, v52
    v_and_b32 v53, 0xffff0000, v22
    v_mov_b32 v61, v53
    v_sub_f32 v61, v61, v40
    v_cvt_pk_bf16_f32 v61, v61, v61
    v_lshlrev_b32 v61, 16, v61
    v_mul_f32 v43, v61, v42
    v_fma_f32 v44, -v43, v41, v61
    v_fma_f32 v61, v44, v42, v43
    v_cvt_pk_bf16_f32 v61, v61, v61
    v_lshlrev_b32 v61, 16, v61
    v_and_b32 v43, 0xffff0000, v30
    v_mul_f32 v61, v61, v43
    v_cvt_pk_bf16_f32 v61, v61, v61
    v_lshlrev_b32 v61, 16, v61
    v_and_b32 v43, 0xffff0000, v37
    v_add_f32 v61, v43, v61
    v_cvt_pk_bf16_f32 v61, v61, v61
    v_lshlrev_b32 v61, 16, v61
    v_add_f32 v53, v53, v61
    v_cvt_pk_bf16_f32 v53, v53, v53
    v_lshlrev_b32 v53, 16, v53
    v_lshlrev_b32 v54, 16, v23
    v_mov_b32 v62, v54
    v_sub_f32 v62, v62, v40
    v_cvt_pk_bf16_f32 v62, v62, v62
    v_lshlrev_b32 v62, 16, v62
    v_mul_f32 v43, v62, v42
    v_fma_f32 v44, -v43, v41, v62
    v_fma_f32 v62, v44, v42, v43
    v_cvt_pk_bf16_f32 v62, v62, v62
    v_lshlrev_b32 v62, 16, v62
    v_lshlrev_b32 v43, 16, v31
    v_mul_f32 v62, v62, v43
    v_cvt_pk_bf16_f32 v62, v62, v62
    v_lshlrev_b32 v62, 16, v62
    v_and_b32 v43, 0xffff0000, v38
    v_add_f32 v62, v43, v62
    v_cvt_pk_bf16_f32 v62, v62, v62
    v_lshlrev_b32 v62, 16, v62
    v_add_f32 v54, v54, v62
    v_cvt_pk_bf16_f32 v54, v54, v54
    v_lshlrev_b32 v54, 16, v54
    v_and_b32 v55, 0xffff0000, v23
    v_mov_b32 v63, v55
    v_sub_f32 v63, v63, v40
    v_cvt_pk_bf16_f32 v63, v63, v63
    v_lshlrev_b32 v63, 16, v63
    v_mul_f32 v43, v63, v42
    v_fma_f32 v44, -v43, v41, v63
    v_fma_f32 v63, v44, v42, v43
    v_cvt_pk_bf16_f32 v63, v63, v63
    v_lshlrev_b32 v63, 16, v63
    v_and_b32 v43, 0xffff0000, v31
    v_mul_f32 v63, v63, v43
    v_cvt_pk_bf16_f32 v63, v63, v63
    v_lshlrev_b32 v63, 16, v63
    v_and_b32 v43, 0xffff0000, v39
    v_add_f32 v63, v43, v63
    v_cvt_pk_bf16_f32 v63, v63, v63
    v_lshlrev_b32 v63, 16, v63
    v_add_f32 v55, v55, v63
    v_cvt_pk_bf16_f32 v55, v55, v55
    v_lshlrev_b32 v55, 16, v55
    v_add_f32 v44, v48, v49
    v_add_f32 v44, v44, v50
    v_add_f32 v44, v44, v51
    v_add_f32 v44, v44, v52
    v_add_f32 v44, v44, v53
    v_add_f32 v44, v44, v54
    v_add_f32 v44, v44, v55
    s_nop 1
    v_add_f32_dpp v44, v44, v44 quad_perm:[1,0,3,2] row_mask:0xf bank_mask:0xf
    s_nop 1
    v_add_f32_dpp v44, v44, v44 quad_perm:[2,3,0,1] row_mask:0xf bank_mask:0xf
    s_nop 1
    v_add_f32_dpp v44, v44, v44 row_half_mirror row_mask:0xf bank_mask:0xf
    s_nop 1
    v_add_f32_dpp v44, v44, v44 row_mirror row_mask:0xf bank_mask:0xf
    s_nop 0
    v_readlane_b32 s70, v44, 0
    v_readlane_b32 s71, v44, 16
    v_readlane_b32 s72, v44, 32
    v_readlane_b32 s73, v44, 48
    v_mov_b32 v44, s70
    v_add_f32 v44, s71, v44
    v_add_f32 v44, s72, v44
    v_add_f32 v44, s73, v44
    v_mul_f32 v44, 0x3b000000, v44
    v_sub_f32 v56, v48, v44
    v_sub_f32 v57, v49, v44
    v_sub_f32 v58, v50, v44
    v_sub_f32 v59, v51, v44
    v_sub_f32 v60, v52, v44
    v_sub_f32 v61, v53, v44
    v_sub_f32 v62, v54, v44
    v_sub_f32 v63, v55, v44
    v_mul_f32 v45, v56, v56
    v_fmac_f32 v45, v57, v57
    v_fmac_f32 v45, v58, v58
    v_fmac_f32 v45, v59, v59
    v_fmac_f32 v45, v60, v60
    v_fmac_f32 v45, v61, v61
    v_fmac_f32 v45, v62, v62
    v_fmac_f32 v45, v63, v63
    s_nop 1
    v_add_f32_dpp v45, v45, v45 quad_perm:[1,0,3,2] row_mask:0xf bank_mask:0xf
    s_nop 1
    v_add_f32_dpp v45, v45, v45 quad_perm:[2,3,0,1] row_mask:0xf bank_mask:0xf
    s_nop 1
    v_add_f32_dpp v45, v45, v45 row_half_mirror row_mask:0xf bank_mask:0xf
    s_nop 1
    v_add_f32_dpp v45, v45, v45 row_mirror row_mask:0xf bank_mask:0xf
    s_nop 0
    v_readlane_b32 s74, v45, 0
    v_readlane_b32 s75, v45, 16
    v_readlane_b32 s76, v45, 32
    v_readlane_b32 s77, v45, 48
    v_mov_b32 v45, s74
    v_add_f32 v45, s75, v45
    v_add_f32 v45, s76, v45
    v_add_f32 v45, s77, v45
    v_mul_f32 v45, 0x3b000000, v45
    v_cvt_pk_bf16_f32 v40, v44, v44
    v_lshlrev_b32 v40, 16, v40
    v_cvt_pk_bf16_f32 v45, v45, v45
    v_lshlrev_b32 v45, 16, v45
    v_add_f32 v45, 0x3727c5ac, v45
    v_cvt_pk_bf16_f32 v45, v45, v45
    v_lshlrev_b32 v45, 16, v45
    v_sqrt_f32 v45, v45
    s_nop 0
    v_cvt_pk_bf16_f32 v41, v45, v45
    v_lshlrev_b32 v41, 16, v41
    v_rcp_f32 v42, v41
    s_mov_b32 s43, 0x07060302
    v_perm_b32 v64, v49, v48, s43
    v_perm_b32 v65, v51, v50, s43
    v_perm_b32 v66, v53, v52, s43
    v_perm_b32 v67, v55, v54, s43
    v_sub_f32 v48, v48, v40
    v_cvt_pk_bf16_f32 v48, v48, v48
    v_lshlrev_b32 v48, 16, v48
    v_mul_f32 v43, v48, v42
    v_fma_f32 v44, -v43, v41, v48
    v_fma_f32 v48, v44, v42, v43
    v_cvt_pk_bf16_f32 v48, v48, v48
    v_lshlrev_b32 v48, 16, v48
    v_sub_f32 v49, v49, v40
    v_cvt_pk_bf16_f32 v49, v49, v49
    v_lshlrev_b32 v49, 16, v49
    v_mul_f32 v43, v49, v42
    v_fma_f32 v44, -v43, v41, v49
    v_fma_f32 v49, v44, v42, v43
    v_cvt_pk_bf16_f32 v49, v49, v49
    v_lshlrev_b32 v49, 16, v49
    v_sub_f32 v50, v50, v40
    v_cvt_pk_bf16_f32 v50, v50, v50
    v_lshlrev_b32 v50, 16, v50
    v_mul_f32 v43, v50, v42
    v_fma_f32 v44, -v43, v41, v50
    v_fma_f32 v50, v44, v42, v43
    v_cvt_pk_bf16_f32 v50, v50, v50
    v_lshlrev_b32 v50, 16, v50
    v_sub_f32 v51, v51, v40
    v_cvt_pk_bf16_f32 v51, v51, v51
    v_lshlrev_b32 v51, 16, v51
    v_mul_f32 v43, v51, v42
    v_fma_f32 v44, -v43, v41, v51
    v_fma_f32 v51, v44, v42, v43
    v_cvt_pk_bf16_f32 v51, v51, v51
    v_lshlrev_b32 v51, 16, v51
    v_sub_f32 v52, v52, v40
    v_cvt_pk_bf16_f32 v52, v52, v52
    v_lshlrev_b32 v52, 16, v52
    v_mul_f32 v43, v52, v42
    v_fma_f32 v44, -v43, v41, v52
    v_fma_f32 v52, v44, v42, v43
    v_cvt_pk_bf16_f32 v52, v52, v52
    v_lshlrev_b32 v52, 16, v52
    v_sub_f32 v53, v53, v40
    v_cvt_pk_bf16_f32 v53, v53, v53
    v_lshlrev_b32 v53, 16, v53
    v_mul_f32 v43, v53, v42
    v_fma_f32 v44, -v43, v41, v53
    v_fma_f32 v53, v44, v42, v43
    v_cvt_pk_bf16_f32 v53, v53, v53
    v_lshlrev_b32 v53, 16, v53
    v_sub_f32 v54, v54, v40
    v_cvt_pk_bf16_f32 v54, v54, v54
    v_lshlrev_b32 v54, 16, v54
    v_mul_f32 v43, v54, v42
    v_fma_f32 v44, -v43, v41, v54
    v_fma_f32 v54, v44, v42, v43
    v_cvt_pk_bf16_f32 v54, v54, v54
    v_lshlrev_b32 v54, 16, v54
    v_sub_f32 v55, v55, v40
    v_cvt_pk_bf16_f32 v55, v55, v55
    v_lshlrev_b32 v55, 16, v55
    v_mul_f32 v43, v55, v42
    v_fma_f32 v44, -v43, v41, v55
    v_fma_f32 v55, v44, v42, v43
    v_cvt_pk_bf16_f32 v55, v55, v55
    v_lshlrev_b32 v55, 16, v55
    v_perm_b32 v68, v49, v48, s43
    v_perm_b32 v69, v51, v50, s43
    v_perm_b32 v70, v53, v52, s43
    v_perm_b32 v71, v55, v54, s43
    buffer_store_dwordx4 v[64:67], v7, s[60:63], s40 offen offset:1024
    s_lshr_b32 s42, s2, 1
    s_lshl_b32 s42, s42, 14
    s_and_b32 s80, s2, 1
    s_lshl_b32 s80, s80, 7
    s_add_u32 s42, s42, s80
    s_add_u32 s42, s42, 16
    v_lshrrev_b32 v72, 2, v1
    v_lshlrev_b32 v72, 10, v72
    v_and_b32 v73, 3, v1
    v_lshl_add_u32 v72, v73, 8, v72
    v_lshl_add_u32 v72, v5, 5, v72
    buffer_store_dwordx4 v[68:71], v72, s[64:67], s42 offen
t2_kernel_done:
    s_endpgm
.section .rodata,"a"
.p2align 6
.amdhsa_kernel t2_kernel
  .amdhsa_next_free_vgpr 80
  .amdhsa_next_free_sgpr 102
  .amdhsa_accum_offset 80
  .amdhsa_group_segment_fixed_size 0
  .amdhsa_kernarg_size 112
  .amdhsa_user_sgpr_count 2
  .amdhsa_user_sgpr_kernarg_segment_ptr 1
  .amdhsa_system_sgpr_workgroup_id_x 1
.end_amdhsa_kernel

.text
.globl ffn1_kernel
.p2align 8
.type ffn1_kernel,@function
ffn1_kernel:
    s_cmp_ge_u32 s2, 256
    s_cbranch_scc1 ffn1_kernel_done
    s_load_dwordx16 s[4:19], s[0:1], 0
    s_load_dwordx8 s[20:27], s[0:1], 64
    s_load_dwordx4 s[28:31], s[0:1], 96
    v_and_b32 v1, 63, v0
    v_lshrrev_b32 v5, 6, v0
    v_lshlrev_b32 v2, 4, v1
    v_readfirstlane_b32 s50, v5
    s_waitcnt lgkmcnt(0)
    s_add_u32 s44, s30, 0xc50000
    s_addc_u32 s45, s31, 0
    s_mov_b32 s46, 0x200000
    s_mov_b32 s47, 0x20000
    s_add_u32 s52, s30, 0x13b0000
    s_addc_u32 s53, s31, 0
    s_mov_b32 s54, 0x2b0000
    s_mov_b32 s55, 0x20000
    s_add_u32 s56, s30, 0xe50000
    s_addc_u32 s57, s31, 0
    s_mov_b32 s58, 0x560000
    s_mov_b32 s59, 0x20000
    s_add_u32 s84, s30, 0x1660000
    s_addc_u32 s85, s31, 0
    s_mov_b32 s86, 0x158000
    s_mov_b32 s87, 0x20000
    s_add_u32 s88, s30, 0x17c0000
    s_addc_u32 s89, s31, 0
    s_mov_b32 s90, 0x10000
    s_mov_b32 s91, 0x20000
    s_and_b32 s60, s2, 7
    s_lshr_b32 s61, s2, 3
    s_and_b32 s40, s60, 3
    s_lshl_b32 s40, s40, 2
    s_and_b32 s62, s61, 3
    s_add_u32 s40, s40, s62
    s_lshr_b32 s41, s60, 2
    s_lshl_b32 s41, s41, 3
    s_lshr_b32 s62, s61, 2
    s_add_u32 s41, s41, s62
    s_mul_i32 s42, s41, 3
    s_lshl_b32 s43, s41, 1
    s_add_u32 s43, s43, 11
    s_cmp_lt_u32 s41, 11
    s_cselect_b32 s42, s42, s43
    s_lshl_b32 s80, s42, 16
    s_lshl_b32 s81, s50, 13
    s_add_u32 s80, s80, s81
    s_lshl_b32 s48, s40, 3
    s_lshl_b32 s49, s50, 1
    s_add_u32 s48, s48, s49
    s_lshl_b32 s49, s48, 14
    s_and_b32 s92, s41, 1
    s_lshl_b32 s93, s40, 1
    s_add_u32 s92, s92, s93
    s_lshr_b32 s93, s41, 1
    s_mul_i32 s94, s92, 172
    s_add_u32 s94, s94, s50
    s_lshl_b32 s94, s94, 10
    s_mul_i32 s95, s93, 43
    s_add_u32 s95, s95, s50
    s_lshl_b32 s95, s95, 12
    v_add_u32 v8, 0, v2
    v_add_u32 v9, 32768, v2
    v_add_u32 v10, 65536, v2
    v_add_u32 v11, 98304, v2
    s_cmp_lt_u32 s41, 11
    s_cbranch_scc0 ffn1_kernel_two
    s_add_u32 s51, s81, 0
    s_mov_b32 m0, s51
    s_add_u32 s61, s80, 0
    buffer_load_dwordx4 v2, s[52:55], s61 offen offset:0 lds
    buffer_load_dwordx4 v2, s[52:55], s61 offen offset:1024 lds
    buffer_load_dwordx4 v2, s[52:55], s61 offen offset:2048 lds
    buffer_load_dwordx4 v2, s[52:55], s61 offen offset:3072 lds
    s_add_u32 s51, s81, 4096
    s_mov_b32 m0, s51
    s_add_u32 s61, s80, 4096
    buffer_load_dwordx4 v2, s[52:55], s61 offen offset:0 lds
    buffer_load_dwordx4 v2, s[52:55], s61 offen offset:1024 lds
    buffer_load_dwordx4 v2, s[52:55], s61 offen offset:2048 lds
    buffer_load_dwordx4 v2, s[52:55], s61 offen offset:3072 lds
    s_add_u32 s51, s49, 0
    buffer_load_dwordx4 v[128:131], v2, s[44:47], s51 offen
    s_add_u32 s51, s49, 1024
    buffer_load_dwordx4 v[132:135], v2, s[44:47], s51 offen
    s_add_u32 s51, s49, 2048
    buffer_load_dwordx4 v[136:139], v2, s[44:47], s51 offen
    s_add_u32 s51, s49, 3072
    buffer_load_dwordx4 v[140:143], v2, s[44:47], s51 offen
    s_add_u32 s51, s49, 4096
    buffer_load_dwordx4 v[144:147], v2, s[44:47], s51 offen
    s_add_u32 s51, s49, 5120
    buffer_load_dwordx4 v[148:151], v2, s[44:47], s51 offen
    s_add_u32 s51, s49, 6144
    buffer_load_dwordx4 v[152:155], v2, s[44:47], s51 offen
    s_add_u32 s51, s49, 7168
    buffer_load_dwordx4 v[156:159], v2, s[44:47], s51 offen
    s_add_u32 s51, s49, 8192
    buffer_load_dwordx4 v[160:163], v2, s[44:47], s51 offen
    s_add_u32 s51, s49, 9216
    buffer_load_dwordx4 v[164:167], v2, s[44:47], s51 offen
    s_add_u32 s51, s49, 10240
    buffer_load_dwordx4 v[168:171], v2, s[44:47], s51 offen
    s_add_u32 s51, s49, 11264
    buffer_load_dwordx4 v[172:175], v2, s[44:47], s51 offen
    s_add_u32 s51, s49, 12288
    buffer_load_dwordx4 v[176:179], v2, s[44:47], s51 offen
    s_add_u32 s51, s49, 13312
    buffer_load_dwordx4 v[180:183], v2, s[44:47], s51 offen
    s_add_u32 s51, s49, 14336
    buffer_load_dwordx4 v[184:187], v2, s[44:47], s51 offen
    s_add_u32 s51, s49, 15360
    buffer_load_dwordx4 v[188:191], v2, s[44:47], s51 offen
    s_add_u32 s51, s49, 16384
    buffer_load_dwordx4 v[192:195], v2, s[44:47], s51 offen
    s_add_u32 s51, s49, 17408
    buffer_load_dwordx4 v[196:199], v2, s[44:47], s51 offen
    s_add_u32 s51, s49, 18432
    buffer_load_dwordx4 v[200:203], v2, s[44:47], s51 offen
    s_add_u32 s51, s49, 19456
    buffer_load_dwordx4 v[204:207], v2, s[44:47], s51 offen
    s_add_u32 s51, s49, 20480
    buffer_load_dwordx4 v[208:211], v2, s[44:47], s51 offen
    s_add_u32 s51, s49, 21504
    buffer_load_dwordx4 v[212:215], v2, s[44:47], s51 offen
    s_add_u32 s51, s49, 22528
    buffer_load_dwordx4 v[216:219], v2, s[44:47], s51 offen
    s_add_u32 s51, s49, 23552
    buffer_load_dwordx4 v[220:223], v2, s[44:47], s51 offen
    s_add_u32 s51, s49, 24576
    buffer_load_dwordx4 v[224:227], v2, s[44:47], s51 offen
    s_add_u32 s51, s49, 25600
    buffer_load_dwordx4 v[228:231], v2, s[44:47], s51 offen
    s_add_u32 s51, s49, 26624
    buffer_load_dwordx4 v[232:235], v2, s[44:47], s51 offen
    s_add_u32 s51, s49, 27648
    buffer_load_dwordx4 v[236:239], v2, s[44:47], s51 offen
    s_add_u32 s51, s49, 28672
    buffer_load_dwordx4 v[240:243], v2, s[44:47], s51 offen
    s_add_u32 s51, s49, 29696
    buffer_load_dwordx4 v[244:247], v2, s[44:47], s51 offen
    s_add_u32 s51, s49, 30720
    buffer_load_dwordx4 v[248:251], v2, s[44:47], s51 offen
    s_add_u32 s51, s49, 31744
    buffer_load_dwordx4 v[252:255], v2, s[44:47], s51 offen
    s_add_u32 s51, s81, 32768
    s_mov_b32 m0, s51
    s_add_u32 s61, s80, 32768
    buffer_load_dwordx4 v2, s[52:55], s61 offen offset:0 lds
    buffer_load_dwordx4 v2, s[52:55], s61 offen offset:1024 lds
    buffer_load_dwordx4 v2, s[52:55], s61 offen offset:2048 lds
    buffer_load_dwordx4 v2, s[52:55], s61 offen offset:3072 lds
    s_add_u32 s51, s81, 36864
    s_mov_b32 m0, s51
    s_add_u32 s61, s80, 36864
    buffer_load_dwordx4 v2, s[52:55], s61 offen offset:0 lds
    buffer_load_dwordx4 v2, s[52:55], s61 offen offset:1024 lds
    buffer_load_dwordx4 v2, s[52:55], s61 offen offset:2048 lds
    buffer_load_dwordx4 v2, s[52:55], s61 offen offset:3072 lds
    s_add_u32 s51, s81, 65536
    s_mov_b32 m0, s51
    s_add_u32 s61, s80, 65536
    buffer_load_dwordx4 v2, s[52:55], s61 offen offset:0 lds
    buffer_load_dwordx4 v2, s[52:55], s61 offen offset:1024 lds
    buffer_load_dwordx4 v2, s[52:55], s61 offen offset:2048 lds
    buffer_load_dwordx4 v2, s[52:55], s61 offen offset:3072 lds
    s_add_u32 s51, s81, 69632
    s_mov_b32 m0, s51
    s_add_u32 s61, s80, 69632
    buffer_load_dwordx4 v2, s[52:55], s61 offen offset:0 lds
    buffer_load_dwordx4 v2, s[52:55], s61 offen offset:1024 lds
    buffer_load_dwordx4 v2, s[52:55], s61 offen offset:2048 lds
    buffer_load_dwordx4 v2, s[52:55], s61 offen offset:3072 lds
    s_add_u32 s51, s81, 98304
    s_mov_b32 m0, s51
    s_add_u32 s61, s80, 98304
    buffer_load_dwordx4 v2, s[52:55], s61 offen offset:0 lds
    buffer_load_dwordx4 v2, s[52:55], s61 offen offset:1024 lds
    buffer_load_dwordx4 v2, s[52:55], s61 offen offset:2048 lds
    buffer_load_dwordx4 v2, s[52:55], s61 offen offset:3072 lds
    s_add_u32 s51, s81, 102400
    s_mov_b32 m0, s51
    s_add_u32 s61, s80, 102400
    buffer_load_dwordx4 v2, s[52:55], s61 offen offset:0 lds
    buffer_load_dwordx4 v2, s[52:55], s61 offen offset:1024 lds
    buffer_load_dwordx4 v2, s[52:55], s61 offen offset:2048 lds
    buffer_load_dwordx4 v2, s[52:55], s61 offen offset:3072 lds
    v_mov_b32 v64, 0
    v_mov_b32 v65, 0
    v_mov_b32 v66, 0
    v_mov_b32 v67, 0
    v_mov_b32 v68, 0
    v_mov_b32 v69, 0
    v_mov_b32 v70, 0
    v_mov_b32 v71, 0
    v_mov_b32 v72, 0
    v_mov_b32 v73, 0
    v_mov_b32 v74, 0
    v_mov_b32 v75, 0
    v_mov_b32 v76, 0
    v_mov_b32 v77, 0
    v_mov_b32 v78, 0
    v_mov_b32 v79, 0
    v_mov_b32 v80, 0
    v_mov_b32 v81, 0
    v_mov_b32 v82, 0
    v_mov_b32 v83, 0
    v_mov_b32 v84, 0
    v_mov_b32 v85, 0
    v_mov_b32 v86, 0
    v_mov_b32 v87, 0
    v_mov_b32 v88, 0
    v_mov_b32 v89, 0
    v_mov_b32 v90, 0
    v_mov_b32 v91, 0
    v_mov_b32 v92, 0
    v_mov_b32 v93, 0
    v_mov_b32 v94, 0
    v_mov_b32 v95, 0
    v_mov_b32 v32, 0
    v_mov_b32 v33, 0
    v_mov_b32 v34, 0
    v_mov_b32 v35, 0
    v_mov_b32 v36, 0
    v_mov_b32 v37, 0
    v_mov_b32 v38, 0
    v_mov_b32 v39, 0
    v_mov_b32 v40, 0
    v_mov_b32 v41, 0
    v_mov_b32 v42, 0
    v_mov_b32 v43, 0
    v_mov_b32 v44, 0
    v_mov_b32 v45, 0
    v_mov_b32 v46, 0
    v_mov_b32 v47, 0
    v_mov_b32 v48, 0
    v_mov_b32 v49, 0
    v_mov_b32 v50, 0
    v_mov_b32 v51, 0
    v_mov_b32 v52, 0
    v_mov_b32 v53, 0
    v_mov_b32 v54, 0
    v_mov_b32 v55, 0
    v_mov_b32 v56, 0
    v_mov_b32 v57, 0
    v_mov_b32 v58, 0
    v_mov_b32 v59, 0
    v_mov_b32 v60, 0
    v_mov_b32 v61, 0
    v_mov_b32 v62, 0
    v_mov_b32 v63, 0
    s_waitcnt vmcnt(24)
    s_barrier
    ds_read_b128 a[192:195], v8 offset:0
    ds_read_b128 a[196:199], v8 offset:1024
    ds_read_b128 a[200:203], v8 offset:2048
    ds_read_b128 a[204:207], v8 offset:3072
    ds_read_b128 a[208:211], v8 offset:4096
    ds_read_b128 a[212:215], v8 offset:5120
    ds_read_b128 a[216:219], v8 offset:6144
    ds_read_b128 a[220:223], v8 offset:7168
    ds_read_b128 a[224:227], v8 offset:8192
    ds_read_b128 a[228:231], v8 offset:9216
    ds_read_b128 a[232:235], v8 offset:10240
    ds_read_b128 a[236:239], v8 offset:11264
    ds_read_b128 a[240:243], v8 offset:12288
    ds_read_b128 a[244:247], v8 offset:13312
    ds_read_b128 a[248:251], v8 offset:14336
    ds_read_b128 a[252:255], v8 offset:15360
    s_waitcnt lgkmcnt(12)
    v_mfma_f32_16x16x32_bf16 v[64:67], a[192:195], v[128:131], v[64:67]
    v_mfma_f32_16x16x32_bf16 v[68:71], a[192:195], v[192:195], v[68:71]
    s_add_u32 s63, s95, 0
    buffer_load_dwordx4 a[0:3], v2, s[84:87], s63 offen offset:0
    v_mfma_f32_16x16x32_bf16 v[72:75], a[196:199], v[128:131], v[72:75]
    v_mfma_f32_16x16x32_bf16 v[76:79], a[196:199], v[192:195], v[76:79]
    v_mfma_f32_16x16x32_bf16 v[80:83], a[200:203], v[128:131], v[80:83]
    v_mfma_f32_16x16x32_bf16 v[84:87], a[200:203], v[192:195], v[84:87]
    v_mfma_f32_16x16x32_bf16 v[88:91], a[204:207], v[128:131], v[88:91]
    v_mfma_f32_16x16x32_bf16 v[92:95], a[204:207], v[192:195], v[92:95]
    ds_read_b128 a[192:195], v8 offset:16384
    ds_read_b128 a[196:199], v8 offset:17408
    ds_read_b128 a[200:203], v8 offset:18432
    ds_read_b128 a[204:207], v8 offset:19456
    s_waitcnt lgkmcnt(12)
    v_mfma_f32_16x16x32_bf16 v[64:67], a[208:211], v[132:135], v[64:67]
    v_mfma_f32_16x16x32_bf16 v[68:71], a[208:211], v[196:199], v[68:71]
    buffer_load_dwordx4 a[4:7], v2, s[84:87], s63 offen offset:1024
    v_mfma_f32_16x16x32_bf16 v[72:75], a[212:215], v[132:135], v[72:75]
    v_mfma_f32_16x16x32_bf16 v[76:79], a[212:215], v[196:199], v[76:79]
    v_mfma_f32_16x16x32_bf16 v[80:83], a[216:219], v[132:135], v[80:83]
    v_mfma_f32_16x16x32_bf16 v[84:87], a[216:219], v[196:199], v[84:87]
    v_mfma_f32_16x16x32_bf16 v[88:91], a[220:223], v[132:135], v[88:91]
    v_mfma_f32_16x16x32_bf16 v[92:95], a[220:223], v[196:199], v[92:95]
    ds_read_b128 a[208:211], v8 offset:20480
    ds_read_b128 a[212:215], v8 offset:21504
    ds_read_b128 a[216:219], v8 offset:22528
    ds_read_b128 a[220:223], v8 offset:23552
    s_waitcnt lgkmcnt(12)
    v_mfma_f32_16x16x32_bf16 v[64:67], a[224:227], v[136:139], v[64:67]
    v_mfma_f32_16x16x32_bf16 v[68:71], a[224:227], v[200:203], v[68:71]
    buffer_load_dwordx4 a[8:11], v2, s[84:87], s63 offen offset:2048
    v_mfma_f32_16x16x32_bf16 v[72:75], a[228:231], v[136:139], v[72:75]
    v_mfma_f32_16x16x32_bf16 v[76:79], a[228:231], v[200:203], v[76:79]
    v_mfma_f32_16x16x32_bf16 v[80:83], a[232:235], v[136:139], v[80:83]
    v_mfma_f32_16x16x32_bf16 v[84:87], a[232:235], v[200:203], v[84:87]
    v_mfma_f32_16x16x32_bf16 v[88:91], a[236:239], v[136:139], v[88:91]
    v_mfma_f32_16x16x32_bf16 v[92:95], a[236:239], v[200:203], v[92:95]
    ds_read_b128 a[224:227], v8 offset:24576
    ds_read_b128 a[228:231], v8 offset:25600
    ds_read_b128 a[232:235], v8 offset:26624
    ds_read_b128 a[236:239], v8 offset:27648
    s_waitcnt lgkmcnt(12)
    v_mfma_f32_16x16x32_bf16 v[64:67], a[240:243], v[140:143], v[64:67]
    v_mfma_f32_16x16x32_bf16 v[68:71], a[240:243], v[204:207], v[68:71]
    buffer_load_dwordx4 a[12:15], v2, s[84:87], s63 offen offset:3072
    v_mfma_f32_16x16x32_bf16 v[72:75], a[244:247], v[140:143], v[72:75]
    v_mfma_f32_16x16x32_bf16 v[76:79], a[244:247], v[204:207], v[76:79]
    v_mfma_f32_16x16x32_bf16 v[80:83], a[248:251], v[140:143], v[80:83]
    v_mfma_f32_16x16x32_bf16 v[84:87], a[248:251], v[204:207], v[84:87]
    v_mfma_f32_16x16x32_bf16 v[88:91], a[252:255], v[140:143], v[88:91]
    v_mfma_f32_16x16x32_bf16 v[92:95], a[252:255], v[204:207], v[92:95]
    ds_read_b128 a[240:243], v8 offset:28672
    ds_read_b128 a[244:247], v8 offset:29696
    ds_read_b128 a[248:251], v8 offset:30720
    ds_read_b128 a[252:255], v8 offset:31744
    s_waitcnt lgkmcnt(12)
    v_mfma_f32_16x16x32_bf16 v[64:67], a[192:195], v[144:147], v[64:67]
    v_mfma_f32_16x16x32_bf16 v[68:71], a[192:195], v[208:211], v[68:71]
    s_add_u32 s63, s95, 16384
    buffer_load_dwordx4 a[16:19], v2, s[84:87], s63 offen offset:0
    v_mfma_f32_16x16x32_bf16 v[72:75], a[196:199], v[144:147], v[72:75]
    v_mfma_f32_16x16x32_bf16 v[76:79], a[196:199], v[208:211], v[76:79]
    v_mfma_f32_16x16x32_bf16 v[80:83], a[200:203], v[144:147], v[80:83]
    v_mfma_f32_16x16x32_bf16 v[84:87], a[200:203], v[208:211], v[84:87]
    v_mfma_f32_16x16x32_bf16 v[88:91], a[204:207], v[144:147], v[88:91]
    v_mfma_f32_16x16x32_bf16 v[92:95], a[204:207], v[208:211], v[92:95]
    s_waitcnt lgkmcnt(8)
    v_mfma_f32_16x16x32_bf16 v[64:67], a[208:211], v[148:151], v[64:67]
    v_mfma_f32_16x16x32_bf16 v[68:71], a[208:211], v[212:215], v[68:71]
    buffer_load_dwordx4 a[20:23], v2, s[84:87], s63 offen offset:1024
    v_mfma_f32_16x16x32_bf16 v[72:75], a[212:215], v[148:151], v[72:75]
    v_mfma_f32_16x16x32_bf16 v[76:79], a[212:215], v[212:215], v[76:79]
    v_mfma_f32_16x16x32_bf16 v[80:83], a[216:219], v[148:151], v[80:83]
    v_mfma_f32_16x16x32_bf16 v[84:87], a[216:219], v[212:215], v[84:87]
    v_mfma_f32_16x16x32_bf16 v[88:91], a[220:223], v[148:151], v[88:91]
    v_mfma_f32_16x16x32_bf16 v[92:95], a[220:223], v[212:215], v[92:95]
    s_waitcnt lgkmcnt(4)
    v_mfma_f32_16x16x32_bf16 v[64:67], a[224:227], v[152:155], v[64:67]
    v_mfma_f32_16x16x32_bf16 v[68:71], a[224:227], v[216:219], v[68:71]
    buffer_load_dwordx4 a[24:27], v2, s[84:87], s63 offen offset:2048
    v_mfma_f32_16x16x32_bf16 v[72:75], a[228:231], v[152:155], v[72:75]
    v_mfma_f32_16x16x32_bf16 v[76:79], a[228:231], v[216:219], v[76:79]
    v_mfma_f32_16x16x32_bf16 v[80:83], a[232:235], v[152:155], v[80:83]
    v_mfma_f32_16x16x32_bf16 v[84:87], a[232:235], v[216:219], v[84:87]
    v_mfma_f32_16x16x32_bf16 v[88:91], a[236:239], v[152:155], v[88:91]
    v_mfma_f32_16x16x32_bf16 v[92:95], a[236:239], v[216:219], v[92:95]
    s_waitcnt lgkmcnt(0)
    v_mfma_f32_16x16x32_bf16 v[64:67], a[240:243], v[156:159], v[64:67]
    v_mfma_f32_16x16x32_bf16 v[68:71], a[240:243], v[220:223], v[68:71]
    buffer_load_dwordx4 a[28:31], v2, s[84:87], s63 offen offset:3072
    v_mfma_f32_16x16x32_bf16 v[72:75], a[244:247], v[156:159], v[72:75]
    v_mfma_f32_16x16x32_bf16 v[76:79], a[244:247], v[220:223], v[76:79]
    v_mfma_f32_16x16x32_bf16 v[80:83], a[248:251], v[156:159], v[80:83]
    v_mfma_f32_16x16x32_bf16 v[84:87], a[248:251], v[220:223], v[84:87]
    v_mfma_f32_16x16x32_bf16 v[88:91], a[252:255], v[156:159], v[88:91]
    v_mfma_f32_16x16x32_bf16 v[92:95], a[252:255], v[220:223], v[92:95]
    s_waitcnt vmcnt(24)
    s_barrier
    ds_read_b128 a[192:195], v9 offset:0
    ds_read_b128 a[196:199], v9 offset:1024
    ds_read_b128 a[200:203], v9 offset:2048
    ds_read_b128 a[204:207], v9 offset:3072
    ds_read_b128 a[208:211], v9 offset:4096
    ds_read_b128 a[212:215], v9 offset:5120
    ds_read_b128 a[216:219], v9 offset:6144
    ds_read_b128 a[220:223], v9 offset:7168
    ds_read_b128 a[224:227], v9 offset:8192
    ds_read_b128 a[228:231], v9 offset:9216
    ds_read_b128 a[232:235], v9 offset:10240
    ds_read_b128 a[236:239], v9 offset:11264
    ds_read_b128 a[240:243], v9 offset:12288
    ds_read_b128 a[244:247], v9 offset:13312
    ds_read_b128 a[248:251], v9 offset:14336
    ds_read_b128 a[252:255], v9 offset:15360
    s_waitcnt lgkmcnt(12)
    v_mfma_f32_16x16x32_bf16 v[64:67], a[192:195], v[160:163], v[64:67]
    v_mfma_f32_16x16x32_bf16 v[68:71], a[192:195], v[224:227], v[68:71]
    s_add_u32 s51, s81, 0
    s_mov_b32 m0, s51
    s_add_u32 s61, s80, 131072
    buffer_load_dwordx4 v2, s[52:55], s61 offen offset:0 lds
    v_mfma_f32_16x16x32_bf16 v[72:75], a[196:199], v[160:163], v[72:75]
    v_mfma_f32_16x16x32_bf16 v[76:79], a[196:199], v[224:227], v[76:79]
    v_mfma_f32_16x16x32_bf16 v[80:83], a[200:203], v[160:163], v[80:83]
    v_mfma_f32_16x16x32_bf16 v[84:87], a[200:203], v[224:227], v[84:87]
    v_mfma_f32_16x16x32_bf16 v[88:91], a[204:207], v[160:163], v[88:91]
    v_mfma_f32_16x16x32_bf16 v[92:95], a[204:207], v[224:227], v[92:95]
    ds_read_b128 a[192:195], v9 offset:16384
    ds_read_b128 a[196:199], v9 offset:17408
    ds_read_b128 a[200:203], v9 offset:18432
    ds_read_b128 a[204:207], v9 offset:19456
    s_waitcnt lgkmcnt(12)
    v_mfma_f32_16x16x32_bf16 v[64:67], a[208:211], v[164:167], v[64:67]
    v_mfma_f32_16x16x32_bf16 v[68:71], a[208:211], v[228:231], v[68:71]
    buffer_load_dwordx4 v2, s[52:55], s61 offen offset:1024 lds
    v_mfma_f32_16x16x32_bf16 v[72:75], a[212:215], v[164:167], v[72:75]
    v_mfma_f32_16x16x32_bf16 v[76:79], a[212:215], v[228:231], v[76:79]
    v_mfma_f32_16x16x32_bf16 v[80:83], a[216:219], v[164:167], v[80:83]
    v_mfma_f32_16x16x32_bf16 v[84:87], a[216:219], v[228:231], v[84:87]
    v_mfma_f32_16x16x32_bf16 v[88:91], a[220:223], v[164:167], v[88:91]
    v_mfma_f32_16x16x32_bf16 v[92:95], a[220:223], v[228:231], v[92:95]
    ds_read_b128 a[208:211], v9 offset:20480
    ds_read_b128 a[212:215], v9 offset:21504
    ds_read_b128 a[216:219], v9 offset:22528
    ds_read_b128 a[220:223], v9 offset:23552
    s_waitcnt lgkmcnt(12)
    v_mfma_f32_16x16x32_bf16 v[64:67], a[224:227], v[168:171], v[64:67]
    v_mfma_f32_16x16x32_bf16 v[68:71], a[224:227], v[232:235], v[68:71]
    buffer_load_dwordx4 v2, s[52:55], s61 offen offset:2048 lds
    v_mfma_f32_16x16x32_bf16 v[72:75], a[228:231], v[168:171], v[72:75]
    v_mfma_f32_16x16x32_bf16 v[76:79], a[228:231], v[232:235], v[76:79]
    v_mfma_f32_16x16x32_bf16 v[80:83], a[232:235], v[168:171], v[80:83]
    v_mfma_f32_16x16x32_bf16 v[84:87], a[232:235], v[232:235], v[84:87]
    v_mfma_f32_16x16x32_bf16 v[88:91], a[236:239], v[168:171], v[88:91]
    v_mfma_f32_16x16x32_bf16 v[92:95], a[236:239], v[232:235], v[92:95]
    ds_read_b128 a[224:227], v9 offset:24576
    ds_read_b128 a[228:231], v9 offset:25600
    ds_read_b128 a[232:235], v9 offset:26624
    ds_read_b128 a[236:239], v9 offset:27648
    s_waitcnt lgkmcnt(12)
    v_mfma_f32_16x16x32_bf16 v[64:67], a[240:243], v[172:175], v[64:67]
    v_mfma_f32_16x16x32_bf16 v[68:71], a[240:243], v[236:239], v[68:71]
    buffer_load_dwordx4 v2, s[52:55], s61 offen offset:3072 lds
    v_mfma_f32_16x16x32_bf16 v[72:75], a[244:247], v[172:175], v[72:75]
    v_mfma_f32_16x16x32_bf16 v[76:79], a[244:247], v[236:239], v[76:79]
    v_mfma_f32_16x16x32_bf16 v[80:83], a[248:251], v[172:175], v[80:83]
    v_mfma_f32_16x16x32_bf16 v[84:87], a[248:251], v[236:239], v[84:87]
    v_mfma_f32_16x16x32_bf16 v[88:91], a[252:255], v[172:175], v[88:91]
    v_mfma_f32_16x16x32_bf16 v[92:95], a[252:255], v[236:239], v[92:95]
    ds_read_b128 a[240:243], v9 offset:28672
    ds_read_b128 a[244:247], v9 offset:29696
    ds_read_b128 a[248:251], v9 offset:30720
    ds_read_b128 a[252:255], v9 offset:31744
    s_waitcnt lgkmcnt(12)
    v_mfma_f32_16x16x32_bf16 v[64:67], a[192:195], v[176:179], v[64:67]
    v_mfma_f32_16x16x32_bf16 v[68:71], a[192:195], v[240:243], v[68:71]
    s_add_u32 s51, s81, 4096
    s_mov_b32 m0, s51
    s_add_u32 s61, s80, 135168
    buffer_load_dwordx4 v2, s[52:55], s61 offen offset:0 lds
    v_mfma_f32_16x16x32_bf16 v[72:75], a[196:199], v[176:179], v[72:75]
    v_mfma_f32_16x16x32_bf16 v[76:79], a[196:199], v[240:243], v[76:79]
    v_mfma_f32_16x16x32_bf16 v[80:83], a[200:203], v[176:179], v[80:83]
    v_mfma_f32_16x16x32_bf16 v[84:87], a[200:203], v[240:243], v[84:87]
    v_mfma_f32_16x16x32_bf16 v[88:91], a[204:207], v[176:179], v[88:91]
    v_mfma_f32_16x16x32_bf16 v[92:95], a[204:207], v[240:243], v[92:95]
    s_waitcnt lgkmcnt(8)
    v_mfma_f32_16x16x32_bf16 v[64:67], a[208:211], v[180:183], v[64:67]
    v_mfma_f32_16x16x32_bf16 v[68:71], a[208:211], v[244:247], v[68:71]
    buffer_load_dwordx4 v2, s[52:55], s61 offen offset:1024 lds
    v_mfma_f32_16x16x32_bf16 v[72:75], a[212:215], v[180:183], v[72:75]
    v_mfma_f32_16x16x32_bf16 v[76:79], a[212:215], v[244:247], v[76:79]
    v_mfma_f32_16x16x32_bf16 v[80:83], a[216:219], v[180:183], v[80:83]
    v_mfma_f32_16x16x32_bf16 v[84:87], a[216:219], v[244:247], v[84:87]
    v_mfma_f32_16x16x32_bf16 v[88:91], a[220:223], v[180:183], v[88:91]
    v_mfma_f32_16x16x32_bf16 v[92:95], a[220:223], v[244:247], v[92:95]
    s_waitcnt lgkmcnt(4)
    v_mfma_f32_16x16x32_bf16 v[64:67], a[224:227], v[184:187], v[64:67]
    v_mfma_f32_16x16x32_bf16 v[68:71], a[224:227], v[248:251], v[68:71]
    buffer_load_dwordx4 v2, s[52:55], s61 offen offset:2048 lds
    v_mfma_f32_16x16x32_bf16 v[72:75], a[228:231], v[184:187], v[72:75]
    v_mfma_f32_16x16x32_bf16 v[76:79], a[228:231], v[248:251], v[76:79]
    v_mfma_f32_16x16x32_bf16 v[80:83], a[232:235], v[184:187], v[80:83]
    v_mfma_f32_16x16x32_bf16 v[84:87], a[232:235], v[248:251], v[84:87]
    v_mfma_f32_16x16x32_bf16 v[88:91], a[236:239], v[184:187], v[88:91]
    v_mfma_f32_16x16x32_bf16 v[92:95], a[236:239], v[248:251], v[92:95]
    s_waitcnt lgkmcnt(0)
    v_mfma_f32_16x16x32_bf16 v[64:67], a[240:243], v[188:191], v[64:67]
    v_mfma_f32_16x16x32_bf16 v[68:71], a[240:243], v[252:255], v[68:71]
    buffer_load_dwordx4 v2, s[52:55], s61 offen offset:3072 lds
    v_mfma_f32_16x16x32_bf16 v[72:75], a[244:247], v[188:191], v[72:75]
    v_mfma_f32_16x16x32_bf16 v[76:79], a[244:247], v[252:255], v[76:79]
    v_mfma_f32_16x16x32_bf16 v[80:83], a[248:251], v[188:191], v[80:83]
    v_mfma_f32_16x16x32_bf16 v[84:87], a[248:251], v[252:255], v[84:87]
    v_mfma_f32_16x16x32_bf16 v[88:91], a[252:255], v[188:191], v[88:91]
    v_mfma_f32_16x16x32_bf16 v[92:95], a[252:255], v[252:255], v[92:95]
    s_waitcnt vmcnt(24)
    s_barrier
    ds_read_b128 a[192:195], v10 offset:0
    ds_read_b128 a[196:199], v10 offset:1024
    ds_read_b128 a[200:203], v10 offset:2048
    ds_read_b128 a[204:207], v10 offset:3072
    ds_read_b128 a[208:211], v10 offset:4096
    ds_read_b128 a[212:215], v10 offset:5120
    ds_read_b128 a[216:219], v10 offset:6144
    ds_read_b128 a[220:223], v10 offset:7168
    ds_read_b128 a[224:227], v10 offset:8192
    ds_read_b128 a[228:231], v10 offset:9216
    ds_read_b128 a[232:235], v10 offset:10240
    ds_read_b128 a[236:239], v10 offset:11264
    ds_read_b128 a[240:243], v10 offset:12288
    ds_read_b128 a[244:247], v10 offset:13312
    ds_read_b128 a[248:251], v10 offset:14336
    ds_read_b128 a[252:255], v10 offset:15360
    s_waitcnt lgkmcnt(12)
    v_mfma_f32_16x16x32_bf16 v[32:35], a[192:195], v[128:131], v[32:35]
    v_cvt_pk_bf16_f32 v64, v64, v64
    v_lshlrev_b32 v64, 16, v64
    v_cvt_pk_bf16_f32 v80, v80, v80
    v_mfma_f32_16x16x32_bf16 v[36:39], a[192:195], v[192:195], v[36:39]
    v_lshlrev_b32 v80, 16, v80
    v_mul_f32 v20, 0xbfb8aa3b, v64
    v_exp_f32 v20, v20
    s_add_u32 s51, s81, 32768
    s_mov_b32 m0, s51
    s_add_u32 s61, s80, 163840
    buffer_load_dwordx4 v2, s[52:55], s61 offen offset:0 lds
    v_mfma_f32_16x16x32_bf16 v[40:43], a[196:199], v[128:131], v[40:43]
    v_add_f32 v20, 1.0, v20
    v_rcp_f32 v20, v20
    s_nop 0
    v_mul_f32 v64, v64, v20
    v_mfma_f32_16x16x32_bf16 v[44:47], a[196:199], v[192:195], v[44:47]
    v_cvt_pk_bf16_f32 v64, v64, v64
    v_lshlrev_b32 v64, 16, v64
    v_mul_f32 v64, v64, v80
    v_mfma_f32_16x16x32_bf16 v[48:51], a[200:203], v[128:131], v[48:51]
    v_cvt_pk_bf16_f32 v65, v65, v65
    v_lshlrev_b32 v65, 16, v65
    v_cvt_pk_bf16_f32 v81, v81, v81
    v_mfma_f32_16x16x32_bf16 v[52:55], a[200:203], v[192:195], v[52:55]
    v_lshlrev_b32 v81, 16, v81
    v_mul_f32 v21, 0xbfb8aa3b, v65
    v_exp_f32 v21, v21
    v_mfma_f32_16x16x32_bf16 v[56:59], a[204:207], v[128:131], v[56:59]
    v_add_f32 v21, 1.0, v21
    v_rcp_f32 v21, v21
    s_nop 0
    v_mul_f32 v65, v65, v21
    v_mfma_f32_16x16x32_bf16 v[60:63], a[204:207], v[192:195], v[60:63]
    v_cvt_pk_bf16_f32 v65, v65, v65
    v_lshlrev_b32 v65, 16, v65
    v_mul_f32 v65, v65, v81
    v_cvt_pk_bf16_f32 v66, v66, v66
    ds_read_b128 a[192:195], v10 offset:16384
    ds_read_b128 a[196:199], v10 offset:17408
    ds_read_b128 a[200:203], v10 offset:18432
    ds_read_b128 a[204:207], v10 offset:19456
    s_waitcnt lgkmcnt(12)
    v_mfma_f32_16x16x32_bf16 v[32:35], a[208:211], v[132:135], v[32:35]
    v_lshlrev_b32 v66, 16, v66
    v_cvt_pk_bf16_f32 v82, v82, v82
    v_lshlrev_b32 v82, 16, v82
    v_mfma_f32_16x16x32_bf16 v[36:39], a[208:211], v[196:199], v[36:39]
    v_mul_f32 v22, 0xbfb8aa3b, v66
    v_exp_f32 v22, v22
    s_nop 0
    v_add_f32 v22, 1.0, v22
    buffer_load_dwordx4 v2, s[52:55], s61 offen offset:1024 lds
    v_mfma_f32_16x16x32_bf16 v[40:43], a[212:215], v[132:135], v[40:43]
    v_rcp_f32 v22, v22
    s_nop 0
    v_mul_f32 v66, v66, v22
    v_cvt_pk_bf16_f32 v66, v66, v66
    v_mfma_f32_16x16x32_bf16 v[44:47], a[212:215], v[196:199], v[44:47]
    v_lshlrev_b32 v66, 16, v66
    v_mul_f32 v66, v66, v82
    v_cvt_pk_bf16_f32 v67, v67, v67
    v_mfma_f32_16x16x32_bf16 v[48:51], a[216:219], v[132:135], v[48:51]
    v_lshlrev_b32 v67, 16, v67
    v_cvt_pk_bf16_f32 v83, v83, v83
    v_lshlrev_b32 v83, 16, v83
    v_mfma_f32_16x16x32_bf16 v[52:55], a[216:219], v[196:199], v[52:55]
    v_mul_f32 v23, 0xbfb8aa3b, v67
    v_exp_f32 v23, v23
    s_nop 0
    v_add_f32 v23, 1.0, v23
    v_mfma_f32_16x16x32_bf16 v[56:59], a[220:223], v[132:135], v[56:59]
    v_rcp_f32 v23, v23
    s_nop 0
    v_mul_f32 v67, v67, v23
    v_cvt_pk_bf16_f32 v67, v67, v67
    v_mfma_f32_16x16x32_bf16 v[60:63], a[220:223], v[196:199], v[60:63]
    v_lshlrev_b32 v67, 16, v67
    v_mul_f32 v67, v67, v83
    v_cvt_pk_bf16_f32 v24, v64, v65
    v_cvt_pk_bf16_f32 v25, v66, v67
    ds_read_b128 a[208:211], v10 offset:20480
    ds_read_b128 a[212:215], v10 offset:21504
    ds_read_b128 a[216:219], v10 offset:22528
    ds_read_b128 a[220:223], v10 offset:23552
    s_waitcnt lgkmcnt(12)
    v_mfma_f32_16x16x32_bf16 v[32:35], a[224:227], v[136:139], v[32:35]
    v_cvt_pk_bf16_f32 v72, v72, v72
    v_lshlrev_b32 v72, 16, v72
    v_cvt_pk_bf16_f32 v88, v88, v88
    v_mfma_f32_16x16x32_bf16 v[36:39], a[224:227], v[200:203], v[36:39]
    v_lshlrev_b32 v88, 16, v88
    v_mul_f32 v20, 0xbfb8aa3b, v72
    v_exp_f32 v20, v20
    buffer_load_dwordx4 v2, s[52:55], s61 offen offset:2048 lds
    v_mfma_f32_16x16x32_bf16 v[40:43], a[228:231], v[136:139], v[40:43]
    v_add_f32 v20, 1.0, v20
    v_rcp_f32 v20, v20
    s_nop 0
    v_mul_f32 v72, v72, v20
    v_mfma_f32_16x16x32_bf16 v[44:47], a[228:231], v[200:203], v[44:47]
    v_cvt_pk_bf16_f32 v72, v72, v72
    v_lshlrev_b32 v72, 16, v72
    v_mul_f32 v72, v72, v88
    v_mfma_f32_16x16x32_bf16 v[48:51], a[232:235], v[136:139], v[48:51]
    v_cvt_pk_bf16_f32 v73, v73, v73
    v_lshlrev_b32 v73, 16, v73
    v_cvt_pk_bf16_f32 v89, v89, v89
    v_mfma_f32_16x16x32_bf16 v[52:55], a[232:235], v[200:203], v[52:55]
    v_lshlrev_b32 v89, 16, v89
    v_mul_f32 v21, 0xbfb8aa3b, v73
    v_exp_f32 v21, v21
    v_mfma_f32_16x16x32_bf16 v[56:59], a[236:239], v[136:139], v[56:59]
    v_add_f32 v21, 1.0, v21
    v_rcp_f32 v21, v21
    s_nop 0
    v_mul_f32 v73, v73, v21
    v_mfma_f32_16x16x32_bf16 v[60:63], a[236:239], v[200:203], v[60:63]
    v_cvt_pk_bf16_f32 v73, v73, v73
    v_lshlrev_b32 v73, 16, v73
    v_mul_f32 v73, v73, v89
    v_cvt_pk_bf16_f32 v74, v74, v74
    ds_read_b128 a[224:227], v10 offset:24576
    ds_read_b128 a[228:231], v10 offset:25600
    ds_read_b128 a[232:235], v10 offset:26624
    ds_read_b128 a[236:239], v10 offset:27648
    s_waitcnt lgkmcnt(12)
    v_mfma_f32_16x16x32_bf16 v[32:35], a[240:243], v[140:143], v[32:35]
    v_lshlrev_b32 v74, 16, v74
    v_cvt_pk_bf16_f32 v90, v90, v90
    v_lshlrev_b32 v90, 16, v90
    v_mfma_f32_16x16x32_bf16 v[36:39], a[240:243], v[204:207], v[36:39]
    v_mul_f32 v22, 0xbfb8aa3b, v74
    v_exp_f32 v22, v22
    s_nop 0
    v_add_f32 v22, 1.0, v22
    buffer_load_dwordx4 v2, s[52:55], s61 offen offset:3072 lds
    v_mfma_f32_16x16x32_bf16 v[40:43], a[244:247], v[140:143], v[40:43]
    v_rcp_f32 v22, v22
    s_nop 0
    v_mul_f32 v74, v74, v22
    v_cvt_pk_bf16_f32 v74, v74, v74
    v_mfma_f32_16x16x32_bf16 v[44:47], a[244:247], v[204:207], v[44:47]
    v_lshlrev_b32 v74, 16, v74
    v_mul_f32 v74, v74, v90
    v_cvt_pk_bf16_f32 v75, v75, v75
    v_mfma_f32_16x16x32_bf16 v[48:51], a[248:251], v[140:143], v[48:51]
    v_lshlrev_b32 v75, 16, v75
    v_cvt_pk_bf16_f32 v91, v91, v91
    v_lshlrev_b32 v91, 16, v91
    v_mfma_f32_16x16x32_bf16 v[52:55], a[248:251], v[204:207], v[52:55]
    v_mul_f32 v23, 0xbfb8aa3b, v75
    v_exp_f32 v23, v23
    s_nop 0
    v_add_f32 v23, 1.0, v23
    v_mfma_f32_16x16x32_bf16 v[56:59], a[252:255], v[140:143], v[56:59]
    v_rcp_f32 v23, v23
    s_nop 0
    v_mul_f32 v75, v75, v23
    v_cvt_pk_bf16_f32 v75, v75, v75
    v_mfma_f32_16x16x32_bf16 v[60:63], a[252:255], v[204:207], v[60:63]
    v_lshlrev_b32 v75, 16, v75
    v_mul_f32 v75, v75, v91
    v_cvt_pk_bf16_f32 v26, v72, v73
    v_cvt_pk_bf16_f32 v27, v74, v75
    ds_read_b128 a[240:243], v10 offset:28672
    ds_read_b128 a[244:247], v10 offset:29696
    ds_read_b128 a[248:251], v10 offset:30720
    ds_read_b128 a[252:255], v10 offset:31744
    s_waitcnt lgkmcnt(12)
    v_mfma_f32_16x16x32_bf16 v[32:35], a[192:195], v[144:147], v[32:35]
    v_cvt_pk_bf16_f32 v68, v68, v68
    v_lshlrev_b32 v68, 16, v68
    v_cvt_pk_bf16_f32 v84, v84, v84
    v_mfma_f32_16x16x32_bf16 v[36:39], a[192:195], v[208:211], v[36:39]
    v_lshlrev_b32 v84, 16, v84
    v_mul_f32 v20, 0xbfb8aa3b, v68
    v_exp_f32 v20, v20
    s_add_u32 s51, s81, 36864
    s_mov_b32 m0, s51
    s_add_u32 s61, s80, 167936
    buffer_load_dwordx4 v2, s[52:55], s61 offen offset:0 lds
    v_mfma_f32_16x16x32_bf16 v[40:43], a[196:199], v[144:147], v[40:43]
    v_add_f32 v20, 1.0, v20
    v_rcp_f32 v20, v20
    s_nop 0
    v_mul_f32 v68, v68, v20
    v_mfma_f32_16x16x32_bf16 v[44:47], a[196:199], v[208:211], v[44:47]
    v_cvt_pk_bf16_f32 v68, v68, v68
    v_lshlrev_b32 v68, 16, v68
    v_mul_f32 v68, v68, v84
    v_mfma_f32_16x16x32_bf16 v[48:51], a[200:203], v[144:147], v[48:51]
    v_cvt_pk_bf16_f32 v69, v69, v69
    v_lshlrev_b32 v69, 16, v69
    v_cvt_pk_bf16_f32 v85, v85, v85
    v_mfma_f32_16x16x32_bf16 v[52:55], a[200:203], v[208:211], v[52:55]
    v_lshlrev_b32 v85, 16, v85
    v_mul_f32 v21, 0xbfb8aa3b, v69
    v_exp_f32 v21, v21
    v_mfma_f32_16x16x32_bf16 v[56:59], a[204:207], v[144:147], v[56:59]
    v_add_f32 v21, 1.0, v21
    v_rcp_f32 v21, v21
    s_nop 0
    v_mul_f32 v69, v69, v21
    v_mfma_f32_16x16x32_bf16 v[60:63], a[204:207], v[208:211], v[60:63]
    v_cvt_pk_bf16_f32 v69, v69, v69
    v_lshlrev_b32 v69, 16, v69
    v_mul_f32 v69, v69, v85
    v_cvt_pk_bf16_f32 v70, v70, v70
    s_waitcnt lgkmcnt(8)
    v_mfma_f32_16x16x32_bf16 v[32:35], a[208:211], v[148:151], v[32:35]
    v_lshlrev_b32 v70, 16, v70
    v_cvt_pk_bf16_f32 v86, v86, v86
    v_lshlrev_b32 v86, 16, v86
    v_mfma_f32_16x16x32_bf16 v[36:39], a[208:211], v[212:215], v[36:39]
    v_mul_f32 v22, 0xbfb8aa3b, v70
    v_exp_f32 v22, v22
    s_nop 0
    v_add_f32 v22, 1.0, v22
    buffer_load_dwordx4 v2, s[52:55], s61 offen offset:1024 lds
    v_mfma_f32_16x16x32_bf16 v[40:43], a[212:215], v[148:151], v[40:43]
    v_rcp_f32 v22, v22
    s_nop 0
    v_mul_f32 v70, v70, v22
    v_cvt_pk_bf16_f32 v70, v70, v70
    v_mfma_f32_16x16x32_bf16 v[44:47], a[212:215], v[212:215], v[44:47]
    v_lshlrev_b32 v70, 16, v70
    v_mul_f32 v70, v70, v86
    v_cvt_pk_bf16_f32 v71, v71, v71
    v_mfma_f32_16x16x32_bf16 v[48:51], a[216:219], v[148:151], v[48:51]
    v_lshlrev_b32 v71, 16, v71
    v_cvt_pk_bf16_f32 v87, v87, v87
    v_lshlrev_b32 v87, 16, v87
    v_mfma_f32_16x16x32_bf16 v[52:55], a[216:219], v[212:215], v[52:55]
    v_mul_f32 v23, 0xbfb8aa3b, v71
    v_exp_f32 v23, v23
    s_nop 0
    v_add_f32 v23, 1.0, v23
    v_mfma_f32_16x16x32_bf16 v[56:59], a[220:223], v[148:151], v[56:59]
    v_rcp_f32 v23, v23
    s_nop 0
    v_mul_f32 v71, v71, v23
    v_cvt_pk_bf16_f32 v71, v71, v71
    v_mfma_f32_16x16x32_bf16 v[60:63], a[220:223], v[212:215], v[60:63]
    v_lshlrev_b32 v71, 16, v71
    v_mul_f32 v71, v71, v87
    v_cvt_pk_bf16_f32 v28, v68, v69
    v_cvt_pk_bf16_f32 v29, v70, v71
    s_waitcnt lgkmcnt(4)
    v_mfma_f32_16x16x32_bf16 v[32:35], a[224:227], v[152:155], v[32:35]
    v_cvt_pk_bf16_f32 v76, v76, v76
    v_lshlrev_b32 v76, 16, v76
    v_cvt_pk_bf16_f32 v92, v92, v92
    v_mfma_f32_16x16x32_bf16 v[36:39], a[224:227], v[216:219], v[36:39]
    v_lshlrev_b32 v92, 16, v92
    v_mul_f32 v20, 0xbfb8aa3b, v76
    v_exp_f32 v20, v20
    buffer_load_dwordx4 v2, s[52:55], s61 offen offset:2048 lds
    v_mfma_f32_16x16x32_bf16 v[40:43], a[228:231], v[152:155], v[40:43]
    v_add_f32 v20, 1.0, v20
    v_rcp_f32 v20, v20
    s_nop 0
    v_mul_f32 v76, v76, v20
    v_mfma_f32_16x16x32_bf16 v[44:47], a[228:231], v[216:219], v[44:47]
    v_cvt_pk_bf16_f32 v76, v76, v76
    v_lshlrev_b32 v76, 16, v76
    v_mul_f32 v76, v76, v92
    v_mfma_f32_16x16x32_bf16 v[48:51], a[232:235], v[152:155], v[48:51]
    v_cvt_pk_bf16_f32 v77, v77, v77
    v_lshlrev_b32 v77, 16, v77
    v_cvt_pk_bf16_f32 v93, v93, v93
    v_mfma_f32_16x16x32_bf16 v[52:55], a[232:235], v[216:219], v[52:55]
    v_lshlrev_b32 v93, 16, v93
    v_mul_f32 v21, 0xbfb8aa3b, v77
    v_exp_f32 v21, v21
    v_mfma_f32_16x16x32_bf16 v[56:59], a[236:239], v[152:155], v[56:59]
    v_add_f32 v21, 1.0, v21
    v_rcp_f32 v21, v21
    s_nop 0
    v_mul_f32 v77, v77, v21
    v_mfma_f32_16x16x32_bf16 v[60:63], a[236:239], v[216:219], v[60:63]
    v_cvt_pk_bf16_f32 v77, v77, v77
    v_lshlrev_b32 v77, 16, v77
    v_mul_f32 v77, v77, v93
    v_cvt_pk_bf16_f32 v78, v78, v78
    s_waitcnt lgkmcnt(0)
    v_mfma_f32_16x16x32_bf16 v[32:35], a[240:243], v[156:159], v[32:35]
    v_lshlrev_b32 v78, 16, v78
    v_cvt_pk_bf16_f32 v94, v94, v94
    v_lshlrev_b32 v94, 16, v94
    v_mfma_f32_16x16x32_bf16 v[36:39], a[240:243], v[220:223], v[36:39]
    v_mul_f32 v22, 0xbfb8aa3b, v78
    v_exp_f32 v22, v22
    s_nop 0
    v_add_f32 v22, 1.0, v22
    buffer_load_dwordx4 v2, s[52:55], s61 offen offset:3072 lds
    v_mfma_f32_16x16x32_bf16 v[40:43], a[244:247], v[156:159], v[40:43]
    v_rcp_f32 v22, v22
    s_nop 0
    v_mul_f32 v78, v78, v22
    v_cvt_pk_bf16_f32 v78, v78, v78
    v_mfma_f32_16x16x32_bf16 v[44:47], a[244:247], v[220:223], v[44:47]
    v_lshlrev_b32 v78, 16, v78
    v_mul_f32 v78, v78, v94
    v_cvt_pk_bf16_f32 v79, v79, v79
    v_mfma_f32_16x16x32_bf16 v[48:51], a[248:251], v[156:159], v[48:51]
    v_lshlrev_b32 v79, 16, v79
    v_cvt_pk_bf16_f32 v95, v95, v95
    v_lshlrev_b32 v95, 16, v95
    v_mfma_f32_16x16x32_bf16 v[52:55], a[248:251], v[220:223], v[52:55]
    v_mul_f32 v23, 0xbfb8aa3b, v79
    v_exp_f32 v23, v23
    s_nop 0
    v_add_f32 v23, 1.0, v23
    v_mfma_f32_16x16x32_bf16 v[56:59], a[252:255], v[156:159], v[56:59]
    v_rcp_f32 v23, v23
    s_nop 0
    v_mul_f32 v79, v79, v23
    v_cvt_pk_bf16_f32 v79, v79, v79
    v_mfma_f32_16x16x32_bf16 v[60:63], a[252:255], v[220:223], v[60:63]
    v_lshlrev_b32 v79, 16, v79
    v_mul_f32 v79, v79, v95
    v_cvt_pk_bf16_f32 v30, v76, v77
    v_cvt_pk_bf16_f32 v31, v78, v79
    s_add_u32 s60, s48, 0
    s_mul_i32 s60, s60, 43
    s_add_u32 s60, s60, s42
    s_add_u32 s60, s60, 0
    s_lshl_b32 s60, s60, 10
    buffer_store_dwordx4 v[24:27], v2, s[56:59], s60 offen sc0 sc1
    s_add_u32 s60, s48, 1
    s_mul_i32 s60, s60, 43
    s_add_u32 s60, s60, s42
    s_add_u32 s60, s60, 0
    s_lshl_b32 s60, s60, 10
    buffer_store_dwordx4 v[28:31], v2, s[56:59], s60 offen sc0 sc1
    v_mov_b32 v64, 0
    v_mov_b32 v65, 0
    v_mov_b32 v66, 0
    v_mov_b32 v67, 0
    v_mov_b32 v68, 0
    v_mov_b32 v69, 0
    v_mov_b32 v70, 0
    v_mov_b32 v71, 0
    v_mov_b32 v72, 0
    v_mov_b32 v73, 0
    v_mov_b32 v74, 0
    v_mov_b32 v75, 0
    v_mov_b32 v76, 0
    v_mov_b32 v77, 0
    v_mov_b32 v78, 0
    v_mov_b32 v79, 0
    v_mov_b32 v80, 0
    v_mov_b32 v81, 0
    v_mov_b32 v82, 0
    v_mov_b32 v83, 0
    v_mov_b32 v84, 0
    v_mov_b32 v85, 0
    v_mov_b32 v86, 0
    v_mov_b32 v87, 0
    v_mov_b32 v88, 0
    v_mov_b32 v89, 0
    v_mov_b32 v90, 0
    v_mov_b32 v91, 0
    v_mov_b32 v92, 0
    v_mov_b32 v93, 0
    v_mov_b32 v94, 0
    v_mov_b32 v95, 0
    s_waitcnt vmcnt(26)
    s_barrier
    ds_read_b128 a[192:195], v11 offset:0
    ds_read_b128 a[196:199], v11 offset:1024
    ds_read_b128 a[200:203], v11 offset:2048
    ds_read_b128 a[204:207], v11 offset:3072
    ds_read_b128 a[208:211], v11 offset:4096
    ds_read_b128 a[212:215], v11 offset:5120
    ds_read_b128 a[216:219], v11 offset:6144
    ds_read_b128 a[220:223], v11 offset:7168
    ds_read_b128 a[224:227], v11 offset:8192
    ds_read_b128 a[228:231], v11 offset:9216
    ds_read_b128 a[232:235], v11 offset:10240
    ds_read_b128 a[236:239], v11 offset:11264
    ds_read_b128 a[240:243], v11 offset:12288
    ds_read_b128 a[244:247], v11 offset:13312
    ds_read_b128 a[248:251], v11 offset:14336
    ds_read_b128 a[252:255], v11 offset:15360
    s_waitcnt lgkmcnt(12)
    v_mfma_f32_16x16x32_bf16 v[32:35], a[192:195], v[160:163], v[32:35]
    v_mfma_f32_16x16x32_bf16 v[36:39], a[192:195], v[224:227], v[36:39]
    s_add_u32 s63, s95, 32768
    buffer_load_dwordx4 a[32:35], v2, s[84:87], s63 offen offset:0
    v_mfma_f32_16x16x32_bf16 v[40:43], a[196:199], v[160:163], v[40:43]
    v_mfma_f32_16x16x32_bf16 v[44:47], a[196:199], v[224:227], v[44:47]
    v_mfma_f32_16x16x32_bf16 v[48:51], a[200:203], v[160:163], v[48:51]
    v_mfma_f32_16x16x32_bf16 v[52:55], a[200:203], v[224:227], v[52:55]
    buffer_load_dwordx4 a[36:39], v2, s[84:87], s63 offen offset:1024
    v_mfma_f32_16x16x32_bf16 v[56:59], a[204:207], v[160:163], v[56:59]
    v_mfma_f32_16x16x32_bf16 v[60:63], a[204:207], v[224:227], v[60:63]
    ds_read_b128 a[192:195], v11 offset:16384
    ds_read_b128 a[196:199], v11 offset:17408
    ds_read_b128 a[200:203], v11 offset:18432
    ds_read_b128 a[204:207], v11 offset:19456
    s_waitcnt lgkmcnt(12)
    v_mfma_f32_16x16x32_bf16 v[32:35], a[208:211], v[164:167], v[32:35]
    v_mfma_f32_16x16x32_bf16 v[36:39], a[208:211], v[228:231], v[36:39]
    buffer_load_dwordx4 a[40:43], v2, s[84:87], s63 offen offset:2048
    v_mfma_f32_16x16x32_bf16 v[40:43], a[212:215], v[164:167], v[40:43]
    v_mfma_f32_16x16x32_bf16 v[44:47], a[212:215], v[228:231], v[44:47]
    v_mfma_f32_16x16x32_bf16 v[48:51], a[216:219], v[164:167], v[48:51]
    v_mfma_f32_16x16x32_bf16 v[52:55], a[216:219], v[228:231], v[52:55]
    v_mfma_f32_16x16x32_bf16 v[56:59], a[220:223], v[164:167], v[56:59]
    v_mfma_f32_16x16x32_bf16 v[60:63], a[220:223], v[228:231], v[60:63]
    ds_read_b128 a[208:211], v11 offset:20480
    ds_read_b128 a[212:215], v11 offset:21504
    ds_read_b128 a[216:219], v11 offset:22528
    ds_read_b128 a[220:223], v11 offset:23552
    s_waitcnt lgkmcnt(12)
    v_mfma_f32_16x16x32_bf16 v[32:35], a[224:227], v[168:171], v[32:35]
    v_mfma_f32_16x16x32_bf16 v[36:39], a[224:227], v[232:235], v[36:39]
    buffer_load_dwordx4 a[44:47], v2, s[84:87], s63 offen offset:3072
    v_mfma_f32_16x16x32_bf16 v[40:43], a[228:231], v[168:171], v[40:43]
    v_mfma_f32_16x16x32_bf16 v[44:47], a[228:231], v[232:235], v[44:47]
    v_mfma_f32_16x16x32_bf16 v[48:51], a[232:235], v[168:171], v[48:51]
    v_mfma_f32_16x16x32_bf16 v[52:55], a[232:235], v[232:235], v[52:55]
    s_add_u32 s63, s95, 49152
    buffer_load_dwordx4 a[48:51], v2, s[84:87], s63 offen offset:0
    v_mfma_f32_16x16x32_bf16 v[56:59], a[236:239], v[168:171], v[56:59]
    v_mfma_f32_16x16x32_bf16 v[60:63], a[236:239], v[232:235], v[60:63]
    ds_read_b128 a[224:227], v11 offset:24576
    ds_read_b128 a[228:231], v11 offset:25600
    ds_read_b128 a[232:235], v11 offset:26624
    ds_read_b128 a[236:239], v11 offset:27648
    s_waitcnt lgkmcnt(12)
    v_mfma_f32_16x16x32_bf16 v[32:35], a[240:243], v[172:175], v[32:35]
    v_mfma_f32_16x16x32_bf16 v[36:39], a[240:243], v[236:239], v[36:39]
    buffer_load_dwordx4 a[52:55], v2, s[84:87], s63 offen offset:1024
    v_mfma_f32_16x16x32_bf16 v[40:43], a[244:247], v[172:175], v[40:43]
    v_mfma_f32_16x16x32_bf16 v[44:47], a[244:247], v[236:239], v[44:47]
    v_mfma_f32_16x16x32_bf16 v[48:51], a[248:251], v[172:175], v[48:51]
    v_mfma_f32_16x16x32_bf16 v[52:55], a[248:251], v[236:239], v[52:55]
    v_mfma_f32_16x16x32_bf16 v[56:59], a[252:255], v[172:175], v[56:59]
    v_mfma_f32_16x16x32_bf16 v[60:63], a[252:255], v[236:239], v[60:63]
    ds_read_b128 a[240:243], v11 offset:28672
    ds_read_b128 a[244:247], v11 offset:29696
    ds_read_b128 a[248:251], v11 offset:30720
    ds_read_b128 a[252:255], v11 offset:31744
    s_waitcnt lgkmcnt(12)
    v_mfma_f32_16x16x32_bf16 v[32:35], a[192:195], v[176:179], v[32:35]
    v_mfma_f32_16x16x32_bf16 v[36:39], a[192:195], v[240:243], v[36:39]
    buffer_load_dwordx4 a[56:59], v2, s[84:87], s63 offen offset:2048
    v_mfma_f32_16x16x32_bf16 v[40:43], a[196:199], v[176:179], v[40:43]
    v_mfma_f32_16x16x32_bf16 v[44:47], a[196:199], v[240:243], v[44:47]
    v_mfma_f32_16x16x32_bf16 v[48:51], a[200:203], v[176:179], v[48:51]
    v_mfma_f32_16x16x32_bf16 v[52:55], a[200:203], v[240:243], v[52:55]
    buffer_load_dwordx4 a[60:63], v2, s[84:87], s63 offen offset:3072
    v_mfma_f32_16x16x32_bf16 v[56:59], a[204:207], v[176:179], v[56:59]
    v_mfma_f32_16x16x32_bf16 v[60:63], a[204:207], v[240:243], v[60:63]
    s_waitcnt lgkmcnt(8)
    v_mfma_f32_16x16x32_bf16 v[32:35], a[208:211], v[180:183], v[32:35]
    v_mfma_f32_16x16x32_bf16 v[36:39], a[208:211], v[244:247], v[36:39]
    s_add_u32 s63, s95, 65536
    buffer_load_dwordx4 a[64:67], v2, s[84:87], s63 offen offset:0
    v_mfma_f32_16x16x32_bf16 v[40:43], a[212:215], v[180:183], v[40:43]
    v_mfma_f32_16x16x32_bf16 v[44:47], a[212:215], v[244:247], v[44:47]
    v_mfma_f32_16x16x32_bf16 v[48:51], a[216:219], v[180:183], v[48:51]
    v_mfma_f32_16x16x32_bf16 v[52:55], a[216:219], v[244:247], v[52:55]
    v_mfma_f32_16x16x32_bf16 v[56:59], a[220:223], v[180:183], v[56:59]
    v_mfma_f32_16x16x32_bf16 v[60:63], a[220:223], v[244:247], v[60:63]
    s_waitcnt lgkmcnt(4)
    v_mfma_f32_16x16x32_bf16 v[32:35], a[224:227], v[184:187], v[32:35]
    v_mfma_f32_16x16x32_bf16 v[36:39], a[224:227], v[248:251], v[36:39]
    buffer_load_dwordx4 a[68:71], v2, s[84:87], s63 offen offset:1024
    v_mfma_f32_16x16x32_bf16 v[40:43], a[228:231], v[184:187], v[40:43]
    v_mfma_f32_16x16x32_bf16 v[44:47], a[228:231], v[248:251], v[44:47]
    v_mfma_f32_16x16x32_bf16 v[48:51], a[232:235], v[184:187], v[48:51]
    v_mfma_f32_16x16x32_bf16 v[52:55], a[232:235], v[248:251], v[52:55]
    buffer_load_dwordx4 a[72:75], v2, s[84:87], s63 offen offset:2048
    v_mfma_f32_16x16x32_bf16 v[56:59], a[236:239], v[184:187], v[56:59]
    v_mfma_f32_16x16x32_bf16 v[60:63], a[236:239], v[248:251], v[60:63]
    s_waitcnt lgkmcnt(0)
    v_mfma_f32_16x16x32_bf16 v[32:35], a[240:243], v[188:191], v[32:35]
    v_mfma_f32_16x16x32_bf16 v[36:39], a[240:243], v[252:255], v[36:39]
    buffer_load_dwordx4 a[76:79], v2, s[84:87], s63 offen offset:3072
    v_mfma_f32_16x16x32_bf16 v[40:43], a[244:247], v[188:191], v[40:43]
    v_mfma_f32_16x16x32_bf16 v[44:47], a[244:247], v[252:255], v[44:47]
    v_mfma_f32_16x16x32_bf16 v[48:51], a[248:251], v[188:191], v[48:51]
    v_mfma_f32_16x16x32_bf16 v[52:55], a[248:251], v[252:255], v[52:55]
    v_mfma_f32_16x16x32_bf16 v[56:59], a[252:255], v[188:191], v[56:59]
    v_mfma_f32_16x16x32_bf16 v[60:63], a[252:255], v[252:255], v[60:63]
    s_waitcnt vmcnt(22)
    s_barrier
    ds_read_b128 a[192:195], v8 offset:0
    ds_read_b128 a[196:199], v8 offset:1024
    ds_read_b128 a[200:203], v8 offset:2048
    ds_read_b128 a[204:207], v8 offset:3072
    ds_read_b128 a[208:211], v8 offset:4096
    ds_read_b128 a[212:215], v8 offset:5120
    ds_read_b128 a[216:219], v8 offset:6144
    ds_read_b128 a[220:223], v8 offset:7168
    ds_read_b128 a[224:227], v8 offset:8192
    ds_read_b128 a[228:231], v8 offset:9216
    ds_read_b128 a[232:235], v8 offset:10240
    ds_read_b128 a[236:239], v8 offset:11264
    ds_read_b128 a[240:243], v8 offset:12288
    ds_read_b128 a[244:247], v8 offset:13312
    ds_read_b128 a[248:251], v8 offset:14336
    ds_read_b128 a[252:255], v8 offset:15360
    s_waitcnt lgkmcnt(12)
    v_mfma_f32_16x16x32_bf16 v[64:67], a[192:195], v[128:131], v[64:67]
    v_cvt_pk_bf16_f32 v32, v32, v32
    v_lshlrev_b32 v32, 16, v32
    v_cvt_pk_bf16_f32 v48, v48, v48
    v_mfma_f32_16x16x32_bf16 v[68:71], a[192:195], v[192:195], v[68:71]
    v_lshlrev_b32 v48, 16, v48
    v_mul_f32 v20, 0xbfb8aa3b, v32
    v_exp_f32 v20, v20
    s_add_u32 s63, s95, 81920
    buffer_load_dwordx4 a[80:83], v2, s[84:87], s63 offen offset:0
    v_mfma_f32_16x16x32_bf16 v[72:75], a[196:199], v[128:131], v[72:75]
    v_add_f32 v20, 1.0, v20
    v_rcp_f32 v20, v20
    s_nop 0
    v_mul_f32 v32, v32, v20
    v_mfma_f32_16x16x32_bf16 v[76:79], a[196:199], v[192:195], v[76:79]
    v_cvt_pk_bf16_f32 v32, v32, v32
    v_lshlrev_b32 v32, 16, v32
    v_mul_f32 v32, v32, v48
    v_mfma_f32_16x16x32_bf16 v[80:83], a[200:203], v[128:131], v[80:83]
    v_cvt_pk_bf16_f32 v33, v33, v33
    v_lshlrev_b32 v33, 16, v33
    v_cvt_pk_bf16_f32 v49, v49, v49
    v_mfma_f32_16x16x32_bf16 v[84:87], a[200:203], v[192:195], v[84:87]
    v_lshlrev_b32 v49, 16, v49
    v_mul_f32 v21, 0xbfb8aa3b, v33
    v_exp_f32 v21, v21
    buffer_load_dwordx4 a[84:87], v2, s[84:87], s63 offen offset:1024
    v_mfma_f32_16x16x32_bf16 v[88:91], a[204:207], v[128:131], v[88:91]
    v_add_f32 v21, 1.0, v21
    v_rcp_f32 v21, v21
    s_nop 0
    v_mul_f32 v33, v33, v21
    v_mfma_f32_16x16x32_bf16 v[92:95], a[204:207], v[192:195], v[92:95]
    v_cvt_pk_bf16_f32 v33, v33, v33
    v_lshlrev_b32 v33, 16, v33
    v_mul_f32 v33, v33, v49
    v_cvt_pk_bf16_f32 v34, v34, v34
    ds_read_b128 a[192:195], v8 offset:16384
    ds_read_b128 a[196:199], v8 offset:17408
    ds_read_b128 a[200:203], v8 offset:18432
    ds_read_b128 a[204:207], v8 offset:19456
    s_waitcnt lgkmcnt(12)
    v_mfma_f32_16x16x32_bf16 v[64:67], a[208:211], v[132:135], v[64:67]
    v_lshlrev_b32 v34, 16, v34
    v_cvt_pk_bf16_f32 v50, v50, v50
    v_lshlrev_b32 v50, 16, v50
    v_mfma_f32_16x16x32_bf16 v[68:71], a[208:211], v[196:199], v[68:71]
    v_mul_f32 v22, 0xbfb8aa3b, v34
    v_exp_f32 v22, v22
    s_nop 0
    v_add_f32 v22, 1.0, v22
    buffer_load_dwordx4 a[88:91], v2, s[84:87], s63 offen offset:2048
    v_mfma_f32_16x16x32_bf16 v[72:75], a[212:215], v[132:135], v[72:75]
    v_rcp_f32 v22, v22
    s_nop 0
    v_mul_f32 v34, v34, v22
    v_cvt_pk_bf16_f32 v34, v34, v34
    v_mfma_f32_16x16x32_bf16 v[76:79], a[212:215], v[196:199], v[76:79]
    v_lshlrev_b32 v34, 16, v34
    v_mul_f32 v34, v34, v50
    v_cvt_pk_bf16_f32 v35, v35, v35
    v_mfma_f32_16x16x32_bf16 v[80:83], a[216:219], v[132:135], v[80:83]
    v_lshlrev_b32 v35, 16, v35
    v_cvt_pk_bf16_f32 v51, v51, v51
    v_lshlrev_b32 v51, 16, v51
    v_mfma_f32_16x16x32_bf16 v[84:87], a[216:219], v[196:199], v[84:87]
    v_mul_f32 v23, 0xbfb8aa3b, v35
    v_exp_f32 v23, v23
    s_nop 0
    v_add_f32 v23, 1.0, v23
    v_mfma_f32_16x16x32_bf16 v[88:91], a[220:223], v[132:135], v[88:91]
    v_rcp_f32 v23, v23
    s_nop 0
    v_mul_f32 v35, v35, v23
    v_cvt_pk_bf16_f32 v35, v35, v35
    v_mfma_f32_16x16x32_bf16 v[92:95], a[220:223], v[196:199], v[92:95]
    v_lshlrev_b32 v35, 16, v35
    v_mul_f32 v35, v35, v51
    v_cvt_pk_bf16_f32 v24, v32, v33
    v_cvt_pk_bf16_f32 v25, v34, v35
    ds_read_b128 a[208:211], v8 offset:20480
    ds_read_b128 a[212:215], v8 offset:21504
    ds_read_b128 a[216:219], v8 offset:22528
    ds_read_b128 a[220:223], v8 offset:23552
    s_waitcnt lgkmcnt(12)
    v_mfma_f32_16x16x32_bf16 v[64:67], a[224:227], v[136:139], v[64:67]
    v_cvt_pk_bf16_f32 v40, v40, v40
    v_lshlrev_b32 v40, 16, v40
    v_cvt_pk_bf16_f32 v56, v56, v56
    v_mfma_f32_16x16x32_bf16 v[68:71], a[224:227], v[200:203], v[68:71]
    v_lshlrev_b32 v56, 16, v56
    v_mul_f32 v20, 0xbfb8aa3b, v40
    v_exp_f32 v20, v20
    buffer_load_dwordx4 a[92:95], v2, s[84:87], s63 offen offset:3072
    v_mfma_f32_16x16x32_bf16 v[72:75], a[228:231], v[136:139], v[72:75]
    v_add_f32 v20, 1.0, v20
    v_rcp_f32 v20, v20
    s_nop 0
    v_mul_f32 v40, v40, v20
    v_mfma_f32_16x16x32_bf16 v[76:79], a[228:231], v[200:203], v[76:79]
    v_cvt_pk_bf16_f32 v40, v40, v40
    v_lshlrev_b32 v40, 16, v40
    v_mul_f32 v40, v40, v56
    v_mfma_f32_16x16x32_bf16 v[80:83], a[232:235], v[136:139], v[80:83]
    v_cvt_pk_bf16_f32 v41, v41, v41
    v_lshlrev_b32 v41, 16, v41
    v_cvt_pk_bf16_f32 v57, v57, v57
    v_mfma_f32_16x16x32_bf16 v[84:87], a[232:235], v[200:203], v[84:87]
    v_lshlrev_b32 v57, 16, v57
    v_mul_f32 v21, 0xbfb8aa3b, v41
    v_exp_f32 v21, v21
    s_add_u32 s63, s95, 98304
    buffer_load_dwordx4 a[96:99], v2, s[84:87], s63 offen offset:0
    v_mfma_f32_16x16x32_bf16 v[88:91], a[236:239], v[136:139], v[88:91]
    v_add_f32 v21, 1.0, v21
    v_rcp_f32 v21, v21
    s_nop 0
    v_mul_f32 v41, v41, v21
    v_mfma_f32_16x16x32_bf16 v[92:95], a[236:239], v[200:203], v[92:95]
    v_cvt_pk_bf16_f32 v41, v41, v41
    v_lshlrev_b32 v41, 16, v41
    v_mul_f32 v41, v41, v57
    v_cvt_pk_bf16_f32 v42, v42, v42
    ds_read_b128 a[224:227], v8 offset:24576
    ds_read_b128 a[228:231], v8 offset:25600
    ds_read_b128 a[232:235], v8 offset:26624
    ds_read_b128 a[236:239], v8 offset:27648
    s_waitcnt lgkmcnt(12)
    v_mfma_f32_16x16x32_bf16 v[64:67], a[240:243], v[140:143], v[64:67]
    v_lshlrev_b32 v42, 16, v42
    v_cvt_pk_bf16_f32 v58, v58, v58
    v_lshlrev_b32 v58, 16, v58
    v_mfma_f32_16x16x32_bf16 v[68:71], a[240:243], v[204:207], v[68:71]
    v_mul_f32 v22, 0xbfb8aa3b, v42
    v_exp_f32 v22, v22
    s_nop 0
    v_add_f32 v22, 1.0, v22
    buffer_load_dwordx4 a[100:103], v2, s[84:87], s63 offen offset:1024
    v_mfma_f32_16x16x32_bf16 v[72:75], a[244:247], v[140:143], v[72:75]
    v_rcp_f32 v22, v22
    s_nop 0
    v_mul_f32 v42, v42, v22
    v_cvt_pk_bf16_f32 v42, v42, v42
    v_mfma_f32_16x16x32_bf16 v[76:79], a[244:247], v[204:207], v[76:79]
    v_lshlrev_b32 v42, 16, v42
    v_mul_f32 v42, v42, v58
    v_cvt_pk_bf16_f32 v43, v43, v43
    v_mfma_f32_16x16x32_bf16 v[80:83], a[248:251], v[140:143], v[80:83]
    v_lshlrev_b32 v43, 16, v43
    v_cvt_pk_bf16_f32 v59, v59, v59
    v_lshlrev_b32 v59, 16, v59
    v_mfma_f32_16x16x32_bf16 v[84:87], a[248:251], v[204:207], v[84:87]
    v_mul_f32 v23, 0xbfb8aa3b, v43
    v_exp_f32 v23, v23
    s_nop 0
    v_add_f32 v23, 1.0, v23
    v_mfma_f32_16x16x32_bf16 v[88:91], a[252:255], v[140:143], v[88:91]
    v_rcp_f32 v23, v23
    s_nop 0
    v_mul_f32 v43, v43, v23
    v_cvt_pk_bf16_f32 v43, v43, v43
    v_mfma_f32_16x16x32_bf16 v[92:95], a[252:255], v[204:207], v[92:95]
    v_lshlrev_b32 v43, 16, v43
    v_mul_f32 v43, v43, v59
    v_cvt_pk_bf16_f32 v26, v40, v41
    v_cvt_pk_bf16_f32 v27, v42, v43
    ds_read_b128 a[240:243], v8 offset:28672
    ds_read_b128 a[244:247], v8 offset:29696
    ds_read_b128 a[248:251], v8 offset:30720
    ds_read_b128 a[252:255], v8 offset:31744
    s_waitcnt lgkmcnt(12)
    v_mfma_f32_16x16x32_bf16 v[64:67], a[192:195], v[144:147], v[64:67]
    v_cvt_pk_bf16_f32 v36, v36, v36
    v_lshlrev_b32 v36, 16, v36
    v_cvt_pk_bf16_f32 v52, v52, v52
    v_mfma_f32_16x16x32_bf16 v[68:71], a[192:195], v[208:211], v[68:71]
    v_lshlrev_b32 v52, 16, v52
    v_mul_f32 v20, 0xbfb8aa3b, v36
    v_exp_f32 v20, v20
    buffer_load_dwordx4 a[104:107], v2, s[84:87], s63 offen offset:2048
    v_mfma_f32_16x16x32_bf16 v[72:75], a[196:199], v[144:147], v[72:75]
    v_add_f32 v20, 1.0, v20
    v_rcp_f32 v20, v20
    s_nop 0
    v_mul_f32 v36, v36, v20
    v_mfma_f32_16x16x32_bf16 v[76:79], a[196:199], v[208:211], v[76:79]
    v_cvt_pk_bf16_f32 v36, v36, v36
    v_lshlrev_b32 v36, 16, v36
    v_mul_f32 v36, v36, v52
    v_mfma_f32_16x16x32_bf16 v[80:83], a[200:203], v[144:147], v[80:83]
    v_cvt_pk_bf16_f32 v37, v37, v37
    v_lshlrev_b32 v37, 16, v37
    v_cvt_pk_bf16_f32 v53, v53, v53
    v_mfma_f32_16x16x32_bf16 v[84:87], a[200:203], v[208:211], v[84:87]
    v_lshlrev_b32 v53, 16, v53
    v_mul_f32 v21, 0xbfb8aa3b, v37
    v_exp_f32 v21, v21
    buffer_load_dwordx4 a[108:111], v2, s[84:87], s63 offen offset:3072
    v_mfma_f32_16x16x32_bf16 v[88:91], a[204:207], v[144:147], v[88:91]
    v_add_f32 v21, 1.0, v21
    v_rcp_f32 v21, v21
    s_nop 0
    v_mul_f32 v37, v37, v21
    v_mfma_f32_16x16x32_bf16 v[92:95], a[204:207], v[208:211], v[92:95]
    v_cvt_pk_bf16_f32 v37, v37, v37
    v_lshlrev_b32 v37, 16, v37
    v_mul_f32 v37, v37, v53
    v_cvt_pk_bf16_f32 v38, v38, v38
    s_waitcnt lgkmcnt(8)
    v_mfma_f32_16x16x32_bf16 v[64:67], a[208:211], v[148:151], v[64:67]
    v_lshlrev_b32 v38, 16, v38
    v_cvt_pk_bf16_f32 v54, v54, v54
    v_lshlrev_b32 v54, 16, v54
    v_mfma_f32_16x16x32_bf16 v[68:71], a[208:211], v[212:215], v[68:71]
    v_mul_f32 v22, 0xbfb8aa3b, v38
    v_exp_f32 v22, v22
    s_nop 0
    v_add_f32 v22, 1.0, v22
    s_add_u32 s63, s95, 114688
    buffer_load_dwordx4 a[112:115], v2, s[84:87], s63 offen offset:0
    v_mfma_f32_16x16x32_bf16 v[72:75], a[212:215], v[148:151], v[72:75]
    v_rcp_f32 v22, v22
    s_nop 0
    v_mul_f32 v38, v38, v22
    v_cvt_pk_bf16_f32 v38, v38, v38
    v_mfma_f32_16x16x32_bf16 v[76:79], a[212:215], v[212:215], v[76:79]
    v_lshlrev_b32 v38, 16, v38
    v_mul_f32 v38, v38, v54
    v_cvt_pk_bf16_f32 v39, v39, v39
    v_mfma_f32_16x16x32_bf16 v[80:83], a[216:219], v[148:151], v[80:83]
    v_lshlrev_b32 v39, 16, v39
    v_cvt_pk_bf16_f32 v55, v55, v55
    v_lshlrev_b32 v55, 16, v55
    v_mfma_f32_16x16x32_bf16 v[84:87], a[216:219], v[212:215], v[84:87]
    v_mul_f32 v23, 0xbfb8aa3b, v39
    v_exp_f32 v23, v23
    s_nop 0
    v_add_f32 v23, 1.0, v23
    v_mfma_f32_16x16x32_bf16 v[88:91], a[220:223], v[148:151], v[88:91]
    v_rcp_f32 v23, v23
    s_nop 0
    v_mul_f32 v39, v39, v23
    v_cvt_pk_bf16_f32 v39, v39, v39
    v_mfma_f32_16x16x32_bf16 v[92:95], a[220:223], v[212:215], v[92:95]
    v_lshlrev_b32 v39, 16, v39
    v_mul_f32 v39, v39, v55
    v_cvt_pk_bf16_f32 v28, v36, v37
    v_cvt_pk_bf16_f32 v29, v38, v39
    s_waitcnt lgkmcnt(4)
    v_mfma_f32_16x16x32_bf16 v[64:67], a[224:227], v[152:155], v[64:67]
    v_cvt_pk_bf16_f32 v44, v44, v44
    v_lshlrev_b32 v44, 16, v44
    v_cvt_pk_bf16_f32 v60, v60, v60
    v_mfma_f32_16x16x32_bf16 v[68:71], a[224:227], v[216:219], v[68:71]
    v_lshlrev_b32 v60, 16, v60
    v_mul_f32 v20, 0xbfb8aa3b, v44
    v_exp_f32 v20, v20
    buffer_load_dwordx4 a[116:119], v2, s[84:87], s63 offen offset:1024
    v_mfma_f32_16x16x32_bf16 v[72:75], a[228:231], v[152:155], v[72:75]
    v_add_f32 v20, 1.0, v20
    v_rcp_f32 v20, v20
    s_nop 0
    v_mul_f32 v44, v44, v20
    v_mfma_f32_16x16x32_bf16 v[76:79], a[228:231], v[216:219], v[76:79]
    v_cvt_pk_bf16_f32 v44, v44, v44
    v_lshlrev_b32 v44, 16, v44
    v_mul_f32 v44, v44, v60
    v_mfma_f32_16x16x32_bf16 v[80:83], a[232:235], v[152:155], v[80:83]
    v_cvt_pk_bf16_f32 v45, v45, v45
    v_lshlrev_b32 v45, 16, v45
    v_cvt_pk_bf16_f32 v61, v61, v61
    v_mfma_f32_16x16x32_bf16 v[84:87], a[232:235], v[216:219], v[84:87]
    v_lshlrev_b32 v61, 16, v61
    v_mul_f32 v21, 0xbfb8aa3b, v45
    v_exp_f32 v21, v21
    buffer_load_dwordx4 a[120:123], v2, s[84:87], s63 offen offset:2048
    v_mfma_f32_16x16x32_bf16 v[88:91], a[236:239], v[152:155], v[88:91]
    v_add_f32 v21, 1.0, v21
    v_rcp_f32 v21, v21
    s_nop 0
    v_mul_f32 v45, v45, v21
    v_mfma_f32_16x16x32_bf16 v[92:95], a[236:239], v[216:219], v[92:95]
    v_cvt_pk_bf16_f32 v45, v45, v45
    v_lshlrev_b32 v45, 16, v45
    v_mul_f32 v45, v45, v61
    v_cvt_pk_bf16_f32 v46, v46, v46
    s_waitcnt lgkmcnt(0)
    v_mfma_f32_16x16x32_bf16 v[64:67], a[240:243], v[156:159], v[64:67]
    v_lshlrev_b32 v46, 16, v46
    v_cvt_pk_bf16_f32 v62, v62, v62
    v_lshlrev_b32 v62, 16, v62
    v_mfma_f32_16x16x32_bf16 v[68:71], a[240:243], v[220:223], v[68:71]
    v_mul_f32 v22, 0xbfb8aa3b, v46
    v_exp_f32 v22, v22
    s_nop 0
    v_add_f32 v22, 1.0, v22
    buffer_load_dwordx4 a[124:127], v2, s[84:87], s63 offen offset:3072
    v_mfma_f32_16x16x32_bf16 v[72:75], a[244:247], v[156:159], v[72:75]
    v_rcp_f32 v22, v22
    s_nop 0
    v_mul_f32 v46, v46, v22
    v_cvt_pk_bf16_f32 v46, v46, v46
    v_mfma_f32_16x16x32_bf16 v[76:79], a[244:247], v[220:223], v[76:79]
    v_lshlrev_b32 v46, 16, v46
    v_mul_f32 v46, v46, v62
    v_cvt_pk_bf16_f32 v47, v47, v47
    v_mfma_f32_16x16x32_bf16 v[80:83], a[248:251], v[156:159], v[80:83]
    v_lshlrev_b32 v47, 16, v47
    v_cvt_pk_bf16_f32 v63, v63, v63
    v_lshlrev_b32 v63, 16, v63
    v_mfma_f32_16x16x32_bf16 v[84:87], a[248:251], v[220:223], v[84:87]
    v_mul_f32 v23, 0xbfb8aa3b, v47
    v_exp_f32 v23, v23
    s_nop 0
    v_add_f32 v23, 1.0, v23
    v_mfma_f32_16x16x32_bf16 v[88:91], a[252:255], v[156:159], v[88:91]
    v_rcp_f32 v23, v23
    s_nop 0
    v_mul_f32 v47, v47, v23
    v_cvt_pk_bf16_f32 v47, v47, v47
    v_mfma_f32_16x16x32_bf16 v[92:95], a[252:255], v[220:223], v[92:95]
    v_lshlrev_b32 v47, 16, v47
    v_mul_f32 v47, v47, v63
    v_cvt_pk_bf16_f32 v30, v44, v45
    v_cvt_pk_bf16_f32 v31, v46, v47
    s_add_u32 s60, s48, 0
    s_mul_i32 s60, s60, 43
    s_add_u32 s60, s60, s42
    s_add_u32 s60, s60, 1
    s_lshl_b32 s60, s60, 10
    buffer_store_dwordx4 v[24:27], v2, s[56:59], s60 offen sc0 sc1
    s_add_u32 s60, s48, 1
    s_mul_i32 s60, s60, 43
    s_add_u32 s60, s60, s42
    s_add_u32 s60, s60, 1
    s_lshl_b32 s60, s60, 10
    buffer_store_dwordx4 v[28:31], v2, s[56:59], s60 offen sc0 sc1
    v_mov_b32 v32, 0
    v_mov_b32 v33, 0
    v_mov_b32 v34, 0
    v_mov_b32 v35, 0
    v_mov_b32 v36, 0
    v_mov_b32 v37, 0
    v_mov_b32 v38, 0
    v_mov_b32 v39, 0
    v_mov_b32 v40, 0
    v_mov_b32 v41, 0
    v_mov_b32 v42, 0
    v_mov_b32 v43, 0
    v_mov_b32 v44, 0
    v_mov_b32 v45, 0
    v_mov_b32 v46, 0
    v_mov_b32 v47, 0
    v_mov_b32 v48, 0
    v_mov_b32 v49, 0
    v_mov_b32 v50, 0
    v_mov_b32 v51, 0
    v_mov_b32 v52, 0
    v_mov_b32 v53, 0
    v_mov_b32 v54, 0
    v_mov_b32 v55, 0
    v_mov_b32 v56, 0
    v_mov_b32 v57, 0
    v_mov_b32 v58, 0
    v_mov_b32 v59, 0
    v_mov_b32 v60, 0
    v_mov_b32 v61, 0
    v_mov_b32 v62, 0
    v_mov_b32 v63, 0
    s_waitcnt vmcnt(28)
    s_barrier
    ds_read_b128 a[192:195], v9 offset:0
    ds_read_b128 a[196:199], v9 offset:1024
    ds_read_b128 a[200:203], v9 offset:2048
    ds_read_b128 a[204:207], v9 offset:3072
    ds_read_b128 a[208:211], v9 offset:4096
    ds_read_b128 a[212:215], v9 offset:5120
    ds_read_b128 a[216:219], v9 offset:6144
    ds_read_b128 a[220:223], v9 offset:7168
    ds_read_b128 a[224:227], v9 offset:8192
    ds_read_b128 a[228:231], v9 offset:9216
    ds_read_b128 a[232:235], v9 offset:10240
    ds_read_b128 a[236:239], v9 offset:11264
    ds_read_b128 a[240:243], v9 offset:12288
    ds_read_b128 a[244:247], v9 offset:13312
    ds_read_b128 a[248:251], v9 offset:14336
    ds_read_b128 a[252:255], v9 offset:15360
    s_waitcnt lgkmcnt(12)
    v_mfma_f32_16x16x32_bf16 v[64:67], a[192:195], v[160:163], v[64:67]
    v_mfma_f32_16x16x32_bf16 v[68:71], a[192:195], v[224:227], v[68:71]
    s_add_u32 s63, s95, 131072
    buffer_load_dwordx4 a[128:131], v2, s[84:87], s63 offen offset:0
    v_mfma_f32_16x16x32_bf16 v[72:75], a[196:199], v[160:163], v[72:75]
    v_mfma_f32_16x16x32_bf16 v[76:79], a[196:199], v[224:227], v[76:79]
    v_mfma_f32_16x16x32_bf16 v[80:83], a[200:203], v[160:163], v[80:83]
    v_mfma_f32_16x16x32_bf16 v[84:87], a[200:203], v[224:227], v[84:87]
    buffer_load_dwordx4 a[132:135], v2, s[84:87], s63 offen offset:1024
    v_mfma_f32_16x16x32_bf16 v[88:91], a[204:207], v[160:163], v[88:91]
    v_mfma_f32_16x16x32_bf16 v[92:95], a[204:207], v[224:227], v[92:95]
    ds_read_b128 a[192:195], v9 offset:16384
    ds_read_b128 a[196:199], v9 offset:17408
    ds_read_b128 a[200:203], v9 offset:18432
    ds_read_b128 a[204:207], v9 offset:19456
    s_waitcnt lgkmcnt(12)
    v_mfma_f32_16x16x32_bf16 v[64:67], a[208:211], v[164:167], v[64:67]
    v_mfma_f32_16x16x32_bf16 v[68:71], a[208:211], v[228:231], v[68:71]
    buffer_load_dwordx4 a[136:139], v2, s[84:87], s63 offen offset:2048
    v_mfma_f32_16x16x32_bf16 v[72:75], a[212:215], v[164:167], v[72:75]
    v_mfma_f32_16x16x32_bf16 v[76:79], a[212:215], v[228:231], v[76:79]
    v_mfma_f32_16x16x32_bf16 v[80:83], a[216:219], v[164:167], v[80:83]
    v_mfma_f32_16x16x32_bf16 v[84:87], a[216:219], v[228:231], v[84:87]
    v_mfma_f32_16x16x32_bf16 v[88:91], a[220:223], v[164:167], v[88:91]
    v_mfma_f32_16x16x32_bf16 v[92:95], a[220:223], v[228:231], v[92:95]
    ds_read_b128 a[208:211], v9 offset:20480
    ds_read_b128 a[212:215], v9 offset:21504
    ds_read_b128 a[216:219], v9 offset:22528
    ds_read_b128 a[220:223], v9 offset:23552
    s_waitcnt lgkmcnt(12)
    v_mfma_f32_16x16x32_bf16 v[64:67], a[224:227], v[168:171], v[64:67]
    v_mfma_f32_16x16x32_bf16 v[68:71], a[224:227], v[232:235], v[68:71]
    buffer_load_dwordx4 a[140:143], v2, s[84:87], s63 offen offset:3072
    v_mfma_f32_16x16x32_bf16 v[72:75], a[228:231], v[168:171], v[72:75]
    v_mfma_f32_16x16x32_bf16 v[76:79], a[228:231], v[232:235], v[76:79]
    v_mfma_f32_16x16x32_bf16 v[80:83], a[232:235], v[168:171], v[80:83]
    v_mfma_f32_16x16x32_bf16 v[84:87], a[232:235], v[232:235], v[84:87]
    s_add_u32 s63, s95, 147456
    buffer_load_dwordx4 a[144:147], v2, s[84:87], s63 offen offset:0
    v_mfma_f32_16x16x32_bf16 v[88:91], a[236:239], v[168:171], v[88:91]
    v_mfma_f32_16x16x32_bf16 v[92:95], a[236:239], v[232:235], v[92:95]
    ds_read_b128 a[224:227], v9 offset:24576
    ds_read_b128 a[228:231], v9 offset:25600
    ds_read_b128 a[232:235], v9 offset:26624
    ds_read_b128 a[236:239], v9 offset:27648
    s_waitcnt lgkmcnt(12)
    v_mfma_f32_16x16x32_bf16 v[64:67], a[240:243], v[172:175], v[64:67]
    v_mfma_f32_16x16x32_bf16 v[68:71], a[240:243], v[236:239], v[68:71]
    buffer_load_dwordx4 a[148:151], v2, s[84:87], s63 offen offset:1024
    v_mfma_f32_16x16x32_bf16 v[72:75], a[244:247], v[172:175], v[72:75]
    v_mfma_f32_16x16x32_bf16 v[76:79], a[244:247], v[236:239], v[76:79]
    v_mfma_f32_16x16x32_bf16 v[80:83], a[248:251], v[172:175], v[80:83]
    v_mfma_f32_16x16x32_bf16 v[84:87], a[248:251], v[236:239], v[84:87]
    v_mfma_f32_16x16x32_bf16 v[88:91], a[252:255], v[172:175], v[88:91]
    v_mfma_f32_16x16x32_bf16 v[92:95], a[252:255], v[236:239], v[92:95]
    ds_read_b128 a[240:243], v9 offset:28672
    ds_read_b128 a[244:247], v9 offset:29696
    ds_read_b128 a[248:251], v9 offset:30720
    ds_read_b128 a[252:255], v9 offset:31744
    s_waitcnt lgkmcnt(12)
    v_mfma_f32_16x16x32_bf16 v[64:67], a[192:195], v[176:179], v[64:67]
    v_mfma_f32_16x16x32_bf16 v[68:71], a[192:195], v[240:243], v[68:71]
    buffer_load_dwordx4 a[152:155], v2, s[84:87], s63 offen offset:2048
    v_mfma_f32_16x16x32_bf16 v[72:75], a[196:199], v[176:179], v[72:75]
    v_mfma_f32_16x16x32_bf16 v[76:79], a[196:199], v[240:243], v[76:79]
    v_mfma_f32_16x16x32_bf16 v[80:83], a[200:203], v[176:179], v[80:83]
    v_mfma_f32_16x16x32_bf16 v[84:87], a[200:203], v[240:243], v[84:87]
    buffer_load_dwordx4 a[156:159], v2, s[84:87], s63 offen offset:3072
    v_mfma_f32_16x16x32_bf16 v[88:91], a[204:207], v[176:179], v[88:91]
    v_mfma_f32_16x16x32_bf16 v[92:95], a[204:207], v[240:243], v[92:95]
    s_waitcnt lgkmcnt(8)
    v_mfma_f32_16x16x32_bf16 v[64:67], a[208:211], v[180:183], v[64:67]
    v_mfma_f32_16x16x32_bf16 v[68:71], a[208:211], v[244:247], v[68:71]
    s_add_u32 s63, s95, 163840
    s_cmp_eq_u32 s50, 3
    s_cselect_b32 s63, 0x7f000000, s63
    buffer_load_dwordx4 a[160:163], v2, s[84:87], s63 offen offset:0
    v_mfma_f32_16x16x32_bf16 v[72:75], a[212:215], v[180:183], v[72:75]
    v_mfma_f32_16x16x32_bf16 v[76:79], a[212:215], v[244:247], v[76:79]
    v_mfma_f32_16x16x32_bf16 v[80:83], a[216:219], v[180:183], v[80:83]
    v_mfma_f32_16x16x32_bf16 v[84:87], a[216:219], v[244:247], v[84:87]
    v_mfma_f32_16x16x32_bf16 v[88:91], a[220:223], v[180:183], v[88:91]
    v_mfma_f32_16x16x32_bf16 v[92:95], a[220:223], v[244:247], v[92:95]
    s_waitcnt lgkmcnt(4)
    v_mfma_f32_16x16x32_bf16 v[64:67], a[224:227], v[184:187], v[64:67]
    v_mfma_f32_16x16x32_bf16 v[68:71], a[224:227], v[248:251], v[68:71]
    buffer_load_dwordx4 a[164:167], v2, s[84:87], s63 offen offset:1024
    v_mfma_f32_16x16x32_bf16 v[72:75], a[228:231], v[184:187], v[72:75]
    v_mfma_f32_16x16x32_bf16 v[76:79], a[228:231], v[248:251], v[76:79]
    v_mfma_f32_16x16x32_bf16 v[80:83], a[232:235], v[184:187], v[80:83]
    v_mfma_f32_16x16x32_bf16 v[84:87], a[232:235], v[248:251], v[84:87]
    buffer_load_dwordx4 a[168:171], v2, s[84:87], s63 offen offset:2048
    v_mfma_f32_16x16x32_bf16 v[88:91], a[236:239], v[184:187], v[88:91]
    v_mfma_f32_16x16x32_bf16 v[92:95], a[236:239], v[248:251], v[92:95]
    s_waitcnt lgkmcnt(0)
    v_mfma_f32_16x16x32_bf16 v[64:67], a[240:243], v[188:191], v[64:67]
    v_mfma_f32_16x16x32_bf16 v[68:71], a[240:243], v[252:255], v[68:71]
    buffer_load_dwordx4 a[172:175], v2, s[84:87], s63 offen offset:3072
    v_mfma_f32_16x16x32_bf16 v[72:75], a[244:247], v[188:191], v[72:75]
    v_mfma_f32_16x16x32_bf16 v[76:79], a[244:247], v[252:255], v[76:79]
    v_mfma_f32_16x16x32_bf16 v[80:83], a[248:251], v[188:191], v[80:83]
    v_mfma_f32_16x16x32_bf16 v[84:87], a[248:251], v[252:255], v[84:87]
    v_mfma_f32_16x16x32_bf16 v[88:91], a[252:255], v[188:191], v[88:91]
    v_mfma_f32_16x16x32_bf16 v[92:95], a[252:255], v[252:255], v[92:95]
    v_cvt_pk_bf16_f32 v64, v64, v64
    v_lshlrev_b32 v64, 16, v64
    s_nop 2
    v_cvt_pk_bf16_f32 v80, v80, v80
    v_lshlrev_b32 v80, 16, v80
    v_mul_f32 v20, 0xbfb8aa3b, v64
    v_exp_f32 v20, v20
    s_nop 0
    v_add_f32 v20, 1.0, v20
    v_rcp_f32 v20, v20
    s_nop 0
    v_mul_f32 v64, v64, v20
    v_cvt_pk_bf16_f32 v64, v64, v64
    v_lshlrev_b32 v64, 16, v64
    v_mul_f32 v64, v64, v80
    v_cvt_pk_bf16_f32 v65, v65, v65
    v_lshlrev_b32 v65, 16, v65
    v_cvt_pk_bf16_f32 v81, v81, v81
    v_lshlrev_b32 v81, 16, v81
    v_mul_f32 v21, 0xbfb8aa3b, v65
    v_exp_f32 v21, v21
    s_nop 0
    v_add_f32 v21, 1.0, v21
    v_rcp_f32 v21, v21
    s_nop 0
    v_mul_f32 v65, v65, v21
    v_cvt_pk_bf16_f32 v65, v65, v65
    v_lshlrev_b32 v65, 16, v65
    v_mul_f32 v65, v65, v81
    v_cvt_pk_bf16_f32 v66, v66, v66
    v_lshlrev_b32 v66, 16, v66
    v_cvt_pk_bf16_f32 v82, v82, v82
    v_lshlrev_b32 v82, 16, v82
    v_mul_f32 v22, 0xbfb8aa3b, v66
    v_exp_f32 v22, v22
    s_nop 0
    v_add_f32 v22, 1.0, v22
    v_rcp_f32 v22, v22
    s_nop 0
    v_mul_f32 v66, v66, v22
    v_cvt_pk_bf16_f32 v66, v66, v66
    v_lshlrev_b32 v66, 16, v66
    v_mul_f32 v66, v66, v82
    v_cvt_pk_bf16_f32 v67, v67, v67
    v_lshlrev_b32 v67, 16, v67
    v_cvt_pk_bf16_f32 v83, v83, v83
    v_lshlrev_b32 v83, 16, v83
    v_mul_f32 v23, 0xbfb8aa3b, v67
    v_exp_f32 v23, v23
    s_nop 0
    v_add_f32 v23, 1.0, v23
    v_rcp_f32 v23, v23
    s_nop 0
    v_mul_f32 v67, v67, v23
    v_cvt_pk_bf16_f32 v67, v67, v67
    v_lshlrev_b32 v67, 16, v67
    v_mul_f32 v67, v67, v83
    v_cvt_pk_bf16_f32 v24, v64, v65
    v_cvt_pk_bf16_f32 v25, v66, v67
    v_cvt_pk_bf16_f32 v72, v72, v72
    v_lshlrev_b32 v72, 16, v72
    v_cvt_pk_bf16_f32 v88, v88, v88
    v_lshlrev_b32 v88, 16, v88
    v_mul_f32 v20, 0xbfb8aa3b, v72
    v_exp_f32 v20, v20
    s_nop 0
    v_add_f32 v20, 1.0, v20
    v_rcp_f32 v20, v20
    s_nop 0
    v_mul_f32 v72, v72, v20
    v_cvt_pk_bf16_f32 v72, v72, v72
    v_lshlrev_b32 v72, 16, v72
    v_mul_f32 v72, v72, v88
    v_cvt_pk_bf16_f32 v73, v73, v73
    v_lshlrev_b32 v73, 16, v73
    v_cvt_pk_bf16_f32 v89, v89, v89
    v_lshlrev_b32 v89, 16, v89
    v_mul_f32 v21, 0xbfb8aa3b, v73
    v_exp_f32 v21, v21
    s_nop 0
    v_add_f32 v21, 1.0, v21
    v_rcp_f32 v21, v21
    s_nop 0
    v_mul_f32 v73, v73, v21
    v_cvt_pk_bf16_f32 v73, v73, v73
    v_lshlrev_b32 v73, 16, v73
    v_mul_f32 v73, v73, v89
    v_cvt_pk_bf16_f32 v74, v74, v74
    v_lshlrev_b32 v74, 16, v74
    v_cvt_pk_bf16_f32 v90, v90, v90
    v_lshlrev_b32 v90, 16, v90
    v_mul_f32 v22, 0xbfb8aa3b, v74
    v_exp_f32 v22, v22
    s_nop 0
    v_add_f32 v22, 1.0, v22
    v_rcp_f32 v22, v22
    s_nop 0
    v_mul_f32 v74, v74, v22
    v_cvt_pk_bf16_f32 v74, v74, v74
    v_lshlrev_b32 v74, 16, v74
    v_mul_f32 v74, v74, v90
    v_cvt_pk_bf16_f32 v75, v75, v75
    v_lshlrev_b32 v75, 16, v75
    v_cvt_pk_bf16_f32 v91, v91, v91
    v_lshlrev_b32 v91, 16, v91
    v_mul_f32 v23, 0xbfb8aa3b, v75
    v_exp_f32 v23, v23
    s_nop 0
    v_add_f32 v23, 1.0, v23
    v_rcp_f32 v23, v23
    s_nop 0
    v_mul_f32 v75, v75, v23
    v_cvt_pk_bf16_f32 v75, v75, v75
    v_lshlrev_b32 v75, 16, v75
    v_mul_f32 v75, v75, v91
    v_cvt_pk_bf16_f32 v26, v72, v73
    v_cvt_pk_bf16_f32 v27, v74, v75
    v_cvt_pk_bf16_f32 v68, v68, v68
    v_lshlrev_b32 v68, 16, v68
    v_cvt_pk_bf16_f32 v84, v84, v84
    v_lshlrev_b32 v84, 16, v84
    v_mul_f32 v20, 0xbfb8aa3b, v68
    v_exp_f32 v20, v20
    s_nop 0
    v_add_f32 v20, 1.0, v20
    v_rcp_f32 v20, v20
    s_nop 0
    v_mul_f32 v68, v68, v20
    v_cvt_pk_bf16_f32 v68, v68, v68
    v_lshlrev_b32 v68, 16, v68
    v_mul_f32 v68, v68, v84
    v_cvt_pk_bf16_f32 v69, v69, v69
    v_lshlrev_b32 v69, 16, v69
    v_cvt_pk_bf16_f32 v85, v85, v85
    v_lshlrev_b32 v85, 16, v85
    v_mul_f32 v21, 0xbfb8aa3b, v69
    v_exp_f32 v21, v21
    s_nop 0
    v_add_f32 v21, 1.0, v21
    v_rcp_f32 v21, v21
    s_nop 0
    v_mul_f32 v69, v69, v21
    v_cvt_pk_bf16_f32 v69, v69, v69
    v_lshlrev_b32 v69, 16, v69
    v_mul_f32 v69, v69, v85
    v_cvt_pk_bf16_f32 v70, v70, v70
    v_lshlrev_b32 v70, 16, v70
    v_cvt_pk_bf16_f32 v86, v86, v86
    v_lshlrev_b32 v86, 16, v86
    v_mul_f32 v22, 0xbfb8aa3b, v70
    v_exp_f32 v22, v22
    s_nop 0
    v_add_f32 v22, 1.0, v22
    v_rcp_f32 v22, v22
    s_nop 0
    v_mul_f32 v70, v70, v22
    v_cvt_pk_bf16_f32 v70, v70, v70
    v_lshlrev_b32 v70, 16, v70
    v_mul_f32 v70, v70, v86
    v_cvt_pk_bf16_f32 v71, v71, v71
    v_lshlrev_b32 v71, 16, v71
    v_cvt_pk_bf16_f32 v87, v87, v87
    v_lshlrev_b32 v87, 16, v87
    v_mul_f32 v23, 0xbfb8aa3b, v71
    v_exp_f32 v23, v23
    s_nop 0
    v_add_f32 v23, 1.0, v23
    v_rcp_f32 v23, v23
    s_nop 0
    v_mul_f32 v71, v71, v23
    v_cvt_pk_bf16_f32 v71, v71, v71
    v_lshlrev_b32 v71, 16, v71
    v_mul_f32 v71, v71, v87
    v_cvt_pk_bf16_f32 v28, v68, v69
    v_cvt_pk_bf16_f32 v29, v70, v71
    v_cvt_pk_bf16_f32 v76, v76, v76
    v_lshlrev_b32 v76, 16, v76
    v_cvt_pk_bf16_f32 v92, v92, v92
    v_lshlrev_b32 v92, 16, v92
    v_mul_f32 v20, 0xbfb8aa3b, v76
    v_exp_f32 v20, v20
    s_nop 0
    v_add_f32 v20, 1.0, v20
    v_rcp_f32 v20, v20
    s_nop 0
    v_mul_f32 v76, v76, v20
    v_cvt_pk_bf16_f32 v76, v76, v76
    v_lshlrev_b32 v76, 16, v76
    v_mul_f32 v76, v76, v92
    v_cvt_pk_bf16_f32 v77, v77, v77
    v_lshlrev_b32 v77, 16, v77
    v_cvt_pk_bf16_f32 v93, v93, v93
    v_lshlrev_b32 v93, 16, v93
    v_mul_f32 v21, 0xbfb8aa3b, v77
    v_exp_f32 v21, v21
    s_nop 0
    v_add_f32 v21, 1.0, v21
    v_rcp_f32 v21, v21
    s_nop 0
    v_mul_f32 v77, v77, v21
    v_cvt_pk_bf16_f32 v77, v77, v77
    v_lshlrev_b32 v77, 16, v77
    v_mul_f32 v77, v77, v93
    v_cvt_pk_bf16_f32 v78, v78, v78
    v_lshlrev_b32 v78, 16, v78
    v_cvt_pk_bf16_f32 v94, v94, v94
    v_lshlrev_b32 v94, 16, v94
    v_mul_f32 v22, 0xbfb8aa3b, v78
    v_exp_f32 v22, v22
    s_nop 0
    v_add_f32 v22, 1.0, v22
    v_rcp_f32 v22, v22
    s_nop 0
    v_mul_f32 v78, v78, v22
    v_cvt_pk_bf16_f32 v78, v78, v78
    v_lshlrev_b32 v78, 16, v78
    v_mul_f32 v78, v78, v94
    v_cvt_pk_bf16_f32 v79, v79, v79
    v_lshlrev_b32 v79, 16, v79
    v_cvt_pk_bf16_f32 v95, v95, v95
    v_lshlrev_b32 v95, 16, v95
    v_mul_f32 v23, 0xbfb8aa3b, v79
    v_exp_f32 v23, v23
    s_nop 0
    v_add_f32 v23, 1.0, v23
    v_rcp_f32 v23, v23
    s_nop 0
    v_mul_f32 v79, v79, v23
    v_cvt_pk_bf16_f32 v79, v79, v79
    v_lshlrev_b32 v79, 16, v79
    v_mul_f32 v79, v79, v95
    v_cvt_pk_bf16_f32 v30, v76, v77
    v_cvt_pk_bf16_f32 v31, v78, v79
    s_add_u32 s60, s48, 0
    s_mul_i32 s60, s60, 43
    s_add_u32 s60, s60, s42
    s_add_u32 s60, s60, 2
    s_lshl_b32 s60, s60, 10
    buffer_store_dwordx4 v[24:27], v2, s[56:59], s60 offen sc0 sc1
    s_add_u32 s60, s48, 1
    s_mul_i32 s60, s60, 43
    s_add_u32 s60, s60, s42
    s_add_u32 s60, s60, 2
    s_lshl_b32 s60, s60, 10
    buffer_store_dwordx4 v[28:31], v2, s[56:59], s60 offen sc0 sc1
    s_branch ffn1_kernel_g2
ffn1_kernel_two:
    s_add_u32 s51, s81, 0
    s_mov_b32 m0, s51
    s_add_u32 s61, s80, 0
    buffer_load_dwordx4 v2, s[52:55], s61 offen offset:0 lds
    buffer_load_dwordx4 v2, s[52:55], s61 offen offset:1024 lds
    buffer_load_dwordx4 v2, s[52:55], s61 offen offset:2048 lds
    buffer_load_dwordx4 v2, s[52:55], s61 offen offset:3072 lds
    s_add_u32 s51, s81, 4096
    s_mov_b32 m0, s51
    s_add_u32 s61, s80, 4096
    buffer_load_dwordx4 v2, s[52:55], s61 offen offset:0 lds
    buffer_load_dwordx4 v2, s[52:55], s61 offen offset:1024 lds
    buffer_load_dwordx4 v2, s[52:55], s61 offen offset:2048 lds
    buffer_load_dwordx4 v2, s[52:55], s61 offen offset:3072 lds
    s_add_u32 s51, s49, 0
    buffer_load_dwordx4 v[128:131], v2, s[44:47], s51 offen
    s_add_u32 s51, s49, 1024
    buffer_load_dwordx4 v[132:135], v2, s[44:47], s51 offen
    s_add_u32 s51, s49, 2048
    buffer_load_dwordx4 v[136:139], v2, s[44:47], s51 offen
    s_add_u32 s51, s49, 3072
    buffer_load_dwordx4 v[140:143], v2, s[44:47], s51 offen
    s_add_u32 s51, s49, 4096
    buffer_load_dwordx4 v[144:147], v2, s[44:47], s51 offen
    s_add_u32 s51, s49, 5120
    buffer_load_dwordx4 v[148:151], v2, s[44:47], s51 offen
    s_add_u32 s51, s49, 6144
    buffer_load_dwordx4 v[152:155], v2, s[44:47], s51 offen
    s_add_u32 s51, s49, 7168
    buffer_load_dwordx4 v[156:159], v2, s[44:47], s51 offen
    s_add_u32 s51, s49, 8192
    buffer_load_dwordx4 v[160:163], v2, s[44:47], s51 offen
    s_add_u32 s51, s49, 9216
    buffer_load_dwordx4 v[164:167], v2, s[44:47], s51 offen
    s_add_u32 s51, s49, 10240
    buffer_load_dwordx4 v[168:171], v2, s[44:47], s51 offen
    s_add_u32 s51, s49, 11264
    buffer_load_dwordx4 v[172:175], v2, s[44:47], s51 offen
    s_add_u32 s51, s49, 12288
    buffer_load_dwordx4 v[176:179], v2, s[44:47], s51 offen
    s_add_u32 s51, s49, 13312
    buffer_load_dwordx4 v[180:183], v2, s[44:47], s51 offen
    s_add_u32 s51, s49, 14336
    buffer_load_dwordx4 v[184:187], v2, s[44:47], s51 offen
    s_add_u32 s51, s49, 15360
    buffer_load_dwordx4 v[188:191], v2, s[44:47], s51 offen
    s_add_u32 s51, s49, 16384
    buffer_load_dwordx4 v[192:195], v2, s[44:47], s51 offen
    s_add_u32 s51, s49, 17408
    buffer_load_dwordx4 v[196:199], v2, s[44:47], s51 offen
    s_add_u32 s51, s49, 18432
    buffer_load_dwordx4 v[200:203], v2, s[44:47], s51 offen
    s_add_u32 s51, s49, 19456
    buffer_load_dwordx4 v[204:207], v2, s[44:47], s51 offen
    s_add_u32 s51, s49, 20480
    buffer_load_dwordx4 v[208:211], v2, s[44:47], s51 offen
    s_add_u32 s51, s49, 21504
    buffer_load_dwordx4 v[212:215], v2, s[44:47], s51 offen
    s_add_u32 s51, s49, 22528
    buffer_load_dwordx4 v[216:219], v2, s[44:47], s51 offen
    s_add_u32 s51, s49, 23552
    buffer_load_dwordx4 v[220:223], v2, s[44:47], s51 offen
    s_add_u32 s51, s49, 24576
    buffer_load_dwordx4 v[224:227], v2, s[44:47], s51 offen
    s_add_u32 s51, s49, 25600
    buffer_load_dwordx4 v[228:231], v2, s[44:47], s51 offen
    s_add_u32 s51, s49, 26624
    buffer_load_dwordx4 v[232:235], v2, s[44:47], s51 offen
    s_add_u32 s51, s49, 27648
    buffer_load_dwordx4 v[236:239], v2, s[44:47], s51 offen
    s_add_u32 s51, s49, 28672
    buffer_load_dwordx4 v[240:243], v2, s[44:47], s51 offen
    s_add_u32 s51, s49, 29696
    buffer_load_dwordx4 v[244:247], v2, s[44:47], s51 offen
    s_add_u32 s51, s49, 30720
    buffer_load_dwordx4 v[248:251], v2, s[44:47], s51 offen
    s_add_u32 s51, s49, 31744
    buffer_load_dwordx4 v[252:255], v2, s[44:47], s51 offen
    s_add_u32 s51, s81, 32768
    s_mov_b32 m0, s51
    s_add_u32 s61, s80, 32768
    buffer_load_dwordx4 v2, s[52:55], s61 offen offset:0 lds
    buffer_load_dwordx4 v2, s[52:55], s61 offen offset:1024 lds
    buffer_load_dwordx4 v2, s[52:55], s61 offen offset:2048 lds
    buffer_load_dwordx4 v2, s[52:55], s61 offen offset:3072 lds
    s_add_u32 s51, s81, 36864
    s_mov_b32 m0, s51
    s_add_u32 s61, s80, 36864
    buffer_load_dwordx4 v2, s[52:55], s61 offen offset:0 lds
    buffer_load_dwordx4 v2, s[52:55], s61 offen offset:1024 lds
    buffer_load_dwordx4 v2, s[52:55], s61 offen offset:2048 lds
    buffer_load_dwordx4 v2, s[52:55], s61 offen offset:3072 lds
    s_add_u32 s51, s81, 65536
    s_mov_b32 m0, s51
    s_add_u32 s61, s80, 65536
    buffer_load_dwordx4 v2, s[52:55], s61 offen offset:0 lds
    buffer_load_dwordx4 v2, s[52:55], s61 offen offset:1024 lds
    buffer_load_dwordx4 v2, s[52:55], s61 offen offset:2048 lds
    buffer_load_dwordx4 v2, s[52:55], s61 offen offset:3072 lds
    s_add_u32 s51, s81, 69632
    s_mov_b32 m0, s51
    s_add_u32 s61, s80, 69632
    buffer_load_dwordx4 v2, s[52:55], s61 offen offset:0 lds
    buffer_load_dwordx4 v2, s[52:55], s61 offen offset:1024 lds
    buffer_load_dwordx4 v2, s[52:55], s61 offen offset:2048 lds
    buffer_load_dwordx4 v2, s[52:55], s61 offen offset:3072 lds
    s_add_u32 s51, s81, 98304
    s_mov_b32 m0, s51
    s_add_u32 s61, s80, 98304
    buffer_load_dwordx4 v2, s[52:55], s61 offen offset:0 lds
    buffer_load_dwordx4 v2, s[52:55], s61 offen offset:1024 lds
    buffer_load_dwordx4 v2, s[52:55], s61 offen offset:2048 lds
    buffer_load_dwordx4 v2, s[52:55], s61 offen offset:3072 lds
    s_add_u32 s51, s81, 102400
    s_mov_b32 m0, s51
    s_add_u32 s61, s80, 102400
    buffer_load_dwordx4 v2, s[52:55], s61 offen offset:0 lds
    buffer_load_dwordx4 v2, s[52:55], s61 offen offset:1024 lds
    buffer_load_dwordx4 v2, s[52:55], s61 offen offset:2048 lds
    buffer_load_dwordx4 v2, s[52:55], s61 offen offset:3072 lds
    v_mov_b32 v64, 0
    v_mov_b32 v65, 0
    v_mov_b32 v66, 0
    v_mov_b32 v67, 0
    v_mov_b32 v68, 0
    v_mov_b32 v69, 0
    v_mov_b32 v70, 0
    v_mov_b32 v71, 0
    v_mov_b32 v72, 0
    v_mov_b32 v73, 0
    v_mov_b32 v74, 0
    v_mov_b32 v75, 0
    v_mov_b32 v76, 0
    v_mov_b32 v77, 0
    v_mov_b32 v78, 0
    v_mov_b32 v79, 0
    v_mov_b32 v80, 0
    v_mov_b32 v81, 0
    v_mov_b32 v82, 0
    v_mov_b32 v83, 0
    v_mov_b32 v84, 0
    v_mov_b32 v85, 0
    v_mov_b32 v86, 0
    v_mov_b32 v87, 0
    v_mov_b32 v88, 0
    v_mov_b32 v89, 0
    v_mov_b32 v90, 0
    v_mov_b32 v91, 0
    v_mov_b32 v92, 0
    v_mov_b32 v93, 0
    v_mov_b32 v94, 0
    v_mov_b32 v95, 0
    v_mov_b32 v32, 0
    v_mov_b32 v33, 0
    v_mov_b32 v34, 0
    v_mov_b32 v35, 0
    v_mov_b32 v36, 0
    v_mov_b32 v37, 0
    v_mov_b32 v38, 0
    v_mov_b32 v39, 0
    v_mov_b32 v40, 0
    v_mov_b32 v41, 0
    v_mov_b32 v42, 0
    v_mov_b32 v43, 0
    v_mov_b32 v44, 0
    v_mov_b32 v45, 0
    v_mov_b32 v46, 0
    v_mov_b32 v47, 0
    v_mov_b32 v48, 0
    v_mov_b32 v49, 0
    v_mov_b32 v50, 0
    v_mov_b32 v51, 0
    v_mov_b32 v52, 0
    v_mov_b32 v53, 0
    v_mov_b32 v54, 0
    v_mov_b32 v55, 0
    v_mov_b32 v56, 0
    v_mov_b32 v57, 0
    v_mov_b32 v58, 0
    v_mov_b32 v59, 0
    v_mov_b32 v60, 0
    v_mov_b32 v61, 0
    v_mov_b32 v62, 0
    v_mov_b32 v63, 0
    s_waitcnt vmcnt(24)
    s_barrier
    ds_read_b128 a[192:195], v8 offset:0
    ds_read_b128 a[196:199], v8 offset:1024
    ds_read_b128 a[200:203], v8 offset:2048
    ds_read_b128 a[204:207], v8 offset:3072
    ds_read_b128 a[208:211], v8 offset:4096
    ds_read_b128 a[212:215], v8 offset:5120
    ds_read_b128 a[216:219], v8 offset:6144
    ds_read_b128 a[220:223], v8 offset:7168
    ds_read_b128 a[224:227], v8 offset:8192
    ds_read_b128 a[228:231], v8 offset:9216
    ds_read_b128 a[232:235], v8 offset:10240
    ds_read_b128 a[236:239], v8 offset:11264
    ds_read_b128 a[240:243], v8 offset:12288
    ds_read_b128 a[244:247], v8 offset:13312
    ds_read_b128 a[248:251], v8 offset:14336
    ds_read_b128 a[252:255], v8 offset:15360
    s_waitcnt lgkmcnt(12)
    v_mfma_f32_16x16x32_bf16 v[64:67], a[192:195], v[128:131], v[64:67]
    v_mfma_f32_16x16x32_bf16 v[68:71], a[192:195], v[192:195], v[68:71]
    s_add_u32 s63, s95, 0
    buffer_load_dwordx4 a[0:3], v2, s[84:87], s63 offen offset:0
    v_mfma_f32_16x16x32_bf16 v[72:75], a[196:199], v[128:131], v[72:75]
    v_mfma_f32_16x16x32_bf16 v[76:79], a[196:199], v[192:195], v[76:79]
    v_mfma_f32_16x16x32_bf16 v[80:83], a[200:203], v[128:131], v[80:83]
    v_mfma_f32_16x16x32_bf16 v[84:87], a[200:203], v[192:195], v[84:87]
    buffer_load_dwordx4 a[4:7], v2, s[84:87], s63 offen offset:1024
    v_mfma_f32_16x16x32_bf16 v[88:91], a[204:207], v[128:131], v[88:91]
    v_mfma_f32_16x16x32_bf16 v[92:95], a[204:207], v[192:195], v[92:95]
    ds_read_b128 a[192:195], v8 offset:16384
    ds_read_b128 a[196:199], v8 offset:17408
    ds_read_b128 a[200:203], v8 offset:18432
    ds_read_b128 a[204:207], v8 offset:19456
    s_waitcnt lgkmcnt(12)
    v_mfma_f32_16x16x32_bf16 v[64:67], a[208:211], v[132:135], v[64:67]
    v_mfma_f32_16x16x32_bf16 v[68:71], a[208:211], v[196:199], v[68:71]
    buffer_load_dwordx4 a[8:11], v2, s[84:87], s63 offen offset:2048
    v_mfma_f32_16x16x32_bf16 v[72:75], a[212:215], v[132:135], v[72:75]
    v_mfma_f32_16x16x32_bf16 v[76:79], a[212:215], v[196:199], v[76:79]
    v_mfma_f32_16x16x32_bf16 v[80:83], a[216:219], v[132:135], v[80:83]
    v_mfma_f32_16x16x32_bf16 v[84:87], a[216:219], v[196:199], v[84:87]
    v_mfma_f32_16x16x32_bf16 v[88:91], a[220:223], v[132:135], v[88:91]
    v_mfma_f32_16x16x32_bf16 v[92:95], a[220:223], v[196:199], v[92:95]
    ds_read_b128 a[208:211], v8 offset:20480
    ds_read_b128 a[212:215], v8 offset:21504
    ds_read_b128 a[216:219], v8 offset:22528
    ds_read_b128 a[220:223], v8 offset:23552
    s_waitcnt lgkmcnt(12)
    v_mfma_f32_16x16x32_bf16 v[64:67], a[224:227], v[136:139], v[64:67]
    v_mfma_f32_16x16x32_bf16 v[68:71], a[224:227], v[200:203], v[68:71]
    buffer_load_dwordx4 a[12:15], v2, s[84:87], s63 offen offset:3072
    v_mfma_f32_16x16x32_bf16 v[72:75], a[228:231], v[136:139], v[72:75]
    v_mfma_f32_16x16x32_bf16 v[76:79], a[228:231], v[200:203], v[76:79]
    v_mfma_f32_16x16x32_bf16 v[80:83], a[232:235], v[136:139], v[80:83]
    v_mfma_f32_16x16x32_bf16 v[84:87], a[232:235], v[200:203], v[84:87]
    s_add_u32 s63, s95, 16384
    buffer_load_dwordx4 a[16:19], v2, s[84:87], s63 offen offset:0
    v_mfma_f32_16x16x32_bf16 v[88:91], a[236:239], v[136:139], v[88:91]
    v_mfma_f32_16x16x32_bf16 v[92:95], a[236:239], v[200:203], v[92:95]
    ds_read_b128 a[224:227], v8 offset:24576
    ds_read_b128 a[228:231], v8 offset:25600
    ds_read_b128 a[232:235], v8 offset:26624
    ds_read_b128 a[236:239], v8 offset:27648
    s_waitcnt lgkmcnt(12)
    v_mfma_f32_16x16x32_bf16 v[64:67], a[240:243], v[140:143], v[64:67]
    v_mfma_f32_16x16x32_bf16 v[68:71], a[240:243], v[204:207], v[68:71]
    v_mfma_f32_16x16x32_bf16 v[72:75], a[244:247], v[140:143], v[72:75]
    v_mfma_f32_16x16x32_bf16 v[76:79], a[244:247], v[204:207], v[76:79]
    v_mfma_f32_16x16x32_bf16 v[80:83], a[248:251], v[140:143], v[80:83]
    v_mfma_f32_16x16x32_bf16 v[84:87], a[248:251], v[204:207], v[84:87]
    buffer_load_dwordx4 a[20:23], v2, s[84:87], s63 offen offset:1024
    v_mfma_f32_16x16x32_bf16 v[88:91], a[252:255], v[140:143], v[88:91]
    v_mfma_f32_16x16x32_bf16 v[92:95], a[252:255], v[204:207], v[92:95]
    ds_read_b128 a[240:243], v8 offset:28672
    ds_read_b128 a[244:247], v8 offset:29696
    ds_read_b128 a[248:251], v8 offset:30720
    ds_read_b128 a[252:255], v8 offset:31744
    s_waitcnt lgkmcnt(12)
    v_mfma_f32_16x16x32_bf16 v[64:67], a[192:195], v[144:147], v[64:67]
    v_mfma_f32_16x16x32_bf16 v[68:71], a[192:195], v[208:211], v[68:71]
    buffer_load_dwordx4 a[24:27], v2, s[84:87], s63 offen offset:2048
    v_mfma_f32_16x16x32_bf16 v[72:75], a[196:199], v[144:147], v[72:75]
    v_mfma_f32_16x16x32_bf16 v[76:79], a[196:199], v[208:211], v[76:79]
    v_mfma_f32_16x16x32_bf16 v[80:83], a[200:203], v[144:147], v[80:83]
    v_mfma_f32_16x16x32_bf16 v[84:87], a[200:203], v[208:211], v[84:87]
    v_mfma_f32_16x16x32_bf16 v[88:91], a[204:207], v[144:147], v[88:91]
    v_mfma_f32_16x16x32_bf16 v[92:95], a[204:207], v[208:211], v[92:95]
    s_waitcnt lgkmcnt(8)
    v_mfma_f32_16x16x32_bf16 v[64:67], a[208:211], v[148:151], v[64:67]
    v_mfma_f32_16x16x32_bf16 v[68:71], a[208:211], v[212:215], v[68:71]
    buffer_load_dwordx4 a[28:31], v2, s[84:87], s63 offen offset:3072
    v_mfma_f32_16x16x32_bf16 v[72:75], a[212:215], v[148:151], v[72:75]
    v_mfma_f32_16x16x32_bf16 v[76:79], a[212:215], v[212:215], v[76:79]
    v_mfma_f32_16x16x32_bf16 v[80:83], a[216:219], v[148:151], v[80:83]
    v_mfma_f32_16x16x32_bf16 v[84:87], a[216:219], v[212:215], v[84:87]
    s_add_u32 s63, s95, 32768
    buffer_load_dwordx4 a[32:35], v2, s[84:87], s63 offen offset:0
    v_mfma_f32_16x16x32_bf16 v[88:91], a[220:223], v[148:151], v[88:91]
    v_mfma_f32_16x16x32_bf16 v[92:95], a[220:223], v[212:215], v[92:95]
    s_waitcnt lgkmcnt(4)
    v_mfma_f32_16x16x32_bf16 v[64:67], a[224:227], v[152:155], v[64:67]
    v_mfma_f32_16x16x32_bf16 v[68:71], a[224:227], v[216:219], v[68:71]
    v_mfma_f32_16x16x32_bf16 v[72:75], a[228:231], v[152:155], v[72:75]
    v_mfma_f32_16x16x32_bf16 v[76:79], a[228:231], v[216:219], v[76:79]
    v_mfma_f32_16x16x32_bf16 v[80:83], a[232:235], v[152:155], v[80:83]
    v_mfma_f32_16x16x32_bf16 v[84:87], a[232:235], v[216:219], v[84:87]
    buffer_load_dwordx4 a[36:39], v2, s[84:87], s63 offen offset:1024
    v_mfma_f32_16x16x32_bf16 v[88:91], a[236:239], v[152:155], v[88:91]
    v_mfma_f32_16x16x32_bf16 v[92:95], a[236:239], v[216:219], v[92:95]
    s_waitcnt lgkmcnt(0)
    v_mfma_f32_16x16x32_bf16 v[64:67], a[240:243], v[156:159], v[64:67]
    v_mfma_f32_16x16x32_bf16 v[68:71], a[240:243], v[220:223], v[68:71]
    buffer_load_dwordx4 a[40:43], v2, s[84:87], s63 offen offset:2048
    v_mfma_f32_16x16x32_bf16 v[72:75], a[244:247], v[156:159], v[72:75]
    v_mfma_f32_16x16x32_bf16 v[76:79], a[244:247], v[220:223], v[76:79]
    v_mfma_f32_16x16x32_bf16 v[80:83], a[248:251], v[156:159], v[80:83]
    v_mfma_f32_16x16x32_bf16 v[84:87], a[248:251], v[220:223], v[84:87]
    v_mfma_f32_16x16x32_bf16 v[88:91], a[252:255], v[156:159], v[88:91]
    v_mfma_f32_16x16x32_bf16 v[92:95], a[252:255], v[220:223], v[92:95]
    s_waitcnt vmcnt(27)
    s_barrier
    ds_read_b128 a[192:195], v9 offset:0
    ds_read_b128 a[196:199], v9 offset:1024
    ds_read_b128 a[200:203], v9 offset:2048
    ds_read_b128 a[204:207], v9 offset:3072
    ds_read_b128 a[208:211], v9 offset:4096
    ds_read_b128 a[212:215], v9 offset:5120
    ds_read_b128 a[216:219], v9 offset:6144
    ds_read_b128 a[220:223], v9 offset:7168
    ds_read_b128 a[224:227], v9 offset:8192
    ds_read_b128 a[228:231], v9 offset:9216
    ds_read_b128 a[232:235], v9 offset:10240
    ds_read_b128 a[236:239], v9 offset:11264
    ds_read_b128 a[240:243], v9 offset:12288
    ds_read_b128 a[244:247], v9 offset:13312
    ds_read_b128 a[248:251], v9 offset:14336
    ds_read_b128 a[252:255], v9 offset:15360
    s_waitcnt lgkmcnt(12)
    v_mfma_f32_16x16x32_bf16 v[64:67], a[192:195], v[160:163], v[64:67]
    v_mfma_f32_16x16x32_bf16 v[68:71], a[192:195], v[224:227], v[68:71]
    buffer_load_dwordx4 a[44:47], v2, s[84:87], s63 offen offset:3072
    v_mfma_f32_16x16x32_bf16 v[72:75], a[196:199], v[160:163], v[72:75]
    v_mfma_f32_16x16x32_bf16 v[76:79], a[196:199], v[224:227], v[76:79]
    v_mfma_f32_16x16x32_bf16 v[80:83], a[200:203], v[160:163], v[80:83]
    v_mfma_f32_16x16x32_bf16 v[84:87], a[200:203], v[224:227], v[84:87]
    s_add_u32 s63, s95, 49152
    buffer_load_dwordx4 a[48:51], v2, s[84:87], s63 offen offset:0
    v_mfma_f32_16x16x32_bf16 v[88:91], a[204:207], v[160:163], v[88:91]
    v_mfma_f32_16x16x32_bf16 v[92:95], a[204:207], v[224:227], v[92:95]
    ds_read_b128 a[192:195], v9 offset:16384
    ds_read_b128 a[196:199], v9 offset:17408
    ds_read_b128 a[200:203], v9 offset:18432
    ds_read_b128 a[204:207], v9 offset:19456
    s_waitcnt lgkmcnt(12)
    v_mfma_f32_16x16x32_bf16 v[64:67], a[208:211], v[164:167], v[64:67]
    v_mfma_f32_16x16x32_bf16 v[68:71], a[208:211], v[228:231], v[68:71]
    buffer_load_dwordx4 a[52:55], v2, s[84:87], s63 offen offset:1024
    v_mfma_f32_16x16x32_bf16 v[72:75], a[212:215], v[164:167], v[72:75]
    v_mfma_f32_16x16x32_bf16 v[76:79], a[212:215], v[228:231], v[76:79]
    v_mfma_f32_16x16x32_bf16 v[80:83], a[216:219], v[164:167], v[80:83]
    v_mfma_f32_16x16x32_bf16 v[84:87], a[216:219], v[228:231], v[84:87]
    v_mfma_f32_16x16x32_bf16 v[88:91], a[220:223], v[164:167], v[88:91]
    v_mfma_f32_16x16x32_bf16 v[92:95], a[220:223], v[228:231], v[92:95]
    ds_read_b128 a[208:211], v9 offset:20480
    ds_read_b128 a[212:215], v9 offset:21504
    ds_read_b128 a[216:219], v9 offset:22528
    ds_read_b128 a[220:223], v9 offset:23552
    s_waitcnt lgkmcnt(12)
    v_mfma_f32_16x16x32_bf16 v[64:67], a[224:227], v[168:171], v[64:67]
    v_mfma_f32_16x16x32_bf16 v[68:71], a[224:227], v[232:235], v[68:71]
    buffer_load_dwordx4 a[56:59], v2, s[84:87], s63 offen offset:2048
    v_mfma_f32_16x16x32_bf16 v[72:75], a[228:231], v[168:171], v[72:75]
    v_mfma_f32_16x16x32_bf16 v[76:79], a[228:231], v[232:235], v[76:79]
    v_mfma_f32_16x16x32_bf16 v[80:83], a[232:235], v[168:171], v[80:83]
    v_mfma_f32_16x16x32_bf16 v[84:87], a[232:235], v[232:235], v[84:87]
    buffer_load_dwordx4 a[60:63], v2, s[84:87], s63 offen offset:3072
    v_mfma_f32_16x16x32_bf16 v[88:91], a[236:239], v[168:171], v[88:91]
    v_mfma_f32_16x16x32_bf16 v[92:95], a[236:239], v[232:235], v[92:95]
    ds_read_b128 a[224:227], v9 offset:24576
    ds_read_b128 a[228:231], v9 offset:25600
    ds_read_b128 a[232:235], v9 offset:26624
    ds_read_b128 a[236:239], v9 offset:27648
    s_waitcnt lgkmcnt(12)
    v_mfma_f32_16x16x32_bf16 v[64:67], a[240:243], v[172:175], v[64:67]
    v_mfma_f32_16x16x32_bf16 v[68:71], a[240:243], v[236:239], v[68:71]
    v_mfma_f32_16x16x32_bf16 v[72:75], a[244:247], v[172:175], v[72:75]
    v_mfma_f32_16x16x32_bf16 v[76:79], a[244:247], v[236:239], v[76:79]
    v_mfma_f32_16x16x32_bf16 v[80:83], a[248:251], v[172:175], v[80:83]
    v_mfma_f32_16x16x32_bf16 v[84:87], a[248:251], v[236:239], v[84:87]
    s_add_u32 s63, s95, 65536
    buffer_load_dwordx4 a[64:67], v2, s[84:87], s63 offen offset:0
    v_mfma_f32_16x16x32_bf16 v[88:91], a[252:255], v[172:175], v[88:91]
    v_mfma_f32_16x16x32_bf16 v[92:95], a[252:255], v[236:239], v[92:95]
    ds_read_b128 a[240:243], v9 offset:28672
    ds_read_b128 a[244:247], v9 offset:29696
    ds_read_b128 a[248:251], v9 offset:30720
    ds_read_b128 a[252:255], v9 offset:31744
    s_waitcnt lgkmcnt(12)
    v_mfma_f32_16x16x32_bf16 v[64:67], a[192:195], v[176:179], v[64:67]
    v_mfma_f32_16x16x32_bf16 v[68:71], a[192:195], v[240:243], v[68:71]
    buffer_load_dwordx4 a[68:71], v2, s[84:87], s63 offen offset:1024
    v_mfma_f32_16x16x32_bf16 v[72:75], a[196:199], v[176:179], v[72:75]
    v_mfma_f32_16x16x32_bf16 v[76:79], a[196:199], v[240:243], v[76:79]
    v_mfma_f32_16x16x32_bf16 v[80:83], a[200:203], v[176:179], v[80:83]
    v_mfma_f32_16x16x32_bf16 v[84:87], a[200:203], v[240:243], v[84:87]
    v_mfma_f32_16x16x32_bf16 v[88:91], a[204:207], v[176:179], v[88:91]
    v_mfma_f32_16x16x32_bf16 v[92:95], a[204:207], v[240:243], v[92:95]
    s_waitcnt lgkmcnt(8)
    v_mfma_f32_16x16x32_bf16 v[64:67], a[208:211], v[180:183], v[64:67]
    v_mfma_f32_16x16x32_bf16 v[68:71], a[208:211], v[244:247], v[68:71]
    buffer_load_dwordx4 a[72:75], v2, s[84:87], s63 offen offset:2048
    v_mfma_f32_16x16x32_bf16 v[72:75], a[212:215], v[180:183], v[72:75]
    v_mfma_f32_16x16x32_bf16 v[76:79], a[212:215], v[244:247], v[76:79]
    v_mfma_f32_16x16x32_bf16 v[80:83], a[216:219], v[180:183], v[80:83]
    v_mfma_f32_16x16x32_bf16 v[84:87], a[216:219], v[244:247], v[84:87]
    buffer_load_dwordx4 a[76:79], v2, s[84:87], s63 offen offset:3072
    v_mfma_f32_16x16x32_bf16 v[88:91], a[220:223], v[180:183], v[88:91]
    v_mfma_f32_16x16x32_bf16 v[92:95], a[220:223], v[244:247], v[92:95]
    s_waitcnt lgkmcnt(4)
    v_mfma_f32_16x16x32_bf16 v[64:67], a[224:227], v[184:187], v[64:67]
    v_mfma_f32_16x16x32_bf16 v[68:71], a[224:227], v[248:251], v[68:71]
    v_mfma_f32_16x16x32_bf16 v[72:75], a[228:231], v[184:187], v[72:75]
    v_mfma_f32_16x16x32_bf16 v[76:79], a[228:231], v[248:251], v[76:79]
    v_mfma_f32_16x16x32_bf16 v[80:83], a[232:235], v[184:187], v[80:83]
    v_mfma_f32_16x16x32_bf16 v[84:87], a[232:235], v[248:251], v[84:87]
    s_add_u32 s63, s95, 81920
    buffer_load_dwordx4 a[80:83], v2, s[84:87], s63 offen offset:0
    v_mfma_f32_16x16x32_bf16 v[88:91], a[236:239], v[184:187], v[88:91]
    v_mfma_f32_16x16x32_bf16 v[92:95], a[236:239], v[248:251], v[92:95]
    s_waitcnt lgkmcnt(0)
    v_mfma_f32_16x16x32_bf16 v[64:67], a[240:243], v[188:191], v[64:67]
    v_mfma_f32_16x16x32_bf16 v[68:71], a[240:243], v[252:255], v[68:71]
    buffer_load_dwordx4 a[84:87], v2, s[84:87], s63 offen offset:1024
    v_mfma_f32_16x16x32_bf16 v[72:75], a[244:247], v[188:191], v[72:75]
    v_mfma_f32_16x16x32_bf16 v[76:79], a[244:247], v[252:255], v[76:79]
    v_mfma_f32_16x16x32_bf16 v[80:83], a[248:251], v[188:191], v[80:83]
    v_mfma_f32_16x16x32_bf16 v[84:87], a[248:251], v[252:255], v[84:87]
    v_mfma_f32_16x16x32_bf16 v[88:91], a[252:255], v[188:191], v[88:91]
    v_mfma_f32_16x16x32_bf16 v[92:95], a[252:255], v[252:255], v[92:95]
    s_waitcnt vmcnt(30)
    s_barrier
    ds_read_b128 a[192:195], v10 offset:0
    ds_read_b128 a[196:199], v10 offset:1024
    ds_read_b128 a[200:203], v10 offset:2048
    ds_read_b128 a[204:207], v10 offset:3072
    ds_read_b128 a[208:211], v10 offset:4096
    ds_read_b128 a[212:215], v10 offset:5120
    ds_read_b128 a[216:219], v10 offset:6144
    ds_read_b128 a[220:223], v10 offset:7168
    ds_read_b128 a[224:227], v10 offset:8192
    ds_read_b128 a[228:231], v10 offset:9216
    ds_read_b128 a[232:235], v10 offset:10240
    ds_read_b128 a[236:239], v10 offset:11264
    ds_read_b128 a[240:243], v10 offset:12288
    ds_read_b128 a[244:247], v10 offset:13312
    ds_read_b128 a[248:251], v10 offset:14336
    ds_read_b128 a[252:255], v10 offset:15360
    s_waitcnt lgkmcnt(12)
    v_mfma_f32_16x16x32_bf16 v[32:35], a[192:195], v[128:131], v[32:35]
    v_cvt_pk_bf16_f32 v64, v64, v64
    v_lshlrev_b32 v64, 16, v64
    v_cvt_pk_bf16_f32 v80, v80, v80
    v_mfma_f32_16x16x32_bf16 v[36:39], a[192:195], v[192:195], v[36:39]
    v_lshlrev_b32 v80, 16, v80
    v_mul_f32 v20, 0xbfb8aa3b, v64
    v_exp_f32 v20, v20
    buffer_load_dwordx4 a[88:91], v2, s[84:87], s63 offen offset:2048
    v_mfma_f32_16x16x32_bf16 v[40:43], a[196:199], v[128:131], v[40:43]
    v_add_f32 v20, 1.0, v20
    v_rcp_f32 v20, v20
    s_nop 0
    v_mul_f32 v64, v64, v20
    v_mfma_f32_16x16x32_bf16 v[44:47], a[196:199], v[192:195], v[44:47]
    v_cvt_pk_bf16_f32 v64, v64, v64
    v_lshlrev_b32 v64, 16, v64
    v_mul_f32 v64, v64, v80
    v_mfma_f32_16x16x32_bf16 v[48:51], a[200:203], v[128:131], v[48:51]
    v_cvt_pk_bf16_f32 v65, v65, v65
    v_lshlrev_b32 v65, 16, v65
    v_cvt_pk_bf16_f32 v81, v81, v81
    v_mfma_f32_16x16x32_bf16 v[52:55], a[200:203], v[192:195], v[52:55]
    v_lshlrev_b32 v81, 16, v81
    v_mul_f32 v21, 0xbfb8aa3b, v65
    v_exp_f32 v21, v21
    buffer_load_dwordx4 a[92:95], v2, s[84:87], s63 offen offset:3072
    v_mfma_f32_16x16x32_bf16 v[56:59], a[204:207], v[128:131], v[56:59]
    v_add_f32 v21, 1.0, v21
    v_rcp_f32 v21, v21
    s_nop 0
    v_mul_f32 v65, v65, v21
    v_mfma_f32_16x16x32_bf16 v[60:63], a[204:207], v[192:195], v[60:63]
    v_cvt_pk_bf16_f32 v65, v65, v65
    v_lshlrev_b32 v65, 16, v65
    v_mul_f32 v65, v65, v81
    v_cvt_pk_bf16_f32 v66, v66, v66
    ds_read_b128 a[192:195], v10 offset:16384
    ds_read_b128 a[196:199], v10 offset:17408
    ds_read_b128 a[200:203], v10 offset:18432
    ds_read_b128 a[204:207], v10 offset:19456
    s_waitcnt lgkmcnt(12)
    v_mfma_f32_16x16x32_bf16 v[32:35], a[208:211], v[132:135], v[32:35]
    v_lshlrev_b32 v66, 16, v66
    v_cvt_pk_bf16_f32 v82, v82, v82
    v_lshlrev_b32 v82, 16, v82
    v_mfma_f32_16x16x32_bf16 v[36:39], a[208:211], v[196:199], v[36:39]
    v_mul_f32 v22, 0xbfb8aa3b, v66
    v_exp_f32 v22, v22
    s_nop 0
    v_add_f32 v22, 1.0, v22
    s_add_u32 s63, s95, 98304
    buffer_load_dwordx4 a[96:99], v2, s[84:87], s63 offen offset:0
    v_mfma_f32_16x16x32_bf16 v[40:43], a[212:215], v[132:135], v[40:43]
    v_rcp_f32 v22, v22
    s_nop 0
    v_mul_f32 v66, v66, v22
    v_cvt_pk_bf16_f32 v66, v66, v66
    v_mfma_f32_16x16x32_bf16 v[44:47], a[212:215], v[196:199], v[44:47]
    v_lshlrev_b32 v66, 16, v66
    v_mul_f32 v66, v66, v82
    v_cvt_pk_bf16_f32 v67, v67, v67
    v_mfma_f32_16x16x32_bf16 v[48:51], a[216:219], v[132:135], v[48:51]
    v_lshlrev_b32 v67, 16, v67
    v_cvt_pk_bf16_f32 v83, v83, v83
    v_lshlrev_b32 v83, 16, v83
    v_mfma_f32_16x16x32_bf16 v[52:55], a[216:219], v[196:199], v[52:55]
    v_mul_f32 v23, 0xbfb8aa3b, v67
    v_exp_f32 v23, v23
    s_nop 0
    v_add_f32 v23, 1.0, v23
    v_mfma_f32_16x16x32_bf16 v[56:59], a[220:223], v[132:135], v[56:59]
    v_rcp_f32 v23, v23
    s_nop 0
    v_mul_f32 v67, v67, v23
    v_cvt_pk_bf16_f32 v67, v67, v67
    v_mfma_f32_16x16x32_bf16 v[60:63], a[220:223], v[196:199], v[60:63]
    v_lshlrev_b32 v67, 16, v67
    v_mul_f32 v67, v67, v83
    v_cvt_pk_bf16_f32 v24, v64, v65
    v_cvt_pk_bf16_f32 v25, v66, v67
    ds_read_b128 a[208:211], v10 offset:20480
    ds_read_b128 a[212:215], v10 offset:21504
    ds_read_b128 a[216:219], v10 offset:22528
    ds_read_b128 a[220:223], v10 offset:23552
    s_waitcnt lgkmcnt(12)
    v_mfma_f32_16x16x32_bf16 v[32:35], a[224:227], v[136:139], v[32:35]
    v_cvt_pk_bf16_f32 v72, v72, v72
    v_lshlrev_b32 v72, 16, v72
    v_cvt_pk_bf16_f32 v88, v88, v88
    v_mfma_f32_16x16x32_bf16 v[36:39], a[224:227], v[200:203], v[36:39]
    v_lshlrev_b32 v88, 16, v88
    v_mul_f32 v20, 0xbfb8aa3b, v72
    v_exp_f32 v20, v20
    buffer_load_dwordx4 a[100:103], v2, s[84:87], s63 offen offset:1024
    v_mfma_f32_16x16x32_bf16 v[40:43], a[228:231], v[136:139], v[40:43]
    v_add_f32 v20, 1.0, v20
    v_rcp_f32 v20, v20
    s_nop 0
    v_mul_f32 v72, v72, v20
    v_mfma_f32_16x16x32_bf16 v[44:47], a[228:231], v[200:203], v[44:47]
    v_cvt_pk_bf16_f32 v72, v72, v72
    v_lshlrev_b32 v72, 16, v72
    v_mul_f32 v72, v72, v88
    v_mfma_f32_16x16x32_bf16 v[48:51], a[232:235], v[136:139], v[48:51]
    v_cvt_pk_bf16_f32 v73, v73, v73
    v_lshlrev_b32 v73, 16, v73
    v_cvt_pk_bf16_f32 v89, v89, v89
    v_mfma_f32_16x16x32_bf16 v[52:55], a[232:235], v[200:203], v[52:55]
    v_lshlrev_b32 v89, 16, v89
    v_mul_f32 v21, 0xbfb8aa3b, v73
    v_exp_f32 v21, v21
    buffer_load_dwordx4 a[104:107], v2, s[84:87], s63 offen offset:2048
    v_mfma_f32_16x16x32_bf16 v[56:59], a[236:239], v[136:139], v[56:59]
    v_add_f32 v21, 1.0, v21
    v_rcp_f32 v21, v21
    s_nop 0
    v_mul_f32 v73, v73, v21
    v_mfma_f32_16x16x32_bf16 v[60:63], a[236:239], v[200:203], v[60:63]
    v_cvt_pk_bf16_f32 v73, v73, v73
    v_lshlrev_b32 v73, 16, v73
    v_mul_f32 v73, v73, v89
    v_cvt_pk_bf16_f32 v74, v74, v74
    ds_read_b128 a[224:227], v10 offset:24576
    ds_read_b128 a[228:231], v10 offset:25600
    ds_read_b128 a[232:235], v10 offset:26624
    ds_read_b128 a[236:239], v10 offset:27648
    s_waitcnt lgkmcnt(12)
    v_mfma_f32_16x16x32_bf16 v[32:35], a[240:243], v[140:143], v[32:35]
    v_lshlrev_b32 v74, 16, v74
    v_cvt_pk_bf16_f32 v90, v90, v90
    v_lshlrev_b32 v90, 16, v90
    v_mfma_f32_16x16x32_bf16 v[36:39], a[240:243], v[204:207], v[36:39]
    v_mul_f32 v22, 0xbfb8aa3b, v74
    v_exp_f32 v22, v22
    s_nop 0
    v_add_f32 v22, 1.0, v22
    v_mfma_f32_16x16x32_bf16 v[40:43], a[244:247], v[140:143], v[40:43]
    v_rcp_f32 v22, v22
    s_nop 0
    v_mul_f32 v74, v74, v22
    v_cvt_pk_bf16_f32 v74, v74, v74
    v_mfma_f32_16x16x32_bf16 v[44:47], a[244:247], v[204:207], v[44:47]
    v_lshlrev_b32 v74, 16, v74
    v_mul_f32 v74, v74, v90
    v_cvt_pk_bf16_f32 v75, v75, v75
    v_mfma_f32_16x16x32_bf16 v[48:51], a[248:251], v[140:143], v[48:51]
    v_lshlrev_b32 v75, 16, v75
    v_cvt_pk_bf16_f32 v91, v91, v91
    v_lshlrev_b32 v91, 16, v91
    v_mfma_f32_16x16x32_bf16 v[52:55], a[248:251], v[204:207], v[52:55]
    v_mul_f32 v23, 0xbfb8aa3b, v75
    v_exp_f32 v23, v23
    s_nop 0
    v_add_f32 v23, 1.0, v23
    buffer_load_dwordx4 a[108:111], v2, s[84:87], s63 offen offset:3072
    v_mfma_f32_16x16x32_bf16 v[56:59], a[252:255], v[140:143], v[56:59]
    v_rcp_f32 v23, v23
    s_nop 0
    v_mul_f32 v75, v75, v23
    v_cvt_pk_bf16_f32 v75, v75, v75
    v_mfma_f32_16x16x32_bf16 v[60:63], a[252:255], v[204:207], v[60:63]
    v_lshlrev_b32 v75, 16, v75
    v_mul_f32 v75, v75, v91
    v_cvt_pk_bf16_f32 v26, v72, v73
    v_cvt_pk_bf16_f32 v27, v74, v75
    ds_read_b128 a[240:243], v10 offset:28672
    ds_read_b128 a[244:247], v10 offset:29696
    ds_read_b128 a[248:251], v10 offset:30720
    ds_read_b128 a[252:255], v10 offset:31744
    s_waitcnt lgkmcnt(12)
    v_mfma_f32_16x16x32_bf16 v[32:35], a[192:195], v[144:147], v[32:35]
    v_cvt_pk_bf16_f32 v68, v68, v68
    v_lshlrev_b32 v68, 16, v68
    v_cvt_pk_bf16_f32 v84, v84, v84
    v_mfma_f32_16x16x32_bf16 v[36:39], a[192:195], v[208:211], v[36:39]
    v_lshlrev_b32 v84, 16, v84
    v_mul_f32 v20, 0xbfb8aa3b, v68
    v_exp_f32 v20, v20
    s_add_u32 s63, s95, 114688
    buffer_load_dwordx4 a[112:115], v2, s[84:87], s63 offen offset:0
    v_mfma_f32_16x16x32_bf16 v[40:43], a[196:199], v[144:147], v[40:43]
    v_add_f32 v20, 1.0, v20
    v_rcp_f32 v20, v20
    s_nop 0
    v_mul_f32 v68, v68, v20
    v_mfma_f32_16x16x32_bf16 v[44:47], a[196:199], v[208:211], v[44:47]
    v_cvt_pk_bf16_f32 v68, v68, v68
    v_lshlrev_b32 v68, 16, v68
    v_mul_f32 v68, v68, v84
    v_mfma_f32_16x16x32_bf16 v[48:51], a[200:203], v[144:147], v[48:51]
    v_cvt_pk_bf16_f32 v69, v69, v69
    v_lshlrev_b32 v69, 16, v69
    v_cvt_pk_bf16_f32 v85, v85, v85
    v_mfma_f32_16x16x32_bf16 v[52:55], a[200:203], v[208:211], v[52:55]
    v_lshlrev_b32 v85, 16, v85
    v_mul_f32 v21, 0xbfb8aa3b, v69
    v_exp_f32 v21, v21
    v_mfma_f32_16x16x32_bf16 v[56:59], a[204:207], v[144:147], v[56:59]
    v_add_f32 v21, 1.0, v21
    v_rcp_f32 v21, v21
    s_nop 0
    v_mul_f32 v69, v69, v21
    v_mfma_f32_16x16x32_bf16 v[60:63], a[204:207], v[208:211], v[60:63]
    v_cvt_pk_bf16_f32 v69, v69, v69
    v_lshlrev_b32 v69, 16, v69
    v_mul_f32 v69, v69, v85
    v_cvt_pk_bf16_f32 v70, v70, v70
    s_waitcnt lgkmcnt(8)
    v_mfma_f32_16x16x32_bf16 v[32:35], a[208:211], v[148:151], v[32:35]
    v_lshlrev_b32 v70, 16, v70
    v_cvt_pk_bf16_f32 v86, v86, v86
    v_lshlrev_b32 v86, 16, v86
    v_mfma_f32_16x16x32_bf16 v[36:39], a[208:211], v[212:215], v[36:39]
    v_mul_f32 v22, 0xbfb8aa3b, v70
    v_exp_f32 v22, v22
    s_nop 0
    v_add_f32 v22, 1.0, v22
    buffer_load_dwordx4 a[116:119], v2, s[84:87], s63 offen offset:1024
    v_mfma_f32_16x16x32_bf16 v[40:43], a[212:215], v[148:151], v[40:43]
    v_rcp_f32 v22, v22
    s_nop 0
    v_mul_f32 v70, v70, v22
    v_cvt_pk_bf16_f32 v70, v70, v70
    v_mfma_f32_16x16x32_bf16 v[44:47], a[212:215], v[212:215], v[44:47]
    v_lshlrev_b32 v70, 16, v70
    v_mul_f32 v70, v70, v86
    v_cvt_pk_bf16_f32 v71, v71, v71
    v_mfma_f32_16x16x32_bf16 v[48:51], a[216:219], v[148:151], v[48:51]
    v_lshlrev_b32 v71, 16, v71
    v_cvt_pk_bf16_f32 v87, v87, v87
    v_lshlrev_b32 v87, 16, v87
    v_mfma_f32_16x16x32_bf16 v[52:55], a[216:219], v[212:215], v[52:55]
    v_mul_f32 v23, 0xbfb8aa3b, v71
    v_exp_f32 v23, v23
    s_nop 0
    v_add_f32 v23, 1.0, v23
    buffer_load_dwordx4 a[120:123], v2, s[84:87], s63 offen offset:2048
    v_mfma_f32_16x16x32_bf16 v[56:59], a[220:223], v[148:151], v[56:59]
    v_rcp_f32 v23, v23
    s_nop 0
    v_mul_f32 v71, v71, v23
    v_cvt_pk_bf16_f32 v71, v71, v71
    v_mfma_f32_16x16x32_bf16 v[60:63], a[220:223], v[212:215], v[60:63]
    v_lshlrev_b32 v71, 16, v71
    v_mul_f32 v71, v71, v87
    v_cvt_pk_bf16_f32 v28, v68, v69
    v_cvt_pk_bf16_f32 v29, v70, v71
    s_waitcnt lgkmcnt(4)
    v_mfma_f32_16x16x32_bf16 v[32:35], a[224:227], v[152:155], v[32:35]
    v_cvt_pk_bf16_f32 v76, v76, v76
    v_lshlrev_b32 v76, 16, v76
    v_cvt_pk_bf16_f32 v92, v92, v92
    v_mfma_f32_16x16x32_bf16 v[36:39], a[224:227], v[216:219], v[36:39]
    v_lshlrev_b32 v92, 16, v92
    v_mul_f32 v20, 0xbfb8aa3b, v76
    v_exp_f32 v20, v20
    v_mfma_f32_16x16x32_bf16 v[40:43], a[228:231], v[152:155], v[40:43]
    v_add_f32 v20, 1.0, v20
    v_rcp_f32 v20, v20
    s_nop 0
    v_mul_f32 v76, v76, v20
    v_mfma_f32_16x16x32_bf16 v[44:47], a[228:231], v[216:219], v[44:47]
    v_cvt_pk_bf16_f32 v76, v76, v76
    v_lshlrev_b32 v76, 16, v76
    v_mul_f32 v76, v76, v92
    v_mfma_f32_16x16x32_bf16 v[48:51], a[232:235], v[152:155], v[48:51]
    v_cvt_pk_bf16_f32 v77, v77, v77
    v_lshlrev_b32 v77, 16, v77
    v_cvt_pk_bf16_f32 v93, v93, v93
    v_mfma_f32_16x16x32_bf16 v[52:55], a[232:235], v[216:219], v[52:55]
    v_lshlrev_b32 v93, 16, v93
    v_mul_f32 v21, 0xbfb8aa3b, v77
    v_exp_f32 v21, v21
    buffer_load_dwordx4 a[124:127], v2, s[84:87], s63 offen offset:3072
    v_mfma_f32_16x16x32_bf16 v[56:59], a[236:239], v[152:155], v[56:59]
    v_add_f32 v21, 1.0, v21
    v_rcp_f32 v21, v21
    s_nop 0
    v_mul_f32 v77, v77, v21
    v_mfma_f32_16x16x32_bf16 v[60:63], a[236:239], v[216:219], v[60:63]
    v_cvt_pk_bf16_f32 v77, v77, v77
    v_lshlrev_b32 v77, 16, v77
    v_mul_f32 v77, v77, v93
    v_cvt_pk_bf16_f32 v78, v78, v78
    s_waitcnt lgkmcnt(0)
    v_mfma_f32_16x16x32_bf16 v[32:35], a[240:243], v[156:159], v[32:35]
    v_lshlrev_b32 v78, 16, v78
    v_cvt_pk_bf16_f32 v94, v94, v94
    v_lshlrev_b32 v94, 16, v94
    v_mfma_f32_16x16x32_bf16 v[36:39], a[240:243], v[220:223], v[36:39]
    v_mul_f32 v22, 0xbfb8aa3b, v78
    v_exp_f32 v22, v22
    s_nop 0
    v_add_f32 v22, 1.0, v22
    s_add_u32 s63, s95, 131072
    buffer_load_dwordx4 a[128:131], v2, s[84:87], s63 offen offset:0
    v_mfma_f32_16x16x32_bf16 v[40:43], a[244:247], v[156:159], v[40:43]
    v_rcp_f32 v22, v22
    s_nop 0
    v_mul_f32 v78, v78, v22
    v_cvt_pk_bf16_f32 v78, v78, v78
    v_mfma_f32_16x16x32_bf16 v[44:47], a[244:247], v[220:223], v[44:47]
    v_lshlrev_b32 v78, 16, v78
    v_mul_f32 v78, v78, v94
    v_cvt_pk_bf16_f32 v79, v79, v79
    v_mfma_f32_16x16x32_bf16 v[48:51], a[248:251], v[156:159], v[48:51]
    v_lshlrev_b32 v79, 16, v79
    v_cvt_pk_bf16_f32 v95, v95, v95
    v_lshlrev_b32 v95, 16, v95
    v_mfma_f32_16x16x32_bf16 v[52:55], a[248:251], v[220:223], v[52:55]
    v_mul_f32 v23, 0xbfb8aa3b, v79
    v_exp_f32 v23, v23
    s_nop 0
    v_add_f32 v23, 1.0, v23
    v_mfma_f32_16x16x32_bf16 v[56:59], a[252:255], v[156:159], v[56:59]
    v_rcp_f32 v23, v23
    s_nop 0
    v_mul_f32 v79, v79, v23
    v_cvt_pk_bf16_f32 v79, v79, v79
    v_mfma_f32_16x16x32_bf16 v[60:63], a[252:255], v[220:223], v[60:63]
    v_lshlrev_b32 v79, 16, v79
    v_mul_f32 v79, v79, v95
    v_cvt_pk_bf16_f32 v30, v76, v77
    v_cvt_pk_bf16_f32 v31, v78, v79
    s_add_u32 s60, s48, 0
    s_mul_i32 s60, s60, 43
    s_add_u32 s60, s60, s42
    s_add_u32 s60, s60, 0
    s_lshl_b32 s60, s60, 10
    buffer_store_dwordx4 v[24:27], v2, s[56:59], s60 offen sc0 sc1
    s_add_u32 s60, s48, 1
    s_mul_i32 s60, s60, 43
    s_add_u32 s60, s60, s42
    s_add_u32 s60, s60, 0
    s_lshl_b32 s60, s60, 10
    buffer_store_dwordx4 v[28:31], v2, s[56:59], s60 offen sc0 sc1
    v_mov_b32 v64, 0
    v_mov_b32 v65, 0
    v_mov_b32 v66, 0
    v_mov_b32 v67, 0
    v_mov_b32 v68, 0
    v_mov_b32 v69, 0
    v_mov_b32 v70, 0
    v_mov_b32 v71, 0
    v_mov_b32 v72, 0
    v_mov_b32 v73, 0
    v_mov_b32 v74, 0
    v_mov_b32 v75, 0
    v_mov_b32 v76, 0
    v_mov_b32 v77, 0
    v_mov_b32 v78, 0
    v_mov_b32 v79, 0
    v_mov_b32 v80, 0
    v_mov_b32 v81, 0
    v_mov_b32 v82, 0
    v_mov_b32 v83, 0
    v_mov_b32 v84, 0
    v_mov_b32 v85, 0
    v_mov_b32 v86, 0
    v_mov_b32 v87, 0
    v_mov_b32 v88, 0
    v_mov_b32 v89, 0
    v_mov_b32 v90, 0
    v_mov_b32 v91, 0
    v_mov_b32 v92, 0
    v_mov_b32 v93, 0
    v_mov_b32 v94, 0
    v_mov_b32 v95, 0
    s_waitcnt vmcnt(35)
    s_barrier
    ds_read_b128 a[192:195], v11 offset:0
    ds_read_b128 a[196:199], v11 offset:1024
    ds_read_b128 a[200:203], v11 offset:2048
    ds_read_b128 a[204:207], v11 offset:3072
    ds_read_b128 a[208:211], v11 offset:4096
    ds_read_b128 a[212:215], v11 offset:5120
    ds_read_b128 a[216:219], v11 offset:6144
    ds_read_b128 a[220:223], v11 offset:7168
    ds_read_b128 a[224:227], v11 offset:8192
    ds_read_b128 a[228:231], v11 offset:9216
    ds_read_b128 a[232:235], v11 offset:10240
    ds_read_b128 a[236:239], v11 offset:11264
    ds_read_b128 a[240:243], v11 offset:12288
    ds_read_b128 a[244:247], v11 offset:13312
    ds_read_b128 a[248:251], v11 offset:14336
    ds_read_b128 a[252:255], v11 offset:15360
    s_waitcnt lgkmcnt(12)
    v_mfma_f32_16x16x32_bf16 v[32:35], a[192:195], v[160:163], v[32:35]
    v_mfma_f32_16x16x32_bf16 v[36:39], a[192:195], v[224:227], v[36:39]
    buffer_load_dwordx4 a[132:135], v2, s[84:87], s63 offen offset:1024
    v_mfma_f32_16x16x32_bf16 v[40:43], a[196:199], v[160:163], v[40:43]
    v_mfma_f32_16x16x32_bf16 v[44:47], a[196:199], v[224:227], v[44:47]
    v_mfma_f32_16x16x32_bf16 v[48:51], a[200:203], v[160:163], v[48:51]
    v_mfma_f32_16x16x32_bf16 v[52:55], a[200:203], v[224:227], v[52:55]
    buffer_load_dwordx4 a[136:139], v2, s[84:87], s63 offen offset:2048
    v_mfma_f32_16x16x32_bf16 v[56:59], a[204:207], v[160:163], v[56:59]
    v_mfma_f32_16x16x32_bf16 v[60:63], a[204:207], v[224:227], v[60:63]
    ds_read_b128 a[192:195], v11 offset:16384
    ds_read_b128 a[196:199], v11 offset:17408
    ds_read_b128 a[200:203], v11 offset:18432
    ds_read_b128 a[204:207], v11 offset:19456
    s_waitcnt lgkmcnt(12)
    v_mfma_f32_16x16x32_bf16 v[32:35], a[208:211], v[164:167], v[32:35]
    v_mfma_f32_16x16x32_bf16 v[36:39], a[208:211], v[228:231], v[36:39]
    buffer_load_dwordx4 a[140:143], v2, s[84:87], s63 offen offset:3072
    v_mfma_f32_16x16x32_bf16 v[40:43], a[212:215], v[164:167], v[40:43]
    v_mfma_f32_16x16x32_bf16 v[44:47], a[212:215], v[228:231], v[44:47]
    v_mfma_f32_16x16x32_bf16 v[48:51], a[216:219], v[164:167], v[48:51]
    v_mfma_f32_16x16x32_bf16 v[52:55], a[216:219], v[228:231], v[52:55]
    v_mfma_f32_16x16x32_bf16 v[56:59], a[220:223], v[164:167], v[56:59]
    v_mfma_f32_16x16x32_bf16 v[60:63], a[220:223], v[228:231], v[60:63]
    ds_read_b128 a[208:211], v11 offset:20480
    ds_read_b128 a[212:215], v11 offset:21504
    ds_read_b128 a[216:219], v11 offset:22528
    ds_read_b128 a[220:223], v11 offset:23552
    s_waitcnt lgkmcnt(12)
    v_mfma_f32_16x16x32_bf16 v[32:35], a[224:227], v[168:171], v[32:35]
    v_mfma_f32_16x16x32_bf16 v[36:39], a[224:227], v[232:235], v[36:39]
    s_add_u32 s63, s95, 147456
    buffer_load_dwordx4 a[144:147], v2, s[84:87], s63 offen offset:0
    v_mfma_f32_16x16x32_bf16 v[40:43], a[228:231], v[168:171], v[40:43]
    v_mfma_f32_16x16x32_bf16 v[44:47], a[228:231], v[232:235], v[44:47]
    v_mfma_f32_16x16x32_bf16 v[48:51], a[232:235], v[168:171], v[48:51]
    v_mfma_f32_16x16x32_bf16 v[52:55], a[232:235], v[232:235], v[52:55]
    buffer_load_dwordx4 a[148:151], v2, s[84:87], s63 offen offset:1024
    v_mfma_f32_16x16x32_bf16 v[56:59], a[236:239], v[168:171], v[56:59]
    v_mfma_f32_16x16x32_bf16 v[60:63], a[236:239], v[232:235], v[60:63]
    ds_read_b128 a[224:227], v11 offset:24576
    ds_read_b128 a[228:231], v11 offset:25600
    ds_read_b128 a[232:235], v11 offset:26624
    ds_read_b128 a[236:239], v11 offset:27648
    s_waitcnt lgkmcnt(12)
    v_mfma_f32_16x16x32_bf16 v[32:35], a[240:243], v[172:175], v[32:35]
    v_mfma_f32_16x16x32_bf16 v[36:39], a[240:243], v[236:239], v[36:39]
    v_mfma_f32_16x16x32_bf16 v[40:43], a[244:247], v[172:175], v[40:43]
    v_mfma_f32_16x16x32_bf16 v[44:47], a[244:247], v[236:239], v[44:47]
    v_mfma_f32_16x16x32_bf16 v[48:51], a[248:251], v[172:175], v[48:51]
    v_mfma_f32_16x16x32_bf16 v[52:55], a[248:251], v[236:239], v[52:55]
    buffer_load_dwordx4 a[152:155], v2, s[84:87], s63 offen offset:2048
    v_mfma_f32_16x16x32_bf16 v[56:59], a[252:255], v[172:175], v[56:59]
    v_mfma_f32_16x16x32_bf16 v[60:63], a[252:255], v[236:239], v[60:63]
    ds_read_b128 a[240:243], v11 offset:28672
    ds_read_b128 a[244:247], v11 offset:29696
    ds_read_b128 a[248:251], v11 offset:30720
    ds_read_b128 a[252:255], v11 offset:31744
    s_waitcnt lgkmcnt(12)
    v_mfma_f32_16x16x32_bf16 v[32:35], a[192:195], v[176:179], v[32:35]
    v_mfma_f32_16x16x32_bf16 v[36:39], a[192:195], v[240:243], v[36:39]
    buffer_load_dwordx4 a[156:159], v2, s[84:87], s63 offen offset:3072
    v_mfma_f32_16x16x32_bf16 v[40:43], a[196:199], v[176:179], v[40:43]
    v_mfma_f32_16x16x32_bf16 v[44:47], a[196:199], v[240:243], v[44:47]
    v_mfma_f32_16x16x32_bf16 v[48:51], a[200:203], v[176:179], v[48:51]
    v_mfma_f32_16x16x32_bf16 v[52:55], a[200:203], v[240:243], v[52:55]
    v_mfma_f32_16x16x32_bf16 v[56:59], a[204:207], v[176:179], v[56:59]
    v_mfma_f32_16x16x32_bf16 v[60:63], a[204:207], v[240:243], v[60:63]
    s_waitcnt lgkmcnt(8)
    v_mfma_f32_16x16x32_bf16 v[32:35], a[208:211], v[180:183], v[32:35]
    v_mfma_f32_16x16x32_bf16 v[36:39], a[208:211], v[244:247], v[36:39]
    s_add_u32 s63, s95, 163840
    s_cmp_eq_u32 s50, 3
    s_cselect_b32 s63, 0x7f000000, s63
    buffer_load_dwordx4 a[160:163], v2, s[84:87], s63 offen offset:0
    v_mfma_f32_16x16x32_bf16 v[40:43], a[212:215], v[180:183], v[40:43]
    v_mfma_f32_16x16x32_bf16 v[44:47], a[212:215], v[244:247], v[44:47]
    v_mfma_f32_16x16x32_bf16 v[48:51], a[216:219], v[180:183], v[48:51]
    v_mfma_f32_16x16x32_bf16 v[52:55], a[216:219], v[244:247], v[52:55]
    buffer_load_dwordx4 a[164:167], v2, s[84:87], s63 offen offset:1024
    v_mfma_f32_16x16x32_bf16 v[56:59], a[220:223], v[180:183], v[56:59]
    v_mfma_f32_16x16x32_bf16 v[60:63], a[220:223], v[244:247], v[60:63]
    s_waitcnt lgkmcnt(4)
    v_mfma_f32_16x16x32_bf16 v[32:35], a[224:227], v[184:187], v[32:35]
    v_mfma_f32_16x16x32_bf16 v[36:39], a[224:227], v[248:251], v[36:39]
    v_mfma_f32_16x16x32_bf16 v[40:43], a[228:231], v[184:187], v[40:43]
    v_mfma_f32_16x16x32_bf16 v[44:47], a[228:231], v[248:251], v[44:47]
    v_mfma_f32_16x16x32_bf16 v[48:51], a[232:235], v[184:187], v[48:51]
    v_mfma_f32_16x16x32_bf16 v[52:55], a[232:235], v[248:251], v[52:55]
    buffer_load_dwordx4 a[168:171], v2, s[84:87], s63 offen offset:2048
    v_mfma_f32_16x16x32_bf16 v[56:59], a[236:239], v[184:187], v[56:59]
    v_mfma_f32_16x16x32_bf16 v[60:63], a[236:239], v[248:251], v[60:63]
    s_waitcnt lgkmcnt(0)
    v_mfma_f32_16x16x32_bf16 v[32:35], a[240:243], v[188:191], v[32:35]
    v_mfma_f32_16x16x32_bf16 v[36:39], a[240:243], v[252:255], v[36:39]
    buffer_load_dwordx4 a[172:175], v2, s[84:87], s63 offen offset:3072
    v_mfma_f32_16x16x32_bf16 v[40:43], a[244:247], v[188:191], v[40:43]
    v_mfma_f32_16x16x32_bf16 v[44:47], a[244:247], v[252:255], v[44:47]
    v_mfma_f32_16x16x32_bf16 v[48:51], a[248:251], v[188:191], v[48:51]
    v_mfma_f32_16x16x32_bf16 v[52:55], a[248:251], v[252:255], v[52:55]
    v_mfma_f32_16x16x32_bf16 v[56:59], a[252:255], v[188:191], v[56:59]
    v_mfma_f32_16x16x32_bf16 v[60:63], a[252:255], v[252:255], v[60:63]
    v_cvt_pk_bf16_f32 v32, v32, v32
    v_lshlrev_b32 v32, 16, v32
    s_nop 2
    v_cvt_pk_bf16_f32 v48, v48, v48
    v_lshlrev_b32 v48, 16, v48
    v_mul_f32 v20, 0xbfb8aa3b, v32
    v_exp_f32 v20, v20
    s_nop 0
    v_add_f32 v20, 1.0, v20
    v_rcp_f32 v20, v20
    s_nop 0
    v_mul_f32 v32, v32, v20
    v_cvt_pk_bf16_f32 v32, v32, v32
    v_lshlrev_b32 v32, 16, v32
    v_mul_f32 v32, v32, v48
    v_cvt_pk_bf16_f32 v33, v33, v33
    v_lshlrev_b32 v33, 16, v33
    v_cvt_pk_bf16_f32 v49, v49, v49
    v_lshlrev_b32 v49, 16, v49
    v_mul_f32 v21, 0xbfb8aa3b, v33
    v_exp_f32 v21, v21
    s_nop 0
    v_add_f32 v21, 1.0, v21
    v_rcp_f32 v21, v21
    s_nop 0
    v_mul_f32 v33, v33, v21
    v_cvt_pk_bf16_f32 v33, v33, v33
    v_lshlrev_b32 v33, 16, v33
    v_mul_f32 v33, v33, v49
    v_cvt_pk_bf16_f32 v34, v34, v34
    v_lshlrev_b32 v34, 16, v34
    v_cvt_pk_bf16_f32 v50, v50, v50
    v_lshlrev_b32 v50, 16, v50
    v_mul_f32 v22, 0xbfb8aa3b, v34
    v_exp_f32 v22, v22
    s_nop 0
    v_add_f32 v22, 1.0, v22
    v_rcp_f32 v22, v22
    s_nop 0
    v_mul_f32 v34, v34, v22
    v_cvt_pk_bf16_f32 v34, v34, v34
    v_lshlrev_b32 v34, 16, v34
    v_mul_f32 v34, v34, v50
    v_cvt_pk_bf16_f32 v35, v35, v35
    v_lshlrev_b32 v35, 16, v35
    v_cvt_pk_bf16_f32 v51, v51, v51
    v_lshlrev_b32 v51, 16, v51
    v_mul_f32 v23, 0xbfb8aa3b, v35
    v_exp_f32 v23, v23
    s_nop 0
    v_add_f32 v23, 1.0, v23
    v_rcp_f32 v23, v23
    s_nop 0
    v_mul_f32 v35, v35, v23
    v_cvt_pk_bf16_f32 v35, v35, v35
    v_lshlrev_b32 v35, 16, v35
    v_mul_f32 v35, v35, v51
    v_cvt_pk_bf16_f32 v24, v32, v33
    v_cvt_pk_bf16_f32 v25, v34, v35
    v_cvt_pk_bf16_f32 v40, v40, v40
    v_lshlrev_b32 v40, 16, v40
    v_cvt_pk_bf16_f32 v56, v56, v56
    v_lshlrev_b32 v56, 16, v56
    v_mul_f32 v20, 0xbfb8aa3b, v40
    v_exp_f32 v20, v20
    s_nop 0
    v_add_f32 v20, 1.0, v20
    v_rcp_f32 v20, v20
    s_nop 0
    v_mul_f32 v40, v40, v20
    v_cvt_pk_bf16_f32 v40, v40, v40
    v_lshlrev_b32 v40, 16, v40
    v_mul_f32 v40, v40, v56
    v_cvt_pk_bf16_f32 v41, v41, v41
    v_lshlrev_b32 v41, 16, v41
    v_cvt_pk_bf16_f32 v57, v57, v57
    v_lshlrev_b32 v57, 16, v57
    v_mul_f32 v21, 0xbfb8aa3b, v41
    v_exp_f32 v21, v21
    s_nop 0
    v_add_f32 v21, 1.0, v21
    v_rcp_f32 v21, v21
    s_nop 0
    v_mul_f32 v41, v41, v21
    v_cvt_pk_bf16_f32 v41, v41, v41
    v_lshlrev_b32 v41, 16, v41
    v_mul_f32 v41, v41, v57
    v_cvt_pk_bf16_f32 v42, v42, v42
    v_lshlrev_b32 v42, 16, v42
    v_cvt_pk_bf16_f32 v58, v58, v58
    v_lshlrev_b32 v58, 16, v58
    v_mul_f32 v22, 0xbfb8aa3b, v42
    v_exp_f32 v22, v22
    s_nop 0
    v_add_f32 v22, 1.0, v22
    v_rcp_f32 v22, v22
    s_nop 0
    v_mul_f32 v42, v42, v22
    v_cvt_pk_bf16_f32 v42, v42, v42
    v_lshlrev_b32 v42, 16, v42
    v_mul_f32 v42, v42, v58
    v_cvt_pk_bf16_f32 v43, v43, v43
    v_lshlrev_b32 v43, 16, v43
    v_cvt_pk_bf16_f32 v59, v59, v59
    v_lshlrev_b32 v59, 16, v59
    v_mul_f32 v23, 0xbfb8aa3b, v43
    v_exp_f32 v23, v23
    s_nop 0
    v_add_f32 v23, 1.0, v23
    v_rcp_f32 v23, v23
    s_nop 0
    v_mul_f32 v43, v43, v23
    v_cvt_pk_bf16_f32 v43, v43, v43
    v_lshlrev_b32 v43, 16, v43
    v_mul_f32 v43, v43, v59
    v_cvt_pk_bf16_f32 v26, v40, v41
    v_cvt_pk_bf16_f32 v27, v42, v43
    v_cvt_pk_bf16_f32 v36, v36, v36
    v_lshlrev_b32 v36, 16, v36
    v_cvt_pk_bf16_f32 v52, v52, v52
    v_lshlrev_b32 v52, 16, v52
    v_mul_f32 v20, 0xbfb8aa3b, v36
    v_exp_f32 v20, v20
    s_nop 0
    v_add_f32 v20, 1.0, v20
    v_rcp_f32 v20, v20
    s_nop 0
    v_mul_f32 v36, v36, v20
    v_cvt_pk_bf16_f32 v36, v36, v36
    v_lshlrev_b32 v36, 16, v36
    v_mul_f32 v36, v36, v52
    v_cvt_pk_bf16_f32 v37, v37, v37
    v_lshlrev_b32 v37, 16, v37
    v_cvt_pk_bf16_f32 v53, v53, v53
    v_lshlrev_b32 v53, 16, v53
    v_mul_f32 v21, 0xbfb8aa3b, v37
    v_exp_f32 v21, v21
    s_nop 0
    v_add_f32 v21, 1.0, v21
    v_rcp_f32 v21, v21
    s_nop 0
    v_mul_f32 v37, v37, v21
    v_cvt_pk_bf16_f32 v37, v37, v37
    v_lshlrev_b32 v37, 16, v37
    v_mul_f32 v37, v37, v53
    v_cvt_pk_bf16_f32 v38, v38, v38
    v_lshlrev_b32 v38, 16, v38
    v_cvt_pk_bf16_f32 v54, v54, v54
    v_lshlrev_b32 v54, 16, v54
    v_mul_f32 v22, 0xbfb8aa3b, v38
    v_exp_f32 v22, v22
    s_nop 0
    v_add_f32 v22, 1.0, v22
    v_rcp_f32 v22, v22
    s_nop 0
    v_mul_f32 v38, v38, v22
    v_cvt_pk_bf16_f32 v38, v38, v38
    v_lshlrev_b32 v38, 16, v38
    v_mul_f32 v38, v38, v54
    v_cvt_pk_bf16_f32 v39, v39, v39
    v_lshlrev_b32 v39, 16, v39
    v_cvt_pk_bf16_f32 v55, v55, v55
    v_lshlrev_b32 v55, 16, v55
    v_mul_f32 v23, 0xbfb8aa3b, v39
    v_exp_f32 v23, v23
    s_nop 0
    v_add_f32 v23, 1.0, v23
    v_rcp_f32 v23, v23
    s_nop 0
    v_mul_f32 v39, v39, v23
    v_cvt_pk_bf16_f32 v39, v39, v39
    v_lshlrev_b32 v39, 16, v39
    v_mul_f32 v39, v39, v55
    v_cvt_pk_bf16_f32 v28, v36, v37
    v_cvt_pk_bf16_f32 v29, v38, v39
    v_cvt_pk_bf16_f32 v44, v44, v44
    v_lshlrev_b32 v44, 16, v44
    v_cvt_pk_bf16_f32 v60, v60, v60
    v_lshlrev_b32 v60, 16, v60
    v_mul_f32 v20, 0xbfb8aa3b, v44
    v_exp_f32 v20, v20
    s_nop 0
    v_add_f32 v20, 1.0, v20
    v_rcp_f32 v20, v20
    s_nop 0
    v_mul_f32 v44, v44, v20
    v_cvt_pk_bf16_f32 v44, v44, v44
    v_lshlrev_b32 v44, 16, v44
    v_mul_f32 v44, v44, v60
    v_cvt_pk_bf16_f32 v45, v45, v45
    v_lshlrev_b32 v45, 16, v45
    v_cvt_pk_bf16_f32 v61, v61, v61
    v_lshlrev_b32 v61, 16, v61
    v_mul_f32 v21, 0xbfb8aa3b, v45
    v_exp_f32 v21, v21
    s_nop 0
    v_add_f32 v21, 1.0, v21
    v_rcp_f32 v21, v21
    s_nop 0
    v_mul_f32 v45, v45, v21
    v_cvt_pk_bf16_f32 v45, v45, v45
    v_lshlrev_b32 v45, 16, v45
    v_mul_f32 v45, v45, v61
    v_cvt_pk_bf16_f32 v46, v46, v46
    v_lshlrev_b32 v46, 16, v46
    v_cvt_pk_bf16_f32 v62, v62, v62
    v_lshlrev_b32 v62, 16, v62
    v_mul_f32 v22, 0xbfb8aa3b, v46
    v_exp_f32 v22, v22
    s_nop 0
    v_add_f32 v22, 1.0, v22
    v_rcp_f32 v22, v22
    s_nop 0
    v_mul_f32 v46, v46, v22
    v_cvt_pk_bf16_f32 v46, v46, v46
    v_lshlrev_b32 v46, 16, v46
    v_mul_f32 v46, v46, v62
    v_cvt_pk_bf16_f32 v47, v47, v47
    v_lshlrev_b32 v47, 16, v47
    v_cvt_pk_bf16_f32 v63, v63, v63
    v_lshlrev_b32 v63, 16, v63
    v_mul_f32 v23, 0xbfb8aa3b, v47
    v_exp_f32 v23, v23
    s_nop 0
    v_add_f32 v23, 1.0, v23
    v_rcp_f32 v23, v23
    s_nop 0
    v_mul_f32 v47, v47, v23
    v_cvt_pk_bf16_f32 v47, v47, v47
    v_lshlrev_b32 v47, 16, v47
    v_mul_f32 v47, v47, v63
    v_cvt_pk_bf16_f32 v30, v44, v45
    v_cvt_pk_bf16_f32 v31, v46, v47
    s_add_u32 s60, s48, 0
    s_mul_i32 s60, s60, 43
    s_add_u32 s60, s60, s42
    s_add_u32 s60, s60, 1
    s_lshl_b32 s60, s60, 10
    buffer_store_dwordx4 v[24:27], v2, s[56:59], s60 offen sc0 sc1
    s_add_u32 s60, s48, 1
    s_mul_i32 s60, s60, 43
    s_add_u32 s60, s60, s42
    s_add_u32 s60, s60, 1
    s_lshl_b32 s60, s60, 10
    buffer_store_dwordx4 v[28:31], v2, s[56:59], s60 offen sc0 sc1
    s_branch ffn1_kernel_g2
ffn1_kernel_g2:
    s_add_u32 s44, s30, 0xe50000
    s_addc_u32 s45, s31, 0
    s_mov_b32 s46, 0x560000
    s_mov_b32 s47, 0x20000
    s_add_u32 s56, s30, 0x650000
    s_addc_u32 s57, s31, 0
    s_mov_b32 s58, 0x200000
    s_mov_b32 s59, 0x20000
    s_add_u32 s60, s30, 0x850000
    s_addc_u32 s61, s31, 0
    s_mov_b32 s62, 0x200000
    s_mov_b32 s63, 0x20000
    s_add_u32 s64, s30, 0x250000
    s_addc_u32 s65, s31, 0
    s_mov_b32 s66, 0x200000
    s_mov_b32 s67, 0x20000
    s_add_u32 s68, s30, 0x245000
    s_addc_u32 s69, s31, 0
    s_mov_b32 s70, 0x4000
    s_mov_b32 s71, 0x20000
    v_and_b32 v3, 15, v1
    v_lshrrev_b32 v4, 4, v1
    v_lshl_add_u32 v6, v5, 4, v3
    v_lshlrev_b32 v6, 10, v6
    v_lshl_add_u32 v6, v4, 5, v6
    s_lshl_b32 s48, s92, 16
    s_lshl_b32 s49, s93, 7
    s_add_u32 s48, s48, s49
    s_waitcnt vmcnt(0)
    s_barrier
    s_add_u32 s51, s40, 64
    s_lshl_b32 s51, s51, 8
    v_mov_b32 v7, 0
    v_mov_b32 v8, 1
    s_cmp_lg_u32 s50, 0
    s_cbranch_scc1 ffn1_kernel_polled
    v_cmp_eq_u32 vcc, 0, v1
    s_nop 1
    s_and_saveexec_b64 s[72:73], vcc
    buffer_atomic_add v8, v7, s[88:91], s51 offen
    s_mov_b64 exec, s[72:73]
    s_mov_b32 s74, 0
ffn1_kernel_poll:
    buffer_load_dword v9, v7, s[88:91], s51 offen sc0 sc1
    s_waitcnt vmcnt(0)
    v_readfirstlane_b32 s75, v9
    s_add_u32 s74, s74, 1
    s_nop 0
    s_cmp_ge_u32 s75, 16
    s_cbranch_scc1 ffn1_kernel_polled
    s_cmp_lt_u32 s74, 0x400000
    s_cbranch_scc0 ffn1_kernel_polled
    s_sleep 1
    s_branch ffn1_kernel_poll
ffn1_kernel_polled:
    s_barrier
    buffer_load_dwordx4 v[16:19], v6, s[56:59], s48 offen sc0 sc1
    buffer_load_dwordx4 v[20:23], v6, s[56:59], s48 offen offset:16 sc0 sc1
    v_mov_b32 v64, 0
    v_mov_b32 v65, 0
    v_mov_b32 v66, 0
    v_mov_b32 v67, 0
    v_mov_b32 v68, 0
    v_mov_b32 v69, 0
    v_mov_b32 v70, 0
    v_mov_b32 v71, 0
    v_mov_b32 v72, 0
    v_mov_b32 v73, 0
    v_mov_b32 v74, 0
    v_mov_b32 v75, 0
    v_mov_b32 v76, 0
    v_mov_b32 v77, 0
    v_mov_b32 v78, 0
    v_mov_b32 v79, 0
    v_mov_b32 v80, 0
    v_mov_b32 v81, 0
    v_mov_b32 v82, 0
    v_mov_b32 v83, 0
    v_mov_b32 v84, 0
    v_mov_b32 v85, 0
    v_mov_b32 v86, 0
    v_mov_b32 v87, 0
    v_mov_b32 v88, 0
    v_mov_b32 v89, 0
    v_mov_b32 v90, 0
    v_mov_b32 v91, 0
    v_mov_b32 v92, 0
    v_mov_b32 v93, 0
    v_mov_b32 v94, 0
    v_mov_b32 v95, 0
    v_mov_b32 v96, 0
    v_mov_b32 v97, 0
    v_mov_b32 v98, 0
    v_mov_b32 v99, 0
    v_mov_b32 v100, 0
    v_mov_b32 v101, 0
    v_mov_b32 v102, 0
    v_mov_b32 v103, 0
    v_mov_b32 v104, 0
    v_mov_b32 v105, 0
    v_mov_b32 v106, 0
    v_mov_b32 v107, 0
    v_mov_b32 v108, 0
    v_mov_b32 v109, 0
    v_mov_b32 v110, 0
    v_mov_b32 v111, 0
    v_mov_b32 v112, 0
    v_mov_b32 v113, 0
    v_mov_b32 v114, 0
    v_mov_b32 v115, 0
    v_mov_b32 v116, 0
    v_mov_b32 v117, 0
    v_mov_b32 v118, 0
    v_mov_b32 v119, 0
    v_mov_b32 v120, 0
    v_mov_b32 v121, 0
    v_mov_b32 v122, 0
    v_mov_b32 v123, 0
    v_mov_b32 v124, 0
    v_mov_b32 v125, 0
    v_mov_b32 v126, 0
    v_mov_b32 v127, 0
    s_add_u32 s51, s94, 0
    buffer_load_dwordx4 v[128:131], v2, s[44:47], s51 offen sc0 sc1
    s_add_u32 s51, s94, 44032
    buffer_load_dwordx4 v[132:135], v2, s[44:47], s51 offen sc0 sc1
    s_add_u32 s51, s94, 88064
    buffer_load_dwordx4 v[136:139], v2, s[44:47], s51 offen sc0 sc1
    s_add_u32 s51, s94, 132096
    buffer_load_dwordx4 v[140:143], v2, s[44:47], s51 offen sc0 sc1
    s_add_u32 s51, s94, 4096
    buffer_load_dwordx4 v[144:147], v2, s[44:47], s51 offen sc0 sc1
    s_add_u32 s51, s94, 48128
    buffer_load_dwordx4 v[148:151], v2, s[44:47], s51 offen sc0 sc1
    s_add_u32 s51, s94, 92160
    buffer_load_dwordx4 v[152:155], v2, s[44:47], s51 offen sc0 sc1
    s_add_u32 s51, s94, 136192
    buffer_load_dwordx4 v[156:159], v2, s[44:47], s51 offen sc0 sc1
    s_add_u32 s51, s94, 8192
    buffer_load_dwordx4 v[160:163], v2, s[44:47], s51 offen sc0 sc1
    s_add_u32 s51, s94, 52224
    buffer_load_dwordx4 v[164:167], v2, s[44:47], s51 offen sc0 sc1
    s_add_u32 s51, s94, 96256
    buffer_load_dwordx4 v[168:171], v2, s[44:47], s51 offen sc0 sc1
    s_add_u32 s51, s94, 140288
    buffer_load_dwordx4 v[172:175], v2, s[44:47], s51 offen sc0 sc1
    s_add_u32 s51, s94, 12288
    buffer_load_dwordx4 v[176:179], v2, s[44:47], s51 offen sc0 sc1
    s_add_u32 s51, s94, 56320
    buffer_load_dwordx4 v[180:183], v2, s[44:47], s51 offen sc0 sc1
    s_add_u32 s51, s94, 100352
    buffer_load_dwordx4 v[184:187], v2, s[44:47], s51 offen sc0 sc1
    s_add_u32 s51, s94, 144384
    buffer_load_dwordx4 v[188:191], v2, s[44:47], s51 offen sc0 sc1
    s_add_u32 s51, s94, 16384
    buffer_load_dwordx4 v[192:195], v2, s[44:47], s51 offen sc0 sc1
    s_add_u32 s51, s94, 60416
    buffer_load_dwordx4 v[196:199], v2, s[44:47], s51 offen sc0 sc1
    s_add_u32 s51, s94, 104448
    buffer_load_dwordx4 v[200:203], v2, s[44:47], s51 offen sc0 sc1
    s_add_u32 s51, s94, 148480
    buffer_load_dwordx4 v[204:207], v2, s[44:47], s51 offen sc0 sc1
    s_add_u32 s51, s94, 20480
    buffer_load_dwordx4 v[208:211], v2, s[44:47], s51 offen sc0 sc1
    s_add_u32 s51, s94, 64512
    buffer_load_dwordx4 v[212:215], v2, s[44:47], s51 offen sc0 sc1
    s_add_u32 s51, s94, 108544
    buffer_load_dwordx4 v[216:219], v2, s[44:47], s51 offen sc0 sc1
    s_add_u32 s51, s94, 152576
    buffer_load_dwordx4 v[220:223], v2, s[44:47], s51 offen sc0 sc1
    s_add_u32 s51, s94, 24576
    buffer_load_dwordx4 v[224:227], v2, s[44:47], s51 offen sc0 sc1
    s_add_u32 s51, s94, 68608
    buffer_load_dwordx4 v[228:231], v2, s[44:47], s51 offen sc0 sc1
    s_add_u32 s51, s94, 112640
    buffer_load_dwordx4 v[232:235], v2, s[44:47], s51 offen sc0 sc1
    s_add_u32 s51, s94, 156672
    buffer_load_dwordx4 v[236:239], v2, s[44:47], s51 offen sc0 sc1
    s_add_u32 s51, s94, 28672
    buffer_load_dwordx4 v[240:243], v2, s[44:47], s51 offen sc0 sc1
    s_add_u32 s51, s94, 72704
    buffer_load_dwordx4 v[244:247], v2, s[44:47], s51 offen sc0 sc1
    s_add_u32 s51, s94, 116736
    buffer_load_dwordx4 v[248:251], v2, s[44:47], s51 offen sc0 sc1
    s_add_u32 s51, s94, 160768
    buffer_load_dwordx4 v[252:255], v2, s[44:47], s51 offen sc0 sc1
    s_waitcnt vmcnt(28)
    v_mfma_f32_16x16x32_bf16 v[64:67], a[0:3], v[128:131], v[64:67]
    v_mfma_f32_16x16x32_bf16 v[68:71], a[4:7], v[128:131], v[68:71]
    v_mfma_f32_16x16x32_bf16 v[72:75], a[8:11], v[128:131], v[72:75]
    v_mfma_f32_16x16x32_bf16 v[76:79], a[12:15], v[128:131], v[76:79]
    v_mfma_f32_16x16x32_bf16 v[80:83], a[0:3], v[132:135], v[80:83]
    v_mfma_f32_16x16x32_bf16 v[84:87], a[4:7], v[132:135], v[84:87]
    v_mfma_f32_16x16x32_bf16 v[88:91], a[8:11], v[132:135], v[88:91]
    v_mfma_f32_16x16x32_bf16 v[92:95], a[12:15], v[132:135], v[92:95]
    v_mfma_f32_16x16x32_bf16 v[96:99], a[0:3], v[136:139], v[96:99]
    v_mfma_f32_16x16x32_bf16 v[100:103], a[4:7], v[136:139], v[100:103]
    v_mfma_f32_16x16x32_bf16 v[104:107], a[8:11], v[136:139], v[104:107]
    v_mfma_f32_16x16x32_bf16 v[108:111], a[12:15], v[136:139], v[108:111]
    v_mfma_f32_16x16x32_bf16 v[112:115], a[0:3], v[140:143], v[112:115]
    v_mfma_f32_16x16x32_bf16 v[116:119], a[4:7], v[140:143], v[116:119]
    v_mfma_f32_16x16x32_bf16 v[120:123], a[8:11], v[140:143], v[120:123]
    v_mfma_f32_16x16x32_bf16 v[124:127], a[12:15], v[140:143], v[124:127]
    s_add_u32 s51, s94, 32768
    buffer_load_dwordx4 v[128:131], v2, s[44:47], s51 offen sc0 sc1
    s_add_u32 s51, s94, 76800
    buffer_load_dwordx4 v[132:135], v2, s[44:47], s51 offen sc0 sc1
    s_add_u32 s51, s94, 120832
    buffer_load_dwordx4 v[136:139], v2, s[44:47], s51 offen sc0 sc1
    s_add_u32 s51, s94, 164864
    buffer_load_dwordx4 v[140:143], v2, s[44:47], s51 offen sc0 sc1
    s_waitcnt vmcnt(28)
    v_mfma_f32_16x16x32_bf16 v[64:67], a[16:19], v[144:147], v[64:67]
    v_mfma_f32_16x16x32_bf16 v[68:71], a[20:23], v[144:147], v[68:71]
    v_mfma_f32_16x16x32_bf16 v[72:75], a[24:27], v[144:147], v[72:75]
    v_mfma_f32_16x16x32_bf16 v[76:79], a[28:31], v[144:147], v[76:79]
    v_mfma_f32_16x16x32_bf16 v[80:83], a[16:19], v[148:151], v[80:83]
    v_mfma_f32_16x16x32_bf16 v[84:87], a[20:23], v[148:151], v[84:87]
    v_mfma_f32_16x16x32_bf16 v[88:91], a[24:27], v[148:151], v[88:91]
    v_mfma_f32_16x16x32_bf16 v[92:95], a[28:31], v[148:151], v[92:95]
    v_mfma_f32_16x16x32_bf16 v[96:99], a[16:19], v[152:155], v[96:99]
    v_mfma_f32_16x16x32_bf16 v[100:103], a[20:23], v[152:155], v[100:103]
    v_mfma_f32_16x16x32_bf16 v[104:107], a[24:27], v[152:155], v[104:107]
    v_mfma_f32_16x16x32_bf16 v[108:111], a[28:31], v[152:155], v[108:111]
    v_mfma_f32_16x16x32_bf16 v[112:115], a[16:19], v[156:159], v[112:115]
    v_mfma_f32_16x16x32_bf16 v[116:119], a[20:23], v[156:159], v[116:119]
    v_mfma_f32_16x16x32_bf16 v[120:123], a[24:27], v[156:159], v[120:123]
    v_mfma_f32_16x16x32_bf16 v[124:127], a[28:31], v[156:159], v[124:127]
    s_add_u32 s51, s94, 36864
    buffer_load_dwordx4 v[144:147], v2, s[44:47], s51 offen sc0 sc1
    s_add_u32 s51, s94, 80896
    buffer_load_dwordx4 v[148:151], v2, s[44:47], s51 offen sc0 sc1
    s_add_u32 s51, s94, 124928
    buffer_load_dwordx4 v[152:155], v2, s[44:47], s51 offen sc0 sc1
    s_add_u32 s51, s94, 168960
    buffer_load_dwordx4 v[156:159], v2, s[44:47], s51 offen sc0 sc1
    s_waitcnt vmcnt(28)
    v_mfma_f32_16x16x32_bf16 v[64:67], a[32:35], v[160:163], v[64:67]
    v_mfma_f32_16x16x32_bf16 v[68:71], a[36:39], v[160:163], v[68:71]
    v_mfma_f32_16x16x32_bf16 v[72:75], a[40:43], v[160:163], v[72:75]
    v_mfma_f32_16x16x32_bf16 v[76:79], a[44:47], v[160:163], v[76:79]
    v_mfma_f32_16x16x32_bf16 v[80:83], a[32:35], v[164:167], v[80:83]
    v_mfma_f32_16x16x32_bf16 v[84:87], a[36:39], v[164:167], v[84:87]
    v_mfma_f32_16x16x32_bf16 v[88:91], a[40:43], v[164:167], v[88:91]
    v_mfma_f32_16x16x32_bf16 v[92:95], a[44:47], v[164:167], v[92:95]
    v_mfma_f32_16x16x32_bf16 v[96:99], a[32:35], v[168:171], v[96:99]
    v_mfma_f32_16x16x32_bf16 v[100:103], a[36:39], v[168:171], v[100:103]
    v_mfma_f32_16x16x32_bf16 v[104:107], a[40:43], v[168:171], v[104:107]
    v_mfma_f32_16x16x32_bf16 v[108:111], a[44:47], v[168:171], v[108:111]
    v_mfma_f32_16x16x32_bf16 v[112:115], a[32:35], v[172:175], v[112:115]
    v_mfma_f32_16x16x32_bf16 v[116:119], a[36:39], v[172:175], v[116:119]
    v_mfma_f32_16x16x32_bf16 v[120:123], a[40:43], v[172:175], v[120:123]
    v_mfma_f32_16x16x32_bf16 v[124:127], a[44:47], v[172:175], v[124:127]
    s_add_u32 s51, s94, 40960
    buffer_load_dwordx4 v[160:163], v2, s[44:47], s51 offen sc0 sc1
    s_add_u32 s51, s94, 84992
    buffer_load_dwordx4 v[164:167], v2, s[44:47], s51 offen sc0 sc1
    s_add_u32 s51, s94, 129024
    buffer_load_dwordx4 v[168:171], v2, s[44:47], s51 offen sc0 sc1
    s_add_u32 s51, s94, 173056
    buffer_load_dwordx4 v[172:175], v2, s[44:47], s51 offen sc0 sc1
    s_waitcnt vmcnt(28)
    v_mfma_f32_16x16x32_bf16 v[64:67], a[48:51], v[176:179], v[64:67]
    v_mfma_f32_16x16x32_bf16 v[68:71], a[52:55], v[176:179], v[68:71]
    v_mfma_f32_16x16x32_bf16 v[72:75], a[56:59], v[176:179], v[72:75]
    v_mfma_f32_16x16x32_bf16 v[76:79], a[60:63], v[176:179], v[76:79]
    v_mfma_f32_16x16x32_bf16 v[80:83], a[48:51], v[180:183], v[80:83]
    v_mfma_f32_16x16x32_bf16 v[84:87], a[52:55], v[180:183], v[84:87]
    v_mfma_f32_16x16x32_bf16 v[88:91], a[56:59], v[180:183], v[88:91]
    v_mfma_f32_16x16x32_bf16 v[92:95], a[60:63], v[180:183], v[92:95]
    v_mfma_f32_16x16x32_bf16 v[96:99], a[48:51], v[184:187], v[96:99]
    v_mfma_f32_16x16x32_bf16 v[100:103], a[52:55], v[184:187], v[100:103]
    v_mfma_f32_16x16x32_bf16 v[104:107], a[56:59], v[184:187], v[104:107]
    v_mfma_f32_16x16x32_bf16 v[108:111], a[60:63], v[184:187], v[108:111]
    v_mfma_f32_16x16x32_bf16 v[112:115], a[48:51], v[188:191], v[112:115]
    v_mfma_f32_16x16x32_bf16 v[116:119], a[52:55], v[188:191], v[116:119]
    v_mfma_f32_16x16x32_bf16 v[120:123], a[56:59], v[188:191], v[120:123]
    v_mfma_f32_16x16x32_bf16 v[124:127], a[60:63], v[188:191], v[124:127]
    s_waitcnt vmcnt(24)
    v_mfma_f32_16x16x32_bf16 v[64:67], a[64:67], v[192:195], v[64:67]
    v_mfma_f32_16x16x32_bf16 v[68:71], a[68:71], v[192:195], v[68:71]
    v_mfma_f32_16x16x32_bf16 v[72:75], a[72:75], v[192:195], v[72:75]
    v_mfma_f32_16x16x32_bf16 v[76:79], a[76:79], v[192:195], v[76:79]
    v_mfma_f32_16x16x32_bf16 v[80:83], a[64:67], v[196:199], v[80:83]
    v_mfma_f32_16x16x32_bf16 v[84:87], a[68:71], v[196:199], v[84:87]
    v_mfma_f32_16x16x32_bf16 v[88:91], a[72:75], v[196:199], v[88:91]
    v_mfma_f32_16x16x32_bf16 v[92:95], a[76:79], v[196:199], v[92:95]
    v_mfma_f32_16x16x32_bf16 v[96:99], a[64:67], v[200:203], v[96:99]
    v_mfma_f32_16x16x32_bf16 v[100:103], a[68:71], v[200:203], v[100:103]
    v_mfma_f32_16x16x32_bf16 v[104:107], a[72:75], v[200:203], v[104:107]
    v_mfma_f32_16x16x32_bf16 v[108:111], a[76:79], v[200:203], v[108:111]
    v_mfma_f32_16x16x32_bf16 v[112:115], a[64:67], v[204:207], v[112:115]
    v_mfma_f32_16x16x32_bf16 v[116:119], a[68:71], v[204:207], v[116:119]
    v_mfma_f32_16x16x32_bf16 v[120:123], a[72:75], v[204:207], v[120:123]
    v_mfma_f32_16x16x32_bf16 v[124:127], a[76:79], v[204:207], v[124:127]
    s_waitcnt vmcnt(20)
    v_mfma_f32_16x16x32_bf16 v[64:67], a[80:83], v[208:211], v[64:67]
    v_mfma_f32_16x16x32_bf16 v[68:71], a[84:87], v[208:211], v[68:71]
    v_mfma_f32_16x16x32_bf16 v[72:75], a[88:91], v[208:211], v[72:75]
    v_mfma_f32_16x16x32_bf16 v[76:79], a[92:95], v[208:211], v[76:79]
    v_mfma_f32_16x16x32_bf16 v[80:83], a[80:83], v[212:215], v[80:83]
    v_mfma_f32_16x16x32_bf16 v[84:87], a[84:87], v[212:215], v[84:87]
    v_mfma_f32_16x16x32_bf16 v[88:91], a[88:91], v[212:215], v[88:91]
    v_mfma_f32_16x16x32_bf16 v[92:95], a[92:95], v[212:215], v[92:95]
    v_mfma_f32_16x16x32_bf16 v[96:99], a[80:83], v[216:219], v[96:99]
    v_mfma_f32_16x16x32_bf16 v[100:103], a[84:87], v[216:219], v[100:103]
    v_mfma_f32_16x16x32_bf16 v[104:107], a[88:91], v[216:219], v[104:107]
    v_mfma_f32_16x16x32_bf16 v[108:111], a[92:95], v[216:219], v[108:111]
    v_mfma_f32_16x16x32_bf16 v[112:115], a[80:83], v[220:223], v[112:115]
    v_mfma_f32_16x16x32_bf16 v[116:119], a[84:87], v[220:223], v[116:119]
    v_mfma_f32_16x16x32_bf16 v[120:123], a[88:91], v[220:223], v[120:123]
    v_mfma_f32_16x16x32_bf16 v[124:127], a[92:95], v[220:223], v[124:127]
    s_waitcnt vmcnt(16)
    v_mfma_f32_16x16x32_bf16 v[64:67], a[96:99], v[224:227], v[64:67]
    v_mfma_f32_16x16x32_bf16 v[68:71], a[100:103], v[224:227], v[68:71]
    v_mfma_f32_16x16x32_bf16 v[72:75], a[104:107], v[224:227], v[72:75]
    v_mfma_f32_16x16x32_bf16 v[76:79], a[108:111], v[224:227], v[76:79]
    v_mfma_f32_16x16x32_bf16 v[80:83], a[96:99], v[228:231], v[80:83]
    v_mfma_f32_16x16x32_bf16 v[84:87], a[100:103], v[228:231], v[84:87]
    v_mfma_f32_16x16x32_bf16 v[88:91], a[104:107], v[228:231], v[88:91]
    v_mfma_f32_16x16x32_bf16 v[92:95], a[108:111], v[228:231], v[92:95]
    v_mfma_f32_16x16x32_bf16 v[96:99], a[96:99], v[232:235], v[96:99]
    v_mfma_f32_16x16x32_bf16 v[100:103], a[100:103], v[232:235], v[100:103]
    v_mfma_f32_16x16x32_bf16 v[104:107], a[104:107], v[232:235], v[104:107]
    v_mfma_f32_16x16x32_bf16 v[108:111], a[108:111], v[232:235], v[108:111]
    v_mfma_f32_16x16x32_bf16 v[112:115], a[96:99], v[236:239], v[112:115]
    v_mfma_f32_16x16x32_bf16 v[116:119], a[100:103], v[236:239], v[116:119]
    v_mfma_f32_16x16x32_bf16 v[120:123], a[104:107], v[236:239], v[120:123]
    v_mfma_f32_16x16x32_bf16 v[124:127], a[108:111], v[236:239], v[124:127]
    s_waitcnt vmcnt(12)
    v_mfma_f32_16x16x32_bf16 v[64:67], a[112:115], v[240:243], v[64:67]
    v_mfma_f32_16x16x32_bf16 v[68:71], a[116:119], v[240:243], v[68:71]
    v_mfma_f32_16x16x32_bf16 v[72:75], a[120:123], v[240:243], v[72:75]
    v_mfma_f32_16x16x32_bf16 v[76:79], a[124:127], v[240:243], v[76:79]
    v_mfma_f32_16x16x32_bf16 v[80:83], a[112:115], v[244:247], v[80:83]
    v_mfma_f32_16x16x32_bf16 v[84:87], a[116:119], v[244:247], v[84:87]
    v_mfma_f32_16x16x32_bf16 v[88:91], a[120:123], v[244:247], v[88:91]
    v_mfma_f32_16x16x32_bf16 v[92:95], a[124:127], v[244:247], v[92:95]
    v_mfma_f32_16x16x32_bf16 v[96:99], a[112:115], v[248:251], v[96:99]
    v_mfma_f32_16x16x32_bf16 v[100:103], a[116:119], v[248:251], v[100:103]
    v_mfma_f32_16x16x32_bf16 v[104:107], a[120:123], v[248:251], v[104:107]
    v_mfma_f32_16x16x32_bf16 v[108:111], a[124:127], v[248:251], v[108:111]
    v_mfma_f32_16x16x32_bf16 v[112:115], a[112:115], v[252:255], v[112:115]
    v_mfma_f32_16x16x32_bf16 v[116:119], a[116:119], v[252:255], v[116:119]
    v_mfma_f32_16x16x32_bf16 v[120:123], a[120:123], v[252:255], v[120:123]
    v_mfma_f32_16x16x32_bf16 v[124:127], a[124:127], v[252:255], v[124:127]
    s_waitcnt vmcnt(8)
    v_mfma_f32_16x16x32_bf16 v[64:67], a[128:131], v[128:131], v[64:67]
    v_mfma_f32_16x16x32_bf16 v[68:71], a[132:135], v[128:131], v[68:71]
    v_mfma_f32_16x16x32_bf16 v[72:75], a[136:139], v[128:131], v[72:75]
    v_mfma_f32_16x16x32_bf16 v[76:79], a[140:143], v[128:131], v[76:79]
    v_mfma_f32_16x16x32_bf16 v[80:83], a[128:131], v[132:135], v[80:83]
    v_mfma_f32_16x16x32_bf16 v[84:87], a[132:135], v[132:135], v[84:87]
    v_mfma_f32_16x16x32_bf16 v[88:91], a[136:139], v[132:135], v[88:91]
    v_mfma_f32_16x16x32_bf16 v[92:95], a[140:143], v[132:135], v[92:95]
    v_mfma_f32_16x16x32_bf16 v[96:99], a[128:131], v[136:139], v[96:99]
    v_mfma_f32_16x16x32_bf16 v[100:103], a[132:135], v[136:139], v[100:103]
    v_mfma_f32_16x16x32_bf16 v[104:107], a[136:139], v[136:139], v[104:107]
    v_mfma_f32_16x16x32_bf16 v[108:111], a[140:143], v[136:139], v[108:111]
    v_mfma_f32_16x16x32_bf16 v[112:115], a[128:131], v[140:143], v[112:115]
    v_mfma_f32_16x16x32_bf16 v[116:119], a[132:135], v[140:143], v[116:119]
    v_mfma_f32_16x16x32_bf16 v[120:123], a[136:139], v[140:143], v[120:123]
    v_mfma_f32_16x16x32_bf16 v[124:127], a[140:143], v[140:143], v[124:127]
    s_waitcnt vmcnt(4)
    v_mfma_f32_16x16x32_bf16 v[64:67], a[144:147], v[144:147], v[64:67]
    v_mfma_f32_16x16x32_bf16 v[68:71], a[148:151], v[144:147], v[68:71]
    v_mfma_f32_16x16x32_bf16 v[72:75], a[152:155], v[144:147], v[72:75]
    v_mfma_f32_16x16x32_bf16 v[76:79], a[156:159], v[144:147], v[76:79]
    v_mfma_f32_16x16x32_bf16 v[80:83], a[144:147], v[148:151], v[80:83]
    v_mfma_f32_16x16x32_bf16 v[84:87], a[148:151], v[148:151], v[84:87]
    v_mfma_f32_16x16x32_bf16 v[88:91], a[152:155], v[148:151], v[88:91]
    v_mfma_f32_16x16x32_bf16 v[92:95], a[156:159], v[148:151], v[92:95]
    v_mfma_f32_16x16x32_bf16 v[96:99], a[144:147], v[152:155], v[96:99]
    v_mfma_f32_16x16x32_bf16 v[100:103], a[148:151], v[152:155], v[100:103]
    v_mfma_f32_16x16x32_bf16 v[104:107], a[152:155], v[152:155], v[104:107]
    v_mfma_f32_16x16x32_bf16 v[108:111], a[156:159], v[152:155], v[108:111]
    v_mfma_f32_16x16x32_bf16 v[112:115], a[144:147], v[156:159], v[112:115]
    v_mfma_f32_16x16x32_bf16 v[116:119], a[148:151], v[156:159], v[116:119]
    v_mfma_f32_16x16x32_bf16 v[120:123], a[152:155], v[156:159], v[120:123]
    v_mfma_f32_16x16x32_bf16 v[124:127], a[156:159], v[156:159], v[124:127]
    s_waitcnt vmcnt(0)
    v_mfma_f32_16x16x32_bf16 v[64:67], a[160:163], v[160:163], v[64:67]
    v_mfma_f32_16x16x32_bf16 v[68:71], a[164:167], v[160:163], v[68:71]
    v_mfma_f32_16x16x32_bf16 v[72:75], a[168:171], v[160:163], v[72:75]
    v_mfma_f32_16x16x32_bf16 v[76:79], a[172:175], v[160:163], v[76:79]
    v_mfma_f32_16x16x32_bf16 v[80:83], a[160:163], v[164:167], v[80:83]
    v_mfma_f32_16x16x32_bf16 v[84:87], a[164:167], v[164:167], v[84:87]
    v_mfma_f32_16x16x32_bf16 v[88:91], a[168:171], v[164:167], v[88:91]
    v_mfma_f32_16x16x32_bf16 v[92:95], a[172:175], v[164:167], v[92:95]
    v_mfma_f32_16x16x32_bf16 v[96:99], a[160:163], v[168:171], v[96:99]
    v_mfma_f32_16x16x32_bf16 v[100:103], a[164:167], v[168:171], v[100:103]
    v_mfma_f32_16x16x32_bf16 v[104:107], a[168:171], v[168:171], v[104:107]
    v_mfma_f32_16x16x32_bf16 v[108:111], a[172:175], v[168:171], v[108:111]
    v_mfma_f32_16x16x32_bf16 v[112:115], a[160:163], v[172:175], v[112:115]
    v_mfma_f32_16x16x32_bf16 v[116:119], a[164:167], v[172:175], v[116:119]
    v_mfma_f32_16x16x32_bf16 v[120:123], a[168:171], v[172:175], v[120:123]
    v_mfma_f32_16x16x32_bf16 v[124:127], a[172:175], v[172:175], v[124:127]
    v_lshl_add_u32 v7, v5, 14, v2
    ds_write_b128 v7, v[64:67] offset:0
    ds_write_b128 v7, v[68:71] offset:1024
    ds_write_b128 v7, v[72:75] offset:2048
    ds_write_b128 v7, v[76:79] offset:3072
    ds_write_b128 v7, v[80:83] offset:4096
    ds_write_b128 v7, v[84:87] offset:5120
    ds_write_b128 v7, v[88:91] offset:6144
    ds_write_b128 v7, v[92:95] offset:7168
    ds_write_b128 v7, v[96:99] offset:8192
    ds_write_b128 v7, v[100:103] offset:9216
    ds_write_b128 v7, v[104:107] offset:10240
    ds_write_b128 v7, v[108:111] offset:11264
    ds_write_b128 v7, v[112:115] offset:12288
    ds_write_b128 v7, v[116:119] offset:13312
    ds_write_b128 v7, v[120:123] offset:14336
    ds_write_b128 v7, v[124:127] offset:15360
    s_waitcnt lgkmcnt(0)
    s_barrier
    v_lshl_add_u32 v7, v5, 12, v2
    ds_read_b128 v[64:67], v7 offset:0
    ds_read_b128 v[68:71], v7 offset:16384
    ds_read_b128 v[72:75], v7 offset:32768
    ds_read_b128 v[76:79], v7 offset:49152
    ds_read_b128 v[80:83], v7 offset:1024
    ds_read_b128 v[84:87], v7 offset:17408
    ds_read_b128 v[88:91], v7 offset:33792
    ds_read_b128 v[92:95], v7 offset:50176
    ds_read_b128 v[96:99], v7 offset:2048
    ds_read_b128 v[100:103], v7 offset:18432
    ds_read_b128 v[104:107], v7 offset:34816
    ds_read_b128 v[108:111], v7 offset:51200
    ds_read_b128 v[112:115], v7 offset:3072
    ds_read_b128 v[116:119], v7 offset:19456
    ds_read_b128 v[120:123], v7 offset:35840
    ds_read_b128 v[124:127], v7 offset:52224
    s_waitcnt lgkmcnt(0)
    v_add_f32 v64, v64, v68
    v_add_f32 v72, v72, v76
    v_add_f32 v64, v64, v72
    v_cvt_pk_bf16_f32 v64, v64, v64
    v_lshlrev_b32 v64, 16, v64
    v_lshlrev_b32 v24, 16, v16
    v_add_f32 v64, v64, v24
    v_cvt_pk_bf16_f32 v64, v64, v64
    v_lshlrev_b32 v64, 16, v64
    v_add_f32 v65, v65, v69
    v_add_f32 v73, v73, v77
    v_add_f32 v65, v65, v73
    v_cvt_pk_bf16_f32 v65, v65, v65
    v_lshlrev_b32 v65, 16, v65
    v_and_b32 v24, 0xffff0000, v16
    v_add_f32 v65, v65, v24
    v_cvt_pk_bf16_f32 v65, v65, v65
    v_lshlrev_b32 v65, 16, v65
    v_add_f32 v66, v66, v70
    v_add_f32 v74, v74, v78
    v_add_f32 v66, v66, v74
    v_cvt_pk_bf16_f32 v66, v66, v66
    v_lshlrev_b32 v66, 16, v66
    v_lshlrev_b32 v24, 16, v17
    v_add_f32 v66, v66, v24
    v_cvt_pk_bf16_f32 v66, v66, v66
    v_lshlrev_b32 v66, 16, v66
    v_add_f32 v67, v67, v71
    v_add_f32 v75, v75, v79
    v_add_f32 v67, v67, v75
    v_cvt_pk_bf16_f32 v67, v67, v67
    v_lshlrev_b32 v67, 16, v67
    v_and_b32 v24, 0xffff0000, v17
    v_add_f32 v67, v67, v24
    v_cvt_pk_bf16_f32 v67, v67, v67
    v_lshlrev_b32 v67, 16, v67
    v_add_f32 v80, v80, v84
    v_add_f32 v88, v88, v92
    v_add_f32 v80, v80, v88
    v_cvt_pk_bf16_f32 v80, v80, v80
    v_lshlrev_b32 v80, 16, v80
    v_lshlrev_b32 v24, 16, v18
    v_add_f32 v80, v80, v24
    v_cvt_pk_bf16_f32 v80, v80, v80
    v_lshlrev_b32 v80, 16, v80
    v_add_f32 v81, v81, v85
    v_add_f32 v89, v89, v93
    v_add_f32 v81, v81, v89
    v_cvt_pk_bf16_f32 v81, v81, v81
    v_lshlrev_b32 v81, 16, v81
    v_and_b32 v24, 0xffff0000, v18
    v_add_f32 v81, v81, v24
    v_cvt_pk_bf16_f32 v81, v81, v81
    v_lshlrev_b32 v81, 16, v81
    v_add_f32 v82, v82, v86
    v_add_f32 v90, v90, v94
    v_add_f32 v82, v82, v90
    v_cvt_pk_bf16_f32 v82, v82, v82
    v_lshlrev_b32 v82, 16, v82
    v_lshlrev_b32 v24, 16, v19
    v_add_f32 v82, v82, v24
    v_cvt_pk_bf16_f32 v82, v82, v82
    v_lshlrev_b32 v82, 16, v82
    v_add_f32 v83, v83, v87
    v_add_f32 v91, v91, v95
    v_add_f32 v83, v83, v91
    v_cvt_pk_bf16_f32 v83, v83, v83
    v_lshlrev_b32 v83, 16, v83
    v_and_b32 v24, 0xffff0000, v19
    v_add_f32 v83, v83, v24
    v_cvt_pk_bf16_f32 v83, v83, v83
    v_lshlrev_b32 v83, 16, v83
    v_add_f32 v96, v96, v100
    v_add_f32 v104, v104, v108
    v_add_f32 v96, v96, v104
    v_cvt_pk_bf16_f32 v96, v96, v96
    v_lshlrev_b32 v96, 16, v96
    v_lshlrev_b32 v24, 16, v20
    v_add_f32 v96, v96, v24
    v_cvt_pk_bf16_f32 v96, v96, v96
    v_lshlrev_b32 v96, 16, v96
    v_add_f32 v97, v97, v101
    v_add_f32 v105, v105, v109
    v_add_f32 v97, v97, v105
    v_cvt_pk_bf16_f32 v97, v97, v97
    v_lshlrev_b32 v97, 16, v97
    v_and_b32 v24, 0xffff0000, v20
    v_add_f32 v97, v97, v24
    v_cvt_pk_bf16_f32 v97, v97, v97
    v_lshlrev_b32 v97, 16, v97
    v_add_f32 v98, v98, v102
    v_add_f32 v106, v106, v110
    v_add_f32 v98, v98, v106
    v_cvt_pk_bf16_f32 v98, v98, v98
    v_lshlrev_b32 v98, 16, v98
    v_lshlrev_b32 v24, 16, v21
    v_add_f32 v98, v98, v24
    v_cvt_pk_bf16_f32 v98, v98, v98
    v_lshlrev_b32 v98, 16, v98
    v_add_f32 v99, v99, v103
    v_add_f32 v107, v107, v111
    v_add_f32 v99, v99, v107
    v_cvt_pk_bf16_f32 v99, v99, v99
    v_lshlrev_b32 v99, 16, v99
    v_and_b32 v24, 0xffff0000, v21
    v_add_f32 v99, v99, v24
    v_cvt_pk_bf16_f32 v99, v99, v99
    v_lshlrev_b32 v99, 16, v99
    v_add_f32 v112, v112, v116
    v_add_f32 v120, v120, v124
    v_add_f32 v112, v112, v120
    v_cvt_pk_bf16_f32 v112, v112, v112
    v_lshlrev_b32 v112, 16, v112
    v_lshlrev_b32 v24, 16, v22
    v_add_f32 v112, v112, v24
    v_cvt_pk_bf16_f32 v112, v112, v112
    v_lshlrev_b32 v112, 16, v112
    v_add_f32 v113, v113, v117
    v_add_f32 v121, v121, v125
    v_add_f32 v113, v113, v121
    v_cvt_pk_bf16_f32 v113, v113, v113
    v_lshlrev_b32 v113, 16, v113
    v_and_b32 v24, 0xffff0000, v22
    v_add_f32 v113, v113, v24
    v_cvt_pk_bf16_f32 v113, v113, v113
    v_lshlrev_b32 v113, 16, v113
    v_add_f32 v114, v114, v118
    v_add_f32 v122, v122, v126
    v_add_f32 v114, v114, v122
    v_cvt_pk_bf16_f32 v114, v114, v114
    v_lshlrev_b32 v114, 16, v114
    v_lshlrev_b32 v24, 16, v23
    v_add_f32 v114, v114, v24
    v_cvt_pk_bf16_f32 v114, v114, v114
    v_lshlrev_b32 v114, 16, v114
    v_add_f32 v115, v115, v119
    v_add_f32 v123, v123, v127
    v_add_f32 v115, v115, v123
    v_cvt_pk_bf16_f32 v115, v115, v115
    v_lshlrev_b32 v115, 16, v115
    v_and_b32 v24, 0xffff0000, v23
    v_add_f32 v115, v115, v24
    v_cvt_pk_bf16_f32 v115, v115, v115
    v_lshlrev_b32 v115, 16, v115
    s_mov_b32 s43, 0x07060302
    v_perm_b32 v32, v65, v64, s43
    v_perm_b32 v33, v67, v66, s43
    v_perm_b32 v34, v81, v80, s43
    v_perm_b32 v35, v83, v82, s43
    v_perm_b32 v36, v97, v96, s43
    v_perm_b32 v37, v99, v98, s43
    v_perm_b32 v38, v113, v112, s43
    v_perm_b32 v39, v115, v114, s43
    buffer_store_dwordx4 v[32:35], v6, s[60:63], s48 offen
    buffer_store_dwordx4 v[36:39], v6, s[60:63], s48 offen offset:16
    v_mov_b32 v24, 0
    v_mov_b32 v25, 0
    v_add_f32 v24, v24, v64
    v_fmac_f32 v25, v64, v64
    v_add_f32 v24, v24, v65
    v_fmac_f32 v25, v65, v65
    v_add_f32 v24, v24, v66
    v_fmac_f32 v25, v66, v66
    v_add_f32 v24, v24, v67
    v_fmac_f32 v25, v67, v67
    v_add_f32 v24, v24, v80
    v_fmac_f32 v25, v80, v80
    v_add_f32 v24, v24, v81
    v_fmac_f32 v25, v81, v81
    v_add_f32 v24, v24, v82
    v_fmac_f32 v25, v82, v82
    v_add_f32 v24, v24, v83
    v_fmac_f32 v25, v83, v83
    v_add_f32 v24, v24, v96
    v_fmac_f32 v25, v96, v96
    v_add_f32 v24, v24, v97
    v_fmac_f32 v25, v97, v97
    v_add_f32 v24, v24, v98
    v_fmac_f32 v25, v98, v98
    v_add_f32 v24, v24, v99
    v_fmac_f32 v25, v99, v99
    v_add_f32 v24, v24, v112
    v_fmac_f32 v25, v112, v112
    v_add_f32 v24, v24, v113
    v_fmac_f32 v25, v113, v113
    v_add_f32 v24, v24, v114
    v_fmac_f32 v25, v114, v114
    v_add_f32 v24, v24, v115
    v_fmac_f32 v25, v115, v115
    v_xor_b32 v26, 16, v1
    v_lshlrev_b32 v26, 2, v26
    v_xor_b32 v27, 32, v1
    v_lshlrev_b32 v27, 2, v27
    ds_bpermute_b32 v28, v26, v24
    ds_bpermute_b32 v29, v26, v25
    s_waitcnt lgkmcnt(0)
    v_add_f32 v24, v24, v28
    v_add_f32 v25, v25, v29
    ds_bpermute_b32 v28, v27, v24
    ds_bpermute_b32 v29, v27, v25
    s_waitcnt lgkmcnt(0)
    v_add_f32 v24, v24, v28
    v_add_f32 v25, v25, v29
    v_lshl_add_u32 v26, v5, 4, v3
    v_lshlrev_b32 v26, 3, v26
    s_lshl_b32 s51, s92, 9
    v_cmp_gt_u32 vcc, 16, v1
    s_nop 1
    s_and_saveexec_b64 s[72:73], vcc
    buffer_atomic_add_f32 v24, v26, s[68:71], s51 offen
    buffer_atomic_add_f32 v25, v26, s[68:71], s51 offen offset:4
    s_mov_b64 exec, s[72:73]
    s_barrier
    v_lshl_add_u32 v26, v5, 4, v3
    v_mul_u32_u24 v26, 144, v26
    v_lshl_add_u32 v26, v4, 5, v26
    ds_write_b128 v26, v[32:35]
    ds_write_b128 v26, v[36:39] offset:16
    s_waitcnt lgkmcnt(0)
    s_barrier
    v_add_u32 v26, 0, v5
    v_mul_u32_u24 v26, 1152, v26
    v_lshl_add_u32 v26, v1, 1, v26
    ds_read_u16 v40, v26 offset:0
    ds_read_u16 v41, v26 offset:144
    ds_read_u16 v42, v26 offset:288
    ds_read_u16 v43, v26 offset:432
    ds_read_u16 v44, v26 offset:576
    ds_read_u16 v45, v26 offset:720
    ds_read_u16 v46, v26 offset:864
    ds_read_u16 v47, v26 offset:1008
    s_waitcnt lgkmcnt(0)
    v_lshl_or_b32 v48, v41, 16, v40
    v_lshl_or_b32 v49, v43, 16, v42
    v_lshl_or_b32 v50, v45, 16, v44
    v_lshl_or_b32 v51, v47, 16, v46
    v_lshlrev_b32 v27, 12, v1
    v_lshl_add_u32 v27, v5, 4, v27
    s_lshl_b32 s51, s93, 18
    s_lshl_b32 s49, s92, 7
    s_add_u32 s51, s51, s49
    s_add_u32 s51, s51, 0
    buffer_store_dwordx4 v[48:51], v27, s[64:67], s51 offen
    v_add_u32 v26, 4, v5
    v_mul_u32_u24 v26, 1152, v26
    v_lshl_add_u32 v26, v1, 1, v26
    ds_read_u16 v40, v26 offset:0
    ds_read_u16 v41, v26 offset:144
    ds_read_u16 v42, v26 offset:288
    ds_read_u16 v43, v26 offset:432
    ds_read_u16 v44, v26 offset:576
    ds_read_u16 v45, v26 offset:720
    ds_read_u16 v46, v26 offset:864
    ds_read_u16 v47, v26 offset:1008
    s_waitcnt lgkmcnt(0)
    v_lshl_or_b32 v48, v41, 16, v40
    v_lshl_or_b32 v49, v43, 16, v42
    v_lshl_or_b32 v50, v45, 16, v44
    v_lshl_or_b32 v51, v47, 16, v46
    v_lshlrev_b32 v27, 12, v1
    v_lshl_add_u32 v27, v5, 4, v27
    s_lshl_b32 s51, s93, 18
    s_lshl_b32 s49, s92, 7
    s_add_u32 s51, s51, s49
    s_add_u32 s51, s51, 64
    buffer_store_dwordx4 v[48:51], v27, s[64:67], s51 offen
ffn1_kernel_done:
    s_endpgm
.section .rodata,"a"
.p2align 6
.amdhsa_kernel ffn1_kernel
  .amdhsa_next_free_vgpr 512
  .amdhsa_next_free_sgpr 102
  .amdhsa_accum_offset 256
  .amdhsa_group_segment_fixed_size 0
  .amdhsa_kernarg_size 112
  .amdhsa_user_sgpr_count 2
  .amdhsa_user_sgpr_kernarg_segment_ptr 1
  .amdhsa_system_sgpr_workgroup_id_x 1
.end_amdhsa_kernel

.text
.globl ffn2_kernel
.p2align 8
.type ffn2_kernel,@function
ffn2_kernel:
    s_cmp_ge_u32 s2, 256
    s_cbranch_scc1 ffn2_kernel_done
    s_load_dwordx16 s[4:19], s[0:1], 0
    s_load_dwordx8 s[20:27], s[0:1], 64
    s_load_dwordx4 s[28:31], s[0:1], 96
    v_and_b32 v1, 63, v0
    v_lshrrev_b32 v5, 6, v0
    v_lshlrev_b32 v2, 4, v1
    v_readfirstlane_b32 s50, v5
    s_waitcnt lgkmcnt(0)
    s_add_u32 s44, s30, 0xc50000
    s_addc_u32 s45, s31, 0
    s_mov_b32 s46, 0x200000
    s_mov_b32 s47, 0x20000
    s_add_u32 s52, s30, 0x13b0000
    s_addc_u32 s53, s31, 0
    s_mov_b32 s54, 0x2b0000
    s_mov_b32 s55, 0x20000
    s_add_u32 s56, s30, 0x1e50000
    s_addc_u32 s57, s31, 0
    s_mov_b32 s58, 0x560000
    s_mov_b32 s59, 0x20000
    s_add_u32 s84, s30, 0x1660000
    s_addc_u32 s85, s31, 0
    s_mov_b32 s86, 0x158000
    s_mov_b32 s87, 0x20000
    s_add_u32 s88, s30, 0x17c0000
    s_addc_u32 s89, s31, 0
    s_mov_b32 s90, 0x10000
    s_mov_b32 s91, 0x20000
    s_and_b32 s60, s2, 7
    s_lshr_b32 s61, s2, 3
    s_and_b32 s40, s60, 3
    s_lshl_b32 s40, s40, 2
    s_and_b32 s62, s61, 3
    s_add_u32 s40, s40, s62
    s_lshr_b32 s41, s60, 2
    s_lshl_b32 s41, s41, 3
    s_lshr_b32 s62, s61, 2
    s_add_u32 s41, s41, s62
    s_mul_i32 s42, s41, 3
    s_lshl_b32 s43, s41, 1
    s_add_u32 s43, s43, 11
    s_cmp_lt_u32 s41, 11
    s_cselect_b32 s42, s42, s43
    s_lshl_b32 s80, s42, 16
    s_lshl_b32 s81, s50, 13
    s_add_u32 s80, s80, s81
    s_lshl_b32 s48, s40, 3
    s_lshl_b32 s49, s50, 1
    s_add_u32 s48, s48, s49
    s_lshl_b32 s49, s48, 14
    s_and_b32 s92, s41, 1
    s_lshl_b32 s93, s40, 1
    s_add_u32 s92, s92, s93
    s_lshr_b32 s93, s41, 1
    s_mul_i32 s94, s92, 172
    s_add_u32 s94, s94, s50
    s_lshl_b32 s94, s94, 10
    s_mul_i32 s95, s93, 43
    s_add_u32 s95, s95, s50
    s_lshl_b32 s95, s95, 12
    v_add_u32 v8, 0, v2
    v_add_u32 v9, 32768, v2
    v_add_u32 v10, 65536, v2
    v_add_u32 v11, 98304, v2
    s_cmp_lt_u32 s41, 11
    s_cbranch_scc0 ffn2_kernel_two
    s_add_u32 s51, s81, 0
    s_mov_b32 m0, s51
    s_add_u32 s61, s80, 0
    buffer_load_dwordx4 v2, s[52:55], s61 offen offset:0 lds
    buffer_load_dwordx4 v2, s[52:55], s61 offen offset:1024 lds
    buffer_load_dwordx4 v2, s[52:55], s61 offen offset:2048 lds
    buffer_load_dwordx4 v2, s[52:55], s61 offen offset:3072 lds
    s_add_u32 s51, s81, 4096
    s_mov_b32 m0, s51
    s_add_u32 s61, s80, 4096
    buffer_load_dwordx4 v2, s[52:55], s61 offen offset:0 lds
    buffer_load_dwordx4 v2, s[52:55], s61 offen offset:1024 lds
    buffer_load_dwordx4 v2, s[52:55], s61 offen offset:2048 lds
    buffer_load_dwordx4 v2, s[52:55], s61 offen offset:3072 lds
    s_add_u32 s51, s49, 0
    buffer_load_dwordx4 v[128:131], v2, s[44:47], s51 offen
    s_add_u32 s51, s49, 1024
    buffer_load_dwordx4 v[132:135], v2, s[44:47], s51 offen
    s_add_u32 s51, s49, 2048
    buffer_load_dwordx4 v[136:139], v2, s[44:47], s51 offen
    s_add_u32 s51, s49, 3072
    buffer_load_dwordx4 v[140:143], v2, s[44:47], s51 offen
    s_add_u32 s51, s49, 4096
    buffer_load_dwordx4 v[144:147], v2, s[44:47], s51 offen
    s_add_u32 s51, s49, 5120
    buffer_load_dwordx4 v[148:151], v2, s[44:47], s51 offen
    s_add_u32 s51, s49, 6144
    buffer_load_dwordx4 v[152:155], v2, s[44:47], s51 offen
    s_add_u32 s51, s49, 7168
    buffer_load_dwordx4 v[156:159], v2, s[44:47], s51 offen
    s_add_u32 s51, s49, 8192
    buffer_load_dwordx4 v[160:163], v2, s[44:47], s51 offen
    s_add_u32 s51, s49, 9216
    buffer_load_dwordx4 v[164:167], v2, s[44:47], s51 offen
    s_add_u32 s51, s49, 10240
    buffer_load_dwordx4 v[168:171], v2, s[44:47], s51 offen
    s_add_u32 s51, s49, 11264
    buffer_load_dwordx4 v[172:175], v2, s[44:47], s51 offen
    s_add_u32 s51, s49, 12288
    buffer_load_dwordx4 v[176:179], v2, s[44:47], s51 offen
    s_add_u32 s51, s49, 13312
    buffer_load_dwordx4 v[180:183], v2, s[44:47], s51 offen
    s_add_u32 s51, s49, 14336
    buffer_load_dwordx4 v[184:187], v2, s[44:47], s51 offen
    s_add_u32 s51, s49, 15360
    buffer_load_dwordx4 v[188:191], v2, s[44:47], s51 offen
    s_add_u32 s51, s49, 16384
    buffer_load_dwordx4 v[192:195], v2, s[44:47], s51 offen
    s_add_u32 s51, s49, 17408
    buffer_load_dwordx4 v[196:199], v2, s[44:47], s51 offen
    s_add_u32 s51, s49, 18432
    buffer_load_dwordx4 v[200:203], v2, s[44:47], s51 offen
    s_add_u32 s51, s49, 19456
    buffer_load_dwordx4 v[204:207], v2, s[44:47], s51 offen
    s_add_u32 s51, s49, 20480
    buffer_load_dwordx4 v[208:211], v2, s[44:47], s51 offen
    s_add_u32 s51, s49, 21504
    buffer_load_dwordx4 v[212:215], v2, s[44:47], s51 offen
    s_add_u32 s51, s49, 22528
    buffer_load_dwordx4 v[216:219], v2, s[44:47], s51 offen
    s_add_u32 s51, s49, 23552
    buffer_load_dwordx4 v[220:223], v2, s[44:47], s51 offen
    s_add_u32 s51, s49, 24576
    buffer_load_dwordx4 v[224:227], v2, s[44:47], s51 offen
    s_add_u32 s51, s49, 25600
    buffer_load_dwordx4 v[228:231], v2, s[44:47], s51 offen
    s_add_u32 s51, s49, 26624
    buffer_load_dwordx4 v[232:235], v2, s[44:47], s51 offen
    s_add_u32 s51, s49, 27648
    buffer_load_dwordx4 v[236:239], v2, s[44:47], s51 offen
    s_add_u32 s51, s49, 28672
    buffer_load_dwordx4 v[240:243], v2, s[44:47], s51 offen
    s_add_u32 s51, s49, 29696
    buffer_load_dwordx4 v[244:247], v2, s[44:47], s51 offen
    s_add_u32 s51, s49, 30720
    buffer_load_dwordx4 v[248:251], v2, s[44:47], s51 offen
    s_add_u32 s51, s49, 31744
    buffer_load_dwordx4 v[252:255], v2, s[44:47], s51 offen
    s_add_u32 s51, s81, 32768
    s_mov_b32 m0, s51
    s_add_u32 s61, s80, 32768
    buffer_load_dwordx4 v2, s[52:55], s61 offen offset:0 lds
    buffer_load_dwordx4 v2, s[52:55], s61 offen offset:1024 lds
    buffer_load_dwordx4 v2, s[52:55], s61 offen offset:2048 lds
    buffer_load_dwordx4 v2, s[52:55], s61 offen offset:3072 lds
    s_add_u32 s51, s81, 36864
    s_mov_b32 m0, s51
    s_add_u32 s61, s80, 36864
    buffer_load_dwordx4 v2, s[52:55], s61 offen offset:0 lds
    buffer_load_dwordx4 v2, s[52:55], s61 offen offset:1024 lds
    buffer_load_dwordx4 v2, s[52:55], s61 offen offset:2048 lds
    buffer_load_dwordx4 v2, s[52:55], s61 offen offset:3072 lds
    s_add_u32 s51, s81, 65536
    s_mov_b32 m0, s51
    s_add_u32 s61, s80, 65536
    buffer_load_dwordx4 v2, s[52:55], s61 offen offset:0 lds
    buffer_load_dwordx4 v2, s[52:55], s61 offen offset:1024 lds
    buffer_load_dwordx4 v2, s[52:55], s61 offen offset:2048 lds
    buffer_load_dwordx4 v2, s[52:55], s61 offen offset:3072 lds
    s_add_u32 s51, s81, 69632
    s_mov_b32 m0, s51
    s_add_u32 s61, s80, 69632
    buffer_load_dwordx4 v2, s[52:55], s61 offen offset:0 lds
    buffer_load_dwordx4 v2, s[52:55], s61 offen offset:1024 lds
    buffer_load_dwordx4 v2, s[52:55], s61 offen offset:2048 lds
    buffer_load_dwordx4 v2, s[52:55], s61 offen offset:3072 lds
    s_add_u32 s51, s81, 98304
    s_mov_b32 m0, s51
    s_add_u32 s61, s80, 98304
    buffer_load_dwordx4 v2, s[52:55], s61 offen offset:0 lds
    buffer_load_dwordx4 v2, s[52:55], s61 offen offset:1024 lds
    buffer_load_dwordx4 v2, s[52:55], s61 offen offset:2048 lds
    buffer_load_dwordx4 v2, s[52:55], s61 offen offset:3072 lds
    s_add_u32 s51, s81, 102400
    s_mov_b32 m0, s51
    s_add_u32 s61, s80, 102400
    buffer_load_dwordx4 v2, s[52:55], s61 offen offset:0 lds
    buffer_load_dwordx4 v2, s[52:55], s61 offen offset:1024 lds
    buffer_load_dwordx4 v2, s[52:55], s61 offen offset:2048 lds
    buffer_load_dwordx4 v2, s[52:55], s61 offen offset:3072 lds
    v_mov_b32 v64, 0
    v_mov_b32 v65, 0
    v_mov_b32 v66, 0
    v_mov_b32 v67, 0
    v_mov_b32 v68, 0
    v_mov_b32 v69, 0
    v_mov_b32 v70, 0
    v_mov_b32 v71, 0
    v_mov_b32 v72, 0
    v_mov_b32 v73, 0
    v_mov_b32 v74, 0
    v_mov_b32 v75, 0
    v_mov_b32 v76, 0
    v_mov_b32 v77, 0
    v_mov_b32 v78, 0
    v_mov_b32 v79, 0
    v_mov_b32 v80, 0
    v_mov_b32 v81, 0
    v_mov_b32 v82, 0
    v_mov_b32 v83, 0
    v_mov_b32 v84, 0
    v_mov_b32 v85, 0
    v_mov_b32 v86, 0
    v_mov_b32 v87, 0
    v_mov_b32 v88, 0
    v_mov_b32 v89, 0
    v_mov_b32 v90, 0
    v_mov_b32 v91, 0
    v_mov_b32 v92, 0
    v_mov_b32 v93, 0
    v_mov_b32 v94, 0
    v_mov_b32 v95, 0
    v_mov_b32 v32, 0
    v_mov_b32 v33, 0
    v_mov_b32 v34, 0
    v_mov_b32 v35, 0
    v_mov_b32 v36, 0
    v_mov_b32 v37, 0
    v_mov_b32 v38, 0
    v_mov_b32 v39, 0
    v_mov_b32 v40, 0
    v_mov_b32 v41, 0
    v_mov_b32 v42, 0
    v_mov_b32 v43, 0
    v_mov_b32 v44, 0
    v_mov_b32 v45, 0
    v_mov_b32 v46, 0
    v_mov_b32 v47, 0
    v_mov_b32 v48, 0
    v_mov_b32 v49, 0
    v_mov_b32 v50, 0
    v_mov_b32 v51, 0
    v_mov_b32 v52, 0
    v_mov_b32 v53, 0
    v_mov_b32 v54, 0
    v_mov_b32 v55, 0
    v_mov_b32 v56, 0
    v_mov_b32 v57, 0
    v_mov_b32 v58, 0
    v_mov_b32 v59, 0
    v_mov_b32 v60, 0
    v_mov_b32 v61, 0
    v_mov_b32 v62, 0
    v_mov_b32 v63, 0
    s_waitcnt vmcnt(24)
    s_barrier
    ds_read_b128 a[192:195], v8 offset:0
    ds_read_b128 a[196:199], v8 offset:1024
    ds_read_b128 a[200:203], v8 offset:2048
    ds_read_b128 a[204:207], v8 offset:3072
    ds_read_b128 a[208:211], v8 offset:4096
    ds_read_b128 a[212:215], v8 offset:5120
    ds_read_b128 a[216:219], v8 offset:6144
    ds_read_b128 a[220:223], v8 offset:7168
    ds_read_b128 a[224:227], v8 offset:8192
    ds_read_b128 a[228:231], v8 offset:9216
    ds_read_b128 a[232:235], v8 offset:10240
    ds_read_b128 a[236:239], v8 offset:11264
    ds_read_b128 a[240:243], v8 offset:12288
    ds_read_b128 a[244:247], v8 offset:13312
    ds_read_b128 a[248:251], v8 offset:14336
    ds_read_b128 a[252:255], v8 offset:15360
    s_waitcnt lgkmcnt(12)
    v_mfma_f32_16x16x32_bf16 v[64:67], a[192:195], v[128:131], v[64:67]
    v_mfma_f32_16x16x32_bf16 v[68:71], a[192:195], v[192:195], v[68:71]
    s_add_u32 s63, s95, 0
    buffer_load_dwordx4 a[0:3], v2, s[84:87], s63 offen offset:0
    v_mfma_f32_16x16x32_bf16 v[72:75], a[196:199], v[128:131], v[72:75]
    v_mfma_f32_16x16x32_bf16 v[76:79], a[196:199], v[192:195], v[76:79]
    v_mfma_f32_16x16x32_bf16 v[80:83], a[200:203], v[128:131], v[80:83]
    v_mfma_f32_16x16x32_bf16 v[84:87], a[200:203], v[192:195], v[84:87]
    v_mfma_f32_16x16x32_bf16 v[88:91], a[204:207], v[128:131], v[88:91]
    v_mfma_f32_16x16x32_bf16 v[92:95], a[204:207], v[192:195], v[92:95]
    ds_read_b128 a[192:195], v8 offset:16384
    ds_read_b128 a[196:199], v8 offset:17408
    ds_read_b128 a[200:203], v8 offset:18432
    ds_read_b128 a[204:207], v8 offset:19456
    s_waitcnt lgkmcnt(12)
    v_mfma_f32_16x16x32_bf16 v[64:67], a[208:211], v[132:135], v[64:67]
    v_mfma_f32_16x16x32_bf16 v[68:71], a[208:211], v[196:199], v[68:71]
    buffer_load_dwordx4 a[4:7], v2, s[84:87], s63 offen offset:1024
    v_mfma_f32_16x16x32_bf16 v[72:75], a[212:215], v[132:135], v[72:75]
    v_mfma_f32_16x16x32_bf16 v[76:79], a[212:215], v[196:199], v[76:79]
    v_mfma_f32_16x16x32_bf16 v[80:83], a[216:219], v[132:135], v[80:83]
    v_mfma_f32_16x16x32_bf16 v[84:87], a[216:219], v[196:199], v[84:87]
    v_mfma_f32_16x16x32_bf16 v[88:91], a[220:223], v[132:135], v[88:91]
    v_mfma_f32_16x16x32_bf16 v[92:95], a[220:223], v[196:199], v[92:95]
    ds_read_b128 a[208:211], v8 offset:20480
    ds_read_b128 a[212:215], v8 offset:21504
    ds_read_b128 a[216:219], v8 offset:22528
    ds_read_b128 a[220:223], v8 offset:23552
    s_waitcnt lgkmcnt(12)
    v_mfma_f32_16x16x32_bf16 v[64:67], a[224:227], v[136:139], v[64:67]
    v_mfma_f32_16x16x32_bf16 v[68:71], a[224:227], v[200:203], v[68:71]
    buffer_load_dwordx4 a[8:11], v2, s[84:87], s63 offen offset:2048
    v_mfma_f32_16x16x32_bf16 v[72:75], a[228:231], v[136:139], v[72:75]
    v_mfma_f32_16x16x32_bf16 v[76:79], a[228:231], v[200:203], v[76:79]
    v_mfma_f32_16x16x32_bf16 v[80:83], a[232:235], v[136:139], v[80:83]
    v_mfma_f32_16x16x32_bf16 v[84:87], a[232:235], v[200:203], v[84:87]
    v_mfma_f32_16x16x32_bf16 v[88:91], a[236:239], v[136:139], v[88:91]
    v_mfma_f32_16x16x32_bf16 v[92:95], a[236:239], v[200:203], v[92:95]
    ds_read_b128 a[224:227], v8 offset:24576
    ds_read_b128 a[228:231], v8 offset:25600
    ds_read_b128 a[232:235], v8 offset:26624
    ds_read_b128 a[236:239], v8 offset:27648
    s_waitcnt lgkmcnt(12)
    v_mfma_f32_16x16x32_bf16 v[64:67], a[240:243], v[140:143], v[64:67]
    v_mfma_f32_16x16x32_bf16 v[68:71], a[240:243], v[204:207], v[68:71]
    buffer_load_dwordx4 a[12:15], v2, s[84:87], s63 offen offset:3072
    v_mfma_f32_16x16x32_bf16 v[72:75], a[244:247], v[140:143], v[72:75]
    v_mfma_f32_16x16x32_bf16 v[76:79], a[244:247], v[204:207], v[76:79]
    v_mfma_f32_16x16x32_bf16 v[80:83], a[248:251], v[140:143], v[80:83]
    v_mfma_f32_16x16x32_bf16 v[84:87], a[248:251], v[204:207], v[84:87]
    v_mfma_f32_16x16x32_bf16 v[88:91], a[252:255], v[140:143], v[88:91]
    v_mfma_f32_16x16x32_bf16 v[92:95], a[252:255], v[204:207], v[92:95]
    ds_read_b128 a[240:243], v8 offset:28672
    ds_read_b128 a[244:247], v8 offset:29696
    ds_read_b128 a[248:251], v8 offset:30720
    ds_read_b128 a[252:255], v8 offset:31744
    s_waitcnt lgkmcnt(12)
    v_mfma_f32_16x16x32_bf16 v[64:67], a[192:195], v[144:147], v[64:67]
    v_mfma_f32_16x16x32_bf16 v[68:71], a[192:195], v[208:211], v[68:71]
    s_add_u32 s63, s95, 16384
    buffer_load_dwordx4 a[16:19], v2, s[84:87], s63 offen offset:0
    v_mfma_f32_16x16x32_bf16 v[72:75], a[196:199], v[144:147], v[72:75]
    v_mfma_f32_16x16x32_bf16 v[76:79], a[196:199], v[208:211], v[76:79]
    v_mfma_f32_16x16x32_bf16 v[80:83], a[200:203], v[144:147], v[80:83]
    v_mfma_f32_16x16x32_bf16 v[84:87], a[200:203], v[208:211], v[84:87]
    v_mfma_f32_16x16x32_bf16 v[88:91], a[204:207], v[144:147], v[88:91]
    v_mfma_f32_16x16x32_bf16 v[92:95], a[204:207], v[208:211], v[92:95]
    s_waitcnt lgkmcnt(8)
    v_mfma_f32_16x16x32_bf16 v[64:67], a[208:211], v[148:151], v[64:67]
    v_mfma_f32_16x16x32_bf16 v[68:71], a[208:211], v[212:215], v[68:71]
    buffer_load_dwordx4 a[20:23], v2, s[84:87], s63 offen offset:1024
    v_mfma_f32_16x16x32_bf16 v[72:75], a[212:215], v[148:151], v[72:75]
    v_mfma_f32_16x16x32_bf16 v[76:79], a[212:215], v[212:215], v[76:79]
    v_mfma_f32_16x16x32_bf16 v[80:83], a[216:219], v[148:151], v[80:83]
    v_mfma_f32_16x16x32_bf16 v[84:87], a[216:219], v[212:215], v[84:87]
    v_mfma_f32_16x16x32_bf16 v[88:91], a[220:223], v[148:151], v[88:91]
    v_mfma_f32_16x16x32_bf16 v[92:95], a[220:223], v[212:215], v[92:95]
    s_waitcnt lgkmcnt(4)
    v_mfma_f32_16x16x32_bf16 v[64:67], a[224:227], v[152:155], v[64:67]
    v_mfma_f32_16x16x32_bf16 v[68:71], a[224:227], v[216:219], v[68:71]
    buffer_load_dwordx4 a[24:27], v2, s[84:87], s63 offen offset:2048
    v_mfma_f32_16x16x32_bf16 v[72:75], a[228:231], v[152:155], v[72:75]
    v_mfma_f32_16x16x32_bf16 v[76:79], a[228:231], v[216:219], v[76:79]
    v_mfma_f32_16x16x32_bf16 v[80:83], a[232:235], v[152:155], v[80:83]
    v_mfma_f32_16x16x32_bf16 v[84:87], a[232:235], v[216:219], v[84:87]
    v_mfma_f32_16x16x32_bf16 v[88:91], a[236:239], v[152:155], v[88:91]
    v_mfma_f32_16x16x32_bf16 v[92:95], a[236:239], v[216:219], v[92:95]
    s_waitcnt lgkmcnt(0)
    v_mfma_f32_16x16x32_bf16 v[64:67], a[240:243], v[156:159], v[64:67]
    v_mfma_f32_16x16x32_bf16 v[68:71], a[240:243], v[220:223], v[68:71]
    buffer_load_dwordx4 a[28:31], v2, s[84:87], s63 offen offset:3072
    v_mfma_f32_16x16x32_bf16 v[72:75], a[244:247], v[156:159], v[72:75]
    v_mfma_f32_16x16x32_bf16 v[76:79], a[244:247], v[220:223], v[76:79]
    v_mfma_f32_16x16x32_bf16 v[80:83], a[248:251], v[156:159], v[80:83]
    v_mfma_f32_16x16x32_bf16 v[84:87], a[248:251], v[220:223], v[84:87]
    v_mfma_f32_16x16x32_bf16 v[88:91], a[252:255], v[156:159], v[88:91]
    v_mfma_f32_16x16x32_bf16 v[92:95], a[252:255], v[220:223], v[92:95]
    s_waitcnt vmcnt(24)
    s_barrier
    ds_read_b128 a[192:195], v9 offset:0
    ds_read_b128 a[196:199], v9 offset:1024
    ds_read_b128 a[200:203], v9 offset:2048
    ds_read_b128 a[204:207], v9 offset:3072
    ds_read_b128 a[208:211], v9 offset:4096
    ds_read_b128 a[212:215], v9 offset:5120
    ds_read_b128 a[216:219], v9 offset:6144
    ds_read_b128 a[220:223], v9 offset:7168
    ds_read_b128 a[224:227], v9 offset:8192
    ds_read_b128 a[228:231], v9 offset:9216
    ds_read_b128 a[232:235], v9 offset:10240
    ds_read_b128 a[236:239], v9 offset:11264
    ds_read_b128 a[240:243], v9 offset:12288
    ds_read_b128 a[244:247], v9 offset:13312
    ds_read_b128 a[248:251], v9 offset:14336
    ds_read_b128 a[252:255], v9 offset:15360
    s_waitcnt lgkmcnt(12)
    v_mfma_f32_16x16x32_bf16 v[64:67], a[192:195], v[160:163], v[64:67]
    v_mfma_f32_16x16x32_bf16 v[68:71], a[192:195], v[224:227], v[68:71]
    s_add_u32 s51, s81, 0
    s_mov_b32 m0, s51
    s_add_u32 s61, s80, 131072
    buffer_load_dwordx4 v2, s[52:55], s61 offen offset:0 lds
    v_mfma_f32_16x16x32_bf16 v[72:75], a[196:199], v[160:163], v[72:75]
    v_mfma_f32_16x16x32_bf16 v[76:79], a[196:199], v[224:227], v[76:79]
    v_mfma_f32_16x16x32_bf16 v[80:83], a[200:203], v[160:163], v[80:83]
    v_mfma_f32_16x16x32_bf16 v[84:87], a[200:203], v[224:227], v[84:87]
    v_mfma_f32_16x16x32_bf16 v[88:91], a[204:207], v[160:163], v[88:91]
    v_mfma_f32_16x16x32_bf16 v[92:95], a[204:207], v[224:227], v[92:95]
    ds_read_b128 a[192:195], v9 offset:16384
    ds_read_b128 a[196:199], v9 offset:17408
    ds_read_b128 a[200:203], v9 offset:18432
    ds_read_b128 a[204:207], v9 offset:19456
    s_waitcnt lgkmcnt(12)
    v_mfma_f32_16x16x32_bf16 v[64:67], a[208:211], v[164:167], v[64:67]
    v_mfma_f32_16x16x32_bf16 v[68:71], a[208:211], v[228:231], v[68:71]
    buffer_load_dwordx4 v2, s[52:55], s61 offen offset:1024 lds
    v_mfma_f32_16x16x32_bf16 v[72:75], a[212:215], v[164:167], v[72:75]
    v_mfma_f32_16x16x32_bf16 v[76:79], a[212:215], v[228:231], v[76:79]
    v_mfma_f32_16x16x32_bf16 v[80:83], a[216:219], v[164:167], v[80:83]
    v_mfma_f32_16x16x32_bf16 v[84:87], a[216:219], v[228:231], v[84:87]
    v_mfma_f32_16x16x32_bf16 v[88:91], a[220:223], v[164:167], v[88:91]
    v_mfma_f32_16x16x32_bf16 v[92:95], a[220:223], v[228:231], v[92:95]
    ds_read_b128 a[208:211], v9 offset:20480
    ds_read_b128 a[212:215], v9 offset:21504
    ds_read_b128 a[216:219], v9 offset:22528
    ds_read_b128 a[220:223], v9 offset:23552
    s_waitcnt lgkmcnt(12)
    v_mfma_f32_16x16x32_bf16 v[64:67], a[224:227], v[168:171], v[64:67]
    v_mfma_f32_16x16x32_bf16 v[68:71], a[224:227], v[232:235], v[68:71]
    buffer_load_dwordx4 v2, s[52:55], s61 offen offset:2048 lds
    v_mfma_f32_16x16x32_bf16 v[72:75], a[228:231], v[168:171], v[72:75]
    v_mfma_f32_16x16x32_bf16 v[76:79], a[228:231], v[232:235], v[76:79]
    v_mfma_f32_16x16x32_bf16 v[80:83], a[232:235], v[168:171], v[80:83]
    v_mfma_f32_16x16x32_bf16 v[84:87], a[232:235], v[232:235], v[84:87]
    v_mfma_f32_16x16x32_bf16 v[88:91], a[236:239], v[168:171], v[88:91]
    v_mfma_f32_16x16x32_bf16 v[92:95], a[236:239], v[232:235], v[92:95]
    ds_read_b128 a[224:227], v9 offset:24576
    ds_read_b128 a[228:231], v9 offset:25600
    ds_read_b128 a[232:235], v9 offset:26624
    ds_read_b128 a[236:239], v9 offset:27648
    s_waitcnt lgkmcnt(12)
    v_mfma_f32_16x16x32_bf16 v[64:67], a[240:243], v[172:175], v[64:67]
    v_mfma_f32_16x16x32_bf16 v[68:71], a[240:243], v[236:239], v[68:71]
    buffer_load_dwordx4 v2, s[52:55], s61 offen offset:3072 lds
    v_mfma_f32_16x16x32_bf16 v[72:75], a[244:247], v[172:175], v[72:75]
    v_mfma_f32_16x16x32_bf16 v[76:79], a[244:247], v[236:239], v[76:79]
    v_mfma_f32_16x16x32_bf16 v[80:83], a[248:251], v[172:175], v[80:83]
    v_mfma_f32_16x16x32_bf16 v[84:87], a[248:251], v[236:239], v[84:87]
    v_mfma_f32_16x16x32_bf16 v[88:91], a[252:255], v[172:175], v[88:91]
    v_mfma_f32_16x16x32_bf16 v[92:95], a[252:255], v[236:239], v[92:95]
    ds_read_b128 a[240:243], v9 offset:28672
    ds_read_b128 a[244:247], v9 offset:29696
    ds_read_b128 a[248:251], v9 offset:30720
    ds_read_b128 a[252:255], v9 offset:31744
    s_waitcnt lgkmcnt(12)
    v_mfma_f32_16x16x32_bf16 v[64:67], a[192:195], v[176:179], v[64:67]
    v_mfma_f32_16x16x32_bf16 v[68:71], a[192:195], v[240:243], v[68:71]
    s_add_u32 s51, s81, 4096
    s_mov_b32 m0, s51
    s_add_u32 s61, s80, 135168
    buffer_load_dwordx4 v2, s[52:55], s61 offen offset:0 lds
    v_mfma_f32_16x16x32_bf16 v[72:75], a[196:199], v[176:179], v[72:75]
    v_mfma_f32_16x16x32_bf16 v[76:79], a[196:199], v[240:243], v[76:79]
    v_mfma_f32_16x16x32_bf16 v[80:83], a[200:203], v[176:179], v[80:83]
    v_mfma_f32_16x16x32_bf16 v[84:87], a[200:203], v[240:243], v[84:87]
    v_mfma_f32_16x16x32_bf16 v[88:91], a[204:207], v[176:179], v[88:91]
    v_mfma_f32_16x16x32_bf16 v[92:95], a[204:207], v[240:243], v[92:95]
    s_waitcnt lgkmcnt(8)
    v_mfma_f32_16x16x32_bf16 v[64:67], a[208:211], v[180:183], v[64:67]
    v_mfma_f32_16x16x32_bf16 v[68:71], a[208:211], v[244:247], v[68:71]
    buffer_load_dwordx4 v2, s[52:55], s61 offen offset:1024 lds
    v_mfma_f32_16x16x32_bf16 v[72:75], a[212:215], v[180:183], v[72:75]
    v_mfma_f32_16x16x32_bf16 v[76:79], a[212:215], v[244:247], v[76:79]
    v_mfma_f32_16x16x32_bf16 v[80:83], a[216:219], v[180:183], v[80:83]
    v_mfma_f32_16x16x32_bf16 v[84:87], a[216:219], v[244:247], v[84:87]
    v_mfma_f32_16x16x32_bf16 v[88:91], a[220:223], v[180:183], v[88:91]
    v_mfma_f32_16x16x32_bf16 v[92:95], a[220:223], v[244:247], v[92:95]
    s_waitcnt lgkmcnt(4)
    v_mfma_f32_16x16x32_bf16 v[64:67], a[224:227], v[184:187], v[64:67]
    v_mfma_f32_16x16x32_bf16 v[68:71], a[224:227], v[248:251], v[68:71]
    buffer_load_dwordx4 v2, s[52:55], s61 offen offset:2048 lds
    v_mfma_f32_16x16x32_bf16 v[72:75], a[228:231], v[184:187], v[72:75]
    v_mfma_f32_16x16x32_bf16 v[76:79], a[228:231], v[248:251], v[76:79]
    v_mfma_f32_16x16x32_bf16 v[80:83], a[232:235], v[184:187], v[80:83]
    v_mfma_f32_16x16x32_bf16 v[84:87], a[232:235], v[248:251], v[84:87]
    v_mfma_f32_16x16x32_bf16 v[88:91], a[236:239], v[184:187], v[88:91]
    v_mfma_f32_16x16x32_bf16 v[92:95], a[236:239], v[248:251], v[92:95]
    s_waitcnt lgkmcnt(0)
    v_mfma_f32_16x16x32_bf16 v[64:67], a[240:243], v[188:191], v[64:67]
    v_mfma_f32_16x16x32_bf16 v[68:71], a[240:243], v[252:255], v[68:71]
    buffer_load_dwordx4 v2, s[52:55], s61 offen offset:3072 lds
    v_mfma_f32_16x16x32_bf16 v[72:75], a[244:247], v[188:191], v[72:75]
    v_mfma_f32_16x16x32_bf16 v[76:79], a[244:247], v[252:255], v[76:79]
    v_mfma_f32_16x16x32_bf16 v[80:83], a[248:251], v[188:191], v[80:83]
    v_mfma_f32_16x16x32_bf16 v[84:87], a[248:251], v[252:255], v[84:87]
    v_mfma_f32_16x16x32_bf16 v[88:91], a[252:255], v[188:191], v[88:91]
    v_mfma_f32_16x16x32_bf16 v[92:95], a[252:255], v[252:255], v[92:95]
    s_waitcnt vmcnt(24)
    s_barrier
    ds_read_b128 a[192:195], v10 offset:0
    ds_read_b128 a[196:199], v10 offset:1024
    ds_read_b128 a[200:203], v10 offset:2048
    ds_read_b128 a[204:207], v10 offset:3072
    ds_read_b128 a[208:211], v10 offset:4096
    ds_read_b128 a[212:215], v10 offset:5120
    ds_read_b128 a[216:219], v10 offset:6144
    ds_read_b128 a[220:223], v10 offset:7168
    ds_read_b128 a[224:227], v10 offset:8192
    ds_read_b128 a[228:231], v10 offset:9216
    ds_read_b128 a[232:235], v10 offset:10240
    ds_read_b128 a[236:239], v10 offset:11264
    ds_read_b128 a[240:243], v10 offset:12288
    ds_read_b128 a[244:247], v10 offset:13312
    ds_read_b128 a[248:251], v10 offset:14336
    ds_read_b128 a[252:255], v10 offset:15360
    s_waitcnt lgkmcnt(12)
    v_mfma_f32_16x16x32_bf16 v[32:35], a[192:195], v[128:131], v[32:35]
    v_cvt_pk_bf16_f32 v64, v64, v64
    v_lshlrev_b32 v64, 16, v64
    v_cvt_pk_bf16_f32 v80, v80, v80
    v_mfma_f32_16x16x32_bf16 v[36:39], a[192:195], v[192:195], v[36:39]
    v_lshlrev_b32 v80, 16, v80
    v_mul_f32 v20, 0xbfb8aa3b, v64
    v_exp_f32 v20, v20
    s_add_u32 s51, s81, 32768
    s_mov_b32 m0, s51
    s_add_u32 s61, s80, 163840
    buffer_load_dwordx4 v2, s[52:55], s61 offen offset:0 lds
    v_mfma_f32_16x16x32_bf16 v[40:43], a[196:199], v[128:131], v[40:43]
    v_add_f32 v20, 1.0, v20
    v_rcp_f32 v20, v20
    s_nop 0
    v_mul_f32 v64, v64, v20
    v_mfma_f32_16x16x32_bf16 v[44:47], a[196:199], v[192:195], v[44:47]
    v_cvt_pk_bf16_f32 v64, v64, v64
    v_lshlrev_b32 v64, 16, v64
    v_mul_f32 v64, v64, v80
    v_mfma_f32_16x16x32_bf16 v[48:51], a[200:203], v[128:131], v[48:51]
    v_cvt_pk_bf16_f32 v65, v65, v65
    v_lshlrev_b32 v65, 16, v65
    v_cvt_pk_bf16_f32 v81, v81, v81
    v_mfma_f32_16x16x32_bf16 v[52:55], a[200:203], v[192:195], v[52:55]
    v_lshlrev_b32 v81, 16, v81
    v_mul_f32 v21, 0xbfb8aa3b, v65
    v_exp_f32 v21, v21
    v_mfma_f32_16x16x32_bf16 v[56:59], a[204:207], v[128:131], v[56:59]
    v_add_f32 v21, 1.0, v21
    v_rcp_f32 v21, v21
    s_nop 0
    v_mul_f32 v65, v65, v21
    v_mfma_f32_16x16x32_bf16 v[60:63], a[204:207], v[192:195], v[60:63]
    v_cvt_pk_bf16_f32 v65, v65, v65
    v_lshlrev_b32 v65, 16, v65
    v_mul_f32 v65, v65, v81
    v_cvt_pk_bf16_f32 v66, v66, v66
    ds_read_b128 a[192:195], v10 offset:16384
    ds_read_b128 a[196:199], v10 offset:17408
    ds_read_b128 a[200:203], v10 offset:18432
    ds_read_b128 a[204:207], v10 offset:19456
    s_waitcnt lgkmcnt(12)
    v_mfma_f32_16x16x32_bf16 v[32:35], a[208:211], v[132:135], v[32:35]
    v_lshlrev_b32 v66, 16, v66
    v_cvt_pk_bf16_f32 v82, v82, v82
    v_lshlrev_b32 v82, 16, v82
    v_mfma_f32_16x16x32_bf16 v[36:39], a[208:211], v[196:199], v[36:39]
    v_mul_f32 v22, 0xbfb8aa3b, v66
    v_exp_f32 v22, v22
    s_nop 0
    v_add_f32 v22, 1.0, v22
    buffer_load_dwordx4 v2, s[52:55], s61 offen offset:1024 lds
    v_mfma_f32_16x16x32_bf16 v[40:43], a[212:215], v[132:135], v[40:43]
    v_rcp_f32 v22, v22
    s_nop 0
    v_mul_f32 v66, v66, v22
    v_cvt_pk_bf16_f32 v66, v66, v66
    v_mfma_f32_16x16x32_bf16 v[44:47], a[212:215], v[196:199], v[44:47]
    v_lshlrev_b32 v66, 16, v66
    v_mul_f32 v66, v66, v82
    v_cvt_pk_bf16_f32 v67, v67, v67
    v_mfma_f32_16x16x32_bf16 v[48:51], a[216:219], v[132:135], v[48:51]
    v_lshlrev_b32 v67, 16, v67
    v_cvt_pk_bf16_f32 v83, v83, v83
    v_lshlrev_b32 v83, 16, v83
    v_mfma_f32_16x16x32_bf16 v[52:55], a[216:219], v[196:199], v[52:55]
    v_mul_f32 v23, 0xbfb8aa3b, v67
    v_exp_f32 v23, v23
    s_nop 0
    v_add_f32 v23, 1.0, v23
    v_mfma_f32_16x16x32_bf16 v[56:59], a[220:223], v[132:135], v[56:59]
    v_rcp_f32 v23, v23
    s_nop 0
    v_mul_f32 v67, v67, v23
    v_cvt_pk_bf16_f32 v67, v67, v67
    v_mfma_f32_16x16x32_bf16 v[60:63], a[220:223], v[196:199], v[60:63]
    v_lshlrev_b32 v67, 16, v67
    v_mul_f32 v67, v67, v83
    v_cvt_pk_bf16_f32 v24, v64, v65
    v_cvt_pk_bf16_f32 v25, v66, v67
    ds_read_b128 a[208:211], v10 offset:20480
    ds_read_b128 a[212:215], v10 offset:21504
    ds_read_b128 a[216:219], v10 offset:22528
    ds_read_b128 a[220:223], v10 offset:23552
    s_waitcnt lgkmcnt(12)
    v_mfma_f32_16x16x32_bf16 v[32:35], a[224:227], v[136:139], v[32:35]
    v_cvt_pk_bf16_f32 v72, v72, v72
    v_lshlrev_b32 v72, 16, v72
    v_cvt_pk_bf16_f32 v88, v88, v88
    v_mfma_f32_16x16x32_bf16 v[36:39], a[224:227], v[200:203], v[36:39]
    v_lshlrev_b32 v88, 16, v88
    v_mul_f32 v20, 0xbfb8aa3b, v72
    v_exp_f32 v20, v20
    buffer_load_dwordx4 v2, s[52:55], s61 offen offset:2048 lds
    v_mfma_f32_16x16x32_bf16 v[40:43], a[228:231], v[136:139], v[40:43]
    v_add_f32 v20, 1.0, v20
    v_rcp_f32 v20, v20
    s_nop 0
    v_mul_f32 v72, v72, v20
    v_mfma_f32_16x16x32_bf16 v[44:47], a[228:231], v[200:203], v[44:47]
    v_cvt_pk_bf16_f32 v72, v72, v72
    v_lshlrev_b32 v72, 16, v72
    v_mul_f32 v72, v72, v88
    v_mfma_f32_16x16x32_bf16 v[48:51], a[232:235], v[136:139], v[48:51]
    v_cvt_pk_bf16_f32 v73, v73, v73
    v_lshlrev_b32 v73, 16, v73
    v_cvt_pk_bf16_f32 v89, v89, v89
    v_mfma_f32_16x16x32_bf16 v[52:55], a[232:235], v[200:203], v[52:55]
    v_lshlrev_b32 v89, 16, v89
    v_mul_f32 v21, 0xbfb8aa3b, v73
    v_exp_f32 v21, v21
    v_mfma_f32_16x16x32_bf16 v[56:59], a[236:239], v[136:139], v[56:59]
    v_add_f32 v21, 1.0, v21
    v_rcp_f32 v21, v21
    s_nop 0
    v_mul_f32 v73, v73, v21
    v_mfma_f32_16x16x32_bf16 v[60:63], a[236:239], v[200:203], v[60:63]
    v_cvt_pk_bf16_f32 v73, v73, v73
    v_lshlrev_b32 v73, 16, v73
    v_mul_f32 v73, v73, v89
    v_cvt_pk_bf16_f32 v74, v74, v74
    ds_read_b128 a[224:227], v10 offset:24576
    ds_read_b128 a[228:231], v10 offset:25600
    ds_read_b128 a[232:235], v10 offset:26624
    ds_read_b128 a[236:239], v10 offset:27648
    s_waitcnt lgkmcnt(12)
    v_mfma_f32_16x16x32_bf16 v[32:35], a[240:243], v[140:143], v[32:35]
    v_lshlrev_b32 v74, 16, v74
    v_cvt_pk_bf16_f32 v90, v90, v90
    v_lshlrev_b32 v90, 16, v90
    v_mfma_f32_16x16x32_bf16 v[36:39], a[240:243], v[204:207], v[36:39]
    v_mul_f32 v22, 0xbfb8aa3b, v74
    v_exp_f32 v22, v22
    s_nop 0
    v_add_f32 v22, 1.0, v22
    buffer_load_dwordx4 v2, s[52:55], s61 offen offset:3072 lds
    v_mfma_f32_16x16x32_bf16 v[40:43], a[244:247], v[140:143], v[40:43]
    v_rcp_f32 v22, v22
    s_nop 0
    v_mul_f32 v74, v74, v22
    v_cvt_pk_bf16_f32 v74, v74, v74
    v_mfma_f32_16x16x32_bf16 v[44:47], a[244:247], v[204:207], v[44:47]
    v_lshlrev_b32 v74, 16, v74
    v_mul_f32 v74, v74, v90
    v_cvt_pk_bf16_f32 v75, v75, v75
    v_mfma_f32_16x16x32_bf16 v[48:51], a[248:251], v[140:143], v[48:51]
    v_lshlrev_b32 v75, 16, v75
    v_cvt_pk_bf16_f32 v91, v91, v91
    v_lshlrev_b32 v91, 16, v91
    v_mfma_f32_16x16x32_bf16 v[52:55], a[248:251], v[204:207], v[52:55]
    v_mul_f32 v23, 0xbfb8aa3b, v75
    v_exp_f32 v23, v23
    s_nop 0
    v_add_f32 v23, 1.0, v23
    v_mfma_f32_16x16x32_bf16 v[56:59], a[252:255], v[140:143], v[56:59]
    v_rcp_f32 v23, v23
    s_nop 0
    v_mul_f32 v75, v75, v23
    v_cvt_pk_bf16_f32 v75, v75, v75
    v_mfma_f32_16x16x32_bf16 v[60:63], a[252:255], v[204:207], v[60:63]
    v_lshlrev_b32 v75, 16, v75
    v_mul_f32 v75, v75, v91
    v_cvt_pk_bf16_f32 v26, v72, v73
    v_cvt_pk_bf16_f32 v27, v74, v75
    ds_read_b128 a[240:243], v10 offset:28672
    ds_read_b128 a[244:247], v10 offset:29696
    ds_read_b128 a[248:251], v10 offset:30720
    ds_read_b128 a[252:255], v10 offset:31744
    s_waitcnt lgkmcnt(12)
    v_mfma_f32_16x16x32_bf16 v[32:35], a[192:195], v[144:147], v[32:35]
    v_cvt_pk_bf16_f32 v68, v68, v68
    v_lshlrev_b32 v68, 16, v68
    v_cvt_pk_bf16_f32 v84, v84, v84
    v_mfma_f32_16x16x32_bf16 v[36:39], a[192:195], v[208:211], v[36:39]
    v_lshlrev_b32 v84, 16, v84
    v_mul_f32 v20, 0xbfb8aa3b, v68
    v_exp_f32 v20, v20
    s_add_u32 s51, s81, 36864
    s_mov_b32 m0, s51
    s_add_u32 s61, s80, 167936
    buffer_load_dwordx4 v2, s[52:55], s61 offen offset:0 lds
    v_mfma_f32_16x16x32_bf16 v[40:43], a[196:199], v[144:147], v[40:43]
    v_add_f32 v20, 1.0, v20
    v_rcp_f32 v20, v20
    s_nop 0
    v_mul_f32 v68, v68, v20
    v_mfma_f32_16x16x32_bf16 v[44:47], a[196:199], v[208:211], v[44:47]
    v_cvt_pk_bf16_f32 v68, v68, v68
    v_lshlrev_b32 v68, 16, v68
    v_mul_f32 v68, v68, v84
    v_mfma_f32_16x16x32_bf16 v[48:51], a[200:203], v[144:147], v[48:51]
    v_cvt_pk_bf16_f32 v69, v69, v69
    v_lshlrev_b32 v69, 16, v69
    v_cvt_pk_bf16_f32 v85, v85, v85
    v_mfma_f32_16x16x32_bf16 v[52:55], a[200:203], v[208:211], v[52:55]
    v_lshlrev_b32 v85, 16, v85
    v_mul_f32 v21, 0xbfb8aa3b, v69
    v_exp_f32 v21, v21
    v_mfma_f32_16x16x32_bf16 v[56:59], a[204:207], v[144:147], v[56:59]
    v_add_f32 v21, 1.0, v21
    v_rcp_f32 v21, v21
    s_nop 0
    v_mul_f32 v69, v69, v21
    v_mfma_f32_16x16x32_bf16 v[60:63], a[204:207], v[208:211], v[60:63]
    v_cvt_pk_bf16_f32 v69, v69, v69
    v_lshlrev_b32 v69, 16, v69
    v_mul_f32 v69, v69, v85
    v_cvt_pk_bf16_f32 v70, v70, v70
    s_waitcnt lgkmcnt(8)
    v_mfma_f32_16x16x32_bf16 v[32:35], a[208:211], v[148:151], v[32:35]
    v_lshlrev_b32 v70, 16, v70
    v_cvt_pk_bf16_f32 v86, v86, v86
    v_lshlrev_b32 v86, 16, v86
    v_mfma_f32_16x16x32_bf16 v[36:39], a[208:211], v[212:215], v[36:39]
    v_mul_f32 v22, 0xbfb8aa3b, v70
    v_exp_f32 v22, v22
    s_nop 0
    v_add_f32 v22, 1.0, v22
    buffer_load_dwordx4 v2, s[52:55], s61 offen offset:1024 lds
    v_mfma_f32_16x16x32_bf16 v[40:43], a[212:215], v[148:151], v[40:43]
    v_rcp_f32 v22, v22
    s_nop 0
    v_mul_f32 v70, v70, v22
    v_cvt_pk_bf16_f32 v70, v70, v70
    v_mfma_f32_16x16x32_bf16 v[44:47], a[212:215], v[212:215], v[44:47]
    v_lshlrev_b32 v70, 16, v70
    v_mul_f32 v70, v70, v86
    v_cvt_pk_bf16_f32 v71, v71, v71
    v_mfma_f32_16x16x32_bf16 v[48:51], a[216:219], v[148:151], v[48:51]
    v_lshlrev_b32 v71, 16, v71
    v_cvt_pk_bf16_f32 v87, v87, v87
    v_lshlrev_b32 v87, 16, v87
    v_mfma_f32_16x16x32_bf16 v[52:55], a[216:219], v[212:215], v[52:55]
    v_mul_f32 v23, 0xbfb8aa3b, v71
    v_exp_f32 v23, v23
    s_nop 0
    v_add_f32 v23, 1.0, v23
    v_mfma_f32_16x16x32_bf16 v[56:59], a[220:223], v[148:151], v[56:59]
    v_rcp_f32 v23, v23
    s_nop 0
    v_mul_f32 v71, v71, v23
    v_cvt_pk_bf16_f32 v71, v71, v71
    v_mfma_f32_16x16x32_bf16 v[60:63], a[220:223], v[212:215], v[60:63]
    v_lshlrev_b32 v71, 16, v71
    v_mul_f32 v71, v71, v87
    v_cvt_pk_bf16_f32 v28, v68, v69
    v_cvt_pk_bf16_f32 v29, v70, v71
    s_waitcnt lgkmcnt(4)
    v_mfma_f32_16x16x32_bf16 v[32:35], a[224:227], v[152:155], v[32:35]
    v_cvt_pk_bf16_f32 v76, v76, v76
    v_lshlrev_b32 v76, 16, v76
    v_cvt_pk_bf16_f32 v92, v92, v92
    v_mfma_f32_16x16x32_bf16 v[36:39], a[224:227], v[216:219], v[36:39]
    v_lshlrev_b32 v92, 16, v92
    v_mul_f32 v20, 0xbfb8aa3b, v76
    v_exp_f32 v20, v20
    buffer_load_dwordx4 v2, s[52:55], s61 offen offset:2048 lds
    v_mfma_f32_16x16x32_bf16 v[40:43], a[228:231], v[152:155], v[40:43]
    v_add_f32 v20, 1.0, v20
    v_rcp_f32 v20, v20
    s_nop 0
    v_mul_f32 v76, v76, v20
    v_mfma_f32_16x16x32_bf16 v[44:47], a[228:231], v[216:219], v[44:47]
    v_cvt_pk_bf16_f32 v76, v76, v76
    v_lshlrev_b32 v76, 16, v76
    v_mul_f32 v76, v76, v92
    v_mfma_f32_16x16x32_bf16 v[48:51], a[232:235], v[152:155], v[48:51]
    v_cvt_pk_bf16_f32 v77, v77, v77
    v_lshlrev_b32 v77, 16, v77
    v_cvt_pk_bf16_f32 v93, v93, v93
    v_mfma_f32_16x16x32_bf16 v[52:55], a[232:235], v[216:219], v[52:55]
    v_lshlrev_b32 v93, 16, v93
    v_mul_f32 v21, 0xbfb8aa3b, v77
    v_exp_f32 v21, v21
    v_mfma_f32_16x16x32_bf16 v[56:59], a[236:239], v[152:155], v[56:59]
    v_add_f32 v21, 1.0, v21
    v_rcp_f32 v21, v21
    s_nop 0
    v_mul_f32 v77, v77, v21
    v_mfma_f32_16x16x32_bf16 v[60:63], a[236:239], v[216:219], v[60:63]
    v_cvt_pk_bf16_f32 v77, v77, v77
    v_lshlrev_b32 v77, 16, v77
    v_mul_f32 v77, v77, v93
    v_cvt_pk_bf16_f32 v78, v78, v78
    s_waitcnt lgkmcnt(0)
    v_mfma_f32_16x16x32_bf16 v[32:35], a[240:243], v[156:159], v[32:35]
    v_lshlrev_b32 v78, 16, v78
    v_cvt_pk_bf16_f32 v94, v94, v94
    v_lshlrev_b32 v94, 16, v94
    v_mfma_f32_16x16x32_bf16 v[36:39], a[240:243], v[220:223], v[36:39]
    v_mul_f32 v22, 0xbfb8aa3b, v78
    v_exp_f32 v22, v22
    s_nop 0
    v_add_f32 v22, 1.0, v22
    buffer_load_dwordx4 v2, s[52:55], s61 offen offset:3072 lds
    v_mfma_f32_16x16x32_bf16 v[40:43], a[244:247], v[156:159], v[40:43]
    v_rcp_f32 v22, v22
    s_nop 0
    v_mul_f32 v78, v78, v22
    v_cvt_pk_bf16_f32 v78, v78, v78
    v_mfma_f32_16x16x32_bf16 v[44:47], a[244:247], v[220:223], v[44:47]
    v_lshlrev_b32 v78, 16, v78
    v_mul_f32 v78, v78, v94
    v_cvt_pk_bf16_f32 v79, v79, v79
    v_mfma_f32_16x16x32_bf16 v[48:51], a[248:251], v[156:159], v[48:51]
    v_lshlrev_b32 v79, 16, v79
    v_cvt_pk_bf16_f32 v95, v95, v95
    v_lshlrev_b32 v95, 16, v95
    v_mfma_f32_16x16x32_bf16 v[52:55], a[248:251], v[220:223], v[52:55]
    v_mul_f32 v23, 0xbfb8aa3b, v79
    v_exp_f32 v23, v23
    s_nop 0
    v_add_f32 v23, 1.0, v23
    v_mfma_f32_16x16x32_bf16 v[56:59], a[252:255], v[156:159], v[56:59]
    v_rcp_f32 v23, v23
    s_nop 0
    v_mul_f32 v79, v79, v23
    v_cvt_pk_bf16_f32 v79, v79, v79
    v_mfma_f32_16x16x32_bf16 v[60:63], a[252:255], v[220:223], v[60:63]
    v_lshlrev_b32 v79, 16, v79
    v_mul_f32 v79, v79, v95
    v_cvt_pk_bf16_f32 v30, v76, v77
    v_cvt_pk_bf16_f32 v31, v78, v79
    s_add_u32 s60, s48, 0
    s_mul_i32 s60, s60, 43
    s_add_u32 s60, s60, s42
    s_add_u32 s60, s60, 0
    s_lshl_b32 s60, s60, 10
    buffer_store_dwordx4 v[24:27], v2, s[56:59], s60 offen sc0 sc1
    s_add_u32 s60, s48, 1
    s_mul_i32 s60, s60, 43
    s_add_u32 s60, s60, s42
    s_add_u32 s60, s60, 0
    s_lshl_b32 s60, s60, 10
    buffer_store_dwordx4 v[28:31], v2, s[56:59], s60 offen sc0 sc1
    v_mov_b32 v64, 0
    v_mov_b32 v65, 0
    v_mov_b32 v66, 0
    v_mov_b32 v67, 0
    v_mov_b32 v68, 0
    v_mov_b32 v69, 0
    v_mov_b32 v70, 0
    v_mov_b32 v71, 0
    v_mov_b32 v72, 0
    v_mov_b32 v73, 0
    v_mov_b32 v74, 0
    v_mov_b32 v75, 0
    v_mov_b32 v76, 0
    v_mov_b32 v77, 0
    v_mov_b32 v78, 0
    v_mov_b32 v79, 0
    v_mov_b32 v80, 0
    v_mov_b32 v81, 0
    v_mov_b32 v82, 0
    v_mov_b32 v83, 0
    v_mov_b32 v84, 0
    v_mov_b32 v85, 0
    v_mov_b32 v86, 0
    v_mov_b32 v87, 0
    v_mov_b32 v88, 0
    v_mov_b32 v89, 0
    v_mov_b32 v90, 0
    v_mov_b32 v91, 0
    v_mov_b32 v92, 0
    v_mov_b32 v93, 0
    v_mov_b32 v94, 0
    v_mov_b32 v95, 0
    s_waitcnt vmcnt(26)
    s_barrier
    ds_read_b128 a[192:195], v11 offset:0
    ds_read_b128 a[196:199], v11 offset:1024
    ds_read_b128 a[200:203], v11 offset:2048
    ds_read_b128 a[204:207], v11 offset:3072
    ds_read_b128 a[208:211], v11 offset:4096
    ds_read_b128 a[212:215], v11 offset:5120
    ds_read_b128 a[216:219], v11 offset:6144
    ds_read_b128 a[220:223], v11 offset:7168
    ds_read_b128 a[224:227], v11 offset:8192
    ds_read_b128 a[228:231], v11 offset:9216
    ds_read_b128 a[232:235], v11 offset:10240
    ds_read_b128 a[236:239], v11 offset:11264
    ds_read_b128 a[240:243], v11 offset:12288
    ds_read_b128 a[244:247], v11 offset:13312
    ds_read_b128 a[248:251], v11 offset:14336
    ds_read_b128 a[252:255], v11 offset:15360
    s_waitcnt lgkmcnt(12)
    v_mfma_f32_16x16x32_bf16 v[32:35], a[192:195], v[160:163], v[32:35]
    v_mfma_f32_16x16x32_bf16 v[36:39], a[192:195], v[224:227], v[36:39]
    s_add_u32 s63, s95, 32768
    buffer_load_dwordx4 a[32:35], v2, s[84:87], s63 offen offset:0
    v_mfma_f32_16x16x32_bf16 v[40:43], a[196:199], v[160:163], v[40:43]
    v_mfma_f32_16x16x32_bf16 v[44:47], a[196:199], v[224:227], v[44:47]
    v_mfma_f32_16x16x32_bf16 v[48:51], a[200:203], v[160:163], v[48:51]
    v_mfma_f32_16x16x32_bf16 v[52:55], a[200:203], v[224:227], v[52:55]
    buffer_load_dwordx4 a[36:39], v2, s[84:87], s63 offen offset:1024
    v_mfma_f32_16x16x32_bf16 v[56:59], a[204:207], v[160:163], v[56:59]
    v_mfma_f32_16x16x32_bf16 v[60:63], a[204:207], v[224:227], v[60:63]
    ds_read_b128 a[192:195], v11 offset:16384
    ds_read_b128 a[196:199], v11 offset:17408
    ds_read_b128 a[200:203], v11 offset:18432
    ds_read_b128 a[204:207], v11 offset:19456
    s_waitcnt lgkmcnt(12)
    v_mfma_f32_16x16x32_bf16 v[32:35], a[208:211], v[164:167], v[32:35]
    v_mfma_f32_16x16x32_bf16 v[36:39], a[208:211], v[228:231], v[36:39]
    buffer_load_dwordx4 a[40:43], v2, s[84:87], s63 offen offset:2048
    v_mfma_f32_16x16x32_bf16 v[40:43], a[212:215], v[164:167], v[40:43]
    v_mfma_f32_16x16x32_bf16 v[44:47], a[212:215], v[228:231], v[44:47]
    v_mfma_f32_16x16x32_bf16 v[48:51], a[216:219], v[164:167], v[48:51]
    v_mfma_f32_16x16x32_bf16 v[52:55], a[216:219], v[228:231], v[52:55]
    v_mfma_f32_16x16x32_bf16 v[56:59], a[220:223], v[164:167], v[56:59]
    v_mfma_f32_16x16x32_bf16 v[60:63], a[220:223], v[228:231], v[60:63]
    ds_read_b128 a[208:211], v11 offset:20480
    ds_read_b128 a[212:215], v11 offset:21504
    ds_read_b128 a[216:219], v11 offset:22528
    ds_read_b128 a[220:223], v11 offset:23552
    s_waitcnt lgkmcnt(12)
    v_mfma_f32_16x16x32_bf16 v[32:35], a[224:227], v[168:171], v[32:35]
    v_mfma_f32_16x16x32_bf16 v[36:39], a[224:227], v[232:235], v[36:39]
    buffer_load_dwordx4 a[44:47], v2, s[84:87], s63 offen offset:3072
    v_mfma_f32_16x16x32_bf16 v[40:43], a[228:231], v[168:171], v[40:43]
    v_mfma_f32_16x16x32_bf16 v[44:47], a[228:231], v[232:235], v[44:47]
    v_mfma_f32_16x16x32_bf16 v[48:51], a[232:235], v[168:171], v[48:51]
    v_mfma_f32_16x16x32_bf16 v[52:55], a[232:235], v[232:235], v[52:55]
    s_add_u32 s63, s95, 49152
    buffer_load_dwordx4 a[48:51], v2, s[84:87], s63 offen offset:0
    v_mfma_f32_16x16x32_bf16 v[56:59], a[236:239], v[168:171], v[56:59]
    v_mfma_f32_16x16x32_bf16 v[60:63], a[236:239], v[232:235], v[60:63]
    ds_read_b128 a[224:227], v11 offset:24576
    ds_read_b128 a[228:231], v11 offset:25600
    ds_read_b128 a[232:235], v11 offset:26624
    ds_read_b128 a[236:239], v11 offset:27648
    s_waitcnt lgkmcnt(12)
    v_mfma_f32_16x16x32_bf16 v[32:35], a[240:243], v[172:175], v[32:35]
    v_mfma_f32_16x16x32_bf16 v[36:39], a[240:243], v[236:239], v[36:39]
    buffer_load_dwordx4 a[52:55], v2, s[84:87], s63 offen offset:1024
    v_mfma_f32_16x16x32_bf16 v[40:43], a[244:247], v[172:175], v[40:43]
    v_mfma_f32_16x16x32_bf16 v[44:47], a[244:247], v[236:239], v[44:47]
    v_mfma_f32_16x16x32_bf16 v[48:51], a[248:251], v[172:175], v[48:51]
    v_mfma_f32_16x16x32_bf16 v[52:55], a[248:251], v[236:239], v[52:55]
    v_mfma_f32_16x16x32_bf16 v[56:59], a[252:255], v[172:175], v[56:59]
    v_mfma_f32_16x16x32_bf16 v[60:63], a[252:255], v[236:239], v[60:63]
    ds_read_b128 a[240:243], v11 offset:28672
    ds_read_b128 a[244:247], v11 offset:29696
    ds_read_b128 a[248:251], v11 offset:30720
    ds_read_b128 a[252:255], v11 offset:31744
    s_waitcnt lgkmcnt(12)
    v_mfma_f32_16x16x32_bf16 v[32:35], a[192:195], v[176:179], v[32:35]
    v_mfma_f32_16x16x32_bf16 v[36:39], a[192:195], v[240:243], v[36:39]
    buffer_load_dwordx4 a[56:59], v2, s[84:87], s63 offen offset:2048
    v_mfma_f32_16x16x32_bf16 v[40:43], a[196:199], v[176:179], v[40:43]
    v_mfma_f32_16x16x32_bf16 v[44:47], a[196:199], v[240:243], v[44:47]
    v_mfma_f32_16x16x32_bf16 v[48:51], a[200:203], v[176:179], v[48:51]
    v_mfma_f32_16x16x32_bf16 v[52:55], a[200:203], v[240:243], v[52:55]
    buffer_load_dwordx4 a[60:63], v2, s[84:87], s63 offen offset:3072
    v_mfma_f32_16x16x32_bf16 v[56:59], a[204:207], v[176:179], v[56:59]
    v_mfma_f32_16x16x32_bf16 v[60:63], a[204:207], v[240:243], v[60:63]
    s_waitcnt lgkmcnt(8)
    v_mfma_f32_16x16x32_bf16 v[32:35], a[208:211], v[180:183], v[32:35]
    v_mfma_f32_16x16x32_bf16 v[36:39], a[208:211], v[244:247], v[36:39]
    s_add_u32 s63, s95, 65536
    buffer_load_dwordx4 a[64:67], v2, s[84:87], s63 offen offset:0
    v_mfma_f32_16x16x32_bf16 v[40:43], a[212:215], v[180:183], v[40:43]
    v_mfma_f32_16x16x32_bf16 v[44:47], a[212:215], v[244:247], v[44:47]
    v_mfma_f32_16x16x32_bf16 v[48:51], a[216:219], v[180:183], v[48:51]
    v_mfma_f32_16x16x32_bf16 v[52:55], a[216:219], v[244:247], v[52:55]
    v_mfma_f32_16x16x32_bf16 v[56:59], a[220:223], v[180:183], v[56:59]
    v_mfma_f32_16x16x32_bf16 v[60:63], a[220:223], v[244:247], v[60:63]
    s_waitcnt lgkmcnt(4)
    v_mfma_f32_16x16x32_bf16 v[32:35], a[224:227], v[184:187], v[32:35]
    v_mfma_f32_16x16x32_bf16 v[36:39], a[224:227], v[248:251], v[36:39]
    buffer_load_dwordx4 a[68:71], v2, s[84:87], s63 offen offset:1024
    v_mfma_f32_16x16x32_bf16 v[40:43], a[228:231], v[184:187], v[40:43]
    v_mfma_f32_16x16x32_bf16 v[44:47], a[228:231], v[248:251], v[44:47]
    v_mfma_f32_16x16x32_bf16 v[48:51], a[232:235], v[184:187], v[48:51]
    v_mfma_f32_16x16x32_bf16 v[52:55], a[232:235], v[248:251], v[52:55]
    buffer_load_dwordx4 a[72:75], v2, s[84:87], s63 offen offset:2048
    v_mfma_f32_16x16x32_bf16 v[56:59], a[236:239], v[184:187], v[56:59]
    v_mfma_f32_16x16x32_bf16 v[60:63], a[236:239], v[248:251], v[60:63]
    s_waitcnt lgkmcnt(0)
    v_mfma_f32_16x16x32_bf16 v[32:35], a[240:243], v[188:191], v[32:35]
    v_mfma_f32_16x16x32_bf16 v[36:39], a[240:243], v[252:255], v[36:39]
    buffer_load_dwordx4 a[76:79], v2, s[84:87], s63 offen offset:3072
    v_mfma_f32_16x16x32_bf16 v[40:43], a[244:247], v[188:191], v[40:43]
    v_mfma_f32_16x16x32_bf16 v[44:47], a[244:247], v[252:255], v[44:47]
    v_mfma_f32_16x16x32_bf16 v[48:51], a[248:251], v[188:191], v[48:51]
    v_mfma_f32_16x16x32_bf16 v[52:55], a[248:251], v[252:255], v[52:55]
    v_mfma_f32_16x16x32_bf16 v[56:59], a[252:255], v[188:191], v[56:59]
    v_mfma_f32_16x16x32_bf16 v[60:63], a[252:255], v[252:255], v[60:63]
    s_waitcnt vmcnt(22)
    s_barrier
    ds_read_b128 a[192:195], v8 offset:0
    ds_read_b128 a[196:199], v8 offset:1024
    ds_read_b128 a[200:203], v8 offset:2048
    ds_read_b128 a[204:207], v8 offset:3072
    ds_read_b128 a[208:211], v8 offset:4096
    ds_read_b128 a[212:215], v8 offset:5120
    ds_read_b128 a[216:219], v8 offset:6144
    ds_read_b128 a[220:223], v8 offset:7168
    ds_read_b128 a[224:227], v8 offset:8192
    ds_read_b128 a[228:231], v8 offset:9216
    ds_read_b128 a[232:235], v8 offset:10240
    ds_read_b128 a[236:239], v8 offset:11264
    ds_read_b128 a[240:243], v8 offset:12288
    ds_read_b128 a[244:247], v8 offset:13312
    ds_read_b128 a[248:251], v8 offset:14336
    ds_read_b128 a[252:255], v8 offset:15360
    s_waitcnt lgkmcnt(12)
    v_mfma_f32_16x16x32_bf16 v[64:67], a[192:195], v[128:131], v[64:67]
    v_cvt_pk_bf16_f32 v32, v32, v32
    v_lshlrev_b32 v32, 16, v32
    v_cvt_pk_bf16_f32 v48, v48, v48
    v_mfma_f32_16x16x32_bf16 v[68:71], a[192:195], v[192:195], v[68:71]
    v_lshlrev_b32 v48, 16, v48
    v_mul_f32 v20, 0xbfb8aa3b, v32
    v_exp_f32 v20, v20
    s_add_u32 s63, s95, 81920
    buffer_load_dwordx4 a[80:83], v2, s[84:87], s63 offen offset:0
    v_mfma_f32_16x16x32_bf16 v[72:75], a[196:199], v[128:131], v[72:75]
    v_add_f32 v20, 1.0, v20
    v_rcp_f32 v20, v20
    s_nop 0
    v_mul_f32 v32, v32, v20
    v_mfma_f32_16x16x32_bf16 v[76:79], a[196:199], v[192:195], v[76:79]
    v_cvt_pk_bf16_f32 v32, v32, v32
    v_lshlrev_b32 v32, 16, v32
    v_mul_f32 v32, v32, v48
    v_mfma_f32_16x16x32_bf16 v[80:83], a[200:203], v[128:131], v[80:83]
    v_cvt_pk_bf16_f32 v33, v33, v33
    v_lshlrev_b32 v33, 16, v33
    v_cvt_pk_bf16_f32 v49, v49, v49
    v_mfma_f32_16x16x32_bf16 v[84:87], a[200:203], v[192:195], v[84:87]
    v_lshlrev_b32 v49, 16, v49
    v_mul_f32 v21, 0xbfb8aa3b, v33
    v_exp_f32 v21, v21
    buffer_load_dwordx4 a[84:87], v2, s[84:87], s63 offen offset:1024
    v_mfma_f32_16x16x32_bf16 v[88:91], a[204:207], v[128:131], v[88:91]
    v_add_f32 v21, 1.0, v21
    v_rcp_f32 v21, v21
    s_nop 0
    v_mul_f32 v33, v33, v21
    v_mfma_f32_16x16x32_bf16 v[92:95], a[204:207], v[192:195], v[92:95]
    v_cvt_pk_bf16_f32 v33, v33, v33
    v_lshlrev_b32 v33, 16, v33
    v_mul_f32 v33, v33, v49
    v_cvt_pk_bf16_f32 v34, v34, v34
    ds_read_b128 a[192:195], v8 offset:16384
    ds_read_b128 a[196:199], v8 offset:17408
    ds_read_b128 a[200:203], v8 offset:18432
    ds_read_b128 a[204:207], v8 offset:19456
    s_waitcnt lgkmcnt(12)
    v_mfma_f32_16x16x32_bf16 v[64:67], a[208:211], v[132:135], v[64:67]
    v_lshlrev_b32 v34, 16, v34
    v_cvt_pk_bf16_f32 v50, v50, v50
    v_lshlrev_b32 v50, 16, v50
    v_mfma_f32_16x16x32_bf16 v[68:71], a[208:211], v[196:199], v[68:71]
    v_mul_f32 v22, 0xbfb8aa3b, v34
    v_exp_f32 v22, v22
    s_nop 0
    v_add_f32 v22, 1.0, v22
    buffer_load_dwordx4 a[88:91], v2, s[84:87], s63 offen offset:2048
    v_mfma_f32_16x16x32_bf16 v[72:75], a[212:215], v[132:135], v[72:75]
    v_rcp_f32 v22, v22
    s_nop 0
    v_mul_f32 v34, v34, v22
    v_cvt_pk_bf16_f32 v34, v34, v34
    v_mfma_f32_16x16x32_bf16 v[76:79], a[212:215], v[196:199], v[76:79]
    v_lshlrev_b32 v34, 16, v34
    v_mul_f32 v34, v34, v50
    v_cvt_pk_bf16_f32 v35, v35, v35
    v_mfma_f32_16x16x32_bf16 v[80:83], a[216:219], v[132:135], v[80:83]
    v_lshlrev_b32 v35, 16, v35
    v_cvt_pk_bf16_f32 v51, v51, v51
    v_lshlrev_b32 v51, 16, v51
    v_mfma_f32_16x16x32_bf16 v[84:87], a[216:219], v[196:199], v[84:87]
    v_mul_f32 v23, 0xbfb8aa3b, v35
    v_exp_f32 v23, v23
    s_nop 0
    v_add_f32 v23, 1.0, v23
    v_mfma_f32_16x16x32_bf16 v[88:91], a[220:223], v[132:135], v[88:91]
    v_rcp_f32 v23, v23
    s_nop 0
    v_mul_f32 v35, v35, v23
    v_cvt_pk_bf16_f32 v35, v35, v35
    v_mfma_f32_16x16x32_bf16 v[92:95], a[220:223], v[196:199], v[92:95]
    v_lshlrev_b32 v35, 16, v35
    v_mul_f32 v35, v35, v51
    v_cvt_pk_bf16_f32 v24, v32, v33
    v_cvt_pk_bf16_f32 v25, v34, v35
    ds_read_b128 a[208:211], v8 offset:20480
    ds_read_b128 a[212:215], v8 offset:21504
    ds_read_b128 a[216:219], v8 offset:22528
    ds_read_b128 a[220:223], v8 offset:23552
    s_waitcnt lgkmcnt(12)
    v_mfma_f32_16x16x32_bf16 v[64:67], a[224:227], v[136:139], v[64:67]
    v_cvt_pk_bf16_f32 v40, v40, v40
    v_lshlrev_b32 v40, 16, v40
    v_cvt_pk_bf16_f32 v56, v56, v56
    v_mfma_f32_16x16x32_bf16 v[68:71], a[224:227], v[200:203], v[68:71]
    v_lshlrev_b32 v56, 16, v56
    v_mul_f32 v20, 0xbfb8aa3b, v40
    v_exp_f32 v20, v20
    buffer_load_dwordx4 a[92:95], v2, s[84:87], s63 offen offset:3072
    v_mfma_f32_16x16x32_bf16 v[72:75], a[228:231], v[136:139], v[72:75]
    v_add_f32 v20, 1.0, v20
    v_rcp_f32 v20, v20
    s_nop 0
    v_mul_f32 v40, v40, v20
    v_mfma_f32_16x16x32_bf16 v[76:79], a[228:231], v[200:203], v[76:79]
    v_cvt_pk_bf16_f32 v40, v40, v40
    v_lshlrev_b32 v40, 16, v40
    v_mul_f32 v40, v40, v56
    v_mfma_f32_16x16x32_bf16 v[80:83], a[232:235], v[136:139], v[80:83]
    v_cvt_pk_bf16_f32 v41, v41, v41
    v_lshlrev_b32 v41, 16, v41
    v_cvt_pk_bf16_f32 v57, v57, v57
    v_mfma_f32_16x16x32_bf16 v[84:87], a[232:235], v[200:203], v[84:87]
    v_lshlrev_b32 v57, 16, v57
    v_mul_f32 v21, 0xbfb8aa3b, v41
    v_exp_f32 v21, v21
    s_add_u32 s63, s95, 98304
    buffer_load_dwordx4 a[96:99], v2, s[84:87], s63 offen offset:0
    v_mfma_f32_16x16x32_bf16 v[88:91], a[236:239], v[136:139], v[88:91]
    v_add_f32 v21, 1.0, v21
    v_rcp_f32 v21, v21
    s_nop 0
    v_mul_f32 v41, v41, v21
    v_mfma_f32_16x16x32_bf16 v[92:95], a[236:239], v[200:203], v[92:95]
    v_cvt_pk_bf16_f32 v41, v41, v41
    v_lshlrev_b32 v41, 16, v41
    v_mul_f32 v41, v41, v57
    v_cvt_pk_bf16_f32 v42, v42, v42
    ds_read_b128 a[224:227], v8 offset:24576
    ds_read_b128 a[228:231], v8 offset:25600
    ds_read_b128 a[232:235], v8 offset:26624
    ds_read_b128 a[236:239], v8 offset:27648
    s_waitcnt lgkmcnt(12)
    v_mfma_f32_16x16x32_bf16 v[64:67], a[240:243], v[140:143], v[64:67]
    v_lshlrev_b32 v42, 16, v42
    v_cvt_pk_bf16_f32 v58, v58, v58
    v_lshlrev_b32 v58, 16, v58
    v_mfma_f32_16x16x32_bf16 v[68:71], a[240:243], v[204:207], v[68:71]
    v_mul_f32 v22, 0xbfb8aa3b, v42
    v_exp_f32 v22, v22
    s_nop 0
    v_add_f32 v22, 1.0, v22
    buffer_load_dwordx4 a[100:103], v2, s[84:87], s63 offen offset:1024
    v_mfma_f32_16x16x32_bf16 v[72:75], a[244:247], v[140:143], v[72:75]
    v_rcp_f32 v22, v22
    s_nop 0
    v_mul_f32 v42, v42, v22
    v_cvt_pk_bf16_f32 v42, v42, v42
    v_mfma_f32_16x16x32_bf16 v[76:79], a[244:247], v[204:207], v[76:79]
    v_lshlrev_b32 v42, 16, v42
    v_mul_f32 v42, v42, v58
    v_cvt_pk_bf16_f32 v43, v43, v43
    v_mfma_f32_16x16x32_bf16 v[80:83], a[248:251], v[140:143], v[80:83]
    v_lshlrev_b32 v43, 16, v43
    v_cvt_pk_bf16_f32 v59, v59, v59
    v_lshlrev_b32 v59, 16, v59
    v_mfma_f32_16x16x32_bf16 v[84:87], a[248:251], v[204:207], v[84:87]
    v_mul_f32 v23, 0xbfb8aa3b, v43
    v_exp_f32 v23, v23
    s_nop 0
    v_add_f32 v23, 1.0, v23
    v_mfma_f32_16x16x32_bf16 v[88:91], a[252:255], v[140:143], v[88:91]
    v_rcp_f32 v23, v23
    s_nop 0
    v_mul_f32 v43, v43, v23
    v_cvt_pk_bf16_f32 v43, v43, v43
    v_mfma_f32_16x16x32_bf16 v[92:95], a[252:255], v[204:207], v[92:95]
    v_lshlrev_b32 v43, 16, v43
    v_mul_f32 v43, v43, v59
    v_cvt_pk_bf16_f32 v26, v40, v41
    v_cvt_pk_bf16_f32 v27, v42, v43
    ds_read_b128 a[240:243], v8 offset:28672
    ds_read_b128 a[244:247], v8 offset:29696
    ds_read_b128 a[248:251], v8 offset:30720
    ds_read_b128 a[252:255], v8 offset:31744
    s_waitcnt lgkmcnt(12)
    v_mfma_f32_16x16x32_bf16 v[64:67], a[192:195], v[144:147], v[64:67]
    v_cvt_pk_bf16_f32 v36, v36, v36
    v_lshlrev_b32 v36, 16, v36
    v_cvt_pk_bf16_f32 v52, v52, v52
    v_mfma_f32_16x16x32_bf16 v[68:71], a[192:195], v[208:211], v[68:71]
    v_lshlrev_b32 v52, 16, v52
    v_mul_f32 v20, 0xbfb8aa3b, v36
    v_exp_f32 v20, v20
    buffer_load_dwordx4 a[104:107], v2, s[84:87], s63 offen offset:2048
    v_mfma_f32_16x16x32_bf16 v[72:75], a[196:199], v[144:147], v[72:75]
    v_add_f32 v20, 1.0, v20
    v_rcp_f32 v20, v20
    s_nop 0
    v_mul_f32 v36, v36, v20
    v_mfma_f32_16x16x32_bf16 v[76:79], a[196:199], v[208:211], v[76:79]
    v_cvt_pk_bf16_f32 v36, v36, v36
    v_lshlrev_b32 v36, 16, v36
    v_mul_f32 v36, v36, v52
    v_mfma_f32_16x16x32_bf16 v[80:83], a[200:203], v[144:147], v[80:83]
    v_cvt_pk_bf16_f32 v37, v37, v37
    v_lshlrev_b32 v37, 16, v37
    v_cvt_pk_bf16_f32 v53, v53, v53
    v_mfma_f32_16x16x32_bf16 v[84:87], a[200:203], v[208:211], v[84:87]
    v_lshlrev_b32 v53, 16, v53
    v_mul_f32 v21, 0xbfb8aa3b, v37
    v_exp_f32 v21, v21
    buffer_load_dwordx4 a[108:111], v2, s[84:87], s63 offen offset:3072
    v_mfma_f32_16x16x32_bf16 v[88:91], a[204:207], v[144:147], v[88:91]
    v_add_f32 v21, 1.0, v21
    v_rcp_f32 v21, v21
    s_nop 0
    v_mul_f32 v37, v37, v21
    v_mfma_f32_16x16x32_bf16 v[92:95], a[204:207], v[208:211], v[92:95]
    v_cvt_pk_bf16_f32 v37, v37, v37
    v_lshlrev_b32 v37, 16, v37
    v_mul_f32 v37, v37, v53
    v_cvt_pk_bf16_f32 v38, v38, v38
    s_waitcnt lgkmcnt(8)
    v_mfma_f32_16x16x32_bf16 v[64:67], a[208:211], v[148:151], v[64:67]
    v_lshlrev_b32 v38, 16, v38
    v_cvt_pk_bf16_f32 v54, v54, v54
    v_lshlrev_b32 v54, 16, v54
    v_mfma_f32_16x16x32_bf16 v[68:71], a[208:211], v[212:215], v[68:71]
    v_mul_f32 v22, 0xbfb8aa3b, v38
    v_exp_f32 v22, v22
    s_nop 0
    v_add_f32 v22, 1.0, v22
    s_add_u32 s63, s95, 114688
    buffer_load_dwordx4 a[112:115], v2, s[84:87], s63 offen offset:0
    v_mfma_f32_16x16x32_bf16 v[72:75], a[212:215], v[148:151], v[72:75]
    v_rcp_f32 v22, v22
    s_nop 0
    v_mul_f32 v38, v38, v22
    v_cvt_pk_bf16_f32 v38, v38, v38
    v_mfma_f32_16x16x32_bf16 v[76:79], a[212:215], v[212:215], v[76:79]
    v_lshlrev_b32 v38, 16, v38
    v_mul_f32 v38, v38, v54
    v_cvt_pk_bf16_f32 v39, v39, v39
    v_mfma_f32_16x16x32_bf16 v[80:83], a[216:219], v[148:151], v[80:83]
    v_lshlrev_b32 v39, 16, v39
    v_cvt_pk_bf16_f32 v55, v55, v55
    v_lshlrev_b32 v55, 16, v55
    v_mfma_f32_16x16x32_bf16 v[84:87], a[216:219], v[212:215], v[84:87]
    v_mul_f32 v23, 0xbfb8aa3b, v39
    v_exp_f32 v23, v23
    s_nop 0
    v_add_f32 v23, 1.0, v23
    v_mfma_f32_16x16x32_bf16 v[88:91], a[220:223], v[148:151], v[88:91]
    v_rcp_f32 v23, v23
    s_nop 0
    v_mul_f32 v39, v39, v23
    v_cvt_pk_bf16_f32 v39, v39, v39
    v_mfma_f32_16x16x32_bf16 v[92:95], a[220:223], v[212:215], v[92:95]
    v_lshlrev_b32 v39, 16, v39
    v_mul_f32 v39, v39, v55
    v_cvt_pk_bf16_f32 v28, v36, v37
    v_cvt_pk_bf16_f32 v29, v38, v39
    s_waitcnt lgkmcnt(4)
    v_mfma_f32_16x16x32_bf16 v[64:67], a[224:227], v[152:155], v[64:67]
    v_cvt_pk_bf16_f32 v44, v44, v44
    v_lshlrev_b32 v44, 16, v44
    v_cvt_pk_bf16_f32 v60, v60, v60
    v_mfma_f32_16x16x32_bf16 v[68:71], a[224:227], v[216:219], v[68:71]
    v_lshlrev_b32 v60, 16, v60
    v_mul_f32 v20, 0xbfb8aa3b, v44
    v_exp_f32 v20, v20
    buffer_load_dwordx4 a[116:119], v2, s[84:87], s63 offen offset:1024
    v_mfma_f32_16x16x32_bf16 v[72:75], a[228:231], v[152:155], v[72:75]
    v_add_f32 v20, 1.0, v20
    v_rcp_f32 v20, v20
    s_nop 0
    v_mul_f32 v44, v44, v20
    v_mfma_f32_16x16x32_bf16 v[76:79], a[228:231], v[216:219], v[76:79]
    v_cvt_pk_bf16_f32 v44, v44, v44
    v_lshlrev_b32 v44, 16, v44
    v_mul_f32 v44, v44, v60
    v_mfma_f32_16x16x32_bf16 v[80:83], a[232:235], v[152:155], v[80:83]
    v_cvt_pk_bf16_f32 v45, v45, v45
    v_lshlrev_b32 v45, 16, v45
    v_cvt_pk_bf16_f32 v61, v61, v61
    v_mfma_f32_16x16x32_bf16 v[84:87], a[232:235], v[216:219], v[84:87]
    v_lshlrev_b32 v61, 16, v61
    v_mul_f32 v21, 0xbfb8aa3b, v45
    v_exp_f32 v21, v21
    buffer_load_dwordx4 a[120:123], v2, s[84:87], s63 offen offset:2048
    v_mfma_f32_16x16x32_bf16 v[88:91], a[236:239], v[152:155], v[88:91]
    v_add_f32 v21, 1.0, v21
    v_rcp_f32 v21, v21
    s_nop 0
    v_mul_f32 v45, v45, v21
    v_mfma_f32_16x16x32_bf16 v[92:95], a[236:239], v[216:219], v[92:95]
    v_cvt_pk_bf16_f32 v45, v45, v45
    v_lshlrev_b32 v45, 16, v45
    v_mul_f32 v45, v45, v61
    v_cvt_pk_bf16_f32 v46, v46, v46
    s_waitcnt lgkmcnt(0)
    v_mfma_f32_16x16x32_bf16 v[64:67], a[240:243], v[156:159], v[64:67]
    v_lshlrev_b32 v46, 16, v46
    v_cvt_pk_bf16_f32 v62, v62, v62
    v_lshlrev_b32 v62, 16, v62
    v_mfma_f32_16x16x32_bf16 v[68:71], a[240:243], v[220:223], v[68:71]
    v_mul_f32 v22, 0xbfb8aa3b, v46
    v_exp_f32 v22, v22
    s_nop 0
    v_add_f32 v22, 1.0, v22
    buffer_load_dwordx4 a[124:127], v2, s[84:87], s63 offen offset:3072
    v_mfma_f32_16x16x32_bf16 v[72:75], a[244:247], v[156:159], v[72:75]
    v_rcp_f32 v22, v22
    s_nop 0
    v_mul_f32 v46, v46, v22
    v_cvt_pk_bf16_f32 v46, v46, v46
    v_mfma_f32_16x16x32_bf16 v[76:79], a[244:247], v[220:223], v[76:79]
    v_lshlrev_b32 v46, 16, v46
    v_mul_f32 v46, v46, v62
    v_cvt_pk_bf16_f32 v47, v47, v47
    v_mfma_f32_16x16x32_bf16 v[80:83], a[248:251], v[156:159], v[80:83]
    v_lshlrev_b32 v47, 16, v47
    v_cvt_pk_bf16_f32 v63, v63, v63
    v_lshlrev_b32 v63, 16, v63
    v_mfma_f32_16x16x32_bf16 v[84:87], a[248:251], v[220:223], v[84:87]
    v_mul_f32 v23, 0xbfb8aa3b, v47
    v_exp_f32 v23, v23
    s_nop 0
    v_add_f32 v23, 1.0, v23
    v_mfma_f32_16x16x32_bf16 v[88:91], a[252:255], v[156:159], v[88:91]
    v_rcp_f32 v23, v23
    s_nop 0
    v_mul_f32 v47, v47, v23
    v_cvt_pk_bf16_f32 v47, v47, v47
    v_mfma_f32_16x16x32_bf16 v[92:95], a[252:255], v[220:223], v[92:95]
    v_lshlrev_b32 v47, 16, v47
    v_mul_f32 v47, v47, v63
    v_cvt_pk_bf16_f32 v30, v44, v45
    v_cvt_pk_bf16_f32 v31, v46, v47
    s_add_u32 s60, s48, 0
    s_mul_i32 s60, s60, 43
    s_add_u32 s60, s60, s42
    s_add_u32 s60, s60, 1
    s_lshl_b32 s60, s60, 10
    buffer_store_dwordx4 v[24:27], v2, s[56:59], s60 offen sc0 sc1
    s_add_u32 s60, s48, 1
    s_mul_i32 s60, s60, 43
    s_add_u32 s60, s60, s42
    s_add_u32 s60, s60, 1
    s_lshl_b32 s60, s60, 10
    buffer_store_dwordx4 v[28:31], v2, s[56:59], s60 offen sc0 sc1
    v_mov_b32 v32, 0
    v_mov_b32 v33, 0
    v_mov_b32 v34, 0
    v_mov_b32 v35, 0
    v_mov_b32 v36, 0
    v_mov_b32 v37, 0
    v_mov_b32 v38, 0
    v_mov_b32 v39, 0
    v_mov_b32 v40, 0
    v_mov_b32 v41, 0
    v_mov_b32 v42, 0
    v_mov_b32 v43, 0
    v_mov_b32 v44, 0
    v_mov_b32 v45, 0
    v_mov_b32 v46, 0
    v_mov_b32 v47, 0
    v_mov_b32 v48, 0
    v_mov_b32 v49, 0
    v_mov_b32 v50, 0
    v_mov_b32 v51, 0
    v_mov_b32 v52, 0
    v_mov_b32 v53, 0
    v_mov_b32 v54, 0
    v_mov_b32 v55, 0
    v_mov_b32 v56, 0
    v_mov_b32 v57, 0
    v_mov_b32 v58, 0
    v_mov_b32 v59, 0
    v_mov_b32 v60, 0
    v_mov_b32 v61, 0
    v_mov_b32 v62, 0
    v_mov_b32 v63, 0
    s_waitcnt vmcnt(28)
    s_barrier
    ds_read_b128 a[192:195], v9 offset:0
    ds_read_b128 a[196:199], v9 offset:1024
    ds_read_b128 a[200:203], v9 offset:2048
    ds_read_b128 a[204:207], v9 offset:3072
    ds_read_b128 a[208:211], v9 offset:4096
    ds_read_b128 a[212:215], v9 offset:5120
    ds_read_b128 a[216:219], v9 offset:6144
    ds_read_b128 a[220:223], v9 offset:7168
    ds_read_b128 a[224:227], v9 offset:8192
    ds_read_b128 a[228:231], v9 offset:9216
    ds_read_b128 a[232:235], v9 offset:10240
    ds_read_b128 a[236:239], v9 offset:11264
    ds_read_b128 a[240:243], v9 offset:12288
    ds_read_b128 a[244:247], v9 offset:13312
    ds_read_b128 a[248:251], v9 offset:14336
    ds_read_b128 a[252:255], v9 offset:15360
    s_waitcnt lgkmcnt(12)
    v_mfma_f32_16x16x32_bf16 v[64:67], a[192:195], v[160:163], v[64:67]
    v_mfma_f32_16x16x32_bf16 v[68:71], a[192:195], v[224:227], v[68:71]
    s_add_u32 s63, s95, 131072
    buffer_load_dwordx4 a[128:131], v2, s[84:87], s63 offen offset:0
    v_mfma_f32_16x16x32_bf16 v[72:75], a[196:199], v[160:163], v[72:75]
    v_mfma_f32_16x16x32_bf16 v[76:79], a[196:199], v[224:227], v[76:79]
    v_mfma_f32_16x16x32_bf16 v[80:83], a[200:203], v[160:163], v[80:83]
    v_mfma_f32_16x16x32_bf16 v[84:87], a[200:203], v[224:227], v[84:87]
    buffer_load_dwordx4 a[132:135], v2, s[84:87], s63 offen offset:1024
    v_mfma_f32_16x16x32_bf16 v[88:91], a[204:207], v[160:163], v[88:91]
    v_mfma_f32_16x16x32_bf16 v[92:95], a[204:207], v[224:227], v[92:95]
    ds_read_b128 a[192:195], v9 offset:16384
    ds_read_b128 a[196:199], v9 offset:17408
    ds_read_b128 a[200:203], v9 offset:18432
    ds_read_b128 a[204:207], v9 offset:19456
    s_waitcnt lgkmcnt(12)
    v_mfma_f32_16x16x32_bf16 v[64:67], a[208:211], v[164:167], v[64:67]
    v_mfma_f32_16x16x32_bf16 v[68:71], a[208:211], v[228:231], v[68:71]
    buffer_load_dwordx4 a[136:139], v2, s[84:87], s63 offen offset:2048
    v_mfma_f32_16x16x32_bf16 v[72:75], a[212:215], v[164:167], v[72:75]
    v_mfma_f32_16x16x32_bf16 v[76:79], a[212:215], v[228:231], v[76:79]
    v_mfma_f32_16x16x32_bf16 v[80:83], a[216:219], v[164:167], v[80:83]
    v_mfma_f32_16x16x32_bf16 v[84:87], a[216:219], v[228:231], v[84:87]
    v_mfma_f32_16x16x32_bf16 v[88:91], a[220:223], v[164:167], v[88:91]
    v_mfma_f32_16x16x32_bf16 v[92:95], a[220:223], v[228:231], v[92:95]
    ds_read_b128 a[208:211], v9 offset:20480
    ds_read_b128 a[212:215], v9 offset:21504
    ds_read_b128 a[216:219], v9 offset:22528
    ds_read_b128 a[220:223], v9 offset:23552
    s_waitcnt lgkmcnt(12)
    v_mfma_f32_16x16x32_bf16 v[64:67], a[224:227], v[168:171], v[64:67]
    v_mfma_f32_16x16x32_bf16 v[68:71], a[224:227], v[232:235], v[68:71]
    buffer_load_dwordx4 a[140:143], v2, s[84:87], s63 offen offset:3072
    v_mfma_f32_16x16x32_bf16 v[72:75], a[228:231], v[168:171], v[72:75]
    v_mfma_f32_16x16x32_bf16 v[76:79], a[228:231], v[232:235], v[76:79]
    v_mfma_f32_16x16x32_bf16 v[80:83], a[232:235], v[168:171], v[80:83]
    v_mfma_f32_16x16x32_bf16 v[84:87], a[232:235], v[232:235], v[84:87]
    s_add_u32 s63, s95, 147456
    buffer_load_dwordx4 a[144:147], v2, s[84:87], s63 offen offset:0
    v_mfma_f32_16x16x32_bf16 v[88:91], a[236:239], v[168:171], v[88:91]
    v_mfma_f32_16x16x32_bf16 v[92:95], a[236:239], v[232:235], v[92:95]
    ds_read_b128 a[224:227], v9 offset:24576
    ds_read_b128 a[228:231], v9 offset:25600
    ds_read_b128 a[232:235], v9 offset:26624
    ds_read_b128 a[236:239], v9 offset:27648
    s_waitcnt lgkmcnt(12)
    v_mfma_f32_16x16x32_bf16 v[64:67], a[240:243], v[172:175], v[64:67]
    v_mfma_f32_16x16x32_bf16 v[68:71], a[240:243], v[236:239], v[68:71]
    buffer_load_dwordx4 a[148:151], v2, s[84:87], s63 offen offset:1024
    v_mfma_f32_16x16x32_bf16 v[72:75], a[244:247], v[172:175], v[72:75]
    v_mfma_f32_16x16x32_bf16 v[76:79], a[244:247], v[236:239], v[76:79]
    v_mfma_f32_16x16x32_bf16 v[80:83], a[248:251], v[172:175], v[80:83]
    v_mfma_f32_16x16x32_bf16 v[84:87], a[248:251], v[236:239], v[84:87]
    v_mfma_f32_16x16x32_bf16 v[88:91], a[252:255], v[172:175], v[88:91]
    v_mfma_f32_16x16x32_bf16 v[92:95], a[252:255], v[236:239], v[92:95]
    ds_read_b128 a[240:243], v9 offset:28672
    ds_read_b128 a[244:247], v9 offset:29696
    ds_read_b128 a[248:251], v9 offset:30720
    ds_read_b128 a[252:255], v9 offset:31744
    s_waitcnt lgkmcnt(12)
    v_mfma_f32_16x16x32_bf16 v[64:67], a[192:195], v[176:179], v[64:67]
    v_mfma_f32_16x16x32_bf16 v[68:71], a[192:195], v[240:243], v[68:71]
    buffer_load_dwordx4 a[152:155], v2, s[84:87], s63 offen offset:2048
    v_mfma_f32_16x16x32_bf16 v[72:75], a[196:199], v[176:179], v[72:75]
    v_mfma_f32_16x16x32_bf16 v[76:79], a[196:199], v[240:243], v[76:79]
    v_mfma_f32_16x16x32_bf16 v[80:83], a[200:203], v[176:179], v[80:83]
    v_mfma_f32_16x16x32_bf16 v[84:87], a[200:203], v[240:243], v[84:87]
    buffer_load_dwordx4 a[156:159], v2, s[84:87], s63 offen offset:3072
    v_mfma_f32_16x16x32_bf16 v[88:91], a[204:207], v[176:179], v[88:91]
    v_mfma_f32_16x16x32_bf16 v[92:95], a[204:207], v[240:243], v[92:95]
    s_waitcnt lgkmcnt(8)
    v_mfma_f32_16x16x32_bf16 v[64:67], a[208:211], v[180:183], v[64:67]
    v_mfma_f32_16x16x32_bf16 v[68:71], a[208:211], v[244:247], v[68:71]
    s_add_u32 s63, s95, 163840
    s_cmp_eq_u32 s50, 3
    s_cselect_b32 s63, 0x7f000000, s63
    buffer_load_dwordx4 a[160:163], v2, s[84:87], s63 offen offset:0
    v_mfma_f32_16x16x32_bf16 v[72:75], a[212:215], v[180:183], v[72:75]
    v_mfma_f32_16x16x32_bf16 v[76:79], a[212:215], v[244:247], v[76:79]
    v_mfma_f32_16x16x32_bf16 v[80:83], a[216:219], v[180:183], v[80:83]
    v_mfma_f32_16x16x32_bf16 v[84:87], a[216:219], v[244:247], v[84:87]
    v_mfma_f32_16x16x32_bf16 v[88:91], a[220:223], v[180:183], v[88:91]
    v_mfma_f32_16x16x32_bf16 v[92:95], a[220:223], v[244:247], v[92:95]
    s_waitcnt lgkmcnt(4)
    v_mfma_f32_16x16x32_bf16 v[64:67], a[224:227], v[184:187], v[64:67]
    v_mfma_f32_16x16x32_bf16 v[68:71], a[224:227], v[248:251], v[68:71]
    buffer_load_dwordx4 a[164:167], v2, s[84:87], s63 offen offset:1024
    v_mfma_f32_16x16x32_bf16 v[72:75], a[228:231], v[184:187], v[72:75]
    v_mfma_f32_16x16x32_bf16 v[76:79], a[228:231], v[248:251], v[76:79]
    v_mfma_f32_16x16x32_bf16 v[80:83], a[232:235], v[184:187], v[80:83]
    v_mfma_f32_16x16x32_bf16 v[84:87], a[232:235], v[248:251], v[84:87]
    buffer_load_dwordx4 a[168:171], v2, s[84:87], s63 offen offset:2048
    v_mfma_f32_16x16x32_bf16 v[88:91], a[236:239], v[184:187], v[88:91]
    v_mfma_f32_16x16x32_bf16 v[92:95], a[236:239], v[248:251], v[92:95]
    s_waitcnt lgkmcnt(0)
    v_mfma_f32_16x16x32_bf16 v[64:67], a[240:243], v[188:191], v[64:67]
    v_mfma_f32_16x16x32_bf16 v[68:71], a[240:243], v[252:255], v[68:71]
    buffer_load_dwordx4 a[172:175], v2, s[84:87], s63 offen offset:3072
    v_mfma_f32_16x16x32_bf16 v[72:75], a[244:247], v[188:191], v[72:75]
    v_mfma_f32_16x16x32_bf16 v[76:79], a[244:247], v[252:255], v[76:79]
    v_mfma_f32_16x16x32_bf16 v[80:83], a[248:251], v[188:191], v[80:83]
    v_mfma_f32_16x16x32_bf16 v[84:87], a[248:251], v[252:255], v[84:87]
    v_mfma_f32_16x16x32_bf16 v[88:91], a[252:255], v[188:191], v[88:91]
    v_mfma_f32_16x16x32_bf16 v[92:95], a[252:255], v[252:255], v[92:95]
    v_cvt_pk_bf16_f32 v64, v64, v64
    v_lshlrev_b32 v64, 16, v64
    s_nop 2
    v_cvt_pk_bf16_f32 v80, v80, v80
    v_lshlrev_b32 v80, 16, v80
    v_mul_f32 v20, 0xbfb8aa3b, v64
    v_exp_f32 v20, v20
    s_nop 0
    v_add_f32 v20, 1.0, v20
    v_rcp_f32 v20, v20
    s_nop 0
    v_mul_f32 v64, v64, v20
    v_cvt_pk_bf16_f32 v64, v64, v64
    v_lshlrev_b32 v64, 16, v64
    v_mul_f32 v64, v64, v80
    v_cvt_pk_bf16_f32 v65, v65, v65
    v_lshlrev_b32 v65, 16, v65
    v_cvt_pk_bf16_f32 v81, v81, v81
    v_lshlrev_b32 v81, 16, v81
    v_mul_f32 v21, 0xbfb8aa3b, v65
    v_exp_f32 v21, v21
    s_nop 0
    v_add_f32 v21, 1.0, v21
    v_rcp_f32 v21, v21
    s_nop 0
    v_mul_f32 v65, v65, v21
    v_cvt_pk_bf16_f32 v65, v65, v65
    v_lshlrev_b32 v65, 16, v65
    v_mul_f32 v65, v65, v81
    v_cvt_pk_bf16_f32 v66, v66, v66
    v_lshlrev_b32 v66, 16, v66
    v_cvt_pk_bf16_f32 v82, v82, v82
    v_lshlrev_b32 v82, 16, v82
    v_mul_f32 v22, 0xbfb8aa3b, v66
    v_exp_f32 v22, v22
    s_nop 0
    v_add_f32 v22, 1.0, v22
    v_rcp_f32 v22, v22
    s_nop 0
    v_mul_f32 v66, v66, v22
    v_cvt_pk_bf16_f32 v66, v66, v66
    v_lshlrev_b32 v66, 16, v66
    v_mul_f32 v66, v66, v82
    v_cvt_pk_bf16_f32 v67, v67, v67
    v_lshlrev_b32 v67, 16, v67
    v_cvt_pk_bf16_f32 v83, v83, v83
    v_lshlrev_b32 v83, 16, v83
    v_mul_f32 v23, 0xbfb8aa3b, v67
    v_exp_f32 v23, v23
    s_nop 0
    v_add_f32 v23, 1.0, v23
    v_rcp_f32 v23, v23
    s_nop 0
    v_mul_f32 v67, v67, v23
    v_cvt_pk_bf16_f32 v67, v67, v67
    v_lshlrev_b32 v67, 16, v67
    v_mul_f32 v67, v67, v83
    v_cvt_pk_bf16_f32 v24, v64, v65
    v_cvt_pk_bf16_f32 v25, v66, v67
    v_cvt_pk_bf16_f32 v72, v72, v72
    v_lshlrev_b32 v72, 16, v72
    v_cvt_pk_bf16_f32 v88, v88, v88
    v_lshlrev_b32 v88, 16, v88
    v_mul_f32 v20, 0xbfb8aa3b, v72
    v_exp_f32 v20, v20
    s_nop 0
    v_add_f32 v20, 1.0, v20
    v_rcp_f32 v20, v20
    s_nop 0
    v_mul_f32 v72, v72, v20
    v_cvt_pk_bf16_f32 v72, v72, v72
    v_lshlrev_b32 v72, 16, v72
    v_mul_f32 v72, v72, v88
    v_cvt_pk_bf16_f32 v73, v73, v73
    v_lshlrev_b32 v73, 16, v73
    v_cvt_pk_bf16_f32 v89, v89, v89
    v_lshlrev_b32 v89, 16, v89
    v_mul_f32 v21, 0xbfb8aa3b, v73
    v_exp_f32 v21, v21
    s_nop 0
    v_add_f32 v21, 1.0, v21
    v_rcp_f32 v21, v21
    s_nop 0
    v_mul_f32 v73, v73, v21
    v_cvt_pk_bf16_f32 v73, v73, v73
    v_lshlrev_b32 v73, 16, v73
    v_mul_f32 v73, v73, v89
    v_cvt_pk_bf16_f32 v74, v74, v74
    v_lshlrev_b32 v74, 16, v74
    v_cvt_pk_bf16_f32 v90, v90, v90
    v_lshlrev_b32 v90, 16, v90
    v_mul_f32 v22, 0xbfb8aa3b, v74
    v_exp_f32 v22, v22
    s_nop 0
    v_add_f32 v22, 1.0, v22
    v_rcp_f32 v22, v22
    s_nop 0
    v_mul_f32 v74, v74, v22
    v_cvt_pk_bf16_f32 v74, v74, v74
    v_lshlrev_b32 v74, 16, v74
    v_mul_f32 v74, v74, v90
    v_cvt_pk_bf16_f32 v75, v75, v75
    v_lshlrev_b32 v75, 16, v75
    v_cvt_pk_bf16_f32 v91, v91, v91
    v_lshlrev_b32 v91, 16, v91
    v_mul_f32 v23, 0xbfb8aa3b, v75
    v_exp_f32 v23, v23
    s_nop 0
    v_add_f32 v23, 1.0, v23
    v_rcp_f32 v23, v23
    s_nop 0
    v_mul_f32 v75, v75, v23
    v_cvt_pk_bf16_f32 v75, v75, v75
    v_lshlrev_b32 v75, 16, v75
    v_mul_f32 v75, v75, v91
    v_cvt_pk_bf16_f32 v26, v72, v73
    v_cvt_pk_bf16_f32 v27, v74, v75
    v_cvt_pk_bf16_f32 v68, v68, v68
    v_lshlrev_b32 v68, 16, v68
    v_cvt_pk_bf16_f32 v84, v84, v84
    v_lshlrev_b32 v84, 16, v84
    v_mul_f32 v20, 0xbfb8aa3b, v68
    v_exp_f32 v20, v20
    s_nop 0
    v_add_f32 v20, 1.0, v20
    v_rcp_f32 v20, v20
    s_nop 0
    v_mul_f32 v68, v68, v20
    v_cvt_pk_bf16_f32 v68, v68, v68
    v_lshlrev_b32 v68, 16, v68
    v_mul_f32 v68, v68, v84
    v_cvt_pk_bf16_f32 v69, v69, v69
    v_lshlrev_b32 v69, 16, v69
    v_cvt_pk_bf16_f32 v85, v85, v85
    v_lshlrev_b32 v85, 16, v85
    v_mul_f32 v21, 0xbfb8aa3b, v69
    v_exp_f32 v21, v21
    s_nop 0
    v_add_f32 v21, 1.0, v21
    v_rcp_f32 v21, v21
    s_nop 0
    v_mul_f32 v69, v69, v21
    v_cvt_pk_bf16_f32 v69, v69, v69
    v_lshlrev_b32 v69, 16, v69
    v_mul_f32 v69, v69, v85
    v_cvt_pk_bf16_f32 v70, v70, v70
    v_lshlrev_b32 v70, 16, v70
    v_cvt_pk_bf16_f32 v86, v86, v86
    v_lshlrev_b32 v86, 16, v86
    v_mul_f32 v22, 0xbfb8aa3b, v70
    v_exp_f32 v22, v22
    s_nop 0
    v_add_f32 v22, 1.0, v22
    v_rcp_f32 v22, v22
    s_nop 0
    v_mul_f32 v70, v70, v22
    v_cvt_pk_bf16_f32 v70, v70, v70
    v_lshlrev_b32 v70, 16, v70
    v_mul_f32 v70, v70, v86
    v_cvt_pk_bf16_f32 v71, v71, v71
    v_lshlrev_b32 v71, 16, v71
    v_cvt_pk_bf16_f32 v87, v87, v87
    v_lshlrev_b32 v87, 16, v87
    v_mul_f32 v23, 0xbfb8aa3b, v71
    v_exp_f32 v23, v23
    s_nop 0
    v_add_f32 v23, 1.0, v23
    v_rcp_f32 v23, v23
    s_nop 0
    v_mul_f32 v71, v71, v23
    v_cvt_pk_bf16_f32 v71, v71, v71
    v_lshlrev_b32 v71, 16, v71
    v_mul_f32 v71, v71, v87
    v_cvt_pk_bf16_f32 v28, v68, v69
    v_cvt_pk_bf16_f32 v29, v70, v71
    v_cvt_pk_bf16_f32 v76, v76, v76
    v_lshlrev_b32 v76, 16, v76
    v_cvt_pk_bf16_f32 v92, v92, v92
    v_lshlrev_b32 v92, 16, v92
    v_mul_f32 v20, 0xbfb8aa3b, v76
    v_exp_f32 v20, v20
    s_nop 0
    v_add_f32 v20, 1.0, v20
    v_rcp_f32 v20, v20
    s_nop 0
    v_mul_f32 v76, v76, v20
    v_cvt_pk_bf16_f32 v76, v76, v76
    v_lshlrev_b32 v76, 16, v76
    v_mul_f32 v76, v76, v92
    v_cvt_pk_bf16_f32 v77, v77, v77
    v_lshlrev_b32 v77, 16, v77
    v_cvt_pk_bf16_f32 v93, v93, v93
    v_lshlrev_b32 v93, 16, v93
    v_mul_f32 v21, 0xbfb8aa3b, v77
    v_exp_f32 v21, v21
    s_nop 0
    v_add_f32 v21, 1.0, v21
    v_rcp_f32 v21, v21
    s_nop 0
    v_mul_f32 v77, v77, v21
    v_cvt_pk_bf16_f32 v77, v77, v77
    v_lshlrev_b32 v77, 16, v77
    v_mul_f32 v77, v77, v93
    v_cvt_pk_bf16_f32 v78, v78, v78
    v_lshlrev_b32 v78, 16, v78
    v_cvt_pk_bf16_f32 v94, v94, v94
    v_lshlrev_b32 v94, 16, v94
    v_mul_f32 v22, 0xbfb8aa3b, v78
    v_exp_f32 v22, v22
    s_nop 0
    v_add_f32 v22, 1.0, v22
    v_rcp_f32 v22, v22
    s_nop 0
    v_mul_f32 v78, v78, v22
    v_cvt_pk_bf16_f32 v78, v78, v78
    v_lshlrev_b32 v78, 16, v78
    v_mul_f32 v78, v78, v94
    v_cvt_pk_bf16_f32 v79, v79, v79
    v_lshlrev_b32 v79, 16, v79
    v_cvt_pk_bf16_f32 v95, v95, v95
    v_lshlrev_b32 v95, 16, v95
    v_mul_f32 v23, 0xbfb8aa3b, v79
    v_exp_f32 v23, v23
    s_nop 0
    v_add_f32 v23, 1.0, v23
    v_rcp_f32 v23, v23
    s_nop 0
    v_mul_f32 v79, v79, v23
    v_cvt_pk_bf16_f32 v79, v79, v79
    v_lshlrev_b32 v79, 16, v79
    v_mul_f32 v79, v79, v95
    v_cvt_pk_bf16_f32 v30, v76, v77
    v_cvt_pk_bf16_f32 v31, v78, v79
    s_add_u32 s60, s48, 0
    s_mul_i32 s60, s60, 43
    s_add_u32 s60, s60, s42
    s_add_u32 s60, s60, 2
    s_lshl_b32 s60, s60, 10
    buffer_store_dwordx4 v[24:27], v2, s[56:59], s60 offen sc0 sc1
    s_add_u32 s60, s48, 1
    s_mul_i32 s60, s60, 43
    s_add_u32 s60, s60, s42
    s_add_u32 s60, s60, 2
    s_lshl_b32 s60, s60, 10
    buffer_store_dwordx4 v[28:31], v2, s[56:59], s60 offen sc0 sc1
    s_branch ffn2_kernel_g2
ffn2_kernel_two:
    s_add_u32 s51, s81, 0
    s_mov_b32 m0, s51
    s_add_u32 s61, s80, 0
    buffer_load_dwordx4 v2, s[52:55], s61 offen offset:0 lds
    buffer_load_dwordx4 v2, s[52:55], s61 offen offset:1024 lds
    buffer_load_dwordx4 v2, s[52:55], s61 offen offset:2048 lds
    buffer_load_dwordx4 v2, s[52:55], s61 offen offset:3072 lds
    s_add_u32 s51, s81, 4096
    s_mov_b32 m0, s51
    s_add_u32 s61, s80, 4096
    buffer_load_dwordx4 v2, s[52:55], s61 offen offset:0 lds
    buffer_load_dwordx4 v2, s[52:55], s61 offen offset:1024 lds
    buffer_load_dwordx4 v2, s[52:55], s61 offen offset:2048 lds
    buffer_load_dwordx4 v2, s[52:55], s61 offen offset:3072 lds
    s_add_u32 s51, s49, 0
    buffer_load_dwordx4 v[128:131], v2, s[44:47], s51 offen
    s_add_u32 s51, s49, 1024
    buffer_load_dwordx4 v[132:135], v2, s[44:47], s51 offen
    s_add_u32 s51, s49, 2048
    buffer_load_dwordx4 v[136:139], v2, s[44:47], s51 offen
    s_add_u32 s51, s49, 3072
    buffer_load_dwordx4 v[140:143], v2, s[44:47], s51 offen
    s_add_u32 s51, s49, 4096
    buffer_load_dwordx4 v[144:147], v2, s[44:47], s51 offen
    s_add_u32 s51, s49, 5120
    buffer_load_dwordx4 v[148:151], v2, s[44:47], s51 offen
    s_add_u32 s51, s49, 6144
    buffer_load_dwordx4 v[152:155], v2, s[44:47], s51 offen
    s_add_u32 s51, s49, 7168
    buffer_load_dwordx4 v[156:159], v2, s[44:47], s51 offen
    s_add_u32 s51, s49, 8192
    buffer_load_dwordx4 v[160:163], v2, s[44:47], s51 offen
    s_add_u32 s51, s49, 9216
    buffer_load_dwordx4 v[164:167], v2, s[44:47], s51 offen
    s_add_u32 s51, s49, 10240
    buffer_load_dwordx4 v[168:171], v2, s[44:47], s51 offen
    s_add_u32 s51, s49, 11264
    buffer_load_dwordx4 v[172:175], v2, s[44:47], s51 offen
    s_add_u32 s51, s49, 12288
    buffer_load_dwordx4 v[176:179], v2, s[44:47], s51 offen
    s_add_u32 s51, s49, 13312
    buffer_load_dwordx4 v[180:183], v2, s[44:47], s51 offen
    s_add_u32 s51, s49, 14336
    buffer_load_dwordx4 v[184:187], v2, s[44:47], s51 offen
    s_add_u32 s51, s49, 15360
    buffer_load_dwordx4 v[188:191], v2, s[44:47], s51 offen
    s_add_u32 s51, s49, 16384
    buffer_load_dwordx4 v[192:195], v2, s[44:47], s51 offen
    s_add_u32 s51, s49, 17408
    buffer_load_dwordx4 v[196:199], v2, s[44:47], s51 offen
    s_add_u32 s51, s49, 18432
    buffer_load_dwordx4 v[200:203], v2, s[44:47], s51 offen
    s_add_u32 s51, s49, 19456
    buffer_load_dwordx4 v[204:207], v2, s[44:47], s51 offen
    s_add_u32 s51, s49, 20480
    buffer_load_dwordx4 v[208:211], v2, s[44:47], s51 offen
    s_add_u32 s51, s49, 21504
    buffer_load_dwordx4 v[212:215], v2, s[44:47], s51 offen
    s_add_u32 s51, s49, 22528
    buffer_load_dwordx4 v[216:219], v2, s[44:47], s51 offen
    s_add_u32 s51, s49, 23552
    buffer_load_dwordx4 v[220:223], v2, s[44:47], s51 offen
    s_add_u32 s51, s49, 24576
    buffer_load_dwordx4 v[224:227], v2, s[44:47], s51 offen
    s_add_u32 s51, s49, 25600
    buffer_load_dwordx4 v[228:231], v2, s[44:47], s51 offen
    s_add_u32 s51, s49, 26624
    buffer_load_dwordx4 v[232:235], v2, s[44:47], s51 offen
    s_add_u32 s51, s49, 27648
    buffer_load_dwordx4 v[236:239], v2, s[44:47], s51 offen
    s_add_u32 s51, s49, 28672
    buffer_load_dwordx4 v[240:243], v2, s[44:47], s51 offen
    s_add_u32 s51, s49, 29696
    buffer_load_dwordx4 v[244:247], v2, s[44:47], s51 offen
    s_add_u32 s51, s49, 30720
    buffer_load_dwordx4 v[248:251], v2, s[44:47], s51 offen
    s_add_u32 s51, s49, 31744
    buffer_load_dwordx4 v[252:255], v2, s[44:47], s51 offen
    s_add_u32 s51, s81, 32768
    s_mov_b32 m0, s51
    s_add_u32 s61, s80, 32768
    buffer_load_dwordx4 v2, s[52:55], s61 offen offset:0 lds
    buffer_load_dwordx4 v2, s[52:55], s61 offen offset:1024 lds
    buffer_load_dwordx4 v2, s[52:55], s61 offen offset:2048 lds
    buffer_load_dwordx4 v2, s[52:55], s61 offen offset:3072 lds
    s_add_u32 s51, s81, 36864
    s_mov_b32 m0, s51
    s_add_u32 s61, s80, 36864
    buffer_load_dwordx4 v2, s[52:55], s61 offen offset:0 lds
    buffer_load_dwordx4 v2, s[52:55], s61 offen offset:1024 lds
    buffer_load_dwordx4 v2, s[52:55], s61 offen offset:2048 lds
    buffer_load_dwordx4 v2, s[52:55], s61 offen offset:3072 lds
    s_add_u32 s51, s81, 65536
    s_mov_b32 m0, s51
    s_add_u32 s61, s80, 65536
    buffer_load_dwordx4 v2, s[52:55], s61 offen offset:0 lds
    buffer_load_dwordx4 v2, s[52:55], s61 offen offset:1024 lds
    buffer_load_dwordx4 v2, s[52:55], s61 offen offset:2048 lds
    buffer_load_dwordx4 v2, s[52:55], s61 offen offset:3072 lds
    s_add_u32 s51, s81, 69632
    s_mov_b32 m0, s51
    s_add_u32 s61, s80, 69632
    buffer_load_dwordx4 v2, s[52:55], s61 offen offset:0 lds
    buffer_load_dwordx4 v2, s[52:55], s61 offen offset:1024 lds
    buffer_load_dwordx4 v2, s[52:55], s61 offen offset:2048 lds
    buffer_load_dwordx4 v2, s[52:55], s61 offen offset:3072 lds
    s_add_u32 s51, s81, 98304
    s_mov_b32 m0, s51
    s_add_u32 s61, s80, 98304
    buffer_load_dwordx4 v2, s[52:55], s61 offen offset:0 lds
    buffer_load_dwordx4 v2, s[52:55], s61 offen offset:1024 lds
    buffer_load_dwordx4 v2, s[52:55], s61 offen offset:2048 lds
    buffer_load_dwordx4 v2, s[52:55], s61 offen offset:3072 lds
    s_add_u32 s51, s81, 102400
    s_mov_b32 m0, s51
    s_add_u32 s61, s80, 102400
    buffer_load_dwordx4 v2, s[52:55], s61 offen offset:0 lds
    buffer_load_dwordx4 v2, s[52:55], s61 offen offset:1024 lds
    buffer_load_dwordx4 v2, s[52:55], s61 offen offset:2048 lds
    buffer_load_dwordx4 v2, s[52:55], s61 offen offset:3072 lds
    v_mov_b32 v64, 0
    v_mov_b32 v65, 0
    v_mov_b32 v66, 0
    v_mov_b32 v67, 0
    v_mov_b32 v68, 0
    v_mov_b32 v69, 0
    v_mov_b32 v70, 0
    v_mov_b32 v71, 0
    v_mov_b32 v72, 0
    v_mov_b32 v73, 0
    v_mov_b32 v74, 0
    v_mov_b32 v75, 0
    v_mov_b32 v76, 0
    v_mov_b32 v77, 0
    v_mov_b32 v78, 0
    v_mov_b32 v79, 0
    v_mov_b32 v80, 0
    v_mov_b32 v81, 0
    v_mov_b32 v82, 0
    v_mov_b32 v83, 0
    v_mov_b32 v84, 0
    v_mov_b32 v85, 0
    v_mov_b32 v86, 0
    v_mov_b32 v87, 0
    v_mov_b32 v88, 0
    v_mov_b32 v89, 0
    v_mov_b32 v90, 0
    v_mov_b32 v91, 0
    v_mov_b32 v92, 0
    v_mov_b32 v93, 0
    v_mov_b32 v94, 0
    v_mov_b32 v95, 0
    v_mov_b32 v32, 0
    v_mov_b32 v33, 0
    v_mov_b32 v34, 0
    v_mov_b32 v35, 0
    v_mov_b32 v36, 0
    v_mov_b32 v37, 0
    v_mov_b32 v38, 0
    v_mov_b32 v39, 0
    v_mov_b32 v40, 0
    v_mov_b32 v41, 0
    v_mov_b32 v42, 0
    v_mov_b32 v43, 0
    v_mov_b32 v44, 0
    v_mov_b32 v45, 0
    v_mov_b32 v46, 0
    v_mov_b32 v47, 0
    v_mov_b32 v48, 0
    v_mov_b32 v49, 0
    v_mov_b32 v50, 0
    v_mov_b32 v51, 0
    v_mov_b32 v52, 0
    v_mov_b32 v53, 0
    v_mov_b32 v54, 0
    v_mov_b32 v55, 0
    v_mov_b32 v56, 0
    v_mov_b32 v57, 0
    v_mov_b32 v58, 0
    v_mov_b32 v59, 0
    v_mov_b32 v60, 0
    v_mov_b32 v61, 0
    v_mov_b32 v62, 0
    v_mov_b32 v63, 0
    s_waitcnt vmcnt(24)
    s_barrier
    ds_read_b128 a[192:195], v8 offset:0
    ds_read_b128 a[196:199], v8 offset:1024
    ds_read_b128 a[200:203], v8 offset:2048
    ds_read_b128 a[204:207], v8 offset:3072
    ds_read_b128 a[208:211], v8 offset:4096
    ds_read_b128 a[212:215], v8 offset:5120
    ds_read_b128 a[216:219], v8 offset:6144
    ds_read_b128 a[220:223], v8 offset:7168
    ds_read_b128 a[224:227], v8 offset:8192
    ds_read_b128 a[228:231], v8 offset:9216
    ds_read_b128 a[232:235], v8 offset:10240
    ds_read_b128 a[236:239], v8 offset:11264
    ds_read_b128 a[240:243], v8 offset:12288
    ds_read_b128 a[244:247], v8 offset:13312
    ds_read_b128 a[248:251], v8 offset:14336
    ds_read_b128 a[252:255], v8 offset:15360
    s_waitcnt lgkmcnt(12)
    v_mfma_f32_16x16x32_bf16 v[64:67], a[192:195], v[128:131], v[64:67]
    v_mfma_f32_16x16x32_bf16 v[68:71], a[192:195], v[192:195], v[68:71]
    s_add_u32 s63, s95, 0
    buffer_load_dwordx4 a[0:3], v2, s[84:87], s63 offen offset:0
    v_mfma_f32_16x16x32_bf16 v[72:75], a[196:199], v[128:131], v[72:75]
    v_mfma_f32_16x16x32_bf16 v[76:79], a[196:199], v[192:195], v[76:79]
    v_mfma_f32_16x16x32_bf16 v[80:83], a[200:203], v[128:131], v[80:83]
    v_mfma_f32_16x16x32_bf16 v[84:87], a[200:203], v[192:195], v[84:87]
    buffer_load_dwordx4 a[4:7], v2, s[84:87], s63 offen offset:1024
    v_mfma_f32_16x16x32_bf16 v[88:91], a[204:207], v[128:131], v[88:91]
    v_mfma_f32_16x16x32_bf16 v[92:95], a[204:207], v[192:195], v[92:95]
    ds_read_b128 a[192:195], v8 offset:16384
    ds_read_b128 a[196:199], v8 offset:17408
    ds_read_b128 a[200:203], v8 offset:18432
    ds_read_b128 a[204:207], v8 offset:19456
    s_waitcnt lgkmcnt(12)
    v_mfma_f32_16x16x32_bf16 v[64:67], a[208:211], v[132:135], v[64:67]
    v_mfma_f32_16x16x32_bf16 v[68:71], a[208:211], v[196:199], v[68:71]
    buffer_load_dwordx4 a[8:11], v2, s[84:87], s63 offen offset:2048
    v_mfma_f32_16x16x32_bf16 v[72:75], a[212:215], v[132:135], v[72:75]
    v_mfma_f32_16x16x32_bf16 v[76:79], a[212:215], v[196:199], v[76:79]
    v_mfma_f32_16x16x32_bf16 v[80:83], a[216:219], v[132:135], v[80:83]
    v_mfma_f32_16x16x32_bf16 v[84:87], a[216:219], v[196:199], v[84:87]
    v_mfma_f32_16x16x32_bf16 v[88:91], a[220:223], v[132:135], v[88:91]
    v_mfma_f32_16x16x32_bf16 v[92:95], a[220:223], v[196:199], v[92:95]
    ds_read_b128 a[208:211], v8 offset:20480
    ds_read_b128 a[212:215], v8 offset:21504
    ds_read_b128 a[216:219], v8 offset:22528
    ds_read_b128 a[220:223], v8 offset:23552
    s_waitcnt lgkmcnt(12)
    v_mfma_f32_16x16x32_bf16 v[64:67], a[224:227], v[136:139], v[64:67]
    v_mfma_f32_16x16x32_bf16 v[68:71], a[224:227], v[200:203], v[68:71]
    buffer_load_dwordx4 a[12:15], v2, s[84:87], s63 offen offset:3072
    v_mfma_f32_16x16x32_bf16 v[72:75], a[228:231], v[136:139], v[72:75]
    v_mfma_f32_16x16x32_bf16 v[76:79], a[228:231], v[200:203], v[76:79]
    v_mfma_f32_16x16x32_bf16 v[80:83], a[232:235], v[136:139], v[80:83]
    v_mfma_f32_16x16x32_bf16 v[84:87], a[232:235], v[200:203], v[84:87]
    s_add_u32 s63, s95, 16384
    buffer_load_dwordx4 a[16:19], v2, s[84:87], s63 offen offset:0
    v_mfma_f32_16x16x32_bf16 v[88:91], a[236:239], v[136:139], v[88:91]
    v_mfma_f32_16x16x32_bf16 v[92:95], a[236:239], v[200:203], v[92:95]
    ds_read_b128 a[224:227], v8 offset:24576
    ds_read_b128 a[228:231], v8 offset:25600
    ds_read_b128 a[232:235], v8 offset:26624
    ds_read_b128 a[236:239], v8 offset:27648
    s_waitcnt lgkmcnt(12)
    v_mfma_f32_16x16x32_bf16 v[64:67], a[240:243], v[140:143], v[64:67]
    v_mfma_f32_16x16x32_bf16 v[68:71], a[240:243], v[204:207], v[68:71]
    v_mfma_f32_16x16x32_bf16 v[72:75], a[244:247], v[140:143], v[72:75]
    v_mfma_f32_16x16x32_bf16 v[76:79], a[244:247], v[204:207], v[76:79]
    v_mfma_f32_16x16x32_bf16 v[80:83], a[248:251], v[140:143], v[80:83]
    v_mfma_f32_16x16x32_bf16 v[84:87], a[248:251], v[204:207], v[84:87]
    buffer_load_dwordx4 a[20:23], v2, s[84:87], s63 offen offset:1024
    v_mfma_f32_16x16x32_bf16 v[88:91], a[252:255], v[140:143], v[88:91]
    v_mfma_f32_16x16x32_bf16 v[92:95], a[252:255], v[204:207], v[92:95]
    ds_read_b128 a[240:243], v8 offset:28672
    ds_read_b128 a[244:247], v8 offset:29696
    ds_read_b128 a[248:251], v8 offset:30720
    ds_read_b128 a[252:255], v8 offset:31744
    s_waitcnt lgkmcnt(12)
    v_mfma_f32_16x16x32_bf16 v[64:67], a[192:195], v[144:147], v[64:67]
    v_mfma_f32_16x16x32_bf16 v[68:71], a[192:195], v[208:211], v[68:71]
    buffer_load_dwordx4 a[24:27], v2, s[84:87], s63 offen offset:2048
    v_mfma_f32_16x16x32_bf16 v[72:75], a[196:199], v[144:147], v[72:75]
    v_mfma_f32_16x16x32_bf16 v[76:79], a[196:199], v[208:211], v[76:79]
    v_mfma_f32_16x16x32_bf16 v[80:83], a[200:203], v[144:147], v[80:83]
    v_mfma_f32_16x16x32_bf16 v[84:87], a[200:203], v[208:211], v[84:87]
    v_mfma_f32_16x16x32_bf16 v[88:91], a[204:207], v[144:147], v[88:91]
    v_mfma_f32_16x16x32_bf16 v[92:95], a[204:207], v[208:211], v[92:95]
    s_waitcnt lgkmcnt(8)
    v_mfma_f32_16x16x32_bf16 v[64:67], a[208:211], v[148:151], v[64:67]
    v_mfma_f32_16x16x32_bf16 v[68:71], a[208:211], v[212:215], v[68:71]
    buffer_load_dwordx4 a[28:31], v2, s[84:87], s63 offen offset:3072
    v_mfma_f32_16x16x32_bf16 v[72:75], a[212:215], v[148:151], v[72:75]
    v_mfma_f32_16x16x32_bf16 v[76:79], a[212:215], v[212:215], v[76:79]
    v_mfma_f32_16x16x32_bf16 v[80:83], a[216:219], v[148:151], v[80:83]
    v_mfma_f32_16x16x32_bf16 v[84:87], a[216:219], v[212:215], v[84:87]
    s_add_u32 s63, s95, 32768
    buffer_load_dwordx4 a[32:35], v2, s[84:87], s63 offen offset:0
    v_mfma_f32_16x16x32_bf16 v[88:91], a[220:223], v[148:151], v[88:91]
    v_mfma_f32_16x16x32_bf16 v[92:95], a[220:223], v[212:215], v[92:95]
    s_waitcnt lgkmcnt(4)
    v_mfma_f32_16x16x32_bf16 v[64:67], a[224:227], v[152:155], v[64:67]
    v_mfma_f32_16x16x32_bf16 v[68:71], a[224:227], v[216:219], v[68:71]
    v_mfma_f32_16x16x32_bf16 v[72:75], a[228:231], v[152:155], v[72:75]
    v_mfma_f32_16x16x32_bf16 v[76:79], a[228:231], v[216:219], v[76:79]
    v_mfma_f32_16x16x32_bf16 v[80:83], a[232:235], v[152:155], v[80:83]
    v_mfma_f32_16x16x32_bf16 v[84:87], a[232:235], v[216:219], v[84:87]
    buffer_load_dwordx4 a[36:39], v2, s[84:87], s63 offen offset:1024
    v_mfma_f32_16x16x32_bf16 v[88:91], a[236:239], v[152:155], v[88:91]
    v_mfma_f32_16x16x32_bf16 v[92:95], a[236:239], v[216:219], v[92:95]
    s_waitcnt lgkmcnt(0)
    v_mfma_f32_16x16x32_bf16 v[64:67], a[240:243], v[156:159], v[64:67]
    v_mfma_f32_16x16x32_bf16 v[68:71], a[240:243], v[220:223], v[68:71]
    buffer_load_dwordx4 a[40:43], v2, s[84:87], s63 offen offset:2048
    v_mfma_f32_16x16x32_bf16 v[72:75], a[244:247], v[156:159], v[72:75]
    v_mfma_f32_16x16x32_bf16 v[76:79], a[244:247], v[220:223], v[76:79]
    v_mfma_f32_16x16x32_bf16 v[80:83], a[248:251], v[156:159], v[80:83]
    v_mfma_f32_16x16x32_bf16 v[84:87], a[248:251], v[220:223], v[84:87]
    v_mfma_f32_16x16x32_bf16 v[88:91], a[252:255], v[156:159], v[88:91]
    v_mfma_f32_16x16x32_bf16 v[92:95], a[252:255], v[220:223], v[92:95]
    s_waitcnt vmcnt(27)
    s_barrier
    ds_read_b128 a[192:195], v9 offset:0
    ds_read_b128 a[196:199], v9 offset:1024
    ds_read_b128 a[200:203], v9 offset:2048
    ds_read_b128 a[204:207], v9 offset:3072
    ds_read_b128 a[208:211], v9 offset:4096
    ds_read_b128 a[212:215], v9 offset:5120
    ds_read_b128 a[216:219], v9 offset:6144
    ds_read_b128 a[220:223], v9 offset:7168
    ds_read_b128 a[224:227], v9 offset:8192
    ds_read_b128 a[228:231], v9 offset:9216
    ds_read_b128 a[232:235], v9 offset:10240
    ds_read_b128 a[236:239], v9 offset:11264
    ds_read_b128 a[240:243], v9 offset:12288
    ds_read_b128 a[244:247], v9 offset:13312
    ds_read_b128 a[248:251], v9 offset:14336
    ds_read_b128 a[252:255], v9 offset:15360
    s_waitcnt lgkmcnt(12)
    v_mfma_f32_16x16x32_bf16 v[64:67], a[192:195], v[160:163], v[64:67]
    v_mfma_f32_16x16x32_bf16 v[68:71], a[192:195], v[224:227], v[68:71]
    buffer_load_dwordx4 a[44:47], v2, s[84:87], s63 offen offset:3072
    v_mfma_f32_16x16x32_bf16 v[72:75], a[196:199], v[160:163], v[72:75]
    v_mfma_f32_16x16x32_bf16 v[76:79], a[196:199], v[224:227], v[76:79]
    v_mfma_f32_16x16x32_bf16 v[80:83], a[200:203], v[160:163], v[80:83]
    v_mfma_f32_16x16x32_bf16 v[84:87], a[200:203], v[224:227], v[84:87]
    s_add_u32 s63, s95, 49152
    buffer_load_dwordx4 a[48:51], v2, s[84:87], s63 offen offset:0
    v_mfma_f32_16x16x32_bf16 v[88:91], a[204:207], v[160:163], v[88:91]
    v_mfma_f32_16x16x32_bf16 v[92:95], a[204:207], v[224:227], v[92:95]
    ds_read_b128 a[192:195], v9 offset:16384
    ds_read_b128 a[196:199], v9 offset:17408
    ds_read_b128 a[200:203], v9 offset:18432
    ds_read_b128 a[204:207], v9 offset:19456
    s_waitcnt lgkmcnt(12)
    v_mfma_f32_16x16x32_bf16 v[64:67], a[208:211], v[164:167], v[64:67]
    v_mfma_f32_16x16x32_bf16 v[68:71], a[208:211], v[228:231], v[68:71]
    buffer_load_dwordx4 a[52:55], v2, s[84:87], s63 offen offset:1024
    v_mfma_f32_16x16x32_bf16 v[72:75], a[212:215], v[164:167], v[72:75]
    v_mfma_f32_16x16x32_bf16 v[76:79], a[212:215], v[228:231], v[76:79]
    v_mfma_f32_16x16x32_bf16 v[80:83], a[216:219], v[164:167], v[80:83]
    v_mfma_f32_16x16x32_bf16 v[84:87], a[216:219], v[228:231], v[84:87]
    v_mfma_f32_16x16x32_bf16 v[88:91], a[220:223], v[164:167], v[88:91]
    v_mfma_f32_16x16x32_bf16 v[92:95], a[220:223], v[228:231], v[92:95]
    ds_read_b128 a[208:211], v9 offset:20480
    ds_read_b128 a[212:215], v9 offset:21504
    ds_read_b128 a[216:219], v9 offset:22528
    ds_read_b128 a[220:223], v9 offset:23552
    s_waitcnt lgkmcnt(12)
    v_mfma_f32_16x16x32_bf16 v[64:67], a[224:227], v[168:171], v[64:67]
    v_mfma_f32_16x16x32_bf16 v[68:71], a[224:227], v[232:235], v[68:71]
    buffer_load_dwordx4 a[56:59], v2, s[84:87], s63 offen offset:2048
    v_mfma_f32_16x16x32_bf16 v[72:75], a[228:231], v[168:171], v[72:75]
    v_mfma_f32_16x16x32_bf16 v[76:79], a[228:231], v[232:235], v[76:79]
    v_mfma_f32_16x16x32_bf16 v[80:83], a[232:235], v[168:171], v[80:83]
    v_mfma_f32_16x16x32_bf16 v[84:87], a[232:235], v[232:235], v[84:87]
    buffer_load_dwordx4 a[60:63], v2, s[84:87], s63 offen offset:3072
    v_mfma_f32_16x16x32_bf16 v[88:91], a[236:239], v[168:171], v[88:91]
    v_mfma_f32_16x16x32_bf16 v[92:95], a[236:239], v[232:235], v[92:95]
    ds_read_b128 a[224:227], v9 offset:24576
    ds_read_b128 a[228:231], v9 offset:25600
    ds_read_b128 a[232:235], v9 offset:26624
    ds_read_b128 a[236:239], v9 offset:27648
    s_waitcnt lgkmcnt(12)
    v_mfma_f32_16x16x32_bf16 v[64:67], a[240:243], v[172:175], v[64:67]
    v_mfma_f32_16x16x32_bf16 v[68:71], a[240:243], v[236:239], v[68:71]
    v_mfma_f32_16x16x32_bf16 v[72:75], a[244:247], v[172:175], v[72:75]
    v_mfma_f32_16x16x32_bf16 v[76:79], a[244:247], v[236:239], v[76:79]
    v_mfma_f32_16x16x32_bf16 v[80:83], a[248:251], v[172:175], v[80:83]
    v_mfma_f32_16x16x32_bf16 v[84:87], a[248:251], v[236:239], v[84:87]
    s_add_u32 s63, s95, 65536
    buffer_load_dwordx4 a[64:67], v2, s[84:87], s63 offen offset:0
    v_mfma_f32_16x16x32_bf16 v[88:91], a[252:255], v[172:175], v[88:91]
    v_mfma_f32_16x16x32_bf16 v[92:95], a[252:255], v[236:239], v[92:95]
    ds_read_b128 a[240:243], v9 offset:28672
    ds_read_b128 a[244:247], v9 offset:29696
    ds_read_b128 a[248:251], v9 offset:30720
    ds_read_b128 a[252:255], v9 offset:31744
    s_waitcnt lgkmcnt(12)
    v_mfma_f32_16x16x32_bf16 v[64:67], a[192:195], v[176:179], v[64:67]
    v_mfma_f32_16x16x32_bf16 v[68:71], a[192:195], v[240:243], v[68:71]
    buffer_load_dwordx4 a[68:71], v2, s[84:87], s63 offen offset:1024
    v_mfma_f32_16x16x32_bf16 v[72:75], a[196:199], v[176:179], v[72:75]
    v_mfma_f32_16x16x32_bf16 v[76:79], a[196:199], v[240:243], v[76:79]
    v_mfma_f32_16x16x32_bf16 v[80:83], a[200:203], v[176:179], v[80:83]
    v_mfma_f32_16x16x32_bf16 v[84:87], a[200:203], v[240:243], v[84:87]
    v_mfma_f32_16x16x32_bf16 v[88:91], a[204:207], v[176:179], v[88:91]
    v_mfma_f32_16x16x32_bf16 v[92:95], a[204:207], v[240:243], v[92:95]
    s_waitcnt lgkmcnt(8)
    v_mfma_f32_16x16x32_bf16 v[64:67], a[208:211], v[180:183], v[64:67]
    v_mfma_f32_16x16x32_bf16 v[68:71], a[208:211], v[244:247], v[68:71]
    buffer_load_dwordx4 a[72:75], v2, s[84:87], s63 offen offset:2048
    v_mfma_f32_16x16x32_bf16 v[72:75], a[212:215], v[180:183], v[72:75]
    v_mfma_f32_16x16x32_bf16 v[76:79], a[212:215], v[244:247], v[76:79]
    v_mfma_f32_16x16x32_bf16 v[80:83], a[216:219], v[180:183], v[80:83]
    v_mfma_f32_16x16x32_bf16 v[84:87], a[216:219], v[244:247], v[84:87]
    buffer_load_dwordx4 a[76:79], v2, s[84:87], s63 offen offset:3072
    v_mfma_f32_16x16x32_bf16 v[88:91], a[220:223], v[180:183], v[88:91]
    v_mfma_f32_16x16x32_bf16 v[92:95], a[220:223], v[244:247], v[92:95]
    s_waitcnt lgkmcnt(4)
    v_mfma_f32_16x16x32_bf16 v[64:67], a[224:227], v[184:187], v[64:67]
    v_mfma_f32_16x16x32_bf16 v[68:71], a[224:227], v[248:251], v[68:71]
    v_mfma_f32_16x16x32_bf16 v[72:75], a[228:231], v[184:187], v[72:75]
    v_mfma_f32_16x16x32_bf16 v[76:79], a[228:231], v[248:251], v[76:79]
    v_mfma_f32_16x16x32_bf16 v[80:83], a[232:235], v[184:187], v[80:83]
    v_mfma_f32_16x16x32_bf16 v[84:87], a[232:235], v[248:251], v[84:87]
    s_add_u32 s63, s95, 81920
    buffer_load_dwordx4 a[80:83], v2, s[84:87], s63 offen offset:0
    v_mfma_f32_16x16x32_bf16 v[88:91], a[236:239], v[184:187], v[88:91]
    v_mfma_f32_16x16x32_bf16 v[92:95], a[236:239], v[248:251], v[92:95]
    s_waitcnt lgkmcnt(0)
    v_mfma_f32_16x16x32_bf16 v[64:67], a[240:243], v[188:191], v[64:67]
    v_mfma_f32_16x16x32_bf16 v[68:71], a[240:243], v[252:255], v[68:71]
    buffer_load_dwordx4 a[84:87], v2, s[84:87], s63 offen offset:1024
    v_mfma_f32_16x16x32_bf16 v[72:75], a[244:247], v[188:191], v[72:75]
    v_mfma_f32_16x16x32_bf16 v[76:79], a[244:247], v[252:255], v[76:79]
    v_mfma_f32_16x16x32_bf16 v[80:83], a[248:251], v[188:191], v[80:83]
    v_mfma_f32_16x16x32_bf16 v[84:87], a[248:251], v[252:255], v[84:87]
    v_mfma_f32_16x16x32_bf16 v[88:91], a[252:255], v[188:191], v[88:91]
    v_mfma_f32_16x16x32_bf16 v[92:95], a[252:255], v[252:255], v[92:95]
    s_waitcnt vmcnt(30)
    s_barrier
    ds_read_b128 a[192:195], v10 offset:0
    ds_read_b128 a[196:199], v10 offset:1024
    ds_read_b128 a[200:203], v10 offset:2048
    ds_read_b128 a[204:207], v10 offset:3072
    ds_read_b128 a[208:211], v10 offset:4096
    ds_read_b128 a[212:215], v10 offset:5120
    ds_read_b128 a[216:219], v10 offset:6144
    ds_read_b128 a[220:223], v10 offset:7168
    ds_read_b128 a[224:227], v10 offset:8192
    ds_read_b128 a[228:231], v10 offset:9216
    ds_read_b128 a[232:235], v10 offset:10240
    ds_read_b128 a[236:239], v10 offset:11264
    ds_read_b128 a[240:243], v10 offset:12288
    ds_read_b128 a[244:247], v10 offset:13312
    ds_read_b128 a[248:251], v10 offset:14336
    ds_read_b128 a[252:255], v10 offset:15360
    s_waitcnt lgkmcnt(12)
    v_mfma_f32_16x16x32_bf16 v[32:35], a[192:195], v[128:131], v[32:35]
    v_cvt_pk_bf16_f32 v64, v64, v64
    v_lshlrev_b32 v64, 16, v64
    v_cvt_pk_bf16_f32 v80, v80, v80
    v_mfma_f32_16x16x32_bf16 v[36:39], a[192:195], v[192:195], v[36:39]
    v_lshlrev_b32 v80, 16, v80
    v_mul_f32 v20, 0xbfb8aa3b, v64
    v_exp_f32 v20, v20
    buffer_load_dwordx4 a[88:91], v2, s[84:87], s63 offen offset:2048
    v_mfma_f32_16x16x32_bf16 v[40:43], a[196:199], v[128:131], v[40:43]
    v_add_f32 v20, 1.0, v20
    v_rcp_f32 v20, v20
    s_nop 0
    v_mul_f32 v64, v64, v20
    v_mfma_f32_16x16x32_bf16 v[44:47], a[196:199], v[192:195], v[44:47]
    v_cvt_pk_bf16_f32 v64, v64, v64
    v_lshlrev_b32 v64, 16, v64
    v_mul_f32 v64, v64, v80
    v_mfma_f32_16x16x32_bf16 v[48:51], a[200:203], v[128:131], v[48:51]
    v_cvt_pk_bf16_f32 v65, v65, v65
    v_lshlrev_b32 v65, 16, v65
    v_cvt_pk_bf16_f32 v81, v81, v81
    v_mfma_f32_16x16x32_bf16 v[52:55], a[200:203], v[192:195], v[52:55]
    v_lshlrev_b32 v81, 16, v81
    v_mul_f32 v21, 0xbfb8aa3b, v65
    v_exp_f32 v21, v21
    buffer_load_dwordx4 a[92:95], v2, s[84:87], s63 offen offset:3072
    v_mfma_f32_16x16x32_bf16 v[56:59], a[204:207], v[128:131], v[56:59]
    v_add_f32 v21, 1.0, v21
    v_rcp_f32 v21, v21
    s_nop 0
    v_mul_f32 v65, v65, v21
    v_mfma_f32_16x16x32_bf16 v[60:63], a[204:207], v[192:195], v[60:63]
    v_cvt_pk_bf16_f32 v65, v65, v65
    v_lshlrev_b32 v65, 16, v65
    v_mul_f32 v65, v65, v81
    v_cvt_pk_bf16_f32 v66, v66, v66
    ds_read_b128 a[192:195], v10 offset:16384
    ds_read_b128 a[196:199], v10 offset:17408
    ds_read_b128 a[200:203], v10 offset:18432
    ds_read_b128 a[204:207], v10 offset:19456
    s_waitcnt lgkmcnt(12)
    v_mfma_f32_16x16x32_bf16 v[32:35], a[208:211], v[132:135], v[32:35]
    v_lshlrev_b32 v66, 16, v66
    v_cvt_pk_bf16_f32 v82, v82, v82
    v_lshlrev_b32 v82, 16, v82
    v_mfma_f32_16x16x32_bf16 v[36:39], a[208:211], v[196:199], v[36:39]
    v_mul_f32 v22, 0xbfb8aa3b, v66
    v_exp_f32 v22, v22
    s_nop 0
    v_add_f32 v22, 1.0, v22
    s_add_u32 s63, s95, 98304
    buffer_load_dwordx4 a[96:99], v2, s[84:87], s63 offen offset:0
    v_mfma_f32_16x16x32_bf16 v[40:43], a[212:215], v[132:135], v[40:43]
    v_rcp_f32 v22, v22
    s_nop 0
    v_mul_f32 v66, v66, v22
    v_cvt_pk_bf16_f32 v66, v66, v66
    v_mfma_f32_16x16x32_bf16 v[44:47], a[212:215], v[196:199], v[44:47]
    v_lshlrev_b32 v66, 16, v66
    v_mul_f32 v66, v66, v82
    v_cvt_pk_bf16_f32 v67, v67, v67
    v_mfma_f32_16x16x32_bf16 v[48:51], a[216:219], v[132:135], v[48:51]
    v_lshlrev_b32 v67, 16, v67
    v_cvt_pk_bf16_f32 v83, v83, v83
    v_lshlrev_b32 v83, 16, v83
    v_mfma_f32_16x16x32_bf16 v[52:55], a[216:219], v[196:199], v[52:55]
    v_mul_f32 v23, 0xbfb8aa3b, v67
    v_exp_f32 v23, v23
    s_nop 0
    v_add_f32 v23, 1.0, v23
    v_mfma_f32_16x16x32_bf16 v[56:59], a[220:223], v[132:135], v[56:59]
    v_rcp_f32 v23, v23
    s_nop 0
    v_mul_f32 v67, v67, v23
    v_cvt_pk_bf16_f32 v67, v67, v67
    v_mfma_f32_16x16x32_bf16 v[60:63], a[220:223], v[196:199], v[60:63]
    v_lshlrev_b32 v67, 16, v67
    v_mul_f32 v67, v67, v83
    v_cvt_pk_bf16_f32 v24, v64, v65
    v_cvt_pk_bf16_f32 v25, v66, v67
    ds_read_b128 a[208:211], v10 offset:20480
    ds_read_b128 a[212:215], v10 offset:21504
    ds_read_b128 a[216:219], v10 offset:22528
    ds_read_b128 a[220:223], v10 offset:23552
    s_waitcnt lgkmcnt(12)
    v_mfma_f32_16x16x32_bf16 v[32:35], a[224:227], v[136:139], v[32:35]
    v_cvt_pk_bf16_f32 v72, v72, v72
    v_lshlrev_b32 v72, 16, v72
    v_cvt_pk_bf16_f32 v88, v88, v88
    v_mfma_f32_16x16x32_bf16 v[36:39], a[224:227], v[200:203], v[36:39]
    v_lshlrev_b32 v88, 16, v88
    v_mul_f32 v20, 0xbfb8aa3b, v72
    v_exp_f32 v20, v20
    buffer_load_dwordx4 a[100:103], v2, s[84:87], s63 offen offset:1024
    v_mfma_f32_16x16x32_bf16 v[40:43], a[228:231], v[136:139], v[40:43]
    v_add_f32 v20, 1.0, v20
    v_rcp_f32 v20, v20
    s_nop 0
    v_mul_f32 v72, v72, v20
    v_mfma_f32_16x16x32_bf16 v[44:47], a[228:231], v[200:203], v[44:47]
    v_cvt_pk_bf16_f32 v72, v72, v72
    v_lshlrev_b32 v72, 16, v72
    v_mul_f32 v72, v72, v88
    v_mfma_f32_16x16x32_bf16 v[48:51], a[232:235], v[136:139], v[48:51]
    v_cvt_pk_bf16_f32 v73, v73, v73
    v_lshlrev_b32 v73, 16, v73
    v_cvt_pk_bf16_f32 v89, v89, v89
    v_mfma_f32_16x16x32_bf16 v[52:55], a[232:235], v[200:203], v[52:55]
    v_lshlrev_b32 v89, 16, v89
    v_mul_f32 v21, 0xbfb8aa3b, v73
    v_exp_f32 v21, v21
    buffer_load_dwordx4 a[104:107], v2, s[84:87], s63 offen offset:2048
    v_mfma_f32_16x16x32_bf16 v[56:59], a[236:239], v[136:139], v[56:59]
    v_add_f32 v21, 1.0, v21
    v_rcp_f32 v21, v21
    s_nop 0
    v_mul_f32 v73, v73, v21
    v_mfma_f32_16x16x32_bf16 v[60:63], a[236:239], v[200:203], v[60:63]
    v_cvt_pk_bf16_f32 v73, v73, v73
    v_lshlrev_b32 v73, 16, v73
    v_mul_f32 v73, v73, v89
    v_cvt_pk_bf16_f32 v74, v74, v74
    ds_read_b128 a[224:227], v10 offset:24576
    ds_read_b128 a[228:231], v10 offset:25600
    ds_read_b128 a[232:235], v10 offset:26624
    ds_read_b128 a[236:239], v10 offset:27648
    s_waitcnt lgkmcnt(12)
    v_mfma_f32_16x16x32_bf16 v[32:35], a[240:243], v[140:143], v[32:35]
    v_lshlrev_b32 v74, 16, v74
    v_cvt_pk_bf16_f32 v90, v90, v90
    v_lshlrev_b32 v90, 16, v90
    v_mfma_f32_16x16x32_bf16 v[36:39], a[240:243], v[204:207], v[36:39]
    v_mul_f32 v22, 0xbfb8aa3b, v74
    v_exp_f32 v22, v22
    s_nop 0
    v_add_f32 v22, 1.0, v22
    v_mfma_f32_16x16x32_bf16 v[40:43], a[244:247], v[140:143], v[40:43]
    v_rcp_f32 v22, v22
    s_nop 0
    v_mul_f32 v74, v74, v22
    v_cvt_pk_bf16_f32 v74, v74, v74
    v_mfma_f32_16x16x32_bf16 v[44:47], a[244:247], v[204:207], v[44:47]
    v_lshlrev_b32 v74, 16, v74
    v_mul_f32 v74, v74, v90
    v_cvt_pk_bf16_f32 v75, v75, v75
    v_mfma_f32_16x16x32_bf16 v[48:51], a[248:251], v[140:143], v[48:51]
    v_lshlrev_b32 v75, 16, v75
    v_cvt_pk_bf16_f32 v91, v91, v91
    v_lshlrev_b32 v91, 16, v91
    v_mfma_f32_16x16x32_bf16 v[52:55], a[248:251], v[204:207], v[52:55]
    v_mul_f32 v23, 0xbfb8aa3b, v75
    v_exp_f32 v23, v23
    s_nop 0
    v_add_f32 v23, 1.0, v23
    buffer_load_dwordx4 a[108:111], v2, s[84:87], s63 offen offset:3072
    v_mfma_f32_16x16x32_bf16 v[56:59], a[252:255], v[140:143], v[56:59]
    v_rcp_f32 v23, v23
    s_nop 0
    v_mul_f32 v75, v75, v23
    v_cvt_pk_bf16_f32 v75, v75, v75
    v_mfma_f32_16x16x32_bf16 v[60:63], a[252:255], v[204:207], v[60:63]
    v_lshlrev_b32 v75, 16, v75
    v_mul_f32 v75, v75, v91
    v_cvt_pk_bf16_f32 v26, v72, v73
    v_cvt_pk_bf16_f32 v27, v74, v75
    ds_read_b128 a[240:243], v10 offset:28672
    ds_read_b128 a[244:247], v10 offset:29696
    ds_read_b128 a[248:251], v10 offset:30720
    ds_read_b128 a[252:255], v10 offset:31744
    s_waitcnt lgkmcnt(12)
    v_mfma_f32_16x16x32_bf16 v[32:35], a[192:195], v[144:147], v[32:35]
    v_cvt_pk_bf16_f32 v68, v68, v68
    v_lshlrev_b32 v68, 16, v68
    v_cvt_pk_bf16_f32 v84, v84, v84
    v_mfma_f32_16x16x32_bf16 v[36:39], a[192:195], v[208:211], v[36:39]
    v_lshlrev_b32 v84, 16, v84
    v_mul_f32 v20, 0xbfb8aa3b, v68
    v_exp_f32 v20, v20
    s_add_u32 s63, s95, 114688
    buffer_load_dwordx4 a[112:115], v2, s[84:87], s63 offen offset:0
    v_mfma_f32_16x16x32_bf16 v[40:43], a[196:199], v[144:147], v[40:43]
    v_add_f32 v20, 1.0, v20
    v_rcp_f32 v20, v20
    s_nop 0
    v_mul_f32 v68, v68, v20
    v_mfma_f32_16x16x32_bf16 v[44:47], a[196:199], v[208:211], v[44:47]
    v_cvt_pk_bf16_f32 v68, v68, v68
    v_lshlrev_b32 v68, 16, v68
    v_mul_f32 v68, v68, v84
    v_mfma_f32_16x16x32_bf16 v[48:51], a[200:203], v[144:147], v[48:51]
    v_cvt_pk_bf16_f32 v69, v69, v69
    v_lshlrev_b32 v69, 16, v69
    v_cvt_pk_bf16_f32 v85, v85, v85
    v_mfma_f32_16x16x32_bf16 v[52:55], a[200:203], v[208:211], v[52:55]
    v_lshlrev_b32 v85, 16, v85
    v_mul_f32 v21, 0xbfb8aa3b, v69
    v_exp_f32 v21, v21
    v_mfma_f32_16x16x32_bf16 v[56:59], a[204:207], v[144:147], v[56:59]
    v_add_f32 v21, 1.0, v21
    v_rcp_f32 v21, v21
    s_nop 0
    v_mul_f32 v69, v69, v21
    v_mfma_f32_16x16x32_bf16 v[60:63], a[204:207], v[208:211], v[60:63]
    v_cvt_pk_bf16_f32 v69, v69, v69
    v_lshlrev_b32 v69, 16, v69
    v_mul_f32 v69, v69, v85
    v_cvt_pk_bf16_f32 v70, v70, v70
    s_waitcnt lgkmcnt(8)
    v_mfma_f32_16x16x32_bf16 v[32:35], a[208:211], v[148:151], v[32:35]
    v_lshlrev_b32 v70, 16, v70
    v_cvt_pk_bf16_f32 v86, v86, v86
    v_lshlrev_b32 v86, 16, v86
    v_mfma_f32_16x16x32_bf16 v[36:39], a[208:211], v[212:215], v[36:39]
    v_mul_f32 v22, 0xbfb8aa3b, v70
    v_exp_f32 v22, v22
    s_nop 0
    v_add_f32 v22, 1.0, v22
    buffer_load_dwordx4 a[116:119], v2, s[84:87], s63 offen offset:1024
    v_mfma_f32_16x16x32_bf16 v[40:43], a[212:215], v[148:151], v[40:43]
    v_rcp_f32 v22, v22
    s_nop 0
    v_mul_f32 v70, v70, v22
    v_cvt_pk_bf16_f32 v70, v70, v70
    v_mfma_f32_16x16x32_bf16 v[44:47], a[212:215], v[212:215], v[44:47]
    v_lshlrev_b32 v70, 16, v70
    v_mul_f32 v70, v70, v86
    v_cvt_pk_bf16_f32 v71, v71, v71
    v_mfma_f32_16x16x32_bf16 v[48:51], a[216:219], v[148:151], v[48:51]
    v_lshlrev_b32 v71, 16, v71
    v_cvt_pk_bf16_f32 v87, v87, v87
    v_lshlrev_b32 v87, 16, v87
    v_mfma_f32_16x16x32_bf16 v[52:55], a[216:219], v[212:215], v[52:55]
    v_mul_f32 v23, 0xbfb8aa3b, v71
    v_exp_f32 v23, v23
    s_nop 0
    v_add_f32 v23, 1.0, v23
    buffer_load_dwordx4 a[120:123], v2, s[84:87], s63 offen offset:2048
    v_mfma_f32_16x16x32_bf16 v[56:59], a[220:223], v[148:151], v[56:59]
    v_rcp_f32 v23, v23
    s_nop 0
    v_mul_f32 v71, v71, v23
    v_cvt_pk_bf16_f32 v71, v71, v71
    v_mfma_f32_16x16x32_bf16 v[60:63], a[220:223], v[212:215], v[60:63]
    v_lshlrev_b32 v71, 16, v71
    v_mul_f32 v71, v71, v87
    v_cvt_pk_bf16_f32 v28, v68, v69
    v_cvt_pk_bf16_f32 v29, v70, v71
    s_waitcnt lgkmcnt(4)
    v_mfma_f32_16x16x32_bf16 v[32:35], a[224:227], v[152:155], v[32:35]
    v_cvt_pk_bf16_f32 v76, v76, v76
    v_lshlrev_b32 v76, 16, v76
    v_cvt_pk_bf16_f32 v92, v92, v92
    v_mfma_f32_16x16x32_bf16 v[36:39], a[224:227], v[216:219], v[36:39]
    v_lshlrev_b32 v92, 16, v92
    v_mul_f32 v20, 0xbfb8aa3b, v76
    v_exp_f32 v20, v20
    v_mfma_f32_16x16x32_bf16 v[40:43], a[228:231], v[152:155], v[40:43]
    v_add_f32 v20, 1.0, v20
    v_rcp_f32 v20, v20
    s_nop 0
    v_mul_f32 v76, v76, v20
    v_mfma_f32_16x16x32_bf16 v[44:47], a[228:231], v[216:219], v[44:47]
    v_cvt_pk_bf16_f32 v76, v76, v76
    v_lshlrev_b32 v76, 16, v76
    v_mul_f32 v76, v76, v92
    v_mfma_f32_16x16x32_bf16 v[48:51], a[232:235], v[152:155], v[48:51]
    v_cvt_pk_bf16_f32 v77, v77, v77
    v_lshlrev_b32 v77, 16, v77
    v_cvt_pk_bf16_f32 v93, v93, v93
    v_mfma_f32_16x16x32_bf16 v[52:55], a[232:235], v[216:219], v[52:55]
    v_lshlrev_b32 v93, 16, v93
    v_mul_f32 v21, 0xbfb8aa3b, v77
    v_exp_f32 v21, v21
    buffer_load_dwordx4 a[124:127], v2, s[84:87], s63 offen offset:3072
    v_mfma_f32_16x16x32_bf16 v[56:59], a[236:239], v[152:155], v[56:59]
    v_add_f32 v21, 1.0, v21
    v_rcp_f32 v21, v21
    s_nop 0
    v_mul_f32 v77, v77, v21
    v_mfma_f32_16x16x32_bf16 v[60:63], a[236:239], v[216:219], v[60:63]
    v_cvt_pk_bf16_f32 v77, v77, v77
    v_lshlrev_b32 v77, 16, v77
    v_mul_f32 v77, v77, v93
    v_cvt_pk_bf16_f32 v78, v78, v78
    s_waitcnt lgkmcnt(0)
    v_mfma_f32_16x16x32_bf16 v[32:35], a[240:243], v[156:159], v[32:35]
    v_lshlrev_b32 v78, 16, v78
    v_cvt_pk_bf16_f32 v94, v94, v94
    v_lshlrev_b32 v94, 16, v94
    v_mfma_f32_16x16x32_bf16 v[36:39], a[240:243], v[220:223], v[36:39]
    v_mul_f32 v22, 0xbfb8aa3b, v78
    v_exp_f32 v22, v22
    s_nop 0
    v_add_f32 v22, 1.0, v22
    s_add_u32 s63, s95, 131072
    buffer_load_dwordx4 a[128:131], v2, s[84:87], s63 offen offset:0
    v_mfma_f32_16x16x32_bf16 v[40:43], a[244:247], v[156:159], v[40:43]
    v_rcp_f32 v22, v22
    s_nop 0
    v_mul_f32 v78, v78, v22
    v_cvt_pk_bf16_f32 v78, v78, v78
    v_mfma_f32_16x16x32_bf16 v[44:47], a[244:247], v[220:223], v[44:47]
    v_lshlrev_b32 v78, 16, v78
    v_mul_f32 v78, v78, v94
    v_cvt_pk_bf16_f32 v79, v79, v79
    v_mfma_f32_16x16x32_bf16 v[48:51], a[248:251], v[156:159], v[48:51]
    v_lshlrev_b32 v79, 16, v79
    v_cvt_pk_bf16_f32 v95, v95, v95
    v_lshlrev_b32 v95, 16, v95
    v_mfma_f32_16x16x32_bf16 v[52:55], a[248:251], v[220:223], v[52:55]
    v_mul_f32 v23, 0xbfb8aa3b, v79
    v_exp_f32 v23, v23
    s_nop 0
    v_add_f32 v23, 1.0, v23
    v_mfma_f32_16x16x32_bf16 v[56:59], a[252:255], v[156:159], v[56:59]
    v_rcp_f32 v23, v23
    s_nop 0
    v_mul_f32 v79, v79, v23
    v_cvt_pk_bf16_f32 v79, v79, v79
    v_mfma_f32_16x16x32_bf16 v[60:63], a[252:255], v[220:223], v[60:63]
    v_lshlrev_b32 v79, 16, v79
    v_mul_f32 v79, v79, v95
    v_cvt_pk_bf16_f32 v30, v76, v77
    v_cvt_pk_bf16_f32 v31, v78, v79
    s_add_u32 s60, s48, 0
    s_mul_i32 s60, s60, 43
    s_add_u32 s60, s60, s42
    s_add_u32 s60, s60, 0
    s_lshl_b32 s60, s60, 10
    buffer_store_dwordx4 v[24:27], v2, s[56:59], s60 offen sc0 sc1
    s_add_u32 s60, s48, 1
    s_mul_i32 s60, s60, 43
    s_add_u32 s60, s60, s42
    s_add_u32 s60, s60, 0
    s_lshl_b32 s60, s60, 10
    buffer_store_dwordx4 v[28:31], v2, s[56:59], s60 offen sc0 sc1
    v_mov_b32 v64, 0
    v_mov_b32 v65, 0
    v_mov_b32 v66, 0
    v_mov_b32 v67, 0
    v_mov_b32 v68, 0
    v_mov_b32 v69, 0
    v_mov_b32 v70, 0
    v_mov_b32 v71, 0
    v_mov_b32 v72, 0
    v_mov_b32 v73, 0
    v_mov_b32 v74, 0
    v_mov_b32 v75, 0
    v_mov_b32 v76, 0
    v_mov_b32 v77, 0
    v_mov_b32 v78, 0
    v_mov_b32 v79, 0
    v_mov_b32 v80, 0
    v_mov_b32 v81, 0
    v_mov_b32 v82, 0
    v_mov_b32 v83, 0
    v_mov_b32 v84, 0
    v_mov_b32 v85, 0
    v_mov_b32 v86, 0
    v_mov_b32 v87, 0
    v_mov_b32 v88, 0
    v_mov_b32 v89, 0
    v_mov_b32 v90, 0
    v_mov_b32 v91, 0
    v_mov_b32 v92, 0
    v_mov_b32 v93, 0
    v_mov_b32 v94, 0
    v_mov_b32 v95, 0
    s_waitcnt vmcnt(35)
    s_barrier
    ds_read_b128 a[192:195], v11 offset:0
    ds_read_b128 a[196:199], v11 offset:1024
    ds_read_b128 a[200:203], v11 offset:2048
    ds_read_b128 a[204:207], v11 offset:3072
    ds_read_b128 a[208:211], v11 offset:4096
    ds_read_b128 a[212:215], v11 offset:5120
    ds_read_b128 a[216:219], v11 offset:6144
    ds_read_b128 a[220:223], v11 offset:7168
    ds_read_b128 a[224:227], v11 offset:8192
    ds_read_b128 a[228:231], v11 offset:9216
    ds_read_b128 a[232:235], v11 offset:10240
    ds_read_b128 a[236:239], v11 offset:11264
    ds_read_b128 a[240:243], v11 offset:12288
    ds_read_b128 a[244:247], v11 offset:13312
    ds_read_b128 a[248:251], v11 offset:14336
    ds_read_b128 a[252:255], v11 offset:15360
    s_waitcnt lgkmcnt(12)
    v_mfma_f32_16x16x32_bf16 v[32:35], a[192:195], v[160:163], v[32:35]
    v_mfma_f32_16x16x32_bf16 v[36:39], a[192:195], v[224:227], v[36:39]
    buffer_load_dwordx4 a[132:135], v2, s[84:87], s63 offen offset:1024
    v_mfma_f32_16x16x32_bf16 v[40:43], a[196:199], v[160:163], v[40:43]
    v_mfma_f32_16x16x32_bf16 v[44:47], a[196:199], v[224:227], v[44:47]
    v_mfma_f32_16x16x32_bf16 v[48:51], a[200:203], v[160:163], v[48:51]
    v_mfma_f32_16x16x32_bf16 v[52:55], a[200:203], v[224:227], v[52:55]
    buffer_load_dwordx4 a[136:139], v2, s[84:87], s63 offen offset:2048
    v_mfma_f32_16x16x32_bf16 v[56:59], a[204:207], v[160:163], v[56:59]
    v_mfma_f32_16x16x32_bf16 v[60:63], a[204:207], v[224:227], v[60:63]
    ds_read_b128 a[192:195], v11 offset:16384
    ds_read_b128 a[196:199], v11 offset:17408
    ds_read_b128 a[200:203], v11 offset:18432
    ds_read_b128 a[204:207], v11 offset:19456
    s_waitcnt lgkmcnt(12)
    v_mfma_f32_16x16x32_bf16 v[32:35], a[208:211], v[164:167], v[32:35]
    v_mfma_f32_16x16x32_bf16 v[36:39], a[208:211], v[228:231], v[36:39]
    buffer_load_dwordx4 a[140:143], v2, s[84:87], s63 offen offset:3072
    v_mfma_f32_16x16x32_bf16 v[40:43], a[212:215], v[164:167], v[40:43]
    v_mfma_f32_16x16x32_bf16 v[44:47], a[212:215], v[228:231], v[44:47]
    v_mfma_f32_16x16x32_bf16 v[48:51], a[216:219], v[164:167], v[48:51]
    v_mfma_f32_16x16x32_bf16 v[52:55], a[216:219], v[228:231], v[52:55]
    v_mfma_f32_16x16x32_bf16 v[56:59], a[220:223], v[164:167], v[56:59]
    v_mfma_f32_16x16x32_bf16 v[60:63], a[220:223], v[228:231], v[60:63]
    ds_read_b128 a[208:211], v11 offset:20480
    ds_read_b128 a[212:215], v11 offset:21504
    ds_read_b128 a[216:219], v11 offset:22528
    ds_read_b128 a[220:223], v11 offset:23552
    s_waitcnt lgkmcnt(12)
    v_mfma_f32_16x16x32_bf16 v[32:35], a[224:227], v[168:171], v[32:35]
    v_mfma_f32_16x16x32_bf16 v[36:39], a[224:227], v[232:235], v[36:39]
    s_add_u32 s63, s95, 147456
    buffer_load_dwordx4 a[144:147], v2, s[84:87], s63 offen offset:0
    v_mfma_f32_16x16x32_bf16 v[40:43], a[228:231], v[168:171], v[40:43]
    v_mfma_f32_16x16x32_bf16 v[44:47], a[228:231], v[232:235], v[44:47]
    v_mfma_f32_16x16x32_bf16 v[48:51], a[232:235], v[168:171], v[48:51]
    v_mfma_f32_16x16x32_bf16 v[52:55], a[232:235], v[232:235], v[52:55]
    buffer_load_dwordx4 a[148:151], v2, s[84:87], s63 offen offset:1024
    v_mfma_f32_16x16x32_bf16 v[56:59], a[236:239], v[168:171], v[56:59]
    v_mfma_f32_16x16x32_bf16 v[60:63], a[236:239], v[232:235], v[60:63]
    ds_read_b128 a[224:227], v11 offset:24576
    ds_read_b128 a[228:231], v11 offset:25600
    ds_read_b128 a[232:235], v11 offset:26624
    ds_read_b128 a[236:239], v11 offset:27648
    s_waitcnt lgkmcnt(12)
    v_mfma_f32_16x16x32_bf16 v[32:35], a[240:243], v[172:175], v[32:35]
    v_mfma_f32_16x16x32_bf16 v[36:39], a[240:243], v[236:239], v[36:39]
    v_mfma_f32_16x16x32_bf16 v[40:43], a[244:247], v[172:175], v[40:43]
    v_mfma_f32_16x16x32_bf16 v[44:47], a[244:247], v[236:239], v[44:47]
    v_mfma_f32_16x16x32_bf16 v[48:51], a[248:251], v[172:175], v[48:51]
    v_mfma_f32_16x16x32_bf16 v[52:55], a[248:251], v[236:239], v[52:55]
    buffer_load_dwordx4 a[152:155], v2, s[84:87], s63 offen offset:2048
    v_mfma_f32_16x16x32_bf16 v[56:59], a[252:255], v[172:175], v[56:59]
    v_mfma_f32_16x16x32_bf16 v[60:63], a[252:255], v[236:239], v[60:63]
    ds_read_b128 a[240:243], v11 offset:28672
    ds_read_b128 a[244:247], v11 offset:29696
    ds_read_b128 a[248:251], v11 offset:30720
    ds_read_b128 a[252:255], v11 offset:31744
    s_waitcnt lgkmcnt(12)
    v_mfma_f32_16x16x32_bf16 v[32:35], a[192:195], v[176:179], v[32:35]
    v_mfma_f32_16x16x32_bf16 v[36:39], a[192:195], v[240:243], v[36:39]
    buffer_load_dwordx4 a[156:159], v2, s[84:87], s63 offen offset:3072
    v_mfma_f32_16x16x32_bf16 v[40:43], a[196:199], v[176:179], v[40:43]
    v_mfma_f32_16x16x32_bf16 v[44:47], a[196:199], v[240:243], v[44:47]
    v_mfma_f32_16x16x32_bf16 v[48:51], a[200:203], v[176:179], v[48:51]
    v_mfma_f32_16x16x32_bf16 v[52:55], a[200:203], v[240:243], v[52:55]
    v_mfma_f32_16x16x32_bf16 v[56:59], a[204:207], v[176:179], v[56:59]
    v_mfma_f32_16x16x32_bf16 v[60:63], a[204:207], v[240:243], v[60:63]
    s_waitcnt lgkmcnt(8)
    v_mfma_f32_16x16x32_bf16 v[32:35], a[208:211], v[180:183], v[32:35]
    v_mfma_f32_16x16x32_bf16 v[36:39], a[208:211], v[244:247], v[36:39]
    s_add_u32 s63, s95, 163840
    s_cmp_eq_u32 s50, 3
    s_cselect_b32 s63, 0x7f000000, s63
    buffer_load_dwordx4 a[160:163], v2, s[84:87], s63 offen offset:0
    v_mfma_f32_16x16x32_bf16 v[40:43], a[212:215], v[180:183], v[40:43]
    v_mfma_f32_16x16x32_bf16 v[44:47], a[212:215], v[244:247], v[44:47]
    v_mfma_f32_16x16x32_bf16 v[48:51], a[216:219], v[180:183], v[48:51]
    v_mfma_f32_16x16x32_bf16 v[52:55], a[216:219], v[244:247], v[52:55]
    buffer_load_dwordx4 a[164:167], v2, s[84:87], s63 offen offset:1024
    v_mfma_f32_16x16x32_bf16 v[56:59], a[220:223], v[180:183], v[56:59]
    v_mfma_f32_16x16x32_bf16 v[60:63], a[220:223], v[244:247], v[60:63]
    s_waitcnt lgkmcnt(4)
    v_mfma_f32_16x16x32_bf16 v[32:35], a[224:227], v[184:187], v[32:35]
    v_mfma_f32_16x16x32_bf16 v[36:39], a[224:227], v[248:251], v[36:39]
    v_mfma_f32_16x16x32_bf16 v[40:43], a[228:231], v[184:187], v[40:43]
    v_mfma_f32_16x16x32_bf16 v[44:47], a[228:231], v[248:251], v[44:47]
    v_mfma_f32_16x16x32_bf16 v[48:51], a[232:235], v[184:187], v[48:51]
    v_mfma_f32_16x16x32_bf16 v[52:55], a[232:235], v[248:251], v[52:55]
    buffer_load_dwordx4 a[168:171], v2, s[84:87], s63 offen offset:2048
    v_mfma_f32_16x16x32_bf16 v[56:59], a[236:239], v[184:187], v[56:59]
    v_mfma_f32_16x16x32_bf16 v[60:63], a[236:239], v[248:251], v[60:63]
    s_waitcnt lgkmcnt(0)
    v_mfma_f32_16x16x32_bf16 v[32:35], a[240:243], v[188:191], v[32:35]
    v_mfma_f32_16x16x32_bf16 v[36:39], a[240:243], v[252:255], v[36:39]
    buffer_load_dwordx4 a[172:175], v2, s[84:87], s63 offen offset:3072
    v_mfma_f32_16x16x32_bf16 v[40:43], a[244:247], v[188:191], v[40:43]
    v_mfma_f32_16x16x32_bf16 v[44:47], a[244:247], v[252:255], v[44:47]
    v_mfma_f32_16x16x32_bf16 v[48:51], a[248:251], v[188:191], v[48:51]
    v_mfma_f32_16x16x32_bf16 v[52:55], a[248:251], v[252:255], v[52:55]
    v_mfma_f32_16x16x32_bf16 v[56:59], a[252:255], v[188:191], v[56:59]
    v_mfma_f32_16x16x32_bf16 v[60:63], a[252:255], v[252:255], v[60:63]
    v_cvt_pk_bf16_f32 v32, v32, v32
    v_lshlrev_b32 v32, 16, v32
    s_nop 2
    v_cvt_pk_bf16_f32 v48, v48, v48
    v_lshlrev_b32 v48, 16, v48
    v_mul_f32 v20, 0xbfb8aa3b, v32
    v_exp_f32 v20, v20
    s_nop 0
    v_add_f32 v20, 1.0, v20
    v_rcp_f32 v20, v20
    s_nop 0
    v_mul_f32 v32, v32, v20
    v_cvt_pk_bf16_f32 v32, v32, v32
    v_lshlrev_b32 v32, 16, v32
    v_mul_f32 v32, v32, v48
    v_cvt_pk_bf16_f32 v33, v33, v33
    v_lshlrev_b32 v33, 16, v33
    v_cvt_pk_bf16_f32 v49, v49, v49
    v_lshlrev_b32 v49, 16, v49
    v_mul_f32 v21, 0xbfb8aa3b, v33
    v_exp_f32 v21, v21
    s_nop 0
    v_add_f32 v21, 1.0, v21
    v_rcp_f32 v21, v21
    s_nop 0
    v_mul_f32 v33, v33, v21
    v_cvt_pk_bf16_f32 v33, v33, v33
    v_lshlrev_b32 v33, 16, v33
    v_mul_f32 v33, v33, v49
    v_cvt_pk_bf16_f32 v34, v34, v34
    v_lshlrev_b32 v34, 16, v34
    v_cvt_pk_bf16_f32 v50, v50, v50
    v_lshlrev_b32 v50, 16, v50
    v_mul_f32 v22, 0xbfb8aa3b, v34
    v_exp_f32 v22, v22
    s_nop 0
    v_add_f32 v22, 1.0, v22
    v_rcp_f32 v22, v22
    s_nop 0
    v_mul_f32 v34, v34, v22
    v_cvt_pk_bf16_f32 v34, v34, v34
    v_lshlrev_b32 v34, 16, v34
    v_mul_f32 v34, v34, v50
    v_cvt_pk_bf16_f32 v35, v35, v35
    v_lshlrev_b32 v35, 16, v35
    v_cvt_pk_bf16_f32 v51, v51, v51
    v_lshlrev_b32 v51, 16, v51
    v_mul_f32 v23, 0xbfb8aa3b, v35
    v_exp_f32 v23, v23
    s_nop 0
    v_add_f32 v23, 1.0, v23
    v_rcp_f32 v23, v23
    s_nop 0
    v_mul_f32 v35, v35, v23
    v_cvt_pk_bf16_f32 v35, v35, v35
    v_lshlrev_b32 v35, 16, v35
    v_mul_f32 v35, v35, v51
    v_cvt_pk_bf16_f32 v24, v32, v33
    v_cvt_pk_bf16_f32 v25, v34, v35
    v_cvt_pk_bf16_f32 v40, v40, v40
    v_lshlrev_b32 v40, 16, v40
    v_cvt_pk_bf16_f32 v56, v56, v56
    v_lshlrev_b32 v56, 16, v56
    v_mul_f32 v20, 0xbfb8aa3b, v40
    v_exp_f32 v20, v20
    s_nop 0
    v_add_f32 v20, 1.0, v20
    v_rcp_f32 v20, v20
    s_nop 0
    v_mul_f32 v40, v40, v20
    v_cvt_pk_bf16_f32 v40, v40, v40
    v_lshlrev_b32 v40, 16, v40
    v_mul_f32 v40, v40, v56
    v_cvt_pk_bf16_f32 v41, v41, v41
    v_lshlrev_b32 v41, 16, v41
    v_cvt_pk_bf16_f32 v57, v57, v57
    v_lshlrev_b32 v57, 16, v57
    v_mul_f32 v21, 0xbfb8aa3b, v41
    v_exp_f32 v21, v21
    s_nop 0
    v_add_f32 v21, 1.0, v21
    v_rcp_f32 v21, v21
    s_nop 0
    v_mul_f32 v41, v41, v21
    v_cvt_pk_bf16_f32 v41, v41, v41
    v_lshlrev_b32 v41, 16, v41
    v_mul_f32 v41, v41, v57
    v_cvt_pk_bf16_f32 v42, v42, v42
    v_lshlrev_b32 v42, 16, v42
    v_cvt_pk_bf16_f32 v58, v58, v58
    v_lshlrev_b32 v58, 16, v58
    v_mul_f32 v22, 0xbfb8aa3b, v42
    v_exp_f32 v22, v22
    s_nop 0
    v_add_f32 v22, 1.0, v22
    v_rcp_f32 v22, v22
    s_nop 0
    v_mul_f32 v42, v42, v22
    v_cvt_pk_bf16_f32 v42, v42, v42
    v_lshlrev_b32 v42, 16, v42
    v_mul_f32 v42, v42, v58
    v_cvt_pk_bf16_f32 v43, v43, v43
    v_lshlrev_b32 v43, 16, v43
    v_cvt_pk_bf16_f32 v59, v59, v59
    v_lshlrev_b32 v59, 16, v59
    v_mul_f32 v23, 0xbfb8aa3b, v43
    v_exp_f32 v23, v23
    s_nop 0
    v_add_f32 v23, 1.0, v23
    v_rcp_f32 v23, v23
    s_nop 0
    v_mul_f32 v43, v43, v23
    v_cvt_pk_bf16_f32 v43, v43, v43
    v_lshlrev_b32 v43, 16, v43
    v_mul_f32 v43, v43, v59
    v_cvt_pk_bf16_f32 v26, v40, v41
    v_cvt_pk_bf16_f32 v27, v42, v43
    v_cvt_pk_bf16_f32 v36, v36, v36
    v_lshlrev_b32 v36, 16, v36
    v_cvt_pk_bf16_f32 v52, v52, v52
    v_lshlrev_b32 v52, 16, v52
    v_mul_f32 v20, 0xbfb8aa3b, v36
    v_exp_f32 v20, v20
    s_nop 0
    v_add_f32 v20, 1.0, v20
    v_rcp_f32 v20, v20
    s_nop 0
    v_mul_f32 v36, v36, v20
    v_cvt_pk_bf16_f32 v36, v36, v36
    v_lshlrev_b32 v36, 16, v36
    v_mul_f32 v36, v36, v52
    v_cvt_pk_bf16_f32 v37, v37, v37
    v_lshlrev_b32 v37, 16, v37
    v_cvt_pk_bf16_f32 v53, v53, v53
    v_lshlrev_b32 v53, 16, v53
    v_mul_f32 v21, 0xbfb8aa3b, v37
    v_exp_f32 v21, v21
    s_nop 0
    v_add_f32 v21, 1.0, v21
    v_rcp_f32 v21, v21
    s_nop 0
    v_mul_f32 v37, v37, v21
    v_cvt_pk_bf16_f32 v37, v37, v37
    v_lshlrev_b32 v37, 16, v37
    v_mul_f32 v37, v37, v53
    v_cvt_pk_bf16_f32 v38, v38, v38
    v_lshlrev_b32 v38, 16, v38
    v_cvt_pk_bf16_f32 v54, v54, v54
    v_lshlrev_b32 v54, 16, v54
    v_mul_f32 v22, 0xbfb8aa3b, v38
    v_exp_f32 v22, v22
    s_nop 0
    v_add_f32 v22, 1.0, v22
    v_rcp_f32 v22, v22
    s_nop 0
    v_mul_f32 v38, v38, v22
    v_cvt_pk_bf16_f32 v38, v38, v38
    v_lshlrev_b32 v38, 16, v38
    v_mul_f32 v38, v38, v54
    v_cvt_pk_bf16_f32 v39, v39, v39
    v_lshlrev_b32 v39, 16, v39
    v_cvt_pk_bf16_f32 v55, v55, v55
    v_lshlrev_b32 v55, 16, v55
    v_mul_f32 v23, 0xbfb8aa3b, v39
    v_exp_f32 v23, v23
    s_nop 0
    v_add_f32 v23, 1.0, v23
    v_rcp_f32 v23, v23
    s_nop 0
    v_mul_f32 v39, v39, v23
    v_cvt_pk_bf16_f32 v39, v39, v39
    v_lshlrev_b32 v39, 16, v39
    v_mul_f32 v39, v39, v55
    v_cvt_pk_bf16_f32 v28, v36, v37
    v_cvt_pk_bf16_f32 v29, v38, v39
    v_cvt_pk_bf16_f32 v44, v44, v44
    v_lshlrev_b32 v44, 16, v44
    v_cvt_pk_bf16_f32 v60, v60, v60
    v_lshlrev_b32 v60, 16, v60
    v_mul_f32 v20, 0xbfb8aa3b, v44
    v_exp_f32 v20, v20
    s_nop 0
    v_add_f32 v20, 1.0, v20
    v_rcp_f32 v20, v20
    s_nop 0
    v_mul_f32 v44, v44, v20
    v_cvt_pk_bf16_f32 v44, v44, v44
    v_lshlrev_b32 v44, 16, v44
    v_mul_f32 v44, v44, v60
    v_cvt_pk_bf16_f32 v45, v45, v45
    v_lshlrev_b32 v45, 16, v45
    v_cvt_pk_bf16_f32 v61, v61, v61
    v_lshlrev_b32 v61, 16, v61
    v_mul_f32 v21, 0xbfb8aa3b, v45
    v_exp_f32 v21, v21
    s_nop 0
    v_add_f32 v21, 1.0, v21
    v_rcp_f32 v21, v21
    s_nop 0
    v_mul_f32 v45, v45, v21
    v_cvt_pk_bf16_f32 v45, v45, v45
    v_lshlrev_b32 v45, 16, v45
    v_mul_f32 v45, v45, v61
    v_cvt_pk_bf16_f32 v46, v46, v46
    v_lshlrev_b32 v46, 16, v46
    v_cvt_pk_bf16_f32 v62, v62, v62
    v_lshlrev_b32 v62, 16, v62
    v_mul_f32 v22, 0xbfb8aa3b, v46
    v_exp_f32 v22, v22
    s_nop 0
    v_add_f32 v22, 1.0, v22
    v_rcp_f32 v22, v22
    s_nop 0
    v_mul_f32 v46, v46, v22
    v_cvt_pk_bf16_f32 v46, v46, v46
    v_lshlrev_b32 v46, 16, v46
    v_mul_f32 v46, v46, v62
    v_cvt_pk_bf16_f32 v47, v47, v47
    v_lshlrev_b32 v47, 16, v47
    v_cvt_pk_bf16_f32 v63, v63, v63
    v_lshlrev_b32 v63, 16, v63
    v_mul_f32 v23, 0xbfb8aa3b, v47
    v_exp_f32 v23, v23
    s_nop 0
    v_add_f32 v23, 1.0, v23
    v_rcp_f32 v23, v23
    s_nop 0
    v_mul_f32 v47, v47, v23
    v_cvt_pk_bf16_f32 v47, v47, v47
    v_lshlrev_b32 v47, 16, v47
    v_mul_f32 v47, v47, v63
    v_cvt_pk_bf16_f32 v30, v44, v45
    v_cvt_pk_bf16_f32 v31, v46, v47
    s_add_u32 s60, s48, 0
    s_mul_i32 s60, s60, 43
    s_add_u32 s60, s60, s42
    s_add_u32 s60, s60, 1
    s_lshl_b32 s60, s60, 10
    buffer_store_dwordx4 v[24:27], v2, s[56:59], s60 offen sc0 sc1
    s_add_u32 s60, s48, 1
    s_mul_i32 s60, s60, 43
    s_add_u32 s60, s60, s42
    s_add_u32 s60, s60, 1
    s_lshl_b32 s60, s60, 10
    buffer_store_dwordx4 v[28:31], v2, s[56:59], s60 offen sc0 sc1
    s_branch ffn2_kernel_g2
ffn2_kernel_g2:
    s_add_u32 s44, s30, 0x1e50000
    s_addc_u32 s45, s31, 0
    s_mov_b32 s46, 0x560000
    s_mov_b32 s47, 0x20000
    s_add_u32 s56, s30, 0xa50000
    s_addc_u32 s57, s31, 0
    s_mov_b32 s58, 0x200000
    s_mov_b32 s59, 0x20000
    s_mov_b32 s60, s26
    s_mov_b32 s61, s27
    s_mov_b32 s62, 0x200000
    s_mov_b32 s63, 0x20000
    v_and_b32 v3, 15, v1
    v_lshrrev_b32 v4, 4, v1
    v_lshl_add_u32 v6, v5, 4, v3
    v_lshlrev_b32 v6, 10, v6
    v_lshl_add_u32 v6, v4, 5, v6
    s_lshl_b32 s48, s92, 16
    s_lshl_b32 s49, s93, 7
    s_add_u32 s48, s48, s49
    s_waitcnt vmcnt(0)
    s_barrier
    s_add_u32 s51, s40, 80
    s_lshl_b32 s51, s51, 8
    v_mov_b32 v7, 0
    v_mov_b32 v8, 1
    s_cmp_lg_u32 s50, 0
    s_cbranch_scc1 ffn2_kernel_polled
    v_cmp_eq_u32 vcc, 0, v1
    s_nop 1
    s_and_saveexec_b64 s[72:73], vcc
    buffer_atomic_add v8, v7, s[88:91], s51 offen
    s_mov_b64 exec, s[72:73]
    s_mov_b32 s74, 0
ffn2_kernel_poll:
    buffer_load_dword v9, v7, s[88:91], s51 offen sc0 sc1
    s_waitcnt vmcnt(0)
    v_readfirstlane_b32 s75, v9
    s_add_u32 s74, s74, 1
    s_nop 0
    s_cmp_ge_u32 s75, 16
    s_cbranch_scc1 ffn2_kernel_polled
    s_cmp_lt_u32 s74, 0x400000
    s_cbranch_scc0 ffn2_kernel_polled
    s_sleep 1
    s_branch ffn2_kernel_poll
ffn2_kernel_polled:
    s_barrier
    buffer_load_dwordx4 v[16:19], v6, s[56:59], s48 offen sc0 sc1
    buffer_load_dwordx4 v[20:23], v6, s[56:59], s48 offen offset:16 sc0 sc1
    v_mov_b32 v64, 0
    v_mov_b32 v65, 0
    v_mov_b32 v66, 0
    v_mov_b32 v67, 0
    v_mov_b32 v68, 0
    v_mov_b32 v69, 0
    v_mov_b32 v70, 0
    v_mov_b32 v71, 0
    v_mov_b32 v72, 0
    v_mov_b32 v73, 0
    v_mov_b32 v74, 0
    v_mov_b32 v75, 0
    v_mov_b32 v76, 0
    v_mov_b32 v77, 0
    v_mov_b32 v78, 0
    v_mov_b32 v79, 0
    v_mov_b32 v80, 0
    v_mov_b32 v81, 0
    v_mov_b32 v82, 0
    v_mov_b32 v83, 0
    v_mov_b32 v84, 0
    v_mov_b32 v85, 0
    v_mov_b32 v86, 0
    v_mov_b32 v87, 0
    v_mov_b32 v88, 0
    v_mov_b32 v89, 0
    v_mov_b32 v90, 0
    v_mov_b32 v91, 0
    v_mov_b32 v92, 0
    v_mov_b32 v93, 0
    v_mov_b32 v94, 0
    v_mov_b32 v95, 0
    v_mov_b32 v96, 0
    v_mov_b32 v97, 0
    v_mov_b32 v98, 0
    v_mov_b32 v99, 0
    v_mov_b32 v100, 0
    v_mov_b32 v101, 0
    v_mov_b32 v102, 0
    v_mov_b32 v103, 0
    v_mov_b32 v104, 0
    v_mov_b32 v105, 0
    v_mov_b32 v106, 0
    v_mov_b32 v107, 0
    v_mov_b32 v108, 0
    v_mov_b32 v109, 0
    v_mov_b32 v110, 0
    v_mov_b32 v111, 0
    v_mov_b32 v112, 0
    v_mov_b32 v113, 0
    v_mov_b32 v114, 0
    v_mov_b32 v115, 0
    v_mov_b32 v116, 0
    v_mov_b32 v117, 0
    v_mov_b32 v118, 0
    v_mov_b32 v119, 0
    v_mov_b32 v120, 0
    v_mov_b32 v121, 0
    v_mov_b32 v122, 0
    v_mov_b32 v123, 0
    v_mov_b32 v124, 0
    v_mov_b32 v125, 0
    v_mov_b32 v126, 0
    v_mov_b32 v127, 0
    s_add_u32 s51, s94, 0
    buffer_load_dwordx4 v[128:131], v2, s[44:47], s51 offen sc0 sc1
    s_add_u32 s51, s94, 44032
    buffer_load_dwordx4 v[132:135], v2, s[44:47], s51 offen sc0 sc1
    s_add_u32 s51, s94, 88064
    buffer_load_dwordx4 v[136:139], v2, s[44:47], s51 offen sc0 sc1
    s_add_u32 s51, s94, 132096
    buffer_load_dwordx4 v[140:143], v2, s[44:47], s51 offen sc0 sc1
    s_add_u32 s51, s94, 4096
    buffer_load_dwordx4 v[144:147], v2, s[44:47], s51 offen sc0 sc1
    s_add_u32 s51, s94, 48128
    buffer_load_dwordx4 v[148:151], v2, s[44:47], s51 offen sc0 sc1
    s_add_u32 s51, s94, 92160
    buffer_load_dwordx4 v[152:155], v2, s[44:47], s51 offen sc0 sc1
    s_add_u32 s51, s94, 136192
    buffer_load_dwordx4 v[156:159], v2, s[44:47], s51 offen sc0 sc1
    s_add_u32 s51, s94, 8192
    buffer_load_dwordx4 v[160:163], v2, s[44:47], s51 offen sc0 sc1
    s_add_u32 s51, s94, 52224
    buffer_load_dwordx4 v[164:167], v2, s[44:47], s51 offen sc0 sc1
    s_add_u32 s51, s94, 96256
    buffer_load_dwordx4 v[168:171], v2, s[44:47], s51 offen sc0 sc1
    s_add_u32 s51, s94, 140288
    buffer_load_dwordx4 v[172:175], v2, s[44:47], s51 offen sc0 sc1
    s_add_u32 s51, s94, 12288
    buffer_load_dwordx4 v[176:179], v2, s[44:47], s51 offen sc0 sc1
    s_add_u32 s51, s94, 56320
    buffer_load_dwordx4 v[180:183], v2, s[44:47], s51 offen sc0 sc1
    s_add_u32 s51, s94, 100352
    buffer_load_dwordx4 v[184:187], v2, s[44:47], s51 offen sc0 sc1
    s_add_u32 s51, s94, 144384
    buffer_load_dwordx4 v[188:191], v2, s[44:47], s51 offen sc0 sc1
    s_add_u32 s51, s94, 16384
    buffer_load_dwordx4 v[192:195], v2, s[44:47], s51 offen sc0 sc1
    s_add_u32 s51, s94, 60416
    buffer_load_dwordx4 v[196:199], v2, s[44:47], s51 offen sc0 sc1
    s_add_u32 s51, s94, 104448
    buffer_load_dwordx4 v[200:203], v2, s[44:47], s51 offen sc0 sc1
    s_add_u32 s51, s94, 148480
    buffer_load_dwordx4 v[204:207], v2, s[44:47], s51 offen sc0 sc1
    s_add_u32 s51, s94, 20480
    buffer_load_dwordx4 v[208:211], v2, s[44:47], s51 offen sc0 sc1
    s_add_u32 s51, s94, 64512
    buffer_load_dwordx4 v[212:215], v2, s[44:47], s51 offen sc0 sc1
    s_add_u32 s51, s94, 108544
    buffer_load_dwordx4 v[216:219], v2, s[44:47], s51 offen sc0 sc1
    s_add_u32 s51, s94, 152576
    buffer_load_dwordx4 v[220:223], v2, s[44:47], s51 offen sc0 sc1
    s_add_u32 s51, s94, 24576
    buffer_load_dwordx4 v[224:227], v2, s[44:47], s51 offen sc0 sc1
    s_add_u32 s51, s94, 68608
    buffer_load_dwordx4 v[228:231], v2, s[44:47], s51 offen sc0 sc1
    s_add_u32 s51, s94, 112640
    buffer_load_dwordx4 v[232:235], v2, s[44:47], s51 offen sc0 sc1
    s_add_u32 s51, s94, 156672
    buffer_load_dwordx4 v[236:239], v2, s[44:47], s51 offen sc0 sc1
    s_add_u32 s51, s94, 28672
    buffer_load_dwordx4 v[240:243], v2, s[44:47], s51 offen sc0 sc1
    s_add_u32 s51, s94, 72704
    buffer_load_dwordx4 v[244:247], v2, s[44:47], s51 offen sc0 sc1
    s_add_u32 s51, s94, 116736
    buffer_load_dwordx4 v[248:251], v2, s[44:47], s51 offen sc0 sc1
    s_add_u32 s51, s94, 160768
    buffer_load_dwordx4 v[252:255], v2, s[44:47], s51 offen sc0 sc1
    s_waitcnt vmcnt(28)
    v_mfma_f32_16x16x32_bf16 v[64:67], a[0:3], v[128:131], v[64:67]
    v_mfma_f32_16x16x32_bf16 v[68:71], a[4:7], v[128:131], v[68:71]
    v_mfma_f32_16x16x32_bf16 v[72:75], a[8:11], v[128:131], v[72:75]
    v_mfma_f32_16x16x32_bf16 v[76:79], a[12:15], v[128:131], v[76:79]
    v_mfma_f32_16x16x32_bf16 v[80:83], a[0:3], v[132:135], v[80:83]
    v_mfma_f32_16x16x32_bf16 v[84:87], a[4:7], v[132:135], v[84:87]
    v_mfma_f32_16x16x32_bf16 v[88:91], a[8:11], v[132:135], v[88:91]
    v_mfma_f32_16x16x32_bf16 v[92:95], a[12:15], v[132:135], v[92:95]
    v_mfma_f32_16x16x32_bf16 v[96:99], a[0:3], v[136:139], v[96:99]
    v_mfma_f32_16x16x32_bf16 v[100:103], a[4:7], v[136:139], v[100:103]
    v_mfma_f32_16x16x32_bf16 v[104:107], a[8:11], v[136:139], v[104:107]
    v_mfma_f32_16x16x32_bf16 v[108:111], a[12:15], v[136:139], v[108:111]
    v_mfma_f32_16x16x32_bf16 v[112:115], a[0:3], v[140:143], v[112:115]
    v_mfma_f32_16x16x32_bf16 v[116:119], a[4:7], v[140:143], v[116:119]
    v_mfma_f32_16x16x32_bf16 v[120:123], a[8:11], v[140:143], v[120:123]
    v_mfma_f32_16x16x32_bf16 v[124:127], a[12:15], v[140:143], v[124:127]
    s_add_u32 s51, s94, 32768
    buffer_load_dwordx4 v[128:131], v2, s[44:47], s51 offen sc0 sc1
    s_add_u32 s51, s94, 76800
    buffer_load_dwordx4 v[132:135], v2, s[44:47], s51 offen sc0 sc1
    s_add_u32 s51, s94, 120832
    buffer_load_dwordx4 v[136:139], v2, s[44:47], s51 offen sc0 sc1
    s_add_u32 s51, s94, 164864
    buffer_load_dwordx4 v[140:143], v2, s[44:47], s51 offen sc0 sc1
    s_waitcnt vmcnt(28)
    v_mfma_f32_16x16x32_bf16 v[64:67], a[16:19], v[144:147], v[64:67]
    v_mfma_f32_16x16x32_bf16 v[68:71], a[20:23], v[144:147], v[68:71]
    v_mfma_f32_16x16x32_bf16 v[72:75], a[24:27], v[144:147], v[72:75]
    v_mfma_f32_16x16x32_bf16 v[76:79], a[28:31], v[144:147], v[76:79]
    v_mfma_f32_16x16x32_bf16 v[80:83], a[16:19], v[148:151], v[80:83]
    v_mfma_f32_16x16x32_bf16 v[84:87], a[20:23], v[148:151], v[84:87]
    v_mfma_f32_16x16x32_bf16 v[88:91], a[24:27], v[148:151], v[88:91]
    v_mfma_f32_16x16x32_bf16 v[92:95], a[28:31], v[148:151], v[92:95]
    v_mfma_f32_16x16x32_bf16 v[96:99], a[16:19], v[152:155], v[96:99]
    v_mfma_f32_16x16x32_bf16 v[100:103], a[20:23], v[152:155], v[100:103]
    v_mfma_f32_16x16x32_bf16 v[104:107], a[24:27], v[152:155], v[104:107]
    v_mfma_f32_16x16x32_bf16 v[108:111], a[28:31], v[152:155], v[108:111]
    v_mfma_f32_16x16x32_bf16 v[112:115], a[16:19], v[156:159], v[112:115]
    v_mfma_f32_16x16x32_bf16 v[116:119], a[20:23], v[156:159], v[116:119]
    v_mfma_f32_16x16x32_bf16 v[120:123], a[24:27], v[156:159], v[120:123]
    v_mfma_f32_16x16x32_bf16 v[124:127], a[28:31], v[156:159], v[124:127]
    s_add_u32 s51, s94, 36864
    buffer_load_dwordx4 v[144:147], v2, s[44:47], s51 offen sc0 sc1
    s_add_u32 s51, s94, 80896
    buffer_load_dwordx4 v[148:151], v2, s[44:47], s51 offen sc0 sc1
    s_add_u32 s51, s94, 124928
    buffer_load_dwordx4 v[152:155], v2, s[44:47], s51 offen sc0 sc1
    s_add_u32 s51, s94, 168960
    buffer_load_dwordx4 v[156:159], v2, s[44:47], s51 offen sc0 sc1
    s_waitcnt vmcnt(28)
    v_mfma_f32_16x16x32_bf16 v[64:67], a[32:35], v[160:163], v[64:67]
    v_mfma_f32_16x16x32_bf16 v[68:71], a[36:39], v[160:163], v[68:71]
    v_mfma_f32_16x16x32_bf16 v[72:75], a[40:43], v[160:163], v[72:75]
    v_mfma_f32_16x16x32_bf16 v[76:79], a[44:47], v[160:163], v[76:79]
    v_mfma_f32_16x16x32_bf16 v[80:83], a[32:35], v[164:167], v[80:83]
    v_mfma_f32_16x16x32_bf16 v[84:87], a[36:39], v[164:167], v[84:87]
    v_mfma_f32_16x16x32_bf16 v[88:91], a[40:43], v[164:167], v[88:91]
    v_mfma_f32_16x16x32_bf16 v[92:95], a[44:47], v[164:167], v[92:95]
    v_mfma_f32_16x16x32_bf16 v[96:99], a[32:35], v[168:171], v[96:99]
    v_mfma_f32_16x16x32_bf16 v[100:103], a[36:39], v[168:171], v[100:103]
    v_mfma_f32_16x16x32_bf16 v[104:107], a[40:43], v[168:171], v[104:107]
    v_mfma_f32_16x16x32_bf16 v[108:111], a[44:47], v[168:171], v[108:111]
    v_mfma_f32_16x16x32_bf16 v[112:115], a[32:35], v[172:175], v[112:115]
    v_mfma_f32_16x16x32_bf16 v[116:119], a[36:39], v[172:175], v[116:119]
    v_mfma_f32_16x16x32_bf16 v[120:123], a[40:43], v[172:175], v[120:123]
    v_mfma_f32_16x16x32_bf16 v[124:127], a[44:47], v[172:175], v[124:127]
    s_add_u32 s51, s94, 40960
    buffer_load_dwordx4 v[160:163], v2, s[44:47], s51 offen sc0 sc1
    s_add_u32 s51, s94, 84992
    buffer_load_dwordx4 v[164:167], v2, s[44:47], s51 offen sc0 sc1
    s_add_u32 s51, s94, 129024
    buffer_load_dwordx4 v[168:171], v2, s[44:47], s51 offen sc0 sc1
    s_add_u32 s51, s94, 173056
    buffer_load_dwordx4 v[172:175], v2, s[44:47], s51 offen sc0 sc1
    s_waitcnt vmcnt(28)
    v_mfma_f32_16x16x32_bf16 v[64:67], a[48:51], v[176:179], v[64:67]
    v_mfma_f32_16x16x32_bf16 v[68:71], a[52:55], v[176:179], v[68:71]
    v_mfma_f32_16x16x32_bf16 v[72:75], a[56:59], v[176:179], v[72:75]
    v_mfma_f32_16x16x32_bf16 v[76:79], a[60:63], v[176:179], v[76:79]
    v_mfma_f32_16x16x32_bf16 v[80:83], a[48:51], v[180:183], v[80:83]
    v_mfma_f32_16x16x32_bf16 v[84:87], a[52:55], v[180:183], v[84:87]
    v_mfma_f32_16x16x32_bf16 v[88:91], a[56:59], v[180:183], v[88:91]
    v_mfma_f32_16x16x32_bf16 v[92:95], a[60:63], v[180:183], v[92:95]
    v_mfma_f32_16x16x32_bf16 v[96:99], a[48:51], v[184:187], v[96:99]
    v_mfma_f32_16x16x32_bf16 v[100:103], a[52:55], v[184:187], v[100:103]
    v_mfma_f32_16x16x32_bf16 v[104:107], a[56:59], v[184:187], v[104:107]
    v_mfma_f32_16x16x32_bf16 v[108:111], a[60:63], v[184:187], v[108:111]
    v_mfma_f32_16x16x32_bf16 v[112:115], a[48:51], v[188:191], v[112:115]
    v_mfma_f32_16x16x32_bf16 v[116:119], a[52:55], v[188:191], v[116:119]
    v_mfma_f32_16x16x32_bf16 v[120:123], a[56:59], v[188:191], v[120:123]
    v_mfma_f32_16x16x32_bf16 v[124:127], a[60:63], v[188:191], v[124:127]
    s_waitcnt vmcnt(24)
    v_mfma_f32_16x16x32_bf16 v[64:67], a[64:67], v[192:195], v[64:67]
    v_mfma_f32_16x16x32_bf16 v[68:71], a[68:71], v[192:195], v[68:71]
    v_mfma_f32_16x16x32_bf16 v[72:75], a[72:75], v[192:195], v[72:75]
    v_mfma_f32_16x16x32_bf16 v[76:79], a[76:79], v[192:195], v[76:79]
    v_mfma_f32_16x16x32_bf16 v[80:83], a[64:67], v[196:199], v[80:83]
    v_mfma_f32_16x16x32_bf16 v[84:87], a[68:71], v[196:199], v[84:87]
    v_mfma_f32_16x16x32_bf16 v[88:91], a[72:75], v[196:199], v[88:91]
    v_mfma_f32_16x16x32_bf16 v[92:95], a[76:79], v[196:199], v[92:95]
    v_mfma_f32_16x16x32_bf16 v[96:99], a[64:67], v[200:203], v[96:99]
    v_mfma_f32_16x16x32_bf16 v[100:103], a[68:71], v[200:203], v[100:103]
    v_mfma_f32_16x16x32_bf16 v[104:107], a[72:75], v[200:203], v[104:107]
    v_mfma_f32_16x16x32_bf16 v[108:111], a[76:79], v[200:203], v[108:111]
    v_mfma_f32_16x16x32_bf16 v[112:115], a[64:67], v[204:207], v[112:115]
    v_mfma_f32_16x16x32_bf16 v[116:119], a[68:71], v[204:207], v[116:119]
    v_mfma_f32_16x16x32_bf16 v[120:123], a[72:75], v[204:207], v[120:123]
    v_mfma_f32_16x16x32_bf16 v[124:127], a[76:79], v[204:207], v[124:127]
    s_waitcnt vmcnt(20)
    v_mfma_f32_16x16x32_bf16 v[64:67], a[80:83], v[208:211], v[64:67]
    v_mfma_f32_16x16x32_bf16 v[68:71], a[84:87], v[208:211], v[68:71]
    v_mfma_f32_16x16x32_bf16 v[72:75], a[88:91], v[208:211], v[72:75]
    v_mfma_f32_16x16x32_bf16 v[76:79], a[92:95], v[208:211], v[76:79]
    v_mfma_f32_16x16x32_bf16 v[80:83], a[80:83], v[212:215], v[80:83]
    v_mfma_f32_16x16x32_bf16 v[84:87], a[84:87], v[212:215], v[84:87]
    v_mfma_f32_16x16x32_bf16 v[88:91], a[88:91], v[212:215], v[88:91]
    v_mfma_f32_16x16x32_bf16 v[92:95], a[92:95], v[212:215], v[92:95]
    v_mfma_f32_16x16x32_bf16 v[96:99], a[80:83], v[216:219], v[96:99]
    v_mfma_f32_16x16x32_bf16 v[100:103], a[84:87], v[216:219], v[100:103]
    v_mfma_f32_16x16x32_bf16 v[104:107], a[88:91], v[216:219], v[104:107]
    v_mfma_f32_16x16x32_bf16 v[108:111], a[92:95], v[216:219], v[108:111]
    v_mfma_f32_16x16x32_bf16 v[112:115], a[80:83], v[220:223], v[112:115]
    v_mfma_f32_16x16x32_bf16 v[116:119], a[84:87], v[220:223], v[116:119]
    v_mfma_f32_16x16x32_bf16 v[120:123], a[88:91], v[220:223], v[120:123]
    v_mfma_f32_16x16x32_bf16 v[124:127], a[92:95], v[220:223], v[124:127]
    s_waitcnt vmcnt(16)
    v_mfma_f32_16x16x32_bf16 v[64:67], a[96:99], v[224:227], v[64:67]
    v_mfma_f32_16x16x32_bf16 v[68:71], a[100:103], v[224:227], v[68:71]
    v_mfma_f32_16x16x32_bf16 v[72:75], a[104:107], v[224:227], v[72:75]
    v_mfma_f32_16x16x32_bf16 v[76:79], a[108:111], v[224:227], v[76:79]
    v_mfma_f32_16x16x32_bf16 v[80:83], a[96:99], v[228:231], v[80:83]
    v_mfma_f32_16x16x32_bf16 v[84:87], a[100:103], v[228:231], v[84:87]
    v_mfma_f32_16x16x32_bf16 v[88:91], a[104:107], v[228:231], v[88:91]
    v_mfma_f32_16x16x32_bf16 v[92:95], a[108:111], v[228:231], v[92:95]
    v_mfma_f32_16x16x32_bf16 v[96:99], a[96:99], v[232:235], v[96:99]
    v_mfma_f32_16x16x32_bf16 v[100:103], a[100:103], v[232:235], v[100:103]
    v_mfma_f32_16x16x32_bf16 v[104:107], a[104:107], v[232:235], v[104:107]
    v_mfma_f32_16x16x32_bf16 v[108:111], a[108:111], v[232:235], v[108:111]
    v_mfma_f32_16x16x32_bf16 v[112:115], a[96:99], v[236:239], v[112:115]
    v_mfma_f32_16x16x32_bf16 v[116:119], a[100:103], v[236:239], v[116:119]
    v_mfma_f32_16x16x32_bf16 v[120:123], a[104:107], v[236:239], v[120:123]
    v_mfma_f32_16x16x32_bf16 v[124:127], a[108:111], v[236:239], v[124:127]
    s_waitcnt vmcnt(12)
    v_mfma_f32_16x16x32_bf16 v[64:67], a[112:115], v[240:243], v[64:67]
    v_mfma_f32_16x16x32_bf16 v[68:71], a[116:119], v[240:243], v[68:71]
    v_mfma_f32_16x16x32_bf16 v[72:75], a[120:123], v[240:243], v[72:75]
    v_mfma_f32_16x16x32_bf16 v[76:79], a[124:127], v[240:243], v[76:79]
    v_mfma_f32_16x16x32_bf16 v[80:83], a[112:115], v[244:247], v[80:83]
    v_mfma_f32_16x16x32_bf16 v[84:87], a[116:119], v[244:247], v[84:87]
    v_mfma_f32_16x16x32_bf16 v[88:91], a[120:123], v[244:247], v[88:91]
    v_mfma_f32_16x16x32_bf16 v[92:95], a[124:127], v[244:247], v[92:95]
    v_mfma_f32_16x16x32_bf16 v[96:99], a[112:115], v[248:251], v[96:99]
    v_mfma_f32_16x16x32_bf16 v[100:103], a[116:119], v[248:251], v[100:103]
    v_mfma_f32_16x16x32_bf16 v[104:107], a[120:123], v[248:251], v[104:107]
    v_mfma_f32_16x16x32_bf16 v[108:111], a[124:127], v[248:251], v[108:111]
    v_mfma_f32_16x16x32_bf16 v[112:115], a[112:115], v[252:255], v[112:115]
    v_mfma_f32_16x16x32_bf16 v[116:119], a[116:119], v[252:255], v[116:119]
    v_mfma_f32_16x16x32_bf16 v[120:123], a[120:123], v[252:255], v[120:123]
    v_mfma_f32_16x16x32_bf16 v[124:127], a[124:127], v[252:255], v[124:127]
    s_waitcnt vmcnt(8)
    v_mfma_f32_16x16x32_bf16 v[64:67], a[128:131], v[128:131], v[64:67]
    v_mfma_f32_16x16x32_bf16 v[68:71], a[132:135], v[128:131], v[68:71]
    v_mfma_f32_16x16x32_bf16 v[72:75], a[136:139], v[128:131], v[72:75]
    v_mfma_f32_16x16x32_bf16 v[76:79], a[140:143], v[128:131], v[76:79]
    v_mfma_f32_16x16x32_bf16 v[80:83], a[128:131], v[132:135], v[80:83]
    v_mfma_f32_16x16x32_bf16 v[84:87], a[132:135], v[132:135], v[84:87]
    v_mfma_f32_16x16x32_bf16 v[88:91], a[136:139], v[132:135], v[88:91]
    v_mfma_f32_16x16x32_bf16 v[92:95], a[140:143], v[132:135], v[92:95]
    v_mfma_f32_16x16x32_bf16 v[96:99], a[128:131], v[136:139], v[96:99]
    v_mfma_f32_16x16x32_bf16 v[100:103], a[132:135], v[136:139], v[100:103]
    v_mfma_f32_16x16x32_bf16 v[104:107], a[136:139], v[136:139], v[104:107]
    v_mfma_f32_16x16x32_bf16 v[108:111], a[140:143], v[136:139], v[108:111]
    v_mfma_f32_16x16x32_bf16 v[112:115], a[128:131], v[140:143], v[112:115]
    v_mfma_f32_16x16x32_bf16 v[116:119], a[132:135], v[140:143], v[116:119]
    v_mfma_f32_16x16x32_bf16 v[120:123], a[136:139], v[140:143], v[120:123]
    v_mfma_f32_16x16x32_bf16 v[124:127], a[140:143], v[140:143], v[124:127]
    s_waitcnt vmcnt(4)
    v_mfma_f32_16x16x32_bf16 v[64:67], a[144:147], v[144:147], v[64:67]
    v_mfma_f32_16x16x32_bf16 v[68:71], a[148:151], v[144:147], v[68:71]
    v_mfma_f32_16x16x32_bf16 v[72:75], a[152:155], v[144:147], v[72:75]
    v_mfma_f32_16x16x32_bf16 v[76:79], a[156:159], v[144:147], v[76:79]
    v_mfma_f32_16x16x32_bf16 v[80:83], a[144:147], v[148:151], v[80:83]
    v_mfma_f32_16x16x32_bf16 v[84:87], a[148:151], v[148:151], v[84:87]
    v_mfma_f32_16x16x32_bf16 v[88:91], a[152:155], v[148:151], v[88:91]
    v_mfma_f32_16x16x32_bf16 v[92:95], a[156:159], v[148:151], v[92:95]
    v_mfma_f32_16x16x32_bf16 v[96:99], a[144:147], v[152:155], v[96:99]
    v_mfma_f32_16x16x32_bf16 v[100:103], a[148:151], v[152:155], v[100:103]
    v_mfma_f32_16x16x32_bf16 v[104:107], a[152:155], v[152:155], v[104:107]
    v_mfma_f32_16x16x32_bf16 v[108:111], a[156:159], v[152:155], v[108:111]
    v_mfma_f32_16x16x32_bf16 v[112:115], a[144:147], v[156:159], v[112:115]
    v_mfma_f32_16x16x32_bf16 v[116:119], a[148:151], v[156:159], v[116:119]
    v_mfma_f32_16x16x32_bf16 v[120:123], a[152:155], v[156:159], v[120:123]
    v_mfma_f32_16x16x32_bf16 v[124:127], a[156:159], v[156:159], v[124:127]
    s_waitcnt vmcnt(0)
    v_mfma_f32_16x16x32_bf16 v[64:67], a[160:163], v[160:163], v[64:67]
    v_mfma_f32_16x16x32_bf16 v[68:71], a[164:167], v[160:163], v[68:71]
    v_mfma_f32_16x16x32_bf16 v[72:75], a[168:171], v[160:163], v[72:75]
    v_mfma_f32_16x16x32_bf16 v[76:79], a[172:175], v[160:163], v[76:79]
    v_mfma_f32_16x16x32_bf16 v[80:83], a[160:163], v[164:167], v[80:83]
    v_mfma_f32_16x16x32_bf16 v[84:87], a[164:167], v[164:167], v[84:87]
    v_mfma_f32_16x16x32_bf16 v[88:91], a[168:171], v[164:167], v[88:91]
    v_mfma_f32_16x16x32_bf16 v[92:95], a[172:175], v[164:167], v[92:95]
    v_mfma_f32_16x16x32_bf16 v[96:99], a[160:163], v[168:171], v[96:99]
    v_mfma_f32_16x16x32_bf16 v[100:103], a[164:167], v[168:171], v[100:103]
    v_mfma_f32_16x16x32_bf16 v[104:107], a[168:171], v[168:171], v[104:107]
    v_mfma_f32_16x16x32_bf16 v[108:111], a[172:175], v[168:171], v[108:111]
    v_mfma_f32_16x16x32_bf16 v[112:115], a[160:163], v[172:175], v[112:115]
    v_mfma_f32_16x16x32_bf16 v[116:119], a[164:167], v[172:175], v[116:119]
    v_mfma_f32_16x16x32_bf16 v[120:123], a[168:171], v[172:175], v[120:123]
    v_mfma_f32_16x16x32_bf16 v[124:127], a[172:175], v[172:175], v[124:127]
    v_lshl_add_u32 v7, v5, 14, v2
    ds_write_b128 v7, v[64:67] offset:0
    ds_write_b128 v7, v[68:71] offset:1024
    ds_write_b128 v7, v[72:75] offset:2048
    ds_write_b128 v7, v[76:79] offset:3072
    ds_write_b128 v7, v[80:83] offset:4096
    ds_write_b128 v7, v[84:87] offset:5120
    ds_write_b128 v7, v[88:91] offset:6144
    ds_write_b128 v7, v[92:95] offset:7168
    ds_write_b128 v7, v[96:99] offset:8192
    ds_write_b128 v7, v[100:103] offset:9216
    ds_write_b128 v7, v[104:107] offset:10240
    ds_write_b128 v7, v[108:111] offset:11264
    ds_write_b128 v7, v[112:115] offset:12288
    ds_write_b128 v7, v[116:119] offset:13312
    ds_write_b128 v7, v[120:123] offset:14336
    ds_write_b128 v7, v[124:127] offset:15360
    s_waitcnt lgkmcnt(0)
    s_barrier
    v_lshl_add_u32 v7, v5, 12, v2
    ds_read_b128 v[64:67], v7 offset:0
    ds_read_b128 v[68:71], v7 offset:16384
    ds_read_b128 v[72:75], v7 offset:32768
    ds_read_b128 v[76:79], v7 offset:49152
    ds_read_b128 v[80:83], v7 offset:1024
    ds_read_b128 v[84:87], v7 offset:17408
    ds_read_b128 v[88:91], v7 offset:33792
    ds_read_b128 v[92:95], v7 offset:50176
    ds_read_b128 v[96:99], v7 offset:2048
    ds_read_b128 v[100:103], v7 offset:18432
    ds_read_b128 v[104:107], v7 offset:34816
    ds_read_b128 v[108:111], v7 offset:51200
    ds_read_b128 v[112:115], v7 offset:3072
    ds_read_b128 v[116:119], v7 offset:19456
    ds_read_b128 v[120:123], v7 offset:35840
    ds_read_b128 v[124:127], v7 offset:52224
    s_waitcnt lgkmcnt(0)
    v_add_f32 v64, v64, v68
    v_add_f32 v72, v72, v76
    v_add_f32 v64, v64, v72
    v_cvt_pk_bf16_f32 v64, v64, v64
    v_lshlrev_b32 v64, 16, v64
    v_lshlrev_b32 v24, 16, v16
    v_add_f32 v64, v64, v24
    v_cvt_pk_bf16_f32 v64, v64, v64
    v_lshlrev_b32 v64, 16, v64
    v_add_f32 v65, v65, v69
    v_add_f32 v73, v73, v77
    v_add_f32 v65, v65, v73
    v_cvt_pk_bf16_f32 v65, v65, v65
    v_lshlrev_b32 v65, 16, v65
    v_and_b32 v24, 0xffff0000, v16
    v_add_f32 v65, v65, v24
    v_cvt_pk_bf16_f32 v65, v65, v65
    v_lshlrev_b32 v65, 16, v65
    v_add_f32 v66, v66, v70
    v_add_f32 v74, v74, v78
    v_add_f32 v66, v66, v74
    v_cvt_pk_bf16_f32 v66, v66, v66
    v_lshlrev_b32 v66, 16, v66
    v_lshlrev_b32 v24, 16, v17
    v_add_f32 v66, v66, v24
    v_cvt_pk_bf16_f32 v66, v66, v66
    v_lshlrev_b32 v66, 16, v66
    v_add_f32 v67, v67, v71
    v_add_f32 v75, v75, v79
    v_add_f32 v67, v67, v75
    v_cvt_pk_bf16_f32 v67, v67, v67
    v_lshlrev_b32 v67, 16, v67
    v_and_b32 v24, 0xffff0000, v17
    v_add_f32 v67, v67, v24
    v_cvt_pk_bf16_f32 v67, v67, v67
    v_lshlrev_b32 v67, 16, v67
    v_add_f32 v80, v80, v84
    v_add_f32 v88, v88, v92
    v_add_f32 v80, v80, v88
    v_cvt_pk_bf16_f32 v80, v80, v80
    v_lshlrev_b32 v80, 16, v80
    v_lshlrev_b32 v24, 16, v18
    v_add_f32 v80, v80, v24
    v_cvt_pk_bf16_f32 v80, v80, v80
    v_lshlrev_b32 v80, 16, v80
    v_add_f32 v81, v81, v85
    v_add_f32 v89, v89, v93
    v_add_f32 v81, v81, v89
    v_cvt_pk_bf16_f32 v81, v81, v81
    v_lshlrev_b32 v81, 16, v81
    v_and_b32 v24, 0xffff0000, v18
    v_add_f32 v81, v81, v24
    v_cvt_pk_bf16_f32 v81, v81, v81
    v_lshlrev_b32 v81, 16, v81
    v_add_f32 v82, v82, v86
    v_add_f32 v90, v90, v94
    v_add_f32 v82, v82, v90
    v_cvt_pk_bf16_f32 v82, v82, v82
    v_lshlrev_b32 v82, 16, v82
    v_lshlrev_b32 v24, 16, v19
    v_add_f32 v82, v82, v24
    v_cvt_pk_bf16_f32 v82, v82, v82
    v_lshlrev_b32 v82, 16, v82
    v_add_f32 v83, v83, v87
    v_add_f32 v91, v91, v95
    v_add_f32 v83, v83, v91
    v_cvt_pk_bf16_f32 v83, v83, v83
    v_lshlrev_b32 v83, 16, v83
    v_and_b32 v24, 0xffff0000, v19
    v_add_f32 v83, v83, v24
    v_cvt_pk_bf16_f32 v83, v83, v83
    v_lshlrev_b32 v83, 16, v83
    v_add_f32 v96, v96, v100
    v_add_f32 v104, v104, v108
    v_add_f32 v96, v96, v104
    v_cvt_pk_bf16_f32 v96, v96, v96
    v_lshlrev_b32 v96, 16, v96
    v_lshlrev_b32 v24, 16, v20
    v_add_f32 v96, v96, v24
    v_cvt_pk_bf16_f32 v96, v96, v96
    v_lshlrev_b32 v96, 16, v96
    v_add_f32 v97, v97, v101
    v_add_f32 v105, v105, v109
    v_add_f32 v97, v97, v105
    v_cvt_pk_bf16_f32 v97, v97, v97
    v_lshlrev_b32 v97, 16, v97
    v_and_b32 v24, 0xffff0000, v20
    v_add_f32 v97, v97, v24
    v_cvt_pk_bf16_f32 v97, v97, v97
    v_lshlrev_b32 v97, 16, v97
    v_add_f32 v98, v98, v102
    v_add_f32 v106, v106, v110
    v_add_f32 v98, v98, v106
    v_cvt_pk_bf16_f32 v98, v98, v98
    v_lshlrev_b32 v98, 16, v98
    v_lshlrev_b32 v24, 16, v21
    v_add_f32 v98, v98, v24
    v_cvt_pk_bf16_f32 v98, v98, v98
    v_lshlrev_b32 v98, 16, v98
    v_add_f32 v99, v99, v103
    v_add_f32 v107, v107, v111
    v_add_f32 v99, v99, v107
    v_cvt_pk_bf16_f32 v99, v99, v99
    v_lshlrev_b32 v99, 16, v99
    v_and_b32 v24, 0xffff0000, v21
    v_add_f32 v99, v99, v24
    v_cvt_pk_bf16_f32 v99, v99, v99
    v_lshlrev_b32 v99, 16, v99
    v_add_f32 v112, v112, v116
    v_add_f32 v120, v120, v124
    v_add_f32 v112, v112, v120
    v_cvt_pk_bf16_f32 v112, v112, v112
    v_lshlrev_b32 v112, 16, v112
    v_lshlrev_b32 v24, 16, v22
    v_add_f32 v112, v112, v24
    v_cvt_pk_bf16_f32 v112, v112, v112
    v_lshlrev_b32 v112, 16, v112
    v_add_f32 v113, v113, v117
    v_add_f32 v121, v121, v125
    v_add_f32 v113, v113, v121
    v_cvt_pk_bf16_f32 v113, v113, v113
    v_lshlrev_b32 v113, 16, v113
    v_and_b32 v24, 0xffff0000, v22
    v_add_f32 v113, v113, v24
    v_cvt_pk_bf16_f32 v113, v113, v113
    v_lshlrev_b32 v113, 16, v113
    v_add_f32 v114, v114, v118
    v_add_f32 v122, v122, v126
    v_add_f32 v114, v114, v122
    v_cvt_pk_bf16_f32 v114, v114, v114
    v_lshlrev_b32 v114, 16, v114
    v_lshlrev_b32 v24, 16, v23
    v_add_f32 v114, v114, v24
    v_cvt_pk_bf16_f32 v114, v114, v114
    v_lshlrev_b32 v114, 16, v114
    v_add_f32 v115, v115, v119
    v_add_f32 v123, v123, v127
    v_add_f32 v115, v115, v123
    v_cvt_pk_bf16_f32 v115, v115, v115
    v_lshlrev_b32 v115, 16, v115
    v_and_b32 v24, 0xffff0000, v23
    v_add_f32 v115, v115, v24
    v_cvt_pk_bf16_f32 v115, v115, v115
    v_lshlrev_b32 v115, 16, v115
    s_mov_b32 s43, 0x07060302
    v_perm_b32 v32, v65, v64, s43
    v_perm_b32 v33, v67, v66, s43
    v_perm_b32 v34, v81, v80, s43
    v_perm_b32 v35, v83, v82, s43
    v_perm_b32 v36, v97, v96, s43
    v_perm_b32 v37, v99, v98, s43
    v_perm_b32 v38, v113, v112, s43
    v_perm_b32 v39, v115, v114, s43
    buffer_store_dwordx4 v[32:35], v6, s[60:63], s48 offen
    buffer_store_dwordx4 v[36:39], v6, s[60:63], s48 offen offset:16
ffn2_kernel_done:
    s_endpgm
.section .rodata,"a"
.p2align 6
.amdhsa_kernel ffn2_kernel
  .amdhsa_next_free_vgpr 512
  .amdhsa_next_free_sgpr 102
  .amdhsa_accum_offset 256
  .amdhsa_group_segment_fixed_size 0
  .amdhsa_kernarg_size 112
  .amdhsa_user_sgpr_count 2
  .amdhsa_user_sgpr_kernarg_segment_ptr 1
  .amdhsa_system_sgpr_workgroup_id_x 1
.end_amdhsa_kernel
```
